```python
import torch

def _softmax(x, axis=-1):
    return torch.softmax(x, dim=axis)
def _gelu(x):
    return torch.nn.functional.gelu(x, approximate="tanh")
def _silu(x):
    return torch.nn.functional.silu(x)
def _sigmoid(x):
    return torch.sigmoid(x)
def _layernorm(x, axis=-1, eps=1e-5):
    m = x.mean(dim=axis, keepdim=True)
    v = x.var(dim=axis, keepdim=True, unbiased=False)
    return (x - m) / torch.sqrt(v + eps)
def _scatter_add(tgt, idx, src, axis=0):
    return tgt.clone().index_add_(axis, idx, src)
def _segment_sum(src, seg, n):
    out = torch.zeros((n,) + src.shape[1:], dtype=src.dtype)
    return out.index_add_(0, seg, src)
def _pad(x, pw):
    flat = tuple(v for pair in reversed(pw) for v in pair)
    return torch.nn.functional.pad(x, flat)

kernel_name = 'recurrent_scan__gqa_block_cached__mixer_s_mlp__prompt'

def setup_inputs():

    _w = (lambda a: (lambda t: t.to(torch.bfloat16) if t.is_floating_point() else t)(torch.as_tensor(a)))
    def _A_setup():
        B, Sq, D = 1, 2048, 576
        Hq, Hkv, Sk, Dh = 32, 16, 2048, 128
        assert Hq % Hkv == 0, (Hq, Hkv)
        return {
            "x": _w((lambda *s: torch.randn(*s, dtype=torch.bfloat16) * 0.05)(B, Sq, D)),
            "k_cache": _w((lambda *s: torch.randn(*s, dtype=torch.bfloat16) * 0.8)(B, Hkv, Sk, Dh)),
            "v_cache": _w((lambda *s: torch.randn(*s, dtype=torch.bfloat16) * 0.8)(B, Hkv, Sk, Dh)),
            "wq": _w((lambda *s: torch.randn(*s, dtype=torch.bfloat16) * 0.8)(D, Hq * Dh) * (D ** -0.5)),
            "wo": _w((lambda *s: torch.randn(*s, dtype=torch.bfloat16) * 0.8)(Hq * Dh, D) * ((Hq * Dh) ** -0.5)),
        }
    _A_in = _A_setup()

    def _B_setup():
        B, S, D, F = 1, 2048, 576, 4608
        return {
            "x":  _w((lambda *s: torch.randn(*s, dtype=torch.bfloat16) * 0.05)(B, S, D)),
            "w1": _w((lambda *s: torch.randn(*s, dtype=torch.bfloat16) * 3.2)(D, D) * (D ** -0.5)),
            "w2": _w((lambda *s: torch.randn(*s, dtype=torch.bfloat16) * 3.2)(D, D) * (D ** -0.5)),
            "w3": _w((lambda *s: torch.randn(*s, dtype=torch.bfloat16) * 3.2)(D, F) * (D ** -0.5)),
            "w4": _w((lambda *s: torch.randn(*s, dtype=torch.bfloat16) * 1.6)(F, D) * (F ** -0.5)),
        }
    _B_in = _B_setup()

    return {
        "A_x": _A_in["x"],
        "A_k_cache": _A_in["k_cache"],
        "A_v_cache": _A_in["v_cache"],
        "A_wq": _A_in["wq"],
        "A_wo": _A_in["wo"],
        "B_x": _B_in["x"],
        "B_w1": _B_in["w1"],
        "B_w2": _B_in["w2"],
        "B_w3": _B_in["w3"],
        "B_w4": _B_in["w4"],
    }

def reference(A_x, A_k_cache, A_v_cache, A_wq, A_wo, B_x, B_w1, B_w2, B_w3, B_w4):
    def _A_ref(x, k_cache, v_cache, wq, wo):
        B, Sq, D = x.shape
        Hq, Dh = 32, 128
        Hkv = k_cache.shape[1]
        rep = Hq // Hkv
        q = (lambda x, *d: x.permute(*d))((x @ wq).reshape(B, Sq, Hq, Dh), 0, 2, 1, 3)
        k = (lambda x, n, axis: torch.repeat_interleave(x, n, dim=axis))(k_cache, rep, axis=1)
        v = (lambda x, n, axis: torch.repeat_interleave(x, n, dim=axis))(v_cache, rep, axis=1)
        scores = torch.einsum("bhqd,bhkd->bhqk", q, k) * (Dh ** -0.5)
        p = _softmax(scores, axis=-1)
        o = torch.einsum("bhqk,bhkd->bhqd", p, v)
        return (lambda x, *d: x.permute(*d))(o, 0, 2, 1, 3).reshape(B, Sq, Hq * Dh) @ wo

    def _B_ref(x, w1, w2, w3, w4):
        B, S, D = x.shape
        h = _gelu(_layernorm(x, axis=-1) @ w1)
        c = D // 4
        g0 = _pad(h[:, :, 0*c:1*c], ((0, 0), (1, 0), (0, 0)))[:, :S, :]
        g1 = _pad(h[:, :, 1*c:2*c], ((0, 0), (0, 1), (0, 0)))[:, 1:, :]
        g2 = _pad(h[:, :, 2*c:3*c], ((0, 0), (2, 0), (0, 0)))[:, :S, :]
        g3 = _pad(h[:, :, 3*c:   ], ((0, 0), (0, 2), (0, 0)))[:, 2:, :]
        hs = torch.concatenate([g0, g1, g2, g3], axis=-1) @ w2
        x1 = x + hs
        h2 = _gelu(_layernorm(x1, axis=-1) @ w3) @ w4
        return x1 + h2

    x = A_x
    xn = _layernorm(x, axis=-1)
    s = _A_ref(xn, A_k_cache, A_v_cache, A_wq, A_wo)
    g = _silu(_B_ref(xn, B_w1, B_w2, B_w3, B_w4))
    return x + s * g
```

```asm
; @launch kernel=kln_kernel grid=(210,1,1) block=(576,1,1) lds=73728
; @launch kernel=kmain_kernel grid=(256,1,1) block=(256,1,1) lds=147520
.amdgcn_target "amdgcn-amd-amdhsa--gfx950"
.text
.globl kln_kernel
.p2align 8
.type kln_kernel,@function
kln_kernel:
    s_cmp_ge_u32 s2, 210
    s_cbranch_scc1 kln_kernel_end
    v_and_b32 v1, 63, v0
    v_lshrrev_b32 v2, 6, v0
    s_nop 0
    v_readfirstlane_b32 s3, v2
    s_cmp_ge_u32 s2, 128
    s_cbranch_scc1 kln_kernel_pack
    s_load_dwordx2 s[4:5], s[0:1], 0
    s_load_dwordx2 s[6:7], s[0:1], 96
    v_and_b32 v3, 15, v0
    v_lshrrev_b32 v4, 4, v0
    s_lshl_b32 s16, s2, 4
    v_add_u32 v5, s16, v3
    s_movk_i32 s17, 1152
    v_mul_lo_u32 v6, v5, s17
    v_lshl_add_u32 v6, v4, 5, v6
    s_waitcnt lgkmcnt(0)
    s_mov_b32 s8, s4
    s_mov_b32 s9, s5
    s_mov_b32 s10, 2359296
    s_mov_b32 s11, 0x20000
    s_mov_b32 s12, s6
    s_mov_b32 s13, s7
    s_mov_b32 s14, 104833024
    s_mov_b32 s15, 0x20000
    buffer_load_dwordx4 v[8:11], v6, s[8:11], 0 offen
    buffer_load_dwordx4 v[12:15], v6, s[8:11], 0 offen offset:16
    s_cmp_lg_u32 s2, 0
    s_cbranch_scc1 kln_kernel_nz
    v_mov_b32 v16, 0
    v_mov_b32 v17, 0
    v_mov_b32 v18, 0
    v_mov_b32 v19, 0
    v_lshlrev_b32 v20, 4, v0
    s_mov_b32 s18, 104816640
    v_cmp_gt_u32 vcc, 512, v0
    s_nop 3
    s_and_saveexec_b64 s[20:21], vcc
    s_cbranch_execz kln_kernel_nz_r
    buffer_store_dwordx4 v[16:19], v20, s[12:15], s18 offen
    v_add_u32 v20, 8192, v20
    buffer_store_dwordx4 v[16:19], v20, s[12:15], s18 offen
kln_kernel_nz_r:
    s_mov_b64 exec, s[20:21]
kln_kernel_nz:
    s_mul_i32 s19, s2, 18
    v_lshrrev_b32 v7, 1, v4
    v_add_u32 v7, s19, v7
    v_lshlrev_b32 v7, 10, v7
    v_and_b32 v20, 1, v4
    v_lshlrev_b32 v20, 9, v20
    v_add_u32 v7, v7, v20
    v_lshl_add_u32 v7, v3, 4, v7
    v_mul_u32_u24 v21, 80, v3
    s_lshl_b32 s18, s3, 3
    v_add_u32 v22, s18, v21
    s_waitcnt vmcnt(0)
    v_lshlrev_b32 v24, 16, v8
    v_and_b32 v25, 0xffff0000, v8
    v_lshlrev_b32 v26, 16, v9
    v_and_b32 v27, 0xffff0000, v9
    v_lshlrev_b32 v28, 16, v10
    v_and_b32 v29, 0xffff0000, v10
    v_lshlrev_b32 v30, 16, v11
    v_and_b32 v31, 0xffff0000, v11
    v_lshlrev_b32 v32, 16, v12
    v_and_b32 v33, 0xffff0000, v12
    v_lshlrev_b32 v34, 16, v13
    v_and_b32 v35, 0xffff0000, v13
    v_lshlrev_b32 v36, 16, v14
    v_and_b32 v37, 0xffff0000, v14
    v_lshlrev_b32 v38, 16, v15
    v_and_b32 v39, 0xffff0000, v15
    v_add_f32 v40, v24, v25
    v_add_f32 v41, v26, v27
    v_add_f32 v42, v28, v29
    v_add_f32 v43, v30, v31
    v_add_f32 v44, v32, v33
    v_add_f32 v45, v34, v35
    v_add_f32 v46, v36, v37
    v_add_f32 v47, v38, v39
    v_add_f32 v40, v40, v41
    v_add_f32 v41, v42, v43
    v_add_f32 v42, v44, v45
    v_add_f32 v43, v46, v47
    v_add_f32 v40, v40, v41
    v_add_f32 v41, v42, v43
    v_add_f32 v40, v40, v41
    v_mov_b32 v50, v40
    v_mov_b32 v48, v50
    s_nop 1
    v_permlane16_swap_b32 v50, v48
    v_add_f32 v50, v50, v48
    v_mov_b32 v48, v50
    s_nop 1
    v_permlane32_swap_b32 v50, v48
    v_add_f32 v50, v50, v48
    ds_write_b32 v22, v50 offset:0
    s_waitcnt lgkmcnt(0)
    s_barrier
    ds_read_b128 v[52:55], v21 offset:0
    ds_read_b128 v[56:59], v21 offset:16
    ds_read_b128 v[60:63], v21 offset:32
    ds_read_b128 v[64:67], v21 offset:48
    ds_read_b64 v[68:69], v21 offset:64
    s_waitcnt lgkmcnt(0)
    v_add_f32 v50, v52, v54
    v_add_f32 v50, v50, v56
    v_add_f32 v50, v50, v58
    v_add_f32 v50, v50, v60
    v_add_f32 v50, v50, v62
    v_add_f32 v50, v50, v64
    v_add_f32 v50, v50, v66
    v_add_f32 v50, v50, v68
    v_mul_f32 v50, 0x3ae38e39, v50
    v_sub_f32 v24, v24, v50
    v_sub_f32 v25, v25, v50
    v_sub_f32 v26, v26, v50
    v_sub_f32 v27, v27, v50
    v_sub_f32 v28, v28, v50
    v_sub_f32 v29, v29, v50
    v_sub_f32 v30, v30, v50
    v_sub_f32 v31, v31, v50
    v_sub_f32 v32, v32, v50
    v_sub_f32 v33, v33, v50
    v_sub_f32 v34, v34, v50
    v_sub_f32 v35, v35, v50
    v_sub_f32 v36, v36, v50
    v_sub_f32 v37, v37, v50
    v_sub_f32 v38, v38, v50
    v_sub_f32 v39, v39, v50
    v_mul_f32 v70, v24, v24
    v_mul_f32 v71, v25, v25
    v_mul_f32 v72, v26, v26
    v_mul_f32 v73, v27, v27
    v_mul_f32 v74, v28, v28
    v_mul_f32 v75, v29, v29
    v_mul_f32 v76, v30, v30
    v_mul_f32 v77, v31, v31
    v_mul_f32 v78, v32, v32
    v_mul_f32 v79, v33, v33
    v_mul_f32 v80, v34, v34
    v_mul_f32 v81, v35, v35
    v_mul_f32 v82, v36, v36
    v_mul_f32 v83, v37, v37
    v_mul_f32 v84, v38, v38
    v_mul_f32 v85, v39, v39
    v_add_f32 v40, v70, v71
    v_add_f32 v41, v72, v73
    v_add_f32 v42, v74, v75
    v_add_f32 v43, v76, v77
    v_add_f32 v44, v78, v79
    v_add_f32 v45, v80, v81
    v_add_f32 v46, v82, v83
    v_add_f32 v47, v84, v85
    v_add_f32 v40, v40, v41
    v_add_f32 v41, v42, v43
    v_add_f32 v42, v44, v45
    v_add_f32 v43, v46, v47
    v_add_f32 v40, v40, v41
    v_add_f32 v41, v42, v43
    v_add_f32 v40, v40, v41
    v_mov_b32 v50, v40
    v_mov_b32 v48, v50
    s_nop 1
    v_permlane16_swap_b32 v50, v48
    v_add_f32 v50, v50, v48
    v_mov_b32 v48, v50
    s_nop 1
    v_permlane32_swap_b32 v50, v48
    v_add_f32 v50, v50, v48
    ds_write_b32 v22, v50 offset:1280
    s_waitcnt lgkmcnt(0)
    s_barrier
    ds_read_b128 v[52:55], v21 offset:1280
    ds_read_b128 v[56:59], v21 offset:1296
    ds_read_b128 v[60:63], v21 offset:1312
    ds_read_b128 v[64:67], v21 offset:1328
    ds_read_b64 v[68:69], v21 offset:1344
    s_waitcnt lgkmcnt(0)
    v_add_f32 v50, v52, v54
    v_add_f32 v50, v50, v56
    v_add_f32 v50, v50, v58
    v_add_f32 v50, v50, v60
    v_add_f32 v50, v50, v62
    v_add_f32 v50, v50, v64
    v_add_f32 v50, v50, v66
    v_add_f32 v50, v50, v68
    v_mov_b32 v51, 0x3727c5ac
    v_fmac_f32 v51, 0x3ae38e39, v50
    v_mul_f32 v49, 0x3ae38e39, v50
    v_rcp_f32 v47, v51
    v_rsq_f32 v51, v51
    s_nop 0
    v_mul_f32 v49, v49, v47
    v_add_f32 v49, 0x3727c5ac, v49
    v_rsq_f32 v49, v49
    v_mul_f32 v24, v24, v51
    v_mul_f32 v25, v25, v51
    v_mul_f32 v26, v26, v51
    v_mul_f32 v27, v27, v51
    v_mul_f32 v28, v28, v51
    v_mul_f32 v29, v29, v51
    v_mul_f32 v30, v30, v51
    v_mul_f32 v31, v31, v51
    v_mul_f32 v32, v32, v51
    v_mul_f32 v33, v33, v51
    v_mul_f32 v34, v34, v51
    v_mul_f32 v35, v35, v51
    v_mul_f32 v36, v36, v51
    v_mul_f32 v37, v37, v51
    v_mul_f32 v38, v38, v51
    v_mul_f32 v39, v39, v51
    v_cvt_pk_bf16_f32 v8, v24, v25
    v_cvt_pk_bf16_f32 v9, v26, v27
    v_cvt_pk_bf16_f32 v10, v28, v29
    v_cvt_pk_bf16_f32 v11, v30, v31
    v_cvt_pk_bf16_f32 v12, v32, v33
    v_cvt_pk_bf16_f32 v13, v34, v35
    v_cvt_pk_bf16_f32 v14, v36, v37
    v_cvt_pk_bf16_f32 v15, v38, v39
    s_mov_b32 s18, 0
    buffer_store_dwordx4 v[8:11], v7, s[12:15], s18 offen
    buffer_store_dwordx4 v[12:15], v7, s[12:15], s18 offen offset:256
    v_cmp_eq_u32 vcc, 0, v4
    v_lshlrev_b32 v20, 2, v5
    s_mov_b32 s18, 9437184
    s_nop 1
    s_and_saveexec_b64 s[20:21], vcc
    s_cbranch_execz kln_kernel_end
    buffer_store_dword v49, v20, s[12:15], s18 offen
    s_branch kln_kernel_end
kln_kernel_pack:
    s_sub_u32 s4, s2, 128
    s_mul_i32 s4, s4, 9
    s_add_u32 s4, s4, s3
    s_lshl_b32 s5, s3, 13
    s_cmp_ge_u32 s4, 738
    s_cbranch_scc1 kln_kernel_pk_end
    s_cmp_ge_u32 s4, 81
    s_cbranch_scc1 kln_kernel_pk_n0
    s_load_dwordx2 s[40:41], s[0:1], 48
    s_mul_hi_u32 s45, s4, 477218589
    s_mul_i32 s46, s45, 9
    s_sub_u32 s46, s4, s46
    s_mov_b32 s44, 1152
    s_mov_b32 s47, 0
    s_mov_b32 s48, 45686784
    s_mov_b32 s49, 18
    s_mov_b32 s42, 663552
    s_branch kln_kernel_pk_go
kln_kernel_pk_n0:
    s_cmp_ge_u32 s4, 162
    s_cbranch_scc1 kln_kernel_pk_n1
    s_load_dwordx2 s[40:41], s[0:1], 56
    s_sub_u32 s4, s4, 81
    s_mul_hi_u32 s45, s4, 477218589
    s_mul_i32 s46, s45, 9
    s_sub_u32 s46, s4, s46
    s_mov_b32 s44, 1152
    s_mov_b32 s47, 0
    s_mov_b32 s48, 46350336
    s_mov_b32 s49, 18
    s_mov_b32 s42, 663552
    s_branch kln_kernel_pk_go
kln_kernel_pk_n1:
    s_load_dwordx2 s[40:41], s[0:1], 24
    s_sub_u32 s4, s4, 162
    s_lshr_b32 s45, s4, 6
    s_and_b32 s46, s4, 63
    s_mov_b32 s44, 8192
    s_mov_b32 s47, 0
    s_mov_b32 s48, 47013888
    s_mov_b32 s49, 18
    s_mov_b32 s42, 4718592
    s_branch kln_kernel_pk_go
kln_kernel_pk_go:
    s_load_dwordx2 s[50:51], s[0:1], 96
    s_mov_b32 s43, 0x20000
    s_waitcnt lgkmcnt(0)
    s_mov_b32 s52, s50
    s_mov_b32 s53, s51
    s_mov_b32 s54, 104833024
    s_mov_b32 s55, 0x20000
    s_mul_i32 s56, s45, s44
    s_lshl_b32 s56, s56, 6
    s_lshl_b32 s57, s46, 7
    s_add_u32 s56, s56, s57
    s_lshl_b32 s57, s44, 3
    v_lshrrev_b32 v8, 3, v1
    v_mul_lo_u32 v8, v8, s44
    v_and_b32 v9, 7, v1
    v_lshl_add_u32 v8, v9, 4, v8
    s_add_u32 m0, s5, 0
    s_nop 0
    buffer_load_dwordx4 v8, s[40:43], s56 offen lds
    s_add_u32 s56, s56, s57
    s_add_u32 m0, s5, 1024
    s_nop 0
    buffer_load_dwordx4 v8, s[40:43], s56 offen lds
    s_add_u32 s56, s56, s57
    s_add_u32 m0, s5, 2048
    s_nop 0
    buffer_load_dwordx4 v8, s[40:43], s56 offen lds
    s_add_u32 s56, s56, s57
    s_add_u32 m0, s5, 3072
    s_nop 0
    buffer_load_dwordx4 v8, s[40:43], s56 offen lds
    s_add_u32 s56, s56, s57
    s_add_u32 m0, s5, 4096
    s_nop 0
    buffer_load_dwordx4 v8, s[40:43], s56 offen lds
    s_add_u32 s56, s56, s57
    s_add_u32 m0, s5, 5120
    s_nop 0
    buffer_load_dwordx4 v8, s[40:43], s56 offen lds
    s_add_u32 s56, s56, s57
    s_add_u32 m0, s5, 6144
    s_nop 0
    buffer_load_dwordx4 v8, s[40:43], s56 offen lds
    s_add_u32 s56, s56, s57
    s_add_u32 m0, s5, 7168
    s_nop 0
    buffer_load_dwordx4 v8, s[40:43], s56 offen lds
    v_lshrrev_b32 v10, 2, v1
    v_and_b32 v10, 3, v10
    v_and_b32 v11, 3, v1
    v_lshrrev_b32 v12, 4, v1
    v_lshlrev_b32 v15, 4, v1
    s_waitcnt vmcnt(0)
    s_cmp_eq_u32 s47, 1
    s_cbranch_scc1 kln_kernel_pk_tn
    s_cmp_eq_u32 s47, 2
    s_cbranch_scc1 kln_kernel_pk_tk
    v_lshl_add_u32 v14, v12, 3, v10
    v_lshlrev_b32 v14, 7, v14
    v_lshl_add_u32 v14, v11, 4, v14
    v_add_u32 v14, s5, v14
    ds_read_b64_tr_b16 v[16:17], v14 offset:0
    ds_read_b64_tr_b16 v[18:19], v14 offset:512
    ds_read_b64_tr_b16 v[20:21], v14 offset:4096
    ds_read_b64_tr_b16 v[22:23], v14 offset:4608
    ds_read_b64_tr_b16 v[24:25], v14 offset:8
    ds_read_b64_tr_b16 v[26:27], v14 offset:520
    ds_read_b64_tr_b16 v[28:29], v14 offset:4104
    ds_read_b64_tr_b16 v[30:31], v14 offset:4616
    ds_read_b64_tr_b16 v[32:33], v14 offset:64
    ds_read_b64_tr_b16 v[34:35], v14 offset:576
    ds_read_b64_tr_b16 v[36:37], v14 offset:4160
    ds_read_b64_tr_b16 v[38:39], v14 offset:4672
    ds_read_b64_tr_b16 v[40:41], v14 offset:72
    ds_read_b64_tr_b16 v[42:43], v14 offset:584
    ds_read_b64_tr_b16 v[44:45], v14 offset:4168
    ds_read_b64_tr_b16 v[46:47], v14 offset:4680
    s_lshl_b32 s58, s46, 2
    s_mul_i32 s58, s58, 18
    s_lshl_b32 s59, s45, 1
    s_add_u32 s58, s58, s59
    s_lshl_b32 s58, s58, 10
    s_add_u32 s58, s58, s48
    s_waitcnt lgkmcnt(0)
    buffer_store_dwordx4 v[16:19], v15, s[52:55], s58 offen offset:0
    buffer_store_dwordx4 v[20:23], v15, s[52:55], s58 offen offset:1024
    s_add_u32 s58, s58, 18432
    buffer_store_dwordx4 v[24:27], v15, s[52:55], s58 offen offset:0
    buffer_store_dwordx4 v[28:31], v15, s[52:55], s58 offen offset:1024
    s_add_u32 s58, s58, 18432
    buffer_store_dwordx4 v[32:35], v15, s[52:55], s58 offen offset:0
    buffer_store_dwordx4 v[36:39], v15, s[52:55], s58 offen offset:1024
    s_add_u32 s58, s58, 18432
    buffer_store_dwordx4 v[40:43], v15, s[52:55], s58 offen offset:0
    buffer_store_dwordx4 v[44:47], v15, s[52:55], s58 offen offset:1024
    s_branch kln_kernel_pk_end
kln_kernel_pk_tn:
    v_lshl_add_u32 v14, v12, 3, v10
    v_lshlrev_b32 v14, 7, v14
    v_lshl_add_u32 v14, v11, 3, v14
    v_add_u32 v14, s5, v14
    ds_read_b64_tr_b16 v[16:17], v14 offset:0
    ds_read_b64_tr_b16 v[18:19], v14 offset:512
    ds_read_b64_tr_b16 v[20:21], v14 offset:4096
    ds_read_b64_tr_b16 v[22:23], v14 offset:4608
    ds_read_b64_tr_b16 v[24:25], v14 offset:32
    ds_read_b64_tr_b16 v[26:27], v14 offset:544
    ds_read_b64_tr_b16 v[28:29], v14 offset:4128
    ds_read_b64_tr_b16 v[30:31], v14 offset:4640
    ds_read_b64_tr_b16 v[32:33], v14 offset:64
    ds_read_b64_tr_b16 v[34:35], v14 offset:576
    ds_read_b64_tr_b16 v[36:37], v14 offset:4160
    ds_read_b64_tr_b16 v[38:39], v14 offset:4672
    ds_read_b64_tr_b16 v[40:41], v14 offset:96
    ds_read_b64_tr_b16 v[42:43], v14 offset:608
    ds_read_b64_tr_b16 v[44:45], v14 offset:4192
    ds_read_b64_tr_b16 v[46:47], v14 offset:4704
    s_lshl_b32 s58, s46, 2
    s_mul_i32 s58, s58, s49
    s_lshl_b32 s59, s45, 1
    s_add_u32 s58, s58, s59
    s_lshl_b32 s58, s58, 10
    s_add_u32 s58, s58, s48
    s_lshl_b32 s60, s49, 10
    s_waitcnt lgkmcnt(0)
    buffer_store_dwordx4 v[16:19], v15, s[52:55], s58 offen offset:0
    buffer_store_dwordx4 v[20:23], v15, s[52:55], s58 offen offset:1024
    s_add_u32 s58, s58, s60
    buffer_store_dwordx4 v[24:27], v15, s[52:55], s58 offen offset:0
    buffer_store_dwordx4 v[28:31], v15, s[52:55], s58 offen offset:1024
    s_add_u32 s58, s58, s60
    buffer_store_dwordx4 v[32:35], v15, s[52:55], s58 offen offset:0
    buffer_store_dwordx4 v[36:39], v15, s[52:55], s58 offen offset:1024
    s_add_u32 s58, s58, s60
    buffer_store_dwordx4 v[40:43], v15, s[52:55], s58 offen offset:0
    buffer_store_dwordx4 v[44:47], v15, s[52:55], s58 offen offset:1024
    s_branch kln_kernel_pk_end
kln_kernel_pk_tk:
    v_lshl_add_u32 v14, v12, 2, v10
    v_lshlrev_b32 v14, 7, v14
    v_lshl_add_u32 v14, v11, 3, v14
    v_add_u32 v14, s5, v14
    ds_read_b64_tr_b16 v[16:17], v14 offset:0
    ds_read_b64_tr_b16 v[18:19], v14 offset:2048
    ds_read_b64_tr_b16 v[20:21], v14 offset:4096
    ds_read_b64_tr_b16 v[22:23], v14 offset:6144
    ds_read_b64_tr_b16 v[24:25], v14 offset:32
    ds_read_b64_tr_b16 v[26:27], v14 offset:2080
    ds_read_b64_tr_b16 v[28:29], v14 offset:4128
    ds_read_b64_tr_b16 v[30:31], v14 offset:6176
    ds_read_b64_tr_b16 v[32:33], v14 offset:64
    ds_read_b64_tr_b16 v[34:35], v14 offset:2112
    ds_read_b64_tr_b16 v[36:37], v14 offset:4160
    ds_read_b64_tr_b16 v[38:39], v14 offset:6208
    ds_read_b64_tr_b16 v[40:41], v14 offset:96
    ds_read_b64_tr_b16 v[42:43], v14 offset:2144
    ds_read_b64_tr_b16 v[44:45], v14 offset:4192
    ds_read_b64_tr_b16 v[46:47], v14 offset:6240
    s_lshl_b32 s58, s46, 2
    s_mul_i32 s58, s58, s49
    s_lshl_b32 s59, s45, 1
    s_add_u32 s58, s58, s59
    s_lshl_b32 s58, s58, 10
    s_add_u32 s58, s58, s48
    s_lshl_b32 s60, s49, 10
    s_waitcnt lgkmcnt(0)
    buffer_store_dwordx4 v[16:19], v15, s[52:55], s58 offen offset:0
    buffer_store_dwordx4 v[20:23], v15, s[52:55], s58 offen offset:1024
    s_add_u32 s58, s58, s60
    buffer_store_dwordx4 v[24:27], v15, s[52:55], s58 offen offset:0
    buffer_store_dwordx4 v[28:31], v15, s[52:55], s58 offen offset:1024
    s_add_u32 s58, s58, s60
    buffer_store_dwordx4 v[32:35], v15, s[52:55], s58 offen offset:0
    buffer_store_dwordx4 v[36:39], v15, s[52:55], s58 offen offset:1024
    s_add_u32 s58, s58, s60
    buffer_store_dwordx4 v[40:43], v15, s[52:55], s58 offen offset:0
    buffer_store_dwordx4 v[44:47], v15, s[52:55], s58 offen offset:1024
kln_kernel_pk_end:
kln_kernel_end:
    s_endpgm
.section .rodata,"a"
.p2align 6
.amdhsa_kernel kln_kernel
  .amdhsa_next_free_vgpr 96
  .amdhsa_next_free_sgpr 102
  .amdhsa_accum_offset 96
  .amdhsa_group_segment_fixed_size 0
  .amdhsa_kernarg_size 104
  .amdhsa_user_sgpr_count 2
  .amdhsa_user_sgpr_kernarg_segment_ptr 1
  .amdhsa_system_sgpr_workgroup_id_x 1
  .amdhsa_float_denorm_mode_32 3
.end_amdhsa_kernel
.text
.globl kmain_kernel
.p2align 8
.type kmain_kernel,@function
kmain_kernel:
kmain_kernel_start:
    s_cmp_ge_u32 s2, 256
    s_cbranch_scc1 kmain_kernel_end
    s_load_dwordx2 s[6:7], s[0:1], 96
    v_and_b32 v1, 63, v0
    v_lshrrev_b32 v7, 6, v0
    v_lshlrev_b32 v2, 4, v1
    v_readfirstlane_b32 s3, v7
    v_mov_b32 v3, v2
    v_add_u32 v4, 36864, v2
    v_add_u32 v5, 73728, v2
    v_add_u32 v6, 110592, v2
    s_waitcnt lgkmcnt(0)
    s_mov_b32 s8, s6
    s_mov_b32 s9, s7
    s_mov_b32 s10, 104833024
    s_mov_b32 s11, 0x20000
    s_mov_b32 s8, s6
    s_mov_b32 s9, s7
    s_mov_b32 s10, 104833024
    s_mov_b32 s11, 0x20000
    s_mul_i32 s21, s3, 9216
    s_load_dwordx2 s[12:13], s[0:1], 8
    s_load_dwordx2 s[14:15], s[0:1], 16
    s_and_b32 s4, s2, 3
    s_lshl_b32 s4, s4, 2
    s_lshr_b32 s5, s2, 3
    s_and_b32 s16, s5, 3
    s_add_u32 s4, s4, s16
    s_lshr_b32 s5, s5, 2
    s_lshr_b32 s16, s2, 2
    s_and_b32 s16, s16, 1
    s_lshl_b32 s16, s16, 3
    s_add_u32 s5, s5, s16
    s_lshl_b32 s16, s5, 2
    s_add_u32 s16, s16, s3
    s_lshl_b32 s16, s16, 1
    s_mul_i32 s20, s4, 294912
    s_add_u32 s20, s20, s21
    s_add_u32 s20, s20, 47013888
    s_mul_i32 s23, s4, 36864
    s_add_u32 s23, s23, s21
    s_add_u32 s62, s23, 45686784
    s_add_u32 s63, s62, 589824
    s_add_u32 s64, s23, 46350336
    s_add_u32 s65, s64, 516096
    s_sub_u32 s22, s4, 2
    s_cmp_lt_u32 s22, 2
    s_cselect_b32 s65, s65, 2130706432
    s_mul_i32 s23, s4, 331776
    s_add_u32 s23, s23, s21
    s_add_u32 s66, s23, 51732480
    v_and_b32 v232, 15, v1
    s_lshl_b32 s18, s16, 4
    v_add_u32 v232, s18, v232
    v_lshlrev_b32 v7, 2, v232
    s_mov_b32 s18, 9437184
    buffer_load_dword v234, v7, s[8:11], s18 offen
    buffer_load_dword v235, v7, s[8:11], s18 offen offset:64
    s_mul_i32 s17, s16, 18432
    s_add_u32 s17, s17, 0
    s_add_u32 m0, s21, 0
    s_add_u32 s22, s62, 0
    buffer_load_dwordx4 v2, s[8:11], s22 offen offset:0 lds
    buffer_load_dwordx4 v2, s[8:11], s22 offen offset:1024 lds
    buffer_load_dwordx4 v2, s[8:11], s22 offen offset:2048 lds
    buffer_load_dwordx4 v2, s[8:11], s22 offen offset:3072 lds
    s_add_u32 m0, s21, 4096
    s_add_u32 s22, s62, 4096
    buffer_load_dwordx4 v2, s[8:11], s22 offen offset:0 lds
    buffer_load_dwordx4 v2, s[8:11], s22 offen offset:1024 lds
    buffer_load_dwordx4 v2, s[8:11], s22 offen offset:2048 lds
    buffer_load_dwordx4 v2, s[8:11], s22 offen offset:3072 lds
    s_add_u32 m0, s21, 8192
    s_add_u32 s22, s62, 8192
    buffer_load_dwordx4 v2, s[8:11], s22 offen offset:0 lds
    s_add_u32 s23, s17, 18432
    buffer_load_dwordx4 v[8:11], v2, s[8:11], s17 offen offset:0
    buffer_load_dwordx4 v[12:15], v2, s[8:11], s23 offen offset:0
    buffer_load_dwordx4 v[16:19], v2, s[8:11], s17 offen offset:1024
    buffer_load_dwordx4 v[20:23], v2, s[8:11], s23 offen offset:1024
    buffer_load_dwordx4 v[24:27], v2, s[8:11], s17 offen offset:2048
    buffer_load_dwordx4 v[28:31], v2, s[8:11], s23 offen offset:2048
    buffer_load_dwordx4 v[32:35], v2, s[8:11], s17 offen offset:3072
    buffer_load_dwordx4 v[36:39], v2, s[8:11], s23 offen offset:3072
    s_add_u32 s17, s17, 4096
    s_add_u32 s23, s23, 4096
    buffer_load_dwordx4 v[40:43], v2, s[8:11], s17 offen offset:0
    buffer_load_dwordx4 v[44:47], v2, s[8:11], s23 offen offset:0
    buffer_load_dwordx4 v[48:51], v2, s[8:11], s17 offen offset:1024
    buffer_load_dwordx4 v[52:55], v2, s[8:11], s23 offen offset:1024
    buffer_load_dwordx4 v[56:59], v2, s[8:11], s17 offen offset:2048
    buffer_load_dwordx4 v[60:63], v2, s[8:11], s23 offen offset:2048
    buffer_load_dwordx4 v[64:67], v2, s[8:11], s17 offen offset:3072
    buffer_load_dwordx4 v[68:71], v2, s[8:11], s23 offen offset:3072
    s_add_u32 s17, s17, 4096
    s_add_u32 s23, s23, 4096
    buffer_load_dwordx4 v[72:75], v2, s[8:11], s17 offen offset:0
    buffer_load_dwordx4 v[76:79], v2, s[8:11], s23 offen offset:0
    buffer_load_dwordx4 v[80:83], v2, s[8:11], s17 offen offset:1024
    buffer_load_dwordx4 v[84:87], v2, s[8:11], s23 offen offset:1024
    buffer_load_dwordx4 v[88:91], v2, s[8:11], s17 offen offset:2048
    buffer_load_dwordx4 v[92:95], v2, s[8:11], s23 offen offset:2048
    buffer_load_dwordx4 v[96:99], v2, s[8:11], s17 offen offset:3072
    buffer_load_dwordx4 v[100:103], v2, s[8:11], s23 offen offset:3072
    s_add_u32 s17, s17, 4096
    s_add_u32 s23, s23, 4096
    buffer_load_dwordx4 v[104:107], v2, s[8:11], s17 offen offset:0
    buffer_load_dwordx4 v[108:111], v2, s[8:11], s23 offen offset:0
    buffer_load_dwordx4 v[112:115], v2, s[8:11], s17 offen offset:1024
    buffer_load_dwordx4 v[116:119], v2, s[8:11], s23 offen offset:1024
    buffer_load_dwordx4 v[120:123], v2, s[8:11], s17 offen offset:2048
    buffer_load_dwordx4 v[124:127], v2, s[8:11], s23 offen offset:2048
    buffer_load_dwordx4 v[128:131], v2, s[8:11], s17 offen offset:3072
    buffer_load_dwordx4 v[132:135], v2, s[8:11], s23 offen offset:3072
    s_add_u32 s17, s17, 4096
    s_add_u32 s23, s23, 4096
    buffer_load_dwordx4 v[136:139], v2, s[8:11], s17 offen offset:0
    buffer_load_dwordx4 v[140:143], v2, s[8:11], s23 offen offset:0
    buffer_load_dwordx4 v[144:147], v2, s[8:11], s17 offen offset:1024
    buffer_load_dwordx4 v[148:151], v2, s[8:11], s23 offen offset:1024
    s_lshl_b32 s75, s3, 13
    s_add_u32 s75, s75, 36864
    s_mul_i32 s61, s5, 14
    s_add_u32 s61, s61, s4
    s_sub_u32 s61, s61, 2
    s_lshl_b32 s61, s61, 2
    s_add_u32 s61, s61, s3
    s_cmp_ge_u32 s4, 2
    s_cbranch_scc1 kmain_kernel_i_nop
    s_add_u32 m0, s21, 36864
    s_add_u32 s22, s63, 0
    buffer_load_dwordx4 v2, s[8:11], s22 offen offset:0 lds
    buffer_load_dwordx4 v2, s[8:11], s22 offen offset:1024 lds
    buffer_load_dwordx4 v2, s[8:11], s22 offen offset:2048 lds
    buffer_load_dwordx4 v2, s[8:11], s22 offen offset:3072 lds
    s_add_u32 m0, s21, 40960
    s_add_u32 s22, s63, 4096
    buffer_load_dwordx4 v2, s[8:11], s22 offen offset:0 lds
    buffer_load_dwordx4 v2, s[8:11], s22 offen offset:1024 lds
    buffer_load_dwordx4 v2, s[8:11], s22 offen offset:2048 lds
    buffer_load_dwordx4 v2, s[8:11], s22 offen offset:3072 lds
    s_add_u32 m0, s21, 45056
    s_add_u32 s22, s63, 8192
    buffer_load_dwordx4 v2, s[8:11], s22 offen offset:0 lds
    s_mov_b32 s61, 0x10000
    s_mov_b32 s75, 0x28000
kmain_kernel_i_nop:
    s_add_u32 m0, s21, 73728
    s_add_u32 s22, s20, 0
    buffer_load_dwordx4 v2, s[8:11], s22 offen offset:0 lds
    buffer_load_dwordx4 v2, s[8:11], s22 offen offset:1024 lds
    buffer_load_dwordx4 v2, s[8:11], s22 offen offset:2048 lds
    buffer_load_dwordx4 v2, s[8:11], s22 offen offset:3072 lds
    s_add_u32 m0, s21, 77824
    s_add_u32 s22, s20, 4096
    buffer_load_dwordx4 v2, s[8:11], s22 offen offset:0 lds
    buffer_load_dwordx4 v2, s[8:11], s22 offen offset:1024 lds
    buffer_load_dwordx4 v2, s[8:11], s22 offen offset:2048 lds
    buffer_load_dwordx4 v2, s[8:11], s22 offen offset:3072 lds
    s_add_u32 m0, s21, 81920
    s_add_u32 s22, s20, 8192
    buffer_load_dwordx4 v2, s[8:11], s22 offen offset:0 lds
    s_add_u32 m0, s21, 110592
    s_add_u32 s22, s20, 36864
    buffer_load_dwordx4 v2, s[8:11], s22 offen offset:0 lds
    buffer_load_dwordx4 v2, s[8:11], s22 offen offset:1024 lds
    buffer_load_dwordx4 v2, s[8:11], s22 offen offset:2048 lds
    buffer_load_dwordx4 v2, s[8:11], s22 offen offset:3072 lds
    s_add_u32 m0, s21, 114688
    s_add_u32 s22, s20, 40960
    buffer_load_dwordx4 v2, s[8:11], s22 offen offset:0 lds
    buffer_load_dwordx4 v2, s[8:11], s22 offen offset:1024 lds
    buffer_load_dwordx4 v2, s[8:11], s22 offen offset:2048 lds
    buffer_load_dwordx4 v2, s[8:11], s22 offen offset:3072 lds
    s_add_u32 m0, s21, 118784
    s_add_u32 s22, s20, 45056
    buffer_load_dwordx4 v2, s[8:11], s22 offen offset:0 lds
    s_cmp_ge_u32 s61, 648
    s_cbranch_scc1 kmain_kernel_pa_n0
    s_load_dwordx2 s[24:25], s[0:1], 64
    s_mul_hi_u32 s57, s61, 59652324
    s_mul_i32 s58, s57, 72
    s_sub_u32 s58, s61, s58
    s_mov_b32 s60, 9216
    s_mov_b32 s54, 0
    s_mov_b32 s26, 5308416
    s_mov_b32 s56, 18432
    s_mul_i32 s55, s58, 72
    s_lshl_b32 s59, s57, 1
    s_add_u32 s55, s55, s59
    s_lshl_b32 s55, s55, 10
    s_add_u32 s55, s55, 51732480
    s_mul_i32 s57, s57, 589824
    s_lshl_b32 s58, s58, 7
    s_add_u32 s57, s57, s58
    s_branch kmain_kernel_pa_go
kmain_kernel_pa_n0:
    s_cmp_ge_u32 s61, 896
    s_cbranch_scc1 kmain_kernel_pa_n1
    s_load_dwordx2 s[24:25], s[0:1], 72
    s_sub_u32 s61, s61, 648
    s_mul_hi_u32 s57, s61, 477218589
    s_mul_i32 s58, s57, 9
    s_sub_u32 s58, s61, s58
    s_mov_b32 s60, 1152
    s_mov_b32 s54, 1
    s_mov_b32 s26, 5308416
    s_mov_b32 s56, 147456
    s_mul_i32 s55, s58, 576
    s_lshl_b32 s59, s57, 1
    s_add_u32 s55, s55, s59
    s_lshl_b32 s55, s55, 10
    s_add_u32 s55, s55, 61759488
    s_mul_i32 s57, s57, 73728
    s_lshl_b32 s58, s58, 7
    s_add_u32 s57, s57, s58
    s_branch kmain_kernel_pa_go
kmain_kernel_pa_n1:
    s_load_dwordx2 s[24:25], s[0:1], 64
    s_mov_b32 s60, 0
    s_mov_b32 s54, 3
    s_mov_b32 s26, 0
    s_mov_b32 s55, 0
    s_mov_b32 s56, 0
    s_mov_b32 s57, 0
kmain_kernel_pa_go:
    s_mov_b32 s27, 0x20000
    v_lshrrev_b32 v184, 3, v1
    v_mul_lo_u32 v184, v184, s60
    v_and_b32 v185, 7, v1
    v_lshl_add_u32 v184, v185, 4, v184
    s_lshl_b32 s60, s60, 3
    s_waitcnt lgkmcnt(0)
    s_add_u32 m0, s75, 0
    s_nop 0
    buffer_load_dwordx4 v184, s[24:27], s57 offen lds
    s_add_u32 s57, s57, s60
    s_add_u32 m0, s75, 1024
    s_nop 0
    buffer_load_dwordx4 v184, s[24:27], s57 offen lds
    s_add_u32 s57, s57, s60
    s_add_u32 m0, s75, 2048
    s_nop 0
    buffer_load_dwordx4 v184, s[24:27], s57 offen lds
    s_add_u32 s57, s57, s60
    s_add_u32 m0, s75, 3072
    s_nop 0
    buffer_load_dwordx4 v184, s[24:27], s57 offen lds
    s_add_u32 s57, s57, s60
    s_add_u32 m0, s75, 4096
    s_nop 0
    buffer_load_dwordx4 v184, s[24:27], s57 offen lds
    s_add_u32 s57, s57, s60
    s_add_u32 m0, s75, 5120
    s_nop 0
    buffer_load_dwordx4 v184, s[24:27], s57 offen lds
    s_add_u32 s57, s57, s60
    s_add_u32 m0, s75, 6144
    s_nop 0
    buffer_load_dwordx4 v184, s[24:27], s57 offen lds
    s_add_u32 s57, s57, s60
    s_add_u32 m0, s75, 7168
    s_nop 0
    buffer_load_dwordx4 v184, s[24:27], s57 offen lds
    s_getpc_b64 s[72:73]
kmain_kernel_pc_1:
    s_lshl_b32 s74, s3, 13
    v_lshlrev_b32 v219, 7, v1
    v_add_u32 v219, s74, v219
    v_min_u32 v220, kmain_kernel_end-kmain_kernel_pc_1, v219
    global_load_dword v221, v220, s[72:73]
    v_add_u32 v219, 32768, v219
    v_min_u32 v220, kmain_kernel_end-kmain_kernel_pc_1, v219
    global_load_dword v222, v220, s[72:73]
    v_add_u32 v219, 32768, v219
    v_min_u32 v220, kmain_kernel_end-kmain_kernel_pc_1, v219
    global_load_dword v223, v220, s[72:73]
    v_lshrrev_b32 v233, 4, v1
    v_lshlrev_b32 v233, 3, v233
    v_mov_b32 v255, 0xc0135761
    s_waitcnt lgkmcnt(0)
    s_lshl_b32 s18, s4, 19
    s_add_u32 s28, s12, s18
    s_addc_u32 s29, s13, 0
    s_mov_b32 s30, 0x80000
    s_mov_b32 s31, 0x20000
    s_add_u32 s32, s14, s18
    s_addc_u32 s33, s15, 0
    s_mov_b32 s34, 0x80000
    s_mov_b32 s35, 0x20000
    v_lshrrev_b32 v190, 4, v1
    v_and_b32 v191, 15, v1
    s_lshl_b32 s18, s3, 4
    v_add_u32 v192, s18, v190
    v_lshlrev_b32 v192, 8, v192
    v_add_u32 v193, 0, v190
    v_xor_b32 v193, v193, v191
    v_lshl_add_u32 v212, v193, 4, v192
    v_add_u32 v193, 4, v190
    v_xor_b32 v193, v193, v191
    v_lshl_add_u32 v213, v193, 4, v192
    v_add_u32 v193, 8, v190
    v_xor_b32 v193, v193, v191
    v_lshl_add_u32 v214, v193, 4, v192
    v_add_u32 v193, 12, v190
    v_xor_b32 v193, v193, v191
    v_lshl_add_u32 v215, v193, 4, v192
    v_add_u32 v193, 0, v190
    v_lshlrev_b32 v193, 1, v193
    v_xor_b32 v193, v193, v191
    v_lshl_add_u32 v216, v193, 4, v192
    v_add_u32 v193, 4, v190
    v_lshlrev_b32 v193, 1, v193
    v_xor_b32 v193, v193, v191
    v_lshl_add_u32 v217, v193, 4, v192
    v_lshlrev_b32 v192, 8, v191
    v_add_u32 v193, 0, v190
    v_xor_b32 v193, v193, v191
    v_lshl_add_u32 v200, v193, 4, v192
    v_add_u32 v193, 4, v190
    v_xor_b32 v193, v193, v191
    v_lshl_add_u32 v201, v193, 4, v192
    v_add_u32 v193, 8, v190
    v_xor_b32 v193, v193, v191
    v_lshl_add_u32 v202, v193, 4, v192
    v_add_u32 v193, 12, v190
    v_xor_b32 v193, v193, v191
    v_lshl_add_u32 v203, v193, 4, v192
    v_lshrrev_b32 v192, 2, v1
    v_and_b32 v192, 3, v192
    v_lshl_add_u32 v192, v190, 2, v192
    v_and_b32 v191, 7, v192
    v_lshlrev_b32 v192, 8, v192
    v_and_b32 v193, 3, v1
    v_lshl_add_u32 v192, v193, 3, v192
    v_add_u32 v192, 0x10000, v192
    v_xor_b32 v193, 0, v191
    v_lshl_add_u32 v204, v193, 5, v192
    v_xor_b32 v193, 1, v191
    v_lshl_add_u32 v205, v193, 5, v192
    v_xor_b32 v193, 2, v191
    v_lshl_add_u32 v206, v193, 5, v192
    v_xor_b32 v193, 3, v191
    v_lshl_add_u32 v207, v193, 5, v192
    v_xor_b32 v193, 4, v191
    v_lshl_add_u32 v208, v193, 5, v192
    v_xor_b32 v193, 5, v191
    v_lshl_add_u32 v209, v193, 5, v192
    v_xor_b32 v193, 6, v191
    v_lshl_add_u32 v210, v193, 5, v192
    v_xor_b32 v193, 7, v191
    v_lshl_add_u32 v211, v193, 5, v192
    s_lshl_b32 s38, s3, 12
    s_add_u32 s39, s38, 0x10000
    s_lshl_b32 s67, s4, 5
    s_add_u32 s68, s67, 512
    s_lshl_b32 s69, s4, 10
    s_add_u32 s69, s69, 2359296
    s_add_u32 s70, s69, 16384
    s_lshl_b32 s71, s5, 6
    s_add_u32 s42, s71, 104818688
    s_add_u32 s71, s71, 104817664
    s_mov_b32 s52, 104819712
    v_min_u32 v194, 2, v1
    v_add_u32 v194, s5, v194
    v_add_u32 v194, 15, v194
    v_and_b32 v194, 15, v194
    v_lshlrev_b32 v194, 6, v194
    v_add_u32 v194, 104817664, v194
    v_mov_b32 v195, 18
    s_cmp_lt_u32 s4, 2
    s_cbranch_scc1 kmain_kernel_h2
    s_waitcnt vmcnt(63)
    s_barrier
    ds_read_b128 a[128:131], v3 offset:0
    ds_read_b128 a[132:135], v3 offset:1024
    ds_read_b128 a[136:139], v3 offset:2048
    ds_read_b128 a[140:143], v3 offset:3072
    ds_read_b128 a[144:147], v3 offset:4096
    ds_read_b128 a[148:151], v3 offset:5120
    ds_read_b128 a[152:155], v3 offset:6144
    ds_read_b128 a[156:159], v3 offset:7168
    ds_read_b128 a[160:163], v3 offset:8192
    s_waitcnt vmcnt(57)
    s_waitcnt lgkmcnt(6)
    v_mfma_f32_16x16x32_bf16 v[152:155], a[128:131], v[8:11], 0
    v_mfma_f32_16x16x32_bf16 v[152:155], a[132:135], v[16:19], v[152:155]
    ds_read_b128 a[164:167], v3 offset:9216
    v_mfma_f32_16x16x32_bf16 v[152:155], a[136:139], v[24:27], v[152:155]
    v_mfma_f32_16x16x32_bf16 v[156:159], a[128:131], v[12:15], 0
    ds_read_b128 a[168:171], v3 offset:10240
    v_mfma_f32_16x16x32_bf16 v[156:159], a[132:135], v[20:23], v[156:159]
    v_mfma_f32_16x16x32_bf16 v[156:159], a[136:139], v[28:31], v[156:159]
    ds_read_b128 a[172:175], v3 offset:11264
    s_waitcnt vmcnt(53)
    s_waitcnt lgkmcnt(6)
    v_mfma_f32_16x16x32_bf16 v[152:155], a[140:143], v[32:35], v[152:155]
    v_mfma_f32_16x16x32_bf16 v[152:155], a[144:147], v[40:43], v[152:155]
    ds_read_b128 a[128:131], v3 offset:12288
    v_mfma_f32_16x16x32_bf16 v[152:155], a[148:151], v[48:51], v[152:155]
    v_mfma_f32_16x16x32_bf16 v[156:159], a[140:143], v[36:39], v[156:159]
    ds_read_b128 a[132:135], v3 offset:13312
    v_mfma_f32_16x16x32_bf16 v[156:159], a[144:147], v[44:47], v[156:159]
    v_mfma_f32_16x16x32_bf16 v[156:159], a[148:151], v[52:55], v[156:159]
    ds_read_b128 a[136:139], v3 offset:14336
    s_waitcnt vmcnt(45)
    s_waitcnt lgkmcnt(6)
    v_mfma_f32_16x16x32_bf16 v[152:155], a[152:155], v[56:59], v[152:155]
    v_mfma_f32_16x16x32_bf16 v[152:155], a[156:159], v[64:67], v[152:155]
    ds_read_b128 a[140:143], v3 offset:15360
    v_mfma_f32_16x16x32_bf16 v[152:155], a[160:163], v[72:75], v[152:155]
    v_mfma_f32_16x16x32_bf16 v[156:159], a[152:155], v[60:63], v[156:159]
    ds_read_b128 a[144:147], v3 offset:16384
    v_mfma_f32_16x16x32_bf16 v[156:159], a[156:159], v[68:71], v[156:159]
    v_mfma_f32_16x16x32_bf16 v[156:159], a[160:163], v[76:79], v[156:159]
    ds_read_b128 a[148:151], v3 offset:17408
    s_waitcnt vmcnt(41)
    s_waitcnt lgkmcnt(6)
    v_mfma_f32_16x16x32_bf16 v[152:155], a[164:167], v[80:83], v[152:155]
    v_mfma_f32_16x16x32_bf16 v[152:155], a[168:171], v[88:91], v[152:155]
    ds_read_b128 a[152:155], v3 offset:18432
    v_mfma_f32_16x16x32_bf16 v[152:155], a[172:175], v[96:99], v[152:155]
    v_mfma_f32_16x16x32_bf16 v[156:159], a[164:167], v[84:87], v[156:159]
    ds_read_b128 a[156:159], v3 offset:19456
    v_mfma_f32_16x16x32_bf16 v[156:159], a[168:171], v[92:95], v[156:159]
    v_mfma_f32_16x16x32_bf16 v[156:159], a[172:175], v[100:103], v[156:159]
    ds_read_b128 a[160:163], v3 offset:20480
    s_waitcnt vmcnt(33)
    s_waitcnt lgkmcnt(6)
    v_mfma_f32_16x16x32_bf16 v[152:155], a[128:131], v[104:107], v[152:155]
    v_mfma_f32_16x16x32_bf16 v[152:155], a[132:135], v[112:115], v[152:155]
    ds_read_b128 a[164:167], v3 offset:21504
    v_mfma_f32_16x16x32_bf16 v[152:155], a[136:139], v[120:123], v[152:155]
    v_mfma_f32_16x16x32_bf16 v[156:159], a[128:131], v[108:111], v[156:159]
    ds_read_b128 a[168:171], v3 offset:22528
    v_mfma_f32_16x16x32_bf16 v[156:159], a[132:135], v[116:119], v[156:159]
    v_mfma_f32_16x16x32_bf16 v[156:159], a[136:139], v[124:127], v[156:159]
    ds_read_b128 a[172:175], v3 offset:23552
    s_waitcnt vmcnt(29)
    s_waitcnt lgkmcnt(6)
    v_mfma_f32_16x16x32_bf16 v[152:155], a[140:143], v[128:131], v[152:155]
    v_mfma_f32_16x16x32_bf16 v[152:155], a[144:147], v[136:139], v[152:155]
    ds_read_b128 a[128:131], v3 offset:24576
    v_mfma_f32_16x16x32_bf16 v[152:155], a[148:151], v[144:147], v[152:155]
    v_mfma_f32_16x16x32_bf16 v[156:159], a[140:143], v[132:135], v[156:159]
    ds_read_b128 a[132:135], v3 offset:25600
    v_mfma_f32_16x16x32_bf16 v[156:159], a[144:147], v[140:143], v[156:159]
    v_mfma_f32_16x16x32_bf16 v[156:159], a[148:151], v[148:151], v[156:159]
    ds_read_b128 a[136:139], v3 offset:26624
    s_waitcnt lgkmcnt(6)
    v_mfma_f32_16x16x32_bf16 v[160:163], a[152:155], v[8:11], 0
    v_mfma_f32_16x16x32_bf16 v[160:163], a[156:159], v[16:19], v[160:163]
    ds_read_b128 a[140:143], v3 offset:27648
    v_mfma_f32_16x16x32_bf16 v[160:163], a[160:163], v[24:27], v[160:163]
    v_mfma_f32_16x16x32_bf16 v[164:167], a[152:155], v[12:15], 0
    ds_read_b128 a[144:147], v3 offset:28672
    v_mfma_f32_16x16x32_bf16 v[164:167], a[156:159], v[20:23], v[164:167]
    v_mfma_f32_16x16x32_bf16 v[164:167], a[160:163], v[28:31], v[164:167]
    ds_read_b128 a[148:151], v3 offset:29696
    s_waitcnt lgkmcnt(6)
    v_mfma_f32_16x16x32_bf16 v[160:163], a[164:167], v[32:35], v[160:163]
    v_mfma_f32_16x16x32_bf16 v[160:163], a[168:171], v[40:43], v[160:163]
    ds_read_b128 a[152:155], v3 offset:30720
    v_mfma_f32_16x16x32_bf16 v[160:163], a[172:175], v[48:51], v[160:163]
    v_mfma_f32_16x16x32_bf16 v[164:167], a[164:167], v[36:39], v[164:167]
    ds_read_b128 a[156:159], v3 offset:31744
    v_mfma_f32_16x16x32_bf16 v[164:167], a[168:171], v[44:47], v[164:167]
    v_mfma_f32_16x16x32_bf16 v[164:167], a[172:175], v[52:55], v[164:167]
    ds_read_b128 a[160:163], v3 offset:32768
    s_waitcnt lgkmcnt(6)
    v_mfma_f32_16x16x32_bf16 v[160:163], a[128:131], v[56:59], v[160:163]
    v_mfma_f32_16x16x32_bf16 v[160:163], a[132:135], v[64:67], v[160:163]
    ds_read_b128 a[164:167], v3 offset:33792
    v_mfma_f32_16x16x32_bf16 v[160:163], a[136:139], v[72:75], v[160:163]
    v_mfma_f32_16x16x32_bf16 v[164:167], a[128:131], v[60:63], v[164:167]
    ds_read_b128 a[168:171], v3 offset:34816
    v_mfma_f32_16x16x32_bf16 v[164:167], a[132:135], v[68:71], v[164:167]
    v_mfma_f32_16x16x32_bf16 v[164:167], a[136:139], v[76:79], v[164:167]
    ds_read_b128 a[172:175], v3 offset:35840
    s_waitcnt lgkmcnt(6)
    v_mfma_f32_16x16x32_bf16 v[160:163], a[140:143], v[80:83], v[160:163]
    v_mfma_f32_16x16x32_bf16 v[160:163], a[144:147], v[88:91], v[160:163]
    v_mfma_f32_16x16x32_bf16 v[160:163], a[148:151], v[96:99], v[160:163]
    v_mfma_f32_16x16x32_bf16 v[164:167], a[140:143], v[84:87], v[164:167]
    v_mfma_f32_16x16x32_bf16 v[164:167], a[144:147], v[92:95], v[164:167]
    v_mfma_f32_16x16x32_bf16 v[164:167], a[148:151], v[100:103], v[164:167]
    s_waitcnt lgkmcnt(3)
    v_mfma_f32_16x16x32_bf16 v[160:163], a[152:155], v[104:107], v[160:163]
    v_mfma_f32_16x16x32_bf16 v[160:163], a[156:159], v[112:115], v[160:163]
    v_mfma_f32_16x16x32_bf16 v[160:163], a[160:163], v[120:123], v[160:163]
    v_mfma_f32_16x16x32_bf16 v[164:167], a[152:155], v[108:111], v[164:167]
    v_mfma_f32_16x16x32_bf16 v[164:167], a[156:159], v[116:119], v[164:167]
    v_mfma_f32_16x16x32_bf16 v[164:167], a[160:163], v[124:127], v[164:167]
    s_waitcnt lgkmcnt(0)
    v_mfma_f32_16x16x32_bf16 v[160:163], a[164:167], v[128:131], v[160:163]
    v_mfma_f32_16x16x32_bf16 v[160:163], a[168:171], v[136:139], v[160:163]
    v_mfma_f32_16x16x32_bf16 v[160:163], a[172:175], v[144:147], v[160:163]
    v_mfma_f32_16x16x32_bf16 v[164:167], a[164:167], v[132:135], v[164:167]
    v_mfma_f32_16x16x32_bf16 v[164:167], a[168:171], v[140:143], v[164:167]
    v_mfma_f32_16x16x32_bf16 v[164:167], a[172:175], v[148:151], v[164:167]
    v_mul_f32 v152, v152, v234
    v_mul_f32 v153, v153, v234
    v_mul_f32 v244, v152, v152
    v_mul_f32 v245, v153, v153
    v_fmamk_f32 v244, v244, 0xbdd2d3e8, v255
    v_fmamk_f32 v245, v245, 0xbdd2d3e8, v255
    v_mul_f32 v244, v244, v152
    v_mul_f32 v245, v245, v153
    v_exp_f32 v244, v244
    v_exp_f32 v245, v245
    v_add_f32 v244, 1.0, v244
    v_add_f32 v245, 1.0, v245
    v_rcp_f32 v244, v244
    v_rcp_f32 v245, v245
    v_mul_f32 v244, v244, v152
    v_mul_f32 v245, v245, v153
    v_cvt_pk_bf16_f32 v236, v244, v245
    v_mul_f32 v154, v154, v234
    v_mul_f32 v155, v155, v234
    v_mul_f32 v246, v154, v154
    v_mul_f32 v247, v155, v155
    v_fmamk_f32 v246, v246, 0xbdd2d3e8, v255
    v_fmamk_f32 v247, v247, 0xbdd2d3e8, v255
    v_mul_f32 v246, v246, v154
    v_mul_f32 v247, v247, v155
    v_exp_f32 v246, v246
    v_exp_f32 v247, v247
    v_add_f32 v246, 1.0, v246
    v_add_f32 v247, 1.0, v247
    v_rcp_f32 v246, v246
    v_rcp_f32 v247, v247
    v_mul_f32 v246, v246, v154
    v_mul_f32 v247, v247, v155
    v_cvt_pk_bf16_f32 v237, v246, v247
    v_mul_f32 v160, v160, v234
    v_mul_f32 v161, v161, v234
    v_mul_f32 v244, v160, v160
    v_mul_f32 v245, v161, v161
    v_fmamk_f32 v244, v244, 0xbdd2d3e8, v255
    v_fmamk_f32 v245, v245, 0xbdd2d3e8, v255
    v_mul_f32 v244, v244, v160
    v_mul_f32 v245, v245, v161
    v_exp_f32 v244, v244
    v_exp_f32 v245, v245
    v_add_f32 v244, 1.0, v244
    v_add_f32 v245, 1.0, v245
    v_rcp_f32 v244, v244
    v_rcp_f32 v245, v245
    v_mul_f32 v244, v244, v160
    v_mul_f32 v245, v245, v161
    v_cvt_pk_bf16_f32 v238, v244, v245
    v_mul_f32 v162, v162, v234
    v_mul_f32 v163, v163, v234
    v_mul_f32 v246, v162, v162
    v_mul_f32 v247, v163, v163
    v_fmamk_f32 v246, v246, 0xbdd2d3e8, v255
    v_fmamk_f32 v247, v247, 0xbdd2d3e8, v255
    v_mul_f32 v246, v246, v162
    v_mul_f32 v247, v247, v163
    v_exp_f32 v246, v246
    v_exp_f32 v247, v247
    v_add_f32 v246, 1.0, v246
    v_add_f32 v247, 1.0, v247
    v_rcp_f32 v246, v246
    v_rcp_f32 v247, v247
    v_mul_f32 v246, v246, v162
    v_mul_f32 v247, v247, v163
    v_cvt_pk_bf16_f32 v239, v246, v247
    v_add_u32 v248, s67, v233
    v_mov_b32 v249, 1
    v_cmp_le_u32 vcc, 144, v248
    s_nop 1
    v_cndmask_b32 v249, v249, -1, vcc
    v_cmp_le_u32 vcc, 288, v248
    s_nop 1
    v_cndmask_b32 v249, v249, 2, vcc
    v_cmp_le_u32 vcc, 432, v248
    s_nop 1
    v_cndmask_b32 v249, v249, -2, vcc
    v_add3_u32 v249, v249, v232, 0
    v_cmp_gt_u32 vcc, 2048, v249
    v_and_b32 v249, 2047, v249
    v_lshrrev_b32 v250, 4, v249
    v_mul_u32_u24 v250, 18432, v250
    v_and_b32 v249, 15, v249
    v_lshl_add_u32 v250, v249, 4, v250
    v_lshl_add_u32 v250, v233, 5, v250
    v_cndmask_b32 v236, 0, v236, vcc
    v_cndmask_b32 v237, 0, v237, vcc
    v_cndmask_b32 v238, 0, v238, vcc
    v_cndmask_b32 v239, 0, v239, vcc
    buffer_store_dwordx4 v[236:239], v250, s[8:11], s69 offen sc1
    v_mul_f32 v156, v156, v235
    v_mul_f32 v157, v157, v235
    v_mul_f32 v244, v156, v156
    v_mul_f32 v245, v157, v157
    v_fmamk_f32 v244, v244, 0xbdd2d3e8, v255
    v_fmamk_f32 v245, v245, 0xbdd2d3e8, v255
    v_mul_f32 v244, v244, v156
    v_mul_f32 v245, v245, v157
    v_exp_f32 v244, v244
    v_exp_f32 v245, v245
    v_add_f32 v244, 1.0, v244
    v_add_f32 v245, 1.0, v245
    v_rcp_f32 v244, v244
    v_rcp_f32 v245, v245
    v_mul_f32 v244, v244, v156
    v_mul_f32 v245, v245, v157
    v_cvt_pk_bf16_f32 v240, v244, v245
    v_mul_f32 v158, v158, v235
    v_mul_f32 v159, v159, v235
    v_mul_f32 v246, v158, v158
    v_mul_f32 v247, v159, v159
    v_fmamk_f32 v246, v246, 0xbdd2d3e8, v255
    v_fmamk_f32 v247, v247, 0xbdd2d3e8, v255
    v_mul_f32 v246, v246, v158
    v_mul_f32 v247, v247, v159
    v_exp_f32 v246, v246
    v_exp_f32 v247, v247
    v_add_f32 v246, 1.0, v246
    v_add_f32 v247, 1.0, v247
    v_rcp_f32 v246, v246
    v_rcp_f32 v247, v247
    v_mul_f32 v246, v246, v158
    v_mul_f32 v247, v247, v159
    v_cvt_pk_bf16_f32 v241, v246, v247
    v_mul_f32 v164, v164, v235
    v_mul_f32 v165, v165, v235
    v_mul_f32 v244, v164, v164
    v_mul_f32 v245, v165, v165
    v_fmamk_f32 v244, v244, 0xbdd2d3e8, v255
    v_fmamk_f32 v245, v245, 0xbdd2d3e8, v255
    v_mul_f32 v244, v244, v164
    v_mul_f32 v245, v245, v165
    v_exp_f32 v244, v244
    v_exp_f32 v245, v245
    v_add_f32 v244, 1.0, v244
    v_add_f32 v245, 1.0, v245
    v_rcp_f32 v244, v244
    v_rcp_f32 v245, v245
    v_mul_f32 v244, v244, v164
    v_mul_f32 v245, v245, v165
    v_cvt_pk_bf16_f32 v242, v244, v245
    v_mul_f32 v166, v166, v235
    v_mul_f32 v167, v167, v235
    v_mul_f32 v246, v166, v166
    v_mul_f32 v247, v167, v167
    v_fmamk_f32 v246, v246, 0xbdd2d3e8, v255
    v_fmamk_f32 v247, v247, 0xbdd2d3e8, v255
    v_mul_f32 v246, v246, v166
    v_mul_f32 v247, v247, v167
    v_exp_f32 v246, v246
    v_exp_f32 v247, v247
    v_add_f32 v246, 1.0, v246
    v_add_f32 v247, 1.0, v247
    v_rcp_f32 v246, v246
    v_rcp_f32 v247, v247
    v_mul_f32 v246, v246, v166
    v_mul_f32 v247, v247, v167
    v_cvt_pk_bf16_f32 v243, v246, v247
    v_add_u32 v248, s67, v233
    v_mov_b32 v249, 1
    v_cmp_le_u32 vcc, 144, v248
    s_nop 1
    v_cndmask_b32 v249, v249, -1, vcc
    v_cmp_le_u32 vcc, 288, v248
    s_nop 1
    v_cndmask_b32 v249, v249, 2, vcc
    v_cmp_le_u32 vcc, 432, v248
    s_nop 1
    v_cndmask_b32 v249, v249, -2, vcc
    v_add3_u32 v249, v249, v232, 16
    v_cmp_gt_u32 vcc, 2048, v249
    v_and_b32 v249, 2047, v249
    v_lshrrev_b32 v251, 4, v249
    v_mul_u32_u24 v251, 18432, v251
    v_and_b32 v249, 15, v249
    v_lshl_add_u32 v251, v249, 4, v251
    v_lshl_add_u32 v251, v233, 5, v251
    v_cndmask_b32 v240, 0, v240, vcc
    v_cndmask_b32 v241, 0, v241, vcc
    v_cndmask_b32 v242, 0, v242, vcc
    v_cndmask_b32 v243, 0, v243, vcc
    buffer_store_dwordx4 v[240:243], v251, s[8:11], s69 offen sc1
    s_mov_b32 s43, 1
    s_branch kmain_kernel_hq
kmain_kernel_h2:
    s_waitcnt vmcnt(63)
    s_barrier
    ds_read_b128 a[128:131], v3 offset:0
    ds_read_b128 a[132:135], v3 offset:1024
    ds_read_b128 a[136:139], v3 offset:2048
    ds_read_b128 a[140:143], v3 offset:3072
    ds_read_b128 a[144:147], v3 offset:4096
    ds_read_b128 a[148:151], v3 offset:5120
    ds_read_b128 a[152:155], v3 offset:6144
    ds_read_b128 a[156:159], v3 offset:7168
    ds_read_b128 a[160:163], v3 offset:8192
    s_waitcnt vmcnt(63)
    s_waitcnt lgkmcnt(6)
    v_mfma_f32_16x16x32_bf16 v[152:155], a[128:131], v[8:11], 0
    v_mfma_f32_16x16x32_bf16 v[152:155], a[132:135], v[16:19], v[152:155]
    ds_read_b128 a[164:167], v3 offset:9216
    v_mfma_f32_16x16x32_bf16 v[152:155], a[136:139], v[24:27], v[152:155]
    v_mfma_f32_16x16x32_bf16 v[156:159], a[128:131], v[12:15], 0
    ds_read_b128 a[168:171], v3 offset:10240
    v_mfma_f32_16x16x32_bf16 v[156:159], a[132:135], v[20:23], v[156:159]
    v_mfma_f32_16x16x32_bf16 v[156:159], a[136:139], v[28:31], v[156:159]
    ds_read_b128 a[172:175], v3 offset:11264
    s_waitcnt vmcnt(62)
    s_waitcnt lgkmcnt(6)
    v_mfma_f32_16x16x32_bf16 v[152:155], a[140:143], v[32:35], v[152:155]
    v_mfma_f32_16x16x32_bf16 v[152:155], a[144:147], v[40:43], v[152:155]
    ds_read_b128 a[128:131], v3 offset:12288
    v_mfma_f32_16x16x32_bf16 v[152:155], a[148:151], v[48:51], v[152:155]
    v_mfma_f32_16x16x32_bf16 v[156:159], a[140:143], v[36:39], v[156:159]
    ds_read_b128 a[132:135], v3 offset:13312
    v_mfma_f32_16x16x32_bf16 v[156:159], a[144:147], v[44:47], v[156:159]
    v_mfma_f32_16x16x32_bf16 v[156:159], a[148:151], v[52:55], v[156:159]
    ds_read_b128 a[136:139], v3 offset:14336
    s_waitcnt vmcnt(54)
    s_waitcnt lgkmcnt(6)
    v_mfma_f32_16x16x32_bf16 v[152:155], a[152:155], v[56:59], v[152:155]
    v_mfma_f32_16x16x32_bf16 v[152:155], a[156:159], v[64:67], v[152:155]
    ds_read_b128 a[140:143], v3 offset:15360
    v_mfma_f32_16x16x32_bf16 v[152:155], a[160:163], v[72:75], v[152:155]
    v_mfma_f32_16x16x32_bf16 v[156:159], a[152:155], v[60:63], v[156:159]
    ds_read_b128 a[144:147], v3 offset:16384
    v_mfma_f32_16x16x32_bf16 v[156:159], a[156:159], v[68:71], v[156:159]
    v_mfma_f32_16x16x32_bf16 v[156:159], a[160:163], v[76:79], v[156:159]
    ds_read_b128 a[148:151], v3 offset:17408
    s_waitcnt vmcnt(50)
    s_waitcnt lgkmcnt(6)
    v_mfma_f32_16x16x32_bf16 v[152:155], a[164:167], v[80:83], v[152:155]
    v_mfma_f32_16x16x32_bf16 v[152:155], a[168:171], v[88:91], v[152:155]
    ds_read_b128 a[152:155], v3 offset:18432
    v_mfma_f32_16x16x32_bf16 v[152:155], a[172:175], v[96:99], v[152:155]
    v_mfma_f32_16x16x32_bf16 v[156:159], a[164:167], v[84:87], v[156:159]
    ds_read_b128 a[156:159], v3 offset:19456
    v_mfma_f32_16x16x32_bf16 v[156:159], a[168:171], v[92:95], v[156:159]
    v_mfma_f32_16x16x32_bf16 v[156:159], a[172:175], v[100:103], v[156:159]
    ds_read_b128 a[160:163], v3 offset:20480
    s_waitcnt vmcnt(42)
    s_waitcnt lgkmcnt(6)
    v_mfma_f32_16x16x32_bf16 v[152:155], a[128:131], v[104:107], v[152:155]
    v_mfma_f32_16x16x32_bf16 v[152:155], a[132:135], v[112:115], v[152:155]
    ds_read_b128 a[164:167], v3 offset:21504
    v_mfma_f32_16x16x32_bf16 v[152:155], a[136:139], v[120:123], v[152:155]
    v_mfma_f32_16x16x32_bf16 v[156:159], a[128:131], v[108:111], v[156:159]
    ds_read_b128 a[168:171], v3 offset:22528
    v_mfma_f32_16x16x32_bf16 v[156:159], a[132:135], v[116:119], v[156:159]
    v_mfma_f32_16x16x32_bf16 v[156:159], a[136:139], v[124:127], v[156:159]
    ds_read_b128 a[172:175], v3 offset:23552
    s_waitcnt vmcnt(38)
    s_waitcnt lgkmcnt(6)
    v_mfma_f32_16x16x32_bf16 v[152:155], a[140:143], v[128:131], v[152:155]
    v_mfma_f32_16x16x32_bf16 v[152:155], a[144:147], v[136:139], v[152:155]
    ds_read_b128 a[128:131], v3 offset:24576
    v_mfma_f32_16x16x32_bf16 v[152:155], a[148:151], v[144:147], v[152:155]
    v_mfma_f32_16x16x32_bf16 v[156:159], a[140:143], v[132:135], v[156:159]
    ds_read_b128 a[132:135], v3 offset:25600
    v_mfma_f32_16x16x32_bf16 v[156:159], a[144:147], v[140:143], v[156:159]
    v_mfma_f32_16x16x32_bf16 v[156:159], a[148:151], v[148:151], v[156:159]
    ds_read_b128 a[136:139], v3 offset:26624
    s_waitcnt lgkmcnt(6)
    v_mfma_f32_16x16x32_bf16 v[160:163], a[152:155], v[8:11], 0
    v_mfma_f32_16x16x32_bf16 v[160:163], a[156:159], v[16:19], v[160:163]
    ds_read_b128 a[140:143], v3 offset:27648
    v_mfma_f32_16x16x32_bf16 v[160:163], a[160:163], v[24:27], v[160:163]
    v_mfma_f32_16x16x32_bf16 v[164:167], a[152:155], v[12:15], 0
    ds_read_b128 a[144:147], v3 offset:28672
    v_mfma_f32_16x16x32_bf16 v[164:167], a[156:159], v[20:23], v[164:167]
    v_mfma_f32_16x16x32_bf16 v[164:167], a[160:163], v[28:31], v[164:167]
    ds_read_b128 a[148:151], v3 offset:29696
    s_waitcnt lgkmcnt(6)
    v_mfma_f32_16x16x32_bf16 v[160:163], a[164:167], v[32:35], v[160:163]
    v_mfma_f32_16x16x32_bf16 v[160:163], a[168:171], v[40:43], v[160:163]
    ds_read_b128 a[152:155], v3 offset:30720
    v_mfma_f32_16x16x32_bf16 v[160:163], a[172:175], v[48:51], v[160:163]
    v_mfma_f32_16x16x32_bf16 v[164:167], a[164:167], v[36:39], v[164:167]
    ds_read_b128 a[156:159], v3 offset:31744
    v_mfma_f32_16x16x32_bf16 v[164:167], a[168:171], v[44:47], v[164:167]
    v_mfma_f32_16x16x32_bf16 v[164:167], a[172:175], v[52:55], v[164:167]
    ds_read_b128 a[160:163], v3 offset:32768
    s_waitcnt lgkmcnt(6)
    v_mfma_f32_16x16x32_bf16 v[160:163], a[128:131], v[56:59], v[160:163]
    v_mfma_f32_16x16x32_bf16 v[160:163], a[132:135], v[64:67], v[160:163]
    ds_read_b128 a[164:167], v3 offset:33792
    v_mfma_f32_16x16x32_bf16 v[160:163], a[136:139], v[72:75], v[160:163]
    v_mfma_f32_16x16x32_bf16 v[164:167], a[128:131], v[60:63], v[164:167]
    ds_read_b128 a[168:171], v3 offset:34816
    v_mfma_f32_16x16x32_bf16 v[164:167], a[132:135], v[68:71], v[164:167]
    v_mfma_f32_16x16x32_bf16 v[164:167], a[136:139], v[76:79], v[164:167]
    ds_read_b128 a[172:175], v3 offset:35840
    s_waitcnt lgkmcnt(6)
    v_mfma_f32_16x16x32_bf16 v[160:163], a[140:143], v[80:83], v[160:163]
    s_waitcnt vmcnt(29)
    s_barrier
    v_mfma_f32_16x16x32_bf16 v[160:163], a[144:147], v[88:91], v[160:163]
    ds_read_b128 a[128:131], v4 offset:0
    v_mfma_f32_16x16x32_bf16 v[160:163], a[148:151], v[96:99], v[160:163]
    v_mfma_f32_16x16x32_bf16 v[164:167], a[140:143], v[84:87], v[164:167]
    ds_read_b128 a[132:135], v4 offset:1024
    v_mfma_f32_16x16x32_bf16 v[164:167], a[144:147], v[92:95], v[164:167]
    v_mfma_f32_16x16x32_bf16 v[164:167], a[148:151], v[100:103], v[164:167]
    ds_read_b128 a[136:139], v4 offset:2048
    s_waitcnt lgkmcnt(6)
    v_mfma_f32_16x16x32_bf16 v[160:163], a[152:155], v[104:107], v[160:163]
    v_mfma_f32_16x16x32_bf16 v[160:163], a[156:159], v[112:115], v[160:163]
    ds_read_b128 a[140:143], v4 offset:3072
    v_mfma_f32_16x16x32_bf16 v[160:163], a[160:163], v[120:123], v[160:163]
    v_mfma_f32_16x16x32_bf16 v[164:167], a[152:155], v[108:111], v[164:167]
    ds_read_b128 a[144:147], v4 offset:4096
    v_mfma_f32_16x16x32_bf16 v[164:167], a[156:159], v[116:119], v[164:167]
    v_mfma_f32_16x16x32_bf16 v[164:167], a[160:163], v[124:127], v[164:167]
    ds_read_b128 a[148:151], v4 offset:5120
    s_waitcnt lgkmcnt(6)
    v_mfma_f32_16x16x32_bf16 v[160:163], a[164:167], v[128:131], v[160:163]
    v_mfma_f32_16x16x32_bf16 v[160:163], a[168:171], v[136:139], v[160:163]
    ds_read_b128 a[152:155], v4 offset:6144
    v_mfma_f32_16x16x32_bf16 v[160:163], a[172:175], v[144:147], v[160:163]
    v_mfma_f32_16x16x32_bf16 v[164:167], a[164:167], v[132:135], v[164:167]
    ds_read_b128 a[156:159], v4 offset:7168
    v_mfma_f32_16x16x32_bf16 v[164:167], a[168:171], v[140:143], v[164:167]
    v_mfma_f32_16x16x32_bf16 v[164:167], a[172:175], v[148:151], v[164:167]
    ds_read_b128 a[160:163], v4 offset:8192
    s_waitcnt lgkmcnt(6)
    v_mfma_f32_16x16x32_bf16 v[168:171], a[128:131], v[8:11], 0
    v_mfma_f32_16x16x32_bf16 v[168:171], a[132:135], v[16:19], v[168:171]
    ds_read_b128 a[164:167], v4 offset:9216
    v_mul_f32 v152, v152, v234
    v_mul_f32 v153, v153, v234
    v_mul_f32 v244, v152, v152
    v_mfma_f32_16x16x32_bf16 v[168:171], a[136:139], v[24:27], v[168:171]
    v_mul_f32 v245, v153, v153
    v_fmamk_f32 v244, v244, 0xbdd2d3e8, v255
    v_fmamk_f32 v245, v245, 0xbdd2d3e8, v255
    v_mfma_f32_16x16x32_bf16 v[172:175], a[128:131], v[12:15], 0
    ds_read_b128 a[168:171], v4 offset:10240
    v_mul_f32 v244, v244, v152
    v_mul_f32 v245, v245, v153
    v_mfma_f32_16x16x32_bf16 v[172:175], a[132:135], v[20:23], v[172:175]
    v_exp_f32 v244, v244
    v_exp_f32 v245, v245
    v_mfma_f32_16x16x32_bf16 v[172:175], a[136:139], v[28:31], v[172:175]
    ds_read_b128 a[172:175], v4 offset:11264
    v_add_f32 v244, 1.0, v244
    v_add_f32 v245, 1.0, v245
    s_waitcnt lgkmcnt(6)
    v_mfma_f32_16x16x32_bf16 v[168:171], a[140:143], v[32:35], v[168:171]
    v_rcp_f32 v244, v244
    v_rcp_f32 v245, v245
    v_mfma_f32_16x16x32_bf16 v[168:171], a[144:147], v[40:43], v[168:171]
    ds_read_b128 a[128:131], v4 offset:12288
    v_mul_f32 v244, v244, v152
    v_mul_f32 v245, v245, v153
    v_mfma_f32_16x16x32_bf16 v[168:171], a[148:151], v[48:51], v[168:171]
    v_cvt_pk_bf16_f32 v236, v244, v245
    v_mul_f32 v154, v154, v234
    v_mul_f32 v155, v155, v234
    v_mfma_f32_16x16x32_bf16 v[172:175], a[140:143], v[36:39], v[172:175]
    ds_read_b128 a[132:135], v4 offset:13312
    v_mul_f32 v246, v154, v154
    v_mul_f32 v247, v155, v155
    v_fmamk_f32 v246, v246, 0xbdd2d3e8, v255
    v_mfma_f32_16x16x32_bf16 v[172:175], a[144:147], v[44:47], v[172:175]
    v_fmamk_f32 v247, v247, 0xbdd2d3e8, v255
    v_mul_f32 v246, v246, v154
    v_mul_f32 v247, v247, v155
    v_mfma_f32_16x16x32_bf16 v[172:175], a[148:151], v[52:55], v[172:175]
    ds_read_b128 a[136:139], v4 offset:14336
    v_exp_f32 v246, v246
    s_waitcnt lgkmcnt(6)
    v_mfma_f32_16x16x32_bf16 v[168:171], a[152:155], v[56:59], v[168:171]
    v_exp_f32 v247, v247
    v_add_f32 v246, 1.0, v246
    v_add_f32 v247, 1.0, v247
    v_mfma_f32_16x16x32_bf16 v[168:171], a[156:159], v[64:67], v[168:171]
    ds_read_b128 a[140:143], v4 offset:15360
    v_rcp_f32 v246, v246
    v_mfma_f32_16x16x32_bf16 v[168:171], a[160:163], v[72:75], v[168:171]
    v_rcp_f32 v247, v247
    v_mul_f32 v246, v246, v154
    v_mul_f32 v247, v247, v155
    v_mfma_f32_16x16x32_bf16 v[172:175], a[152:155], v[60:63], v[172:175]
    ds_read_b128 a[144:147], v4 offset:16384
    v_cvt_pk_bf16_f32 v237, v246, v247
    v_mul_f32 v160, v160, v234
    v_mfma_f32_16x16x32_bf16 v[172:175], a[156:159], v[68:71], v[172:175]
    v_mul_f32 v161, v161, v234
    v_mul_f32 v244, v160, v160
    v_mul_f32 v245, v161, v161
    v_fmamk_f32 v244, v244, 0xbdd2d3e8, v255
    v_mfma_f32_16x16x32_bf16 v[172:175], a[160:163], v[76:79], v[172:175]
    ds_read_b128 a[148:151], v4 offset:17408
    v_fmamk_f32 v245, v245, 0xbdd2d3e8, v255
    s_waitcnt lgkmcnt(6)
    v_mfma_f32_16x16x32_bf16 v[168:171], a[164:167], v[80:83], v[168:171]
    v_mul_f32 v244, v244, v160
    v_mul_f32 v245, v245, v161
    v_exp_f32 v244, v244
    v_mfma_f32_16x16x32_bf16 v[168:171], a[168:171], v[88:91], v[168:171]
    ds_read_b128 a[152:155], v4 offset:18432
    v_exp_f32 v245, v245
    v_mfma_f32_16x16x32_bf16 v[168:171], a[172:175], v[96:99], v[168:171]
    v_add_f32 v244, 1.0, v244
    v_add_f32 v245, 1.0, v245
    v_rcp_f32 v244, v244
    v_mfma_f32_16x16x32_bf16 v[172:175], a[164:167], v[84:87], v[172:175]
    ds_read_b128 a[156:159], v4 offset:19456
    v_rcp_f32 v245, v245
    v_mul_f32 v244, v244, v160
    v_mfma_f32_16x16x32_bf16 v[172:175], a[168:171], v[92:95], v[172:175]
    v_mul_f32 v245, v245, v161
    v_cvt_pk_bf16_f32 v238, v244, v245
    v_mul_f32 v162, v162, v234
    v_mfma_f32_16x16x32_bf16 v[172:175], a[172:175], v[100:103], v[172:175]
    ds_read_b128 a[160:163], v4 offset:20480
    v_mul_f32 v163, v163, v234
    v_mul_f32 v246, v162, v162
    s_waitcnt lgkmcnt(6)
    v_mfma_f32_16x16x32_bf16 v[168:171], a[128:131], v[104:107], v[168:171]
    v_mul_f32 v247, v163, v163
    v_fmamk_f32 v246, v246, 0xbdd2d3e8, v255
    v_fmamk_f32 v247, v247, 0xbdd2d3e8, v255
    v_mfma_f32_16x16x32_bf16 v[168:171], a[132:135], v[112:115], v[168:171]
    ds_read_b128 a[164:167], v4 offset:21504
    v_mul_f32 v246, v246, v162
    v_mul_f32 v247, v247, v163
    v_mfma_f32_16x16x32_bf16 v[168:171], a[136:139], v[120:123], v[168:171]
    v_exp_f32 v246, v246
    v_exp_f32 v247, v247
    v_mfma_f32_16x16x32_bf16 v[172:175], a[128:131], v[108:111], v[172:175]
    ds_read_b128 a[168:171], v4 offset:22528
    v_add_f32 v246, 1.0, v246
    v_add_f32 v247, 1.0, v247
    v_mfma_f32_16x16x32_bf16 v[172:175], a[132:135], v[116:119], v[172:175]
    v_rcp_f32 v246, v246
    v_rcp_f32 v247, v247
    v_mfma_f32_16x16x32_bf16 v[172:175], a[136:139], v[124:127], v[172:175]
    ds_read_b128 a[172:175], v4 offset:23552
    v_mul_f32 v246, v246, v162
    v_mul_f32 v247, v247, v163
    s_waitcnt lgkmcnt(6)
    v_mfma_f32_16x16x32_bf16 v[168:171], a[140:143], v[128:131], v[168:171]
    v_cvt_pk_bf16_f32 v239, v246, v247
    v_add_u32 v248, s67, v233
    v_mov_b32 v249, 1
    v_mfma_f32_16x16x32_bf16 v[168:171], a[144:147], v[136:139], v[168:171]
    ds_read_b128 a[128:131], v4 offset:24576
    v_cmp_le_u32 vcc, 144, v248
    s_nop 1
    v_cndmask_b32 v249, v249, -1, vcc
    v_cmp_le_u32 vcc, 288, v248
    v_mfma_f32_16x16x32_bf16 v[168:171], a[148:151], v[144:147], v[168:171]
    s_nop 0
    v_cndmask_b32 v249, v249, 2, vcc
    v_cmp_le_u32 vcc, 432, v248
    s_nop 1
    v_cndmask_b32 v249, v249, -2, vcc
    v_add3_u32 v249, v249, v232, 0
    v_mfma_f32_16x16x32_bf16 v[172:175], a[140:143], v[132:135], v[172:175]
    ds_read_b128 a[132:135], v4 offset:25600
    v_cmp_gt_u32 vcc, 2048, v249
    v_and_b32 v249, 2047, v249
    v_mfma_f32_16x16x32_bf16 v[172:175], a[144:147], v[140:143], v[172:175]
    v_lshrrev_b32 v250, 4, v249
    v_mul_u32_u24 v250, 18432, v250
    v_and_b32 v249, 15, v249
    v_lshl_add_u32 v250, v249, 4, v250
    v_mfma_f32_16x16x32_bf16 v[172:175], a[148:151], v[148:151], v[172:175]
    ds_read_b128 a[136:139], v4 offset:26624
    v_lshl_add_u32 v250, v233, 5, v250
    s_waitcnt lgkmcnt(6)
    v_mfma_f32_16x16x32_bf16 v[176:179], a[152:155], v[8:11], 0
    v_cndmask_b32 v236, 0, v236, vcc
    v_cndmask_b32 v237, 0, v237, vcc
    v_cndmask_b32 v238, 0, v238, vcc
    v_cndmask_b32 v239, 0, v239, vcc
    v_mfma_f32_16x16x32_bf16 v[176:179], a[156:159], v[16:19], v[176:179]
    ds_read_b128 a[140:143], v4 offset:27648
    buffer_store_dwordx4 v[236:239], v250, s[8:11], s69 offen sc1
    v_mfma_f32_16x16x32_bf16 v[176:179], a[160:163], v[24:27], v[176:179]
    v_mul_f32 v156, v156, v235
    v_mul_f32 v157, v157, v235
    v_mul_f32 v244, v156, v156
    v_mfma_f32_16x16x32_bf16 v[180:183], a[152:155], v[12:15], 0
    ds_read_b128 a[144:147], v4 offset:28672
    v_mul_f32 v245, v157, v157
    v_fmamk_f32 v244, v244, 0xbdd2d3e8, v255
    v_mfma_f32_16x16x32_bf16 v[180:183], a[156:159], v[20:23], v[180:183]
    v_fmamk_f32 v245, v245, 0xbdd2d3e8, v255
    v_mul_f32 v244, v244, v156
    v_mul_f32 v245, v245, v157
    v_mfma_f32_16x16x32_bf16 v[180:183], a[160:163], v[28:31], v[180:183]
    ds_read_b128 a[148:151], v4 offset:29696
    v_exp_f32 v244, v244
    s_waitcnt lgkmcnt(6)
    v_mfma_f32_16x16x32_bf16 v[176:179], a[164:167], v[32:35], v[176:179]
    v_exp_f32 v245, v245
    v_add_f32 v244, 1.0, v244
    v_add_f32 v245, 1.0, v245
    v_mfma_f32_16x16x32_bf16 v[176:179], a[168:171], v[40:43], v[176:179]
    ds_read_b128 a[152:155], v4 offset:30720
    v_rcp_f32 v244, v244
    v_mfma_f32_16x16x32_bf16 v[176:179], a[172:175], v[48:51], v[176:179]
    v_rcp_f32 v245, v245
    v_mul_f32 v244, v244, v156
    v_mul_f32 v245, v245, v157
    v_mfma_f32_16x16x32_bf16 v[180:183], a[164:167], v[36:39], v[180:183]
    ds_read_b128 a[156:159], v4 offset:31744
    v_cvt_pk_bf16_f32 v240, v244, v245
    v_mul_f32 v158, v158, v235
    v_mul_f32 v159, v159, v235
    v_mfma_f32_16x16x32_bf16 v[180:183], a[168:171], v[44:47], v[180:183]
    v_mul_f32 v246, v158, v158
    v_mul_f32 v247, v159, v159
    v_fmamk_f32 v246, v246, 0xbdd2d3e8, v255
    v_mfma_f32_16x16x32_bf16 v[180:183], a[172:175], v[52:55], v[180:183]
    ds_read_b128 a[160:163], v4 offset:32768
    v_fmamk_f32 v247, v247, 0xbdd2d3e8, v255
    v_mul_f32 v246, v246, v158
    s_waitcnt lgkmcnt(6)
    v_mfma_f32_16x16x32_bf16 v[176:179], a[128:131], v[56:59], v[176:179]
    v_mul_f32 v247, v247, v159
    v_exp_f32 v246, v246
    v_mfma_f32_16x16x32_bf16 v[176:179], a[132:135], v[64:67], v[176:179]
    ds_read_b128 a[164:167], v4 offset:33792
    v_exp_f32 v247, v247
    v_add_f32 v246, 1.0, v246
    v_mfma_f32_16x16x32_bf16 v[176:179], a[136:139], v[72:75], v[176:179]
    v_add_f32 v247, 1.0, v247
    v_rcp_f32 v246, v246
    v_mfma_f32_16x16x32_bf16 v[180:183], a[128:131], v[60:63], v[180:183]
    ds_read_b128 a[168:171], v4 offset:34816
    v_rcp_f32 v247, v247
    v_mul_f32 v246, v246, v158
    v_mfma_f32_16x16x32_bf16 v[180:183], a[132:135], v[68:71], v[180:183]
    v_mul_f32 v247, v247, v159
    v_cvt_pk_bf16_f32 v241, v246, v247
    v_mul_f32 v164, v164, v235
    v_mul_f32 v165, v165, v235
    v_mfma_f32_16x16x32_bf16 v[180:183], a[136:139], v[76:79], v[180:183]
    ds_read_b128 a[172:175], v4 offset:35840
    v_mul_f32 v244, v164, v164
    s_waitcnt lgkmcnt(6)
    v_mfma_f32_16x16x32_bf16 v[176:179], a[140:143], v[80:83], v[176:179]
    v_mul_f32 v245, v165, v165
    v_fmamk_f32 v244, v244, 0xbdd2d3e8, v255
    v_fmamk_f32 v245, v245, 0xbdd2d3e8, v255
    v_mul_f32 v244, v244, v164
    v_mfma_f32_16x16x32_bf16 v[176:179], a[144:147], v[88:91], v[176:179]
    v_mul_f32 v245, v245, v165
    v_exp_f32 v244, v244
    v_mfma_f32_16x16x32_bf16 v[176:179], a[148:151], v[96:99], v[176:179]
    v_exp_f32 v245, v245
    v_add_f32 v244, 1.0, v244
    v_add_f32 v245, 1.0, v245
    v_mfma_f32_16x16x32_bf16 v[180:183], a[140:143], v[84:87], v[180:183]
    v_rcp_f32 v244, v244
    v_rcp_f32 v245, v245
    v_mfma_f32_16x16x32_bf16 v[180:183], a[144:147], v[92:95], v[180:183]
    v_mul_f32 v244, v244, v164
    v_mul_f32 v245, v245, v165
    v_cvt_pk_bf16_f32 v242, v244, v245
    v_mfma_f32_16x16x32_bf16 v[180:183], a[148:151], v[100:103], v[180:183]
    v_mul_f32 v166, v166, v235
    v_mul_f32 v167, v167, v235
    s_waitcnt lgkmcnt(3)
    v_mfma_f32_16x16x32_bf16 v[176:179], a[152:155], v[104:107], v[176:179]
    v_mul_f32 v246, v166, v166
    v_mul_f32 v247, v167, v167
    v_fmamk_f32 v246, v246, 0xbdd2d3e8, v255
    v_fmamk_f32 v247, v247, 0xbdd2d3e8, v255
    v_mfma_f32_16x16x32_bf16 v[176:179], a[156:159], v[112:115], v[176:179]
    v_mul_f32 v246, v246, v166
    v_mul_f32 v247, v247, v167
    v_exp_f32 v246, v246
    v_mfma_f32_16x16x32_bf16 v[176:179], a[160:163], v[120:123], v[176:179]
    v_exp_f32 v247, v247
    v_add_f32 v246, 1.0, v246
    v_mfma_f32_16x16x32_bf16 v[180:183], a[152:155], v[108:111], v[180:183]
    v_add_f32 v247, 1.0, v247
    v_rcp_f32 v246, v246
    v_mfma_f32_16x16x32_bf16 v[180:183], a[156:159], v[116:119], v[180:183]
    v_rcp_f32 v247, v247
    v_mul_f32 v246, v246, v166
    v_mul_f32 v247, v247, v167
    v_mfma_f32_16x16x32_bf16 v[180:183], a[160:163], v[124:127], v[180:183]
    v_cvt_pk_bf16_f32 v243, v246, v247
    v_add_u32 v248, s67, v233
    v_mov_b32 v249, 1
    s_waitcnt lgkmcnt(0)
    v_mfma_f32_16x16x32_bf16 v[176:179], a[164:167], v[128:131], v[176:179]
    v_cmp_le_u32 vcc, 144, v248
    s_nop 1
    v_cndmask_b32 v249, v249, -1, vcc
    v_cmp_le_u32 vcc, 288, v248
    v_mfma_f32_16x16x32_bf16 v[176:179], a[168:171], v[136:139], v[176:179]
    s_nop 0
    v_cndmask_b32 v249, v249, 2, vcc
    v_cmp_le_u32 vcc, 432, v248
    s_nop 1
    v_cndmask_b32 v249, v249, -2, vcc
    v_add3_u32 v249, v249, v232, 16
    v_mfma_f32_16x16x32_bf16 v[176:179], a[172:175], v[144:147], v[176:179]
    v_cmp_gt_u32 vcc, 2048, v249
    v_and_b32 v249, 2047, v249
    v_lshrrev_b32 v251, 4, v249
    v_mfma_f32_16x16x32_bf16 v[180:183], a[164:167], v[132:135], v[180:183]
    v_mul_u32_u24 v251, 18432, v251
    v_and_b32 v249, 15, v249
    v_lshl_add_u32 v251, v249, 4, v251
    v_lshl_add_u32 v251, v233, 5, v251
    v_mfma_f32_16x16x32_bf16 v[180:183], a[168:171], v[140:143], v[180:183]
    v_cndmask_b32 v240, 0, v240, vcc
    v_cndmask_b32 v241, 0, v241, vcc
    v_cndmask_b32 v242, 0, v242, vcc
    v_mfma_f32_16x16x32_bf16 v[180:183], a[172:175], v[148:151], v[180:183]
    v_cndmask_b32 v243, 0, v243, vcc
    buffer_store_dwordx4 v[240:243], v251, s[8:11], s69 offen sc1
    v_mul_f32 v168, v168, v234
    v_mul_f32 v169, v169, v234
    v_mul_f32 v244, v168, v168
    v_mul_f32 v245, v169, v169
    v_fmamk_f32 v244, v244, 0xbdd2d3e8, v255
    v_fmamk_f32 v245, v245, 0xbdd2d3e8, v255
    v_mul_f32 v244, v244, v168
    v_mul_f32 v245, v245, v169
    v_exp_f32 v244, v244
    v_exp_f32 v245, v245
    v_add_f32 v244, 1.0, v244
    v_add_f32 v245, 1.0, v245
    v_rcp_f32 v244, v244
    v_rcp_f32 v245, v245
    v_mul_f32 v244, v244, v168
    v_mul_f32 v245, v245, v169
    v_cvt_pk_bf16_f32 v236, v244, v245
    v_mul_f32 v170, v170, v234
    v_mul_f32 v171, v171, v234
    v_mul_f32 v246, v170, v170
    v_mul_f32 v247, v171, v171
    v_fmamk_f32 v246, v246, 0xbdd2d3e8, v255
    v_fmamk_f32 v247, v247, 0xbdd2d3e8, v255
    v_mul_f32 v246, v246, v170
    v_mul_f32 v247, v247, v171
    v_exp_f32 v246, v246
    v_exp_f32 v247, v247
    v_add_f32 v246, 1.0, v246
    v_add_f32 v247, 1.0, v247
    v_rcp_f32 v246, v246
    v_rcp_f32 v247, v247
    v_mul_f32 v246, v246, v170
    v_mul_f32 v247, v247, v171
    v_cvt_pk_bf16_f32 v237, v246, v247
    v_mul_f32 v176, v176, v234
    v_mul_f32 v177, v177, v234
    v_mul_f32 v244, v176, v176
    v_mul_f32 v245, v177, v177
    v_fmamk_f32 v244, v244, 0xbdd2d3e8, v255
    v_fmamk_f32 v245, v245, 0xbdd2d3e8, v255
    v_mul_f32 v244, v244, v176
    v_mul_f32 v245, v245, v177
    v_exp_f32 v244, v244
    v_exp_f32 v245, v245
    v_add_f32 v244, 1.0, v244
    v_add_f32 v245, 1.0, v245
    v_rcp_f32 v244, v244
    v_rcp_f32 v245, v245
    v_mul_f32 v244, v244, v176
    v_mul_f32 v245, v245, v177
    v_cvt_pk_bf16_f32 v238, v244, v245
    v_mul_f32 v178, v178, v234
    v_mul_f32 v179, v179, v234
    v_mul_f32 v246, v178, v178
    v_mul_f32 v247, v179, v179
    v_fmamk_f32 v246, v246, 0xbdd2d3e8, v255
    v_fmamk_f32 v247, v247, 0xbdd2d3e8, v255
    v_mul_f32 v246, v246, v178
    v_mul_f32 v247, v247, v179
    v_exp_f32 v246, v246
    v_exp_f32 v247, v247
    v_add_f32 v246, 1.0, v246
    v_add_f32 v247, 1.0, v247
    v_rcp_f32 v246, v246
    v_rcp_f32 v247, v247
    v_mul_f32 v246, v246, v178
    v_mul_f32 v247, v247, v179
    v_cvt_pk_bf16_f32 v239, v246, v247
    v_add_u32 v248, s68, v233
    v_mov_b32 v249, 1
    v_cmp_le_u32 vcc, 144, v248
    s_nop 1
    v_cndmask_b32 v249, v249, -1, vcc
    v_cmp_le_u32 vcc, 288, v248
    s_nop 1
    v_cndmask_b32 v249, v249, 2, vcc
    v_cmp_le_u32 vcc, 432, v248
    s_nop 1
    v_cndmask_b32 v249, v249, -2, vcc
    v_add3_u32 v249, v249, v232, 0
    v_cmp_gt_u32 vcc, 2048, v249
    v_and_b32 v249, 2047, v249
    v_lshrrev_b32 v250, 4, v249
    v_mul_u32_u24 v250, 18432, v250
    v_and_b32 v249, 15, v249
    v_lshl_add_u32 v250, v249, 4, v250
    v_lshl_add_u32 v250, v233, 5, v250
    v_cndmask_b32 v236, 0, v236, vcc
    v_cndmask_b32 v237, 0, v237, vcc
    v_cndmask_b32 v238, 0, v238, vcc
    v_cndmask_b32 v239, 0, v239, vcc
    buffer_store_dwordx4 v[236:239], v250, s[8:11], s70 offen sc1
    v_mul_f32 v172, v172, v235
    v_mul_f32 v173, v173, v235
    v_mul_f32 v244, v172, v172
    v_mul_f32 v245, v173, v173
    v_fmamk_f32 v244, v244, 0xbdd2d3e8, v255
    v_fmamk_f32 v245, v245, 0xbdd2d3e8, v255
    v_mul_f32 v244, v244, v172
    v_mul_f32 v245, v245, v173
    v_exp_f32 v244, v244
    v_exp_f32 v245, v245
    v_add_f32 v244, 1.0, v244
    v_add_f32 v245, 1.0, v245
    v_rcp_f32 v244, v244
    v_rcp_f32 v245, v245
    v_mul_f32 v244, v244, v172
    v_mul_f32 v245, v245, v173
    v_cvt_pk_bf16_f32 v240, v244, v245
    v_mul_f32 v174, v174, v235
    v_mul_f32 v175, v175, v235
    v_mul_f32 v246, v174, v174
    v_mul_f32 v247, v175, v175
    v_fmamk_f32 v246, v246, 0xbdd2d3e8, v255
    v_fmamk_f32 v247, v247, 0xbdd2d3e8, v255
    v_mul_f32 v246, v246, v174
    v_mul_f32 v247, v247, v175
    v_exp_f32 v246, v246
    v_exp_f32 v247, v247
    v_add_f32 v246, 1.0, v246
    v_add_f32 v247, 1.0, v247
    v_rcp_f32 v246, v246
    v_rcp_f32 v247, v247
    v_mul_f32 v246, v246, v174
    v_mul_f32 v247, v247, v175
    v_cvt_pk_bf16_f32 v241, v246, v247
    v_mul_f32 v180, v180, v235
    v_mul_f32 v181, v181, v235
    v_mul_f32 v244, v180, v180
    v_mul_f32 v245, v181, v181
    v_fmamk_f32 v244, v244, 0xbdd2d3e8, v255
    v_fmamk_f32 v245, v245, 0xbdd2d3e8, v255
    v_mul_f32 v244, v244, v180
    v_mul_f32 v245, v245, v181
    v_exp_f32 v244, v244
    v_exp_f32 v245, v245
    v_add_f32 v244, 1.0, v244
    v_add_f32 v245, 1.0, v245
    v_rcp_f32 v244, v244
    v_rcp_f32 v245, v245
    v_mul_f32 v244, v244, v180
    v_mul_f32 v245, v245, v181
    v_cvt_pk_bf16_f32 v242, v244, v245
    v_mul_f32 v182, v182, v235
    v_mul_f32 v183, v183, v235
    v_mul_f32 v246, v182, v182
    v_mul_f32 v247, v183, v183
    v_fmamk_f32 v246, v246, 0xbdd2d3e8, v255
    v_fmamk_f32 v247, v247, 0xbdd2d3e8, v255
    v_mul_f32 v246, v246, v182
    v_mul_f32 v247, v247, v183
    v_exp_f32 v246, v246
    v_exp_f32 v247, v247
    v_add_f32 v246, 1.0, v246
    v_add_f32 v247, 1.0, v247
    v_rcp_f32 v246, v246
    v_rcp_f32 v247, v247
    v_mul_f32 v246, v246, v182
    v_mul_f32 v247, v247, v183
    v_cvt_pk_bf16_f32 v243, v246, v247
    v_add_u32 v248, s68, v233
    v_mov_b32 v249, 1
    v_cmp_le_u32 vcc, 144, v248
    s_nop 1
    v_cndmask_b32 v249, v249, -1, vcc
    v_cmp_le_u32 vcc, 288, v248
    s_nop 1
    v_cndmask_b32 v249, v249, 2, vcc
    v_cmp_le_u32 vcc, 432, v248
    s_nop 1
    v_cndmask_b32 v249, v249, -2, vcc
    v_add3_u32 v249, v249, v232, 16
    v_cmp_gt_u32 vcc, 2048, v249
    v_and_b32 v249, 2047, v249
    v_lshrrev_b32 v251, 4, v249
    v_mul_u32_u24 v251, 18432, v251
    v_and_b32 v249, 15, v249
    v_lshl_add_u32 v251, v249, 4, v251
    v_lshl_add_u32 v251, v233, 5, v251
    v_cndmask_b32 v240, 0, v240, vcc
    v_cndmask_b32 v241, 0, v241, vcc
    v_cndmask_b32 v242, 0, v242, vcc
    v_cndmask_b32 v243, 0, v243, vcc
    buffer_store_dwordx4 v[240:243], v251, s[8:11], s70 offen sc1
    s_mov_b32 s43, 2
kmain_kernel_hq:
    s_waitcnt vmcnt(22)
    s_barrier
    ds_read_b128 a[128:131], v5 offset:0
    ds_read_b128 a[132:135], v5 offset:1024
    ds_read_b128 a[136:139], v5 offset:2048
    ds_read_b128 a[140:143], v5 offset:3072
    ds_read_b128 a[144:147], v5 offset:4096
    ds_read_b128 a[148:151], v5 offset:5120
    ds_read_b128 a[152:155], v5 offset:6144
    ds_read_b128 a[156:159], v5 offset:7168
    ds_read_b128 a[160:163], v5 offset:8192
    s_waitcnt lgkmcnt(6)
    v_mfma_f32_16x16x32_bf16 v[152:155], a[128:131], v[8:11], 0
    s_add_u32 m0, s21, 0
    v_mfma_f32_16x16x32_bf16 v[152:155], a[132:135], v[16:19], v[152:155]
    ds_read_b128 a[164:167], v5 offset:9216
    s_add_u32 s22, s20, 73728
    v_mfma_f32_16x16x32_bf16 v[152:155], a[136:139], v[24:27], v[152:155]
    buffer_load_dwordx4 v2, s[8:11], s22 offen offset:0 lds
    v_mfma_f32_16x16x32_bf16 v[156:159], a[128:131], v[12:15], 0
    ds_read_b128 a[168:171], v5 offset:10240
    v_mfma_f32_16x16x32_bf16 v[156:159], a[132:135], v[20:23], v[156:159]
    buffer_load_dwordx4 v2, s[8:11], s22 offen offset:1024 lds
    v_mfma_f32_16x16x32_bf16 v[156:159], a[136:139], v[28:31], v[156:159]
    ds_read_b128 a[172:175], v5 offset:11264
    s_waitcnt lgkmcnt(6)
    v_mfma_f32_16x16x32_bf16 v[152:155], a[140:143], v[32:35], v[152:155]
    buffer_load_dwordx4 v2, s[8:11], s22 offen offset:2048 lds
    v_mfma_f32_16x16x32_bf16 v[152:155], a[144:147], v[40:43], v[152:155]
    ds_read_b128 a[128:131], v5 offset:12288
    buffer_load_dwordx4 v2, s[8:11], s22 offen offset:3072 lds
    v_mfma_f32_16x16x32_bf16 v[152:155], a[148:151], v[48:51], v[152:155]
    s_add_u32 m0, s21, 4096
    v_mfma_f32_16x16x32_bf16 v[156:159], a[140:143], v[36:39], v[156:159]
    ds_read_b128 a[132:135], v5 offset:13312
    v_mfma_f32_16x16x32_bf16 v[156:159], a[144:147], v[44:47], v[156:159]
    s_add_u32 s22, s20, 77824
    v_mfma_f32_16x16x32_bf16 v[156:159], a[148:151], v[52:55], v[156:159]
    ds_read_b128 a[136:139], v5 offset:14336
    s_waitcnt lgkmcnt(6)
    v_mfma_f32_16x16x32_bf16 v[152:155], a[152:155], v[56:59], v[152:155]
    buffer_load_dwordx4 v2, s[8:11], s22 offen offset:0 lds
    v_mfma_f32_16x16x32_bf16 v[152:155], a[156:159], v[64:67], v[152:155]
    ds_read_b128 a[140:143], v5 offset:15360
    buffer_load_dwordx4 v2, s[8:11], s22 offen offset:1024 lds
    v_mfma_f32_16x16x32_bf16 v[152:155], a[160:163], v[72:75], v[152:155]
    buffer_load_dwordx4 v2, s[8:11], s22 offen offset:2048 lds
    v_mfma_f32_16x16x32_bf16 v[156:159], a[152:155], v[60:63], v[156:159]
    ds_read_b128 a[144:147], v5 offset:16384
    v_mfma_f32_16x16x32_bf16 v[156:159], a[156:159], v[68:71], v[156:159]
    buffer_load_dwordx4 v2, s[8:11], s22 offen offset:3072 lds
    v_mfma_f32_16x16x32_bf16 v[156:159], a[160:163], v[76:79], v[156:159]
    ds_read_b128 a[148:151], v5 offset:17408
    s_waitcnt lgkmcnt(6)
    v_mfma_f32_16x16x32_bf16 v[152:155], a[164:167], v[80:83], v[152:155]
    s_add_u32 m0, s21, 8192
    s_add_u32 s22, s20, 81920
    v_mfma_f32_16x16x32_bf16 v[152:155], a[168:171], v[88:91], v[152:155]
    ds_read_b128 a[152:155], v5 offset:18432
    v_mfma_f32_16x16x32_bf16 v[152:155], a[172:175], v[96:99], v[152:155]
    buffer_load_dwordx4 v2, s[8:11], s22 offen offset:0 lds
    v_mfma_f32_16x16x32_bf16 v[156:159], a[164:167], v[84:87], v[156:159]
    ds_read_b128 a[156:159], v5 offset:19456
    v_mfma_f32_16x16x32_bf16 v[156:159], a[168:171], v[92:95], v[156:159]
    v_mfma_f32_16x16x32_bf16 v[156:159], a[172:175], v[100:103], v[156:159]
    ds_read_b128 a[160:163], v5 offset:20480
    s_waitcnt lgkmcnt(6)
    v_mfma_f32_16x16x32_bf16 v[152:155], a[128:131], v[104:107], v[152:155]
    v_mfma_f32_16x16x32_bf16 v[152:155], a[132:135], v[112:115], v[152:155]
    ds_read_b128 a[164:167], v5 offset:21504
    v_mfma_f32_16x16x32_bf16 v[152:155], a[136:139], v[120:123], v[152:155]
    v_mfma_f32_16x16x32_bf16 v[156:159], a[128:131], v[108:111], v[156:159]
    ds_read_b128 a[168:171], v5 offset:22528
    v_mfma_f32_16x16x32_bf16 v[156:159], a[132:135], v[116:119], v[156:159]
    v_mfma_f32_16x16x32_bf16 v[156:159], a[136:139], v[124:127], v[156:159]
    ds_read_b128 a[172:175], v5 offset:23552
    s_waitcnt lgkmcnt(6)
    v_mfma_f32_16x16x32_bf16 v[152:155], a[140:143], v[128:131], v[152:155]
    v_mfma_f32_16x16x32_bf16 v[152:155], a[144:147], v[136:139], v[152:155]
    ds_read_b128 a[128:131], v5 offset:24576
    v_mfma_f32_16x16x32_bf16 v[152:155], a[148:151], v[144:147], v[152:155]
    v_mfma_f32_16x16x32_bf16 v[156:159], a[140:143], v[132:135], v[156:159]
    ds_read_b128 a[132:135], v5 offset:25600
    v_mfma_f32_16x16x32_bf16 v[156:159], a[144:147], v[140:143], v[156:159]
    v_mfma_f32_16x16x32_bf16 v[156:159], a[148:151], v[148:151], v[156:159]
    ds_read_b128 a[136:139], v5 offset:26624
    s_waitcnt lgkmcnt(6)
    v_mfma_f32_16x16x32_bf16 v[160:163], a[152:155], v[8:11], 0
    v_mfma_f32_16x16x32_bf16 v[160:163], a[156:159], v[16:19], v[160:163]
    ds_read_b128 a[140:143], v5 offset:27648
    v_mfma_f32_16x16x32_bf16 v[160:163], a[160:163], v[24:27], v[160:163]
    v_mfma_f32_16x16x32_bf16 v[164:167], a[152:155], v[12:15], 0
    ds_read_b128 a[144:147], v5 offset:28672
    v_mfma_f32_16x16x32_bf16 v[164:167], a[156:159], v[20:23], v[164:167]
    v_mfma_f32_16x16x32_bf16 v[164:167], a[160:163], v[28:31], v[164:167]
    ds_read_b128 a[148:151], v5 offset:29696
    s_waitcnt lgkmcnt(6)
    v_mfma_f32_16x16x32_bf16 v[160:163], a[164:167], v[32:35], v[160:163]
    v_mfma_f32_16x16x32_bf16 v[160:163], a[168:171], v[40:43], v[160:163]
    ds_read_b128 a[152:155], v5 offset:30720
    v_mfma_f32_16x16x32_bf16 v[160:163], a[172:175], v[48:51], v[160:163]
    v_mfma_f32_16x16x32_bf16 v[164:167], a[164:167], v[36:39], v[164:167]
    ds_read_b128 a[156:159], v5 offset:31744
    v_mfma_f32_16x16x32_bf16 v[164:167], a[168:171], v[44:47], v[164:167]
    v_mfma_f32_16x16x32_bf16 v[164:167], a[172:175], v[52:55], v[164:167]
    ds_read_b128 a[160:163], v5 offset:32768
    s_waitcnt lgkmcnt(6)
    v_mfma_f32_16x16x32_bf16 v[160:163], a[128:131], v[56:59], v[160:163]
    v_mfma_f32_16x16x32_bf16 v[160:163], a[132:135], v[64:67], v[160:163]
    ds_read_b128 a[164:167], v5 offset:33792
    v_mfma_f32_16x16x32_bf16 v[160:163], a[136:139], v[72:75], v[160:163]
    v_mfma_f32_16x16x32_bf16 v[164:167], a[128:131], v[60:63], v[164:167]
    ds_read_b128 a[168:171], v5 offset:34816
    v_mfma_f32_16x16x32_bf16 v[164:167], a[132:135], v[68:71], v[164:167]
    v_mfma_f32_16x16x32_bf16 v[164:167], a[136:139], v[76:79], v[164:167]
    ds_read_b128 a[172:175], v5 offset:35840
    s_waitcnt lgkmcnt(6)
    v_mfma_f32_16x16x32_bf16 v[160:163], a[140:143], v[80:83], v[160:163]
    s_waitcnt vmcnt(14)
    s_cmp_eq_u32 s54, 3
    s_cbranch_scc1 kmain_kernel_pa_fi
    v_lshrrev_b32 v190, 2, v1
    v_and_b32 v190, 3, v190
    v_and_b32 v191, 3, v1
    v_lshrrev_b32 v192, 4, v1
    s_cmp_eq_u32 s54, 1
    s_cbranch_scc1 kmain_kernel_pa_fn
    s_cmp_eq_u32 s54, 2
    s_cbranch_scc1 kmain_kernel_pa_fk
    v_lshl_add_u32 v193, v192, 3, v190
    v_lshlrev_b32 v193, 7, v193
    v_lshl_add_u32 v193, v191, 4, v193
    v_add_u32 v193, s75, v193
    ds_read_b64_tr_b16 v[224:225], v193 offset:0
    ds_read_b64_tr_b16 v[226:227], v193 offset:512
    ds_read_b64_tr_b16 v[228:229], v193 offset:4096
    ds_read_b64_tr_b16 v[230:231], v193 offset:4608
    ds_read_b64_tr_b16 v[232:233], v193 offset:8
    ds_read_b64_tr_b16 v[234:235], v193 offset:520
    ds_read_b64_tr_b16 v[236:237], v193 offset:4104
    ds_read_b64_tr_b16 v[238:239], v193 offset:4616
    ds_read_b64_tr_b16 v[240:241], v193 offset:64
    ds_read_b64_tr_b16 v[242:243], v193 offset:576
    ds_read_b64_tr_b16 v[244:245], v193 offset:4160
    ds_read_b64_tr_b16 v[246:247], v193 offset:4672
    ds_read_b64_tr_b16 v[248:249], v193 offset:72
    ds_read_b64_tr_b16 v[250:251], v193 offset:584
    ds_read_b64_tr_b16 v[252:253], v193 offset:4168
    ds_read_b64_tr_b16 v[254:255], v193 offset:4680
    s_mov_b32 s57, s55
    s_waitcnt lgkmcnt(0)
    buffer_store_dwordx4 v[224:227], v2, s[8:11], s57 offen offset:0 sc1
    buffer_store_dwordx4 v[228:231], v2, s[8:11], s57 offen offset:1024 sc1
    s_add_u32 s57, s57, 18432
    buffer_store_dwordx4 v[232:235], v2, s[8:11], s57 offen offset:0 sc1
    buffer_store_dwordx4 v[236:239], v2, s[8:11], s57 offen offset:1024 sc1
    s_add_u32 s57, s57, 18432
    buffer_store_dwordx4 v[240:243], v2, s[8:11], s57 offen offset:0 sc1
    buffer_store_dwordx4 v[244:247], v2, s[8:11], s57 offen offset:1024 sc1
    s_add_u32 s57, s57, 18432
    buffer_store_dwordx4 v[248:251], v2, s[8:11], s57 offen offset:0 sc1
    buffer_store_dwordx4 v[252:255], v2, s[8:11], s57 offen offset:1024 sc1
    s_branch kmain_kernel_pa_fe
kmain_kernel_pa_fn:
    v_lshl_add_u32 v193, v192, 3, v190
    v_lshlrev_b32 v193, 7, v193
    v_lshl_add_u32 v193, v191, 3, v193
    v_add_u32 v193, s75, v193
    ds_read_b64_tr_b16 v[224:225], v193 offset:0
    ds_read_b64_tr_b16 v[226:227], v193 offset:512
    ds_read_b64_tr_b16 v[228:229], v193 offset:4096
    ds_read_b64_tr_b16 v[230:231], v193 offset:4608
    ds_read_b64_tr_b16 v[232:233], v193 offset:32
    ds_read_b64_tr_b16 v[234:235], v193 offset:544
    ds_read_b64_tr_b16 v[236:237], v193 offset:4128
    ds_read_b64_tr_b16 v[238:239], v193 offset:4640
    ds_read_b64_tr_b16 v[240:241], v193 offset:64
    ds_read_b64_tr_b16 v[242:243], v193 offset:576
    ds_read_b64_tr_b16 v[244:245], v193 offset:4160
    ds_read_b64_tr_b16 v[246:247], v193 offset:4672
    ds_read_b64_tr_b16 v[248:249], v193 offset:96
    ds_read_b64_tr_b16 v[250:251], v193 offset:608
    ds_read_b64_tr_b16 v[252:253], v193 offset:4192
    ds_read_b64_tr_b16 v[254:255], v193 offset:4704
    s_mov_b32 s57, s55
    s_waitcnt lgkmcnt(0)
    buffer_store_dwordx4 v[224:227], v2, s[8:11], s57 offen offset:0 sc1
    buffer_store_dwordx4 v[228:231], v2, s[8:11], s57 offen offset:1024 sc1
    s_add_u32 s57, s57, s56
    buffer_store_dwordx4 v[232:235], v2, s[8:11], s57 offen offset:0 sc1
    buffer_store_dwordx4 v[236:239], v2, s[8:11], s57 offen offset:1024 sc1
    s_add_u32 s57, s57, s56
    buffer_store_dwordx4 v[240:243], v2, s[8:11], s57 offen offset:0 sc1
    buffer_store_dwordx4 v[244:247], v2, s[8:11], s57 offen offset:1024 sc1
    s_add_u32 s57, s57, s56
    buffer_store_dwordx4 v[248:251], v2, s[8:11], s57 offen offset:0 sc1
    buffer_store_dwordx4 v[252:255], v2, s[8:11], s57 offen offset:1024 sc1
    s_branch kmain_kernel_pa_fe
kmain_kernel_pa_fk:
    v_lshl_add_u32 v193, v192, 2, v190
    v_lshlrev_b32 v193, 7, v193
    v_lshl_add_u32 v193, v191, 3, v193
    v_add_u32 v193, s75, v193
    ds_read_b64_tr_b16 v[224:225], v193 offset:0
    ds_read_b64_tr_b16 v[226:227], v193 offset:2048
    ds_read_b64_tr_b16 v[228:229], v193 offset:4096
    ds_read_b64_tr_b16 v[230:231], v193 offset:6144
    ds_read_b64_tr_b16 v[232:233], v193 offset:32
    ds_read_b64_tr_b16 v[234:235], v193 offset:2080
    ds_read_b64_tr_b16 v[236:237], v193 offset:4128
    ds_read_b64_tr_b16 v[238:239], v193 offset:6176
    ds_read_b64_tr_b16 v[240:241], v193 offset:64
    ds_read_b64_tr_b16 v[242:243], v193 offset:2112
    ds_read_b64_tr_b16 v[244:245], v193 offset:4160
    ds_read_b64_tr_b16 v[246:247], v193 offset:6208
    ds_read_b64_tr_b16 v[248:249], v193 offset:96
    ds_read_b64_tr_b16 v[250:251], v193 offset:2144
    ds_read_b64_tr_b16 v[252:253], v193 offset:4192
    ds_read_b64_tr_b16 v[254:255], v193 offset:6240
    s_mov_b32 s57, s55
    s_waitcnt lgkmcnt(0)
    buffer_store_dwordx4 v[224:227], v2, s[8:11], s57 offen offset:0 sc1
    buffer_store_dwordx4 v[228:231], v2, s[8:11], s57 offen offset:1024 sc1
    s_add_u32 s57, s57, s56
    buffer_store_dwordx4 v[232:235], v2, s[8:11], s57 offen offset:0 sc1
    buffer_store_dwordx4 v[236:239], v2, s[8:11], s57 offen offset:1024 sc1
    s_add_u32 s57, s57, s56
    buffer_store_dwordx4 v[240:243], v2, s[8:11], s57 offen offset:0 sc1
    buffer_store_dwordx4 v[244:247], v2, s[8:11], s57 offen offset:1024 sc1
    s_add_u32 s57, s57, s56
    buffer_store_dwordx4 v[248:251], v2, s[8:11], s57 offen offset:0 sc1
    buffer_store_dwordx4 v[252:255], v2, s[8:11], s57 offen offset:1024 sc1
    s_branch kmain_kernel_pa_fe
kmain_kernel_pa_fi:
    s_mov_b32 s57, 0x7f000000
    buffer_store_dwordx4 v[224:227], v2, s[8:11], s57 offen
    buffer_store_dwordx4 v[224:227], v2, s[8:11], s57 offen
    buffer_store_dwordx4 v[224:227], v2, s[8:11], s57 offen
    buffer_store_dwordx4 v[224:227], v2, s[8:11], s57 offen
    buffer_store_dwordx4 v[224:227], v2, s[8:11], s57 offen
    buffer_store_dwordx4 v[224:227], v2, s[8:11], s57 offen
    buffer_store_dwordx4 v[224:227], v2, s[8:11], s57 offen
    buffer_store_dwordx4 v[224:227], v2, s[8:11], s57 offen
kmain_kernel_pa_fe:
    s_waitcnt vmcnt(17)
    s_barrier
    s_cmp_lg_u32 s3, 0
    s_cbranch_scc1 kmain_kernel_sg1_2
    v_mov_b32 v190, s43
    v_mov_b32 v191, 0
    v_cmp_eq_u32 vcc, 0, v1
    s_nop 3
    s_and_saveexec_b64 s[50:51], vcc
    buffer_atomic_add v190, v191, s[8:11], s71 offen
    s_mov_b64 exec, s[50:51]
kmain_kernel_sg1_2:
    v_mfma_f32_16x16x32_bf16 v[160:163], a[144:147], v[88:91], v[160:163]
    ds_read_b128 a[128:131], v6 offset:0
    v_mfma_f32_16x16x32_bf16 v[160:163], a[148:151], v[96:99], v[160:163]
    s_add_u32 m0, s21, 36864
    v_mfma_f32_16x16x32_bf16 v[164:167], a[140:143], v[84:87], v[164:167]
    ds_read_b128 a[132:135], v6 offset:1024
    v_mfma_f32_16x16x32_bf16 v[164:167], a[144:147], v[92:95], v[164:167]
    s_add_u32 s22, s20, 110592
    v_mfma_f32_16x16x32_bf16 v[164:167], a[148:151], v[100:103], v[164:167]
    ds_read_b128 a[136:139], v6 offset:2048
    s_waitcnt lgkmcnt(6)
    v_mfma_f32_16x16x32_bf16 v[160:163], a[152:155], v[104:107], v[160:163]
    buffer_load_dwordx4 v2, s[8:11], s22 offen offset:0 lds
    v_mfma_f32_16x16x32_bf16 v[160:163], a[156:159], v[112:115], v[160:163]
    ds_read_b128 a[140:143], v6 offset:3072
    v_mfma_f32_16x16x32_bf16 v[160:163], a[160:163], v[120:123], v[160:163]
    buffer_load_dwordx4 v2, s[8:11], s22 offen offset:1024 lds
    v_mfma_f32_16x16x32_bf16 v[164:167], a[152:155], v[108:111], v[164:167]
    ds_read_b128 a[144:147], v6 offset:4096
    v_mfma_f32_16x16x32_bf16 v[164:167], a[156:159], v[116:119], v[164:167]
    buffer_load_dwordx4 v2, s[8:11], s22 offen offset:2048 lds
    v_mfma_f32_16x16x32_bf16 v[164:167], a[160:163], v[124:127], v[164:167]
    ds_read_b128 a[148:151], v6 offset:5120
    s_waitcnt lgkmcnt(6)
    v_mfma_f32_16x16x32_bf16 v[160:163], a[164:167], v[128:131], v[160:163]
    buffer_load_dwordx4 v2, s[8:11], s22 offen offset:3072 lds
    v_mfma_f32_16x16x32_bf16 v[160:163], a[168:171], v[136:139], v[160:163]
    ds_read_b128 a[152:155], v6 offset:6144
    v_mfma_f32_16x16x32_bf16 v[160:163], a[172:175], v[144:147], v[160:163]
    s_add_u32 m0, s21, 40960
    v_mfma_f32_16x16x32_bf16 v[164:167], a[164:167], v[132:135], v[164:167]
    ds_read_b128 a[156:159], v6 offset:7168
    v_mfma_f32_16x16x32_bf16 v[164:167], a[168:171], v[140:143], v[164:167]
    s_add_u32 s22, s20, 114688
    v_mfma_f32_16x16x32_bf16 v[164:167], a[172:175], v[148:151], v[164:167]
    ds_read_b128 a[160:163], v6 offset:8192
    s_waitcnt lgkmcnt(6)
    v_mfma_f32_16x16x32_bf16 v[168:171], a[128:131], v[8:11], 0
    buffer_load_dwordx4 v2, s[8:11], s22 offen offset:0 lds
    v_mfma_f32_16x16x32_bf16 v[168:171], a[132:135], v[16:19], v[168:171]
    ds_read_b128 a[164:167], v6 offset:9216
    v_mfma_f32_16x16x32_bf16 v[168:171], a[136:139], v[24:27], v[168:171]
    v_mul_f32 v184, 0x3e0293ee, v152
    v_mfma_f32_16x16x32_bf16 v[172:175], a[128:131], v[12:15], 0
    ds_read_b128 a[168:171], v6 offset:10240
    v_mul_f32 v185, 0x3e0293ee, v153
    v_mfma_f32_16x16x32_bf16 v[172:175], a[132:135], v[20:23], v[172:175]
    buffer_load_dwordx4 v2, s[8:11], s22 offen offset:1024 lds
    v_mfma_f32_16x16x32_bf16 v[172:175], a[136:139], v[28:31], v[172:175]
    ds_read_b128 a[172:175], v6 offset:11264
    s_waitcnt lgkmcnt(6)
    v_mfma_f32_16x16x32_bf16 v[168:171], a[140:143], v[32:35], v[168:171]
    v_cvt_pk_bf16_f32 v186, v184, v185
    v_mfma_f32_16x16x32_bf16 v[168:171], a[144:147], v[40:43], v[168:171]
    ds_read_b128 a[128:131], v6 offset:12288
    v_mfma_f32_16x16x32_bf16 v[168:171], a[148:151], v[48:51], v[168:171]
    buffer_load_dwordx4 v2, s[8:11], s22 offen offset:2048 lds
    v_mfma_f32_16x16x32_bf16 v[172:175], a[140:143], v[36:39], v[172:175]
    ds_read_b128 a[132:135], v6 offset:13312
    v_mfma_f32_16x16x32_bf16 v[172:175], a[144:147], v[44:47], v[172:175]
    v_accvgpr_write_b32 a0, v186
    v_mul_f32 v187, 0x3e0293ee, v154
    v_mfma_f32_16x16x32_bf16 v[172:175], a[148:151], v[52:55], v[172:175]
    ds_read_b128 a[136:139], v6 offset:14336
    s_waitcnt lgkmcnt(6)
    v_mfma_f32_16x16x32_bf16 v[168:171], a[152:155], v[56:59], v[168:171]
    buffer_load_dwordx4 v2, s[8:11], s22 offen offset:3072 lds
    v_mfma_f32_16x16x32_bf16 v[168:171], a[156:159], v[64:67], v[168:171]
    ds_read_b128 a[140:143], v6 offset:15360
    v_mfma_f32_16x16x32_bf16 v[168:171], a[160:163], v[72:75], v[168:171]
    s_add_u32 m0, s21, 45056
    v_mfma_f32_16x16x32_bf16 v[172:175], a[152:155], v[60:63], v[172:175]
    ds_read_b128 a[144:147], v6 offset:16384
    v_mfma_f32_16x16x32_bf16 v[172:175], a[156:159], v[68:71], v[172:175]
    s_add_u32 s22, s20, 118784
    v_mul_f32 v188, 0x3e0293ee, v155
    v_mfma_f32_16x16x32_bf16 v[172:175], a[160:163], v[76:79], v[172:175]
    ds_read_b128 a[148:151], v6 offset:17408
    s_waitcnt lgkmcnt(6)
    v_mfma_f32_16x16x32_bf16 v[168:171], a[164:167], v[80:83], v[168:171]
    v_cvt_pk_bf16_f32 v189, v187, v188
    v_mfma_f32_16x16x32_bf16 v[168:171], a[168:171], v[88:91], v[168:171]
    ds_read_b128 a[152:155], v6 offset:18432
    v_mfma_f32_16x16x32_bf16 v[168:171], a[172:175], v[96:99], v[168:171]
    buffer_load_dwordx4 v2, s[8:11], s22 offen offset:0 lds
    v_mfma_f32_16x16x32_bf16 v[172:175], a[164:167], v[84:87], v[172:175]
    ds_read_b128 a[156:159], v6 offset:19456
    v_mfma_f32_16x16x32_bf16 v[172:175], a[168:171], v[92:95], v[172:175]
    v_accvgpr_write_b32 a1, v189
    v_mul_f32 v184, 0x3e0293ee, v160
    v_mfma_f32_16x16x32_bf16 v[172:175], a[172:175], v[100:103], v[172:175]
    ds_read_b128 a[160:163], v6 offset:20480
    s_waitcnt lgkmcnt(6)
    v_mfma_f32_16x16x32_bf16 v[168:171], a[128:131], v[104:107], v[168:171]
    v_mul_f32 v185, 0x3e0293ee, v161
    v_mfma_f32_16x16x32_bf16 v[168:171], a[132:135], v[112:115], v[168:171]
    ds_read_b128 a[164:167], v6 offset:21504
    v_mfma_f32_16x16x32_bf16 v[168:171], a[136:139], v[120:123], v[168:171]
    v_cvt_pk_bf16_f32 v186, v184, v185
    v_mfma_f32_16x16x32_bf16 v[172:175], a[128:131], v[108:111], v[172:175]
    ds_read_b128 a[168:171], v6 offset:22528
    v_mfma_f32_16x16x32_bf16 v[172:175], a[132:135], v[116:119], v[172:175]
    v_accvgpr_write_b32 a2, v186
    v_mul_f32 v187, 0x3e0293ee, v162
    v_mfma_f32_16x16x32_bf16 v[172:175], a[136:139], v[124:127], v[172:175]
    ds_read_b128 a[172:175], v6 offset:23552
    s_waitcnt lgkmcnt(6)
    v_mfma_f32_16x16x32_bf16 v[168:171], a[140:143], v[128:131], v[168:171]
    v_mul_f32 v188, 0x3e0293ee, v163
    v_mfma_f32_16x16x32_bf16 v[168:171], a[144:147], v[136:139], v[168:171]
    ds_read_b128 a[128:131], v6 offset:24576
    v_mfma_f32_16x16x32_bf16 v[168:171], a[148:151], v[144:147], v[168:171]
    v_cvt_pk_bf16_f32 v189, v187, v188
    v_mfma_f32_16x16x32_bf16 v[172:175], a[140:143], v[132:135], v[172:175]
    ds_read_b128 a[132:135], v6 offset:25600
    v_accvgpr_write_b32 a3, v189
    v_mfma_f32_16x16x32_bf16 v[172:175], a[144:147], v[140:143], v[172:175]
    v_mul_f32 v184, 0x3e0293ee, v156
    v_mfma_f32_16x16x32_bf16 v[172:175], a[148:151], v[148:151], v[172:175]
    ds_read_b128 a[136:139], v6 offset:26624
    s_waitcnt lgkmcnt(6)
    v_mfma_f32_16x16x32_bf16 v[176:179], a[152:155], v[8:11], 0
    v_mul_f32 v185, 0x3e0293ee, v157
    v_mfma_f32_16x16x32_bf16 v[176:179], a[156:159], v[16:19], v[176:179]
    ds_read_b128 a[140:143], v6 offset:27648
    v_mfma_f32_16x16x32_bf16 v[176:179], a[160:163], v[24:27], v[176:179]
    v_cvt_pk_bf16_f32 v186, v184, v185
    v_accvgpr_write_b32 a16, v186
    v_mfma_f32_16x16x32_bf16 v[180:183], a[152:155], v[12:15], 0
    ds_read_b128 a[144:147], v6 offset:28672
    v_mfma_f32_16x16x32_bf16 v[180:183], a[156:159], v[20:23], v[180:183]
    v_mul_f32 v187, 0x3e0293ee, v158
    v_mfma_f32_16x16x32_bf16 v[180:183], a[160:163], v[28:31], v[180:183]
    ds_read_b128 a[148:151], v6 offset:29696
    s_waitcnt lgkmcnt(6)
    v_mfma_f32_16x16x32_bf16 v[176:179], a[164:167], v[32:35], v[176:179]
    v_mul_f32 v188, 0x3e0293ee, v159
    v_mfma_f32_16x16x32_bf16 v[176:179], a[168:171], v[40:43], v[176:179]
    ds_read_b128 a[152:155], v6 offset:30720
    v_cvt_pk_bf16_f32 v189, v187, v188
    v_mfma_f32_16x16x32_bf16 v[176:179], a[172:175], v[48:51], v[176:179]
    v_accvgpr_write_b32 a17, v189
    v_mfma_f32_16x16x32_bf16 v[180:183], a[164:167], v[36:39], v[180:183]
    ds_read_b128 a[156:159], v6 offset:31744
    v_mfma_f32_16x16x32_bf16 v[180:183], a[168:171], v[44:47], v[180:183]
    v_mul_f32 v184, 0x3e0293ee, v164
    v_mfma_f32_16x16x32_bf16 v[180:183], a[172:175], v[52:55], v[180:183]
    ds_read_b128 a[160:163], v6 offset:32768
    s_waitcnt lgkmcnt(6)
    v_mfma_f32_16x16x32_bf16 v[176:179], a[128:131], v[56:59], v[176:179]
    v_mul_f32 v185, 0x3e0293ee, v165
    v_mfma_f32_16x16x32_bf16 v[176:179], a[132:135], v[64:67], v[176:179]
    ds_read_b128 a[164:167], v6 offset:33792
    v_cvt_pk_bf16_f32 v186, v184, v185
    v_mfma_f32_16x16x32_bf16 v[176:179], a[136:139], v[72:75], v[176:179]
    v_accvgpr_write_b32 a18, v186
    v_mfma_f32_16x16x32_bf16 v[180:183], a[128:131], v[60:63], v[180:183]
    ds_read_b128 a[168:171], v6 offset:34816
    v_mfma_f32_16x16x32_bf16 v[180:183], a[132:135], v[68:71], v[180:183]
    v_mul_f32 v187, 0x3e0293ee, v166
    v_mfma_f32_16x16x32_bf16 v[180:183], a[136:139], v[76:79], v[180:183]
    ds_read_b128 a[172:175], v6 offset:35840
    s_waitcnt lgkmcnt(6)
    v_mfma_f32_16x16x32_bf16 v[176:179], a[140:143], v[80:83], v[176:179]
    s_waitcnt vmcnt(17)
    s_barrier
    v_mfma_f32_16x16x32_bf16 v[176:179], a[144:147], v[88:91], v[176:179]
    ds_read_b128 a[128:131], v3 offset:0
    v_mul_f32 v188, 0x3e0293ee, v167
    v_mfma_f32_16x16x32_bf16 v[176:179], a[148:151], v[96:99], v[176:179]
    s_add_u32 m0, s21, 73728
    v_mfma_f32_16x16x32_bf16 v[180:183], a[140:143], v[84:87], v[180:183]
    ds_read_b128 a[132:135], v3 offset:1024
    v_mfma_f32_16x16x32_bf16 v[180:183], a[144:147], v[92:95], v[180:183]
    s_add_u32 s22, s20, 147456
    v_mfma_f32_16x16x32_bf16 v[180:183], a[148:151], v[100:103], v[180:183]
    ds_read_b128 a[136:139], v3 offset:2048
    s_waitcnt lgkmcnt(6)
    v_mfma_f32_16x16x32_bf16 v[176:179], a[152:155], v[104:107], v[176:179]
    buffer_load_dwordx4 v2, s[8:11], s22 offen offset:0 lds
    v_mfma_f32_16x16x32_bf16 v[176:179], a[156:159], v[112:115], v[176:179]
    ds_read_b128 a[140:143], v3 offset:3072
    v_cvt_pk_bf16_f32 v189, v187, v188
    v_mfma_f32_16x16x32_bf16 v[176:179], a[160:163], v[120:123], v[176:179]
    buffer_load_dwordx4 v2, s[8:11], s22 offen offset:1024 lds
    v_mfma_f32_16x16x32_bf16 v[180:183], a[152:155], v[108:111], v[180:183]
    ds_read_b128 a[144:147], v3 offset:4096
    v_mfma_f32_16x16x32_bf16 v[180:183], a[156:159], v[116:119], v[180:183]
    buffer_load_dwordx4 v2, s[8:11], s22 offen offset:2048 lds
    v_mfma_f32_16x16x32_bf16 v[180:183], a[160:163], v[124:127], v[180:183]
    ds_read_b128 a[148:151], v3 offset:5120
    s_waitcnt lgkmcnt(6)
    v_mfma_f32_16x16x32_bf16 v[176:179], a[164:167], v[128:131], v[176:179]
    buffer_load_dwordx4 v2, s[8:11], s22 offen offset:3072 lds
    v_mfma_f32_16x16x32_bf16 v[176:179], a[168:171], v[136:139], v[176:179]
    ds_read_b128 a[152:155], v3 offset:6144
    v_mfma_f32_16x16x32_bf16 v[176:179], a[172:175], v[144:147], v[176:179]
    s_add_u32 m0, s21, 77824
    v_mfma_f32_16x16x32_bf16 v[180:183], a[164:167], v[132:135], v[180:183]
    ds_read_b128 a[156:159], v3 offset:7168
    v_accvgpr_write_b32 a19, v189
    v_mfma_f32_16x16x32_bf16 v[180:183], a[168:171], v[140:143], v[180:183]
    s_add_u32 s22, s20, 151552
    v_mfma_f32_16x16x32_bf16 v[180:183], a[172:175], v[148:151], v[180:183]
    ds_read_b128 a[160:163], v3 offset:8192
    s_waitcnt lgkmcnt(6)
    v_mfma_f32_16x16x32_bf16 v[152:155], a[128:131], v[8:11], 0
    buffer_load_dwordx4 v2, s[8:11], s22 offen offset:0 lds
    v_mfma_f32_16x16x32_bf16 v[152:155], a[132:135], v[16:19], v[152:155]
    ds_read_b128 a[164:167], v3 offset:9216
    v_mfma_f32_16x16x32_bf16 v[152:155], a[136:139], v[24:27], v[152:155]
    v_mul_f32 v184, 0x3e0293ee, v168
    v_mfma_f32_16x16x32_bf16 v[156:159], a[128:131], v[12:15], 0
    ds_read_b128 a[168:171], v3 offset:10240
    v_mul_f32 v185, 0x3e0293ee, v169
    v_mfma_f32_16x16x32_bf16 v[156:159], a[132:135], v[20:23], v[156:159]
    buffer_load_dwordx4 v2, s[8:11], s22 offen offset:1024 lds
    v_mfma_f32_16x16x32_bf16 v[156:159], a[136:139], v[28:31], v[156:159]
    ds_read_b128 a[172:175], v3 offset:11264
    s_waitcnt lgkmcnt(6)
    v_mfma_f32_16x16x32_bf16 v[152:155], a[140:143], v[32:35], v[152:155]
    v_cvt_pk_bf16_f32 v186, v184, v185
    v_mfma_f32_16x16x32_bf16 v[152:155], a[144:147], v[40:43], v[152:155]
    ds_read_b128 a[128:131], v3 offset:12288
    v_mfma_f32_16x16x32_bf16 v[152:155], a[148:151], v[48:51], v[152:155]
    buffer_load_dwordx4 v2, s[8:11], s22 offen offset:2048 lds
    v_mfma_f32_16x16x32_bf16 v[156:159], a[140:143], v[36:39], v[156:159]
    ds_read_b128 a[132:135], v3 offset:13312
    v_mfma_f32_16x16x32_bf16 v[156:159], a[144:147], v[44:47], v[156:159]
    v_accvgpr_write_b32 a4, v186
    v_mul_f32 v187, 0x3e0293ee, v170
    v_mfma_f32_16x16x32_bf16 v[156:159], a[148:151], v[52:55], v[156:159]
    ds_read_b128 a[136:139], v3 offset:14336
    s_waitcnt lgkmcnt(6)
    v_mfma_f32_16x16x32_bf16 v[152:155], a[152:155], v[56:59], v[152:155]
    buffer_load_dwordx4 v2, s[8:11], s22 offen offset:3072 lds
    v_mfma_f32_16x16x32_bf16 v[152:155], a[156:159], v[64:67], v[152:155]
    ds_read_b128 a[140:143], v3 offset:15360
    v_mfma_f32_16x16x32_bf16 v[152:155], a[160:163], v[72:75], v[152:155]
    s_add_u32 m0, s21, 81920
    v_mfma_f32_16x16x32_bf16 v[156:159], a[152:155], v[60:63], v[156:159]
    ds_read_b128 a[144:147], v3 offset:16384
    v_mfma_f32_16x16x32_bf16 v[156:159], a[156:159], v[68:71], v[156:159]
    s_add_u32 s22, s20, 155648
    v_mul_f32 v188, 0x3e0293ee, v171
    v_mfma_f32_16x16x32_bf16 v[156:159], a[160:163], v[76:79], v[156:159]
    ds_read_b128 a[148:151], v3 offset:17408
    s_waitcnt lgkmcnt(6)
    v_mfma_f32_16x16x32_bf16 v[152:155], a[164:167], v[80:83], v[152:155]
    v_cvt_pk_bf16_f32 v189, v187, v188
    v_mfma_f32_16x16x32_bf16 v[152:155], a[168:171], v[88:91], v[152:155]
    ds_read_b128 a[152:155], v3 offset:18432
    v_mfma_f32_16x16x32_bf16 v[152:155], a[172:175], v[96:99], v[152:155]
    buffer_load_dwordx4 v2, s[8:11], s22 offen offset:0 lds
    v_mfma_f32_16x16x32_bf16 v[156:159], a[164:167], v[84:87], v[156:159]
    ds_read_b128 a[156:159], v3 offset:19456
    v_mfma_f32_16x16x32_bf16 v[156:159], a[168:171], v[92:95], v[156:159]
    v_accvgpr_write_b32 a5, v189
    v_mul_f32 v184, 0x3e0293ee, v176
    v_mfma_f32_16x16x32_bf16 v[156:159], a[172:175], v[100:103], v[156:159]
    ds_read_b128 a[160:163], v3 offset:20480
    s_waitcnt lgkmcnt(6)
    v_mfma_f32_16x16x32_bf16 v[152:155], a[128:131], v[104:107], v[152:155]
    v_mul_f32 v185, 0x3e0293ee, v177
    v_mfma_f32_16x16x32_bf16 v[152:155], a[132:135], v[112:115], v[152:155]
    ds_read_b128 a[164:167], v3 offset:21504
    v_mfma_f32_16x16x32_bf16 v[152:155], a[136:139], v[120:123], v[152:155]
    v_cvt_pk_bf16_f32 v186, v184, v185
    v_mfma_f32_16x16x32_bf16 v[156:159], a[128:131], v[108:111], v[156:159]
    ds_read_b128 a[168:171], v3 offset:22528
    v_mfma_f32_16x16x32_bf16 v[156:159], a[132:135], v[116:119], v[156:159]
    v_accvgpr_write_b32 a6, v186
    v_mul_f32 v187, 0x3e0293ee, v178
    v_mfma_f32_16x16x32_bf16 v[156:159], a[136:139], v[124:127], v[156:159]
    ds_read_b128 a[172:175], v3 offset:23552
    s_waitcnt lgkmcnt(6)
    v_mfma_f32_16x16x32_bf16 v[152:155], a[140:143], v[128:131], v[152:155]
    v_mul_f32 v188, 0x3e0293ee, v179
    v_mfma_f32_16x16x32_bf16 v[152:155], a[144:147], v[136:139], v[152:155]
    ds_read_b128 a[128:131], v3 offset:24576
    v_mfma_f32_16x16x32_bf16 v[152:155], a[148:151], v[144:147], v[152:155]
    v_cvt_pk_bf16_f32 v189, v187, v188
    v_mfma_f32_16x16x32_bf16 v[156:159], a[140:143], v[132:135], v[156:159]
    ds_read_b128 a[132:135], v3 offset:25600
    v_accvgpr_write_b32 a7, v189
    v_mfma_f32_16x16x32_bf16 v[156:159], a[144:147], v[140:143], v[156:159]
    v_mul_f32 v184, 0x3e0293ee, v172
    v_mfma_f32_16x16x32_bf16 v[156:159], a[148:151], v[148:151], v[156:159]
    ds_read_b128 a[136:139], v3 offset:26624
    s_waitcnt lgkmcnt(6)
    v_mfma_f32_16x16x32_bf16 v[160:163], a[152:155], v[8:11], 0
    v_mul_f32 v185, 0x3e0293ee, v173
    v_mfma_f32_16x16x32_bf16 v[160:163], a[156:159], v[16:19], v[160:163]
    ds_read_b128 a[140:143], v3 offset:27648
    v_mfma_f32_16x16x32_bf16 v[160:163], a[160:163], v[24:27], v[160:163]
    v_cvt_pk_bf16_f32 v186, v184, v185
    v_accvgpr_write_b32 a20, v186
    v_mfma_f32_16x16x32_bf16 v[164:167], a[152:155], v[12:15], 0
    ds_read_b128 a[144:147], v3 offset:28672
    v_mfma_f32_16x16x32_bf16 v[164:167], a[156:159], v[20:23], v[164:167]
    v_mul_f32 v187, 0x3e0293ee, v174
    v_mfma_f32_16x16x32_bf16 v[164:167], a[160:163], v[28:31], v[164:167]
    ds_read_b128 a[148:151], v3 offset:29696
    s_waitcnt lgkmcnt(6)
    v_mfma_f32_16x16x32_bf16 v[160:163], a[164:167], v[32:35], v[160:163]
    v_mul_f32 v188, 0x3e0293ee, v175
    v_mfma_f32_16x16x32_bf16 v[160:163], a[168:171], v[40:43], v[160:163]
    ds_read_b128 a[152:155], v3 offset:30720
    v_cvt_pk_bf16_f32 v189, v187, v188
    v_mfma_f32_16x16x32_bf16 v[160:163], a[172:175], v[48:51], v[160:163]
    v_accvgpr_write_b32 a21, v189
    v_mfma_f32_16x16x32_bf16 v[164:167], a[164:167], v[36:39], v[164:167]
    ds_read_b128 a[156:159], v3 offset:31744
    v_mfma_f32_16x16x32_bf16 v[164:167], a[168:171], v[44:47], v[164:167]
    v_mul_f32 v184, 0x3e0293ee, v180
    v_mfma_f32_16x16x32_bf16 v[164:167], a[172:175], v[52:55], v[164:167]
    ds_read_b128 a[160:163], v3 offset:32768
    s_waitcnt lgkmcnt(6)
    v_mfma_f32_16x16x32_bf16 v[160:163], a[128:131], v[56:59], v[160:163]
    v_mul_f32 v185, 0x3e0293ee, v181
    v_mfma_f32_16x16x32_bf16 v[160:163], a[132:135], v[64:67], v[160:163]
    ds_read_b128 a[164:167], v3 offset:33792
    v_cvt_pk_bf16_f32 v186, v184, v185
    v_mfma_f32_16x16x32_bf16 v[160:163], a[136:139], v[72:75], v[160:163]
    v_accvgpr_write_b32 a22, v186
    v_mfma_f32_16x16x32_bf16 v[164:167], a[128:131], v[60:63], v[164:167]
    ds_read_b128 a[168:171], v3 offset:34816
    v_mfma_f32_16x16x32_bf16 v[164:167], a[132:135], v[68:71], v[164:167]
    v_mul_f32 v187, 0x3e0293ee, v182
    v_mfma_f32_16x16x32_bf16 v[164:167], a[136:139], v[76:79], v[164:167]
    ds_read_b128 a[172:175], v3 offset:35840
    s_waitcnt lgkmcnt(6)
    v_mfma_f32_16x16x32_bf16 v[160:163], a[140:143], v[80:83], v[160:163]
    s_waitcnt vmcnt(9)
    s_barrier
    v_mfma_f32_16x16x32_bf16 v[160:163], a[144:147], v[88:91], v[160:163]
    ds_read_b128 a[128:131], v4 offset:0
    v_mul_f32 v188, 0x3e0293ee, v183
    v_mfma_f32_16x16x32_bf16 v[160:163], a[148:151], v[96:99], v[160:163]
    s_add_u32 m0, s21, 110592
    v_mfma_f32_16x16x32_bf16 v[164:167], a[140:143], v[84:87], v[164:167]
    ds_read_b128 a[132:135], v4 offset:1024
    v_mfma_f32_16x16x32_bf16 v[164:167], a[144:147], v[92:95], v[164:167]
    s_add_u32 s22, s20, 184320
    v_mfma_f32_16x16x32_bf16 v[164:167], a[148:151], v[100:103], v[164:167]
    ds_read_b128 a[136:139], v4 offset:2048
    s_waitcnt lgkmcnt(6)
    v_mfma_f32_16x16x32_bf16 v[160:163], a[152:155], v[104:107], v[160:163]
    buffer_load_dwordx4 v2, s[8:11], s22 offen offset:0 lds
    v_mfma_f32_16x16x32_bf16 v[160:163], a[156:159], v[112:115], v[160:163]
    ds_read_b128 a[140:143], v4 offset:3072
    v_cvt_pk_bf16_f32 v189, v187, v188
    v_mfma_f32_16x16x32_bf16 v[160:163], a[160:163], v[120:123], v[160:163]
    buffer_load_dwordx4 v2, s[8:11], s22 offen offset:1024 lds
    v_mfma_f32_16x16x32_bf16 v[164:167], a[152:155], v[108:111], v[164:167]
    ds_read_b128 a[144:147], v4 offset:4096
    v_mfma_f32_16x16x32_bf16 v[164:167], a[156:159], v[116:119], v[164:167]
    buffer_load_dwordx4 v2, s[8:11], s22 offen offset:2048 lds
    v_mfma_f32_16x16x32_bf16 v[164:167], a[160:163], v[124:127], v[164:167]
    ds_read_b128 a[148:151], v4 offset:5120
    s_waitcnt lgkmcnt(6)
    v_mfma_f32_16x16x32_bf16 v[160:163], a[164:167], v[128:131], v[160:163]
    buffer_load_dwordx4 v2, s[8:11], s22 offen offset:3072 lds
    v_mfma_f32_16x16x32_bf16 v[160:163], a[168:171], v[136:139], v[160:163]
    ds_read_b128 a[152:155], v4 offset:6144
    v_mfma_f32_16x16x32_bf16 v[160:163], a[172:175], v[144:147], v[160:163]
    s_add_u32 m0, s21, 114688
    v_mfma_f32_16x16x32_bf16 v[164:167], a[164:167], v[132:135], v[164:167]
    ds_read_b128 a[156:159], v4 offset:7168
    v_accvgpr_write_b32 a23, v189
    v_mfma_f32_16x16x32_bf16 v[164:167], a[168:171], v[140:143], v[164:167]
    s_add_u32 s22, s20, 188416
    v_mfma_f32_16x16x32_bf16 v[164:167], a[172:175], v[148:151], v[164:167]
    ds_read_b128 a[160:163], v4 offset:8192
    s_waitcnt lgkmcnt(6)
    v_mfma_f32_16x16x32_bf16 v[168:171], a[128:131], v[8:11], 0
    buffer_load_dwordx4 v2, s[8:11], s22 offen offset:0 lds
    v_mfma_f32_16x16x32_bf16 v[168:171], a[132:135], v[16:19], v[168:171]
    ds_read_b128 a[164:167], v4 offset:9216
    v_mfma_f32_16x16x32_bf16 v[168:171], a[136:139], v[24:27], v[168:171]
    v_mul_f32 v184, 0x3e0293ee, v152
    v_mfma_f32_16x16x32_bf16 v[172:175], a[128:131], v[12:15], 0
    ds_read_b128 a[168:171], v4 offset:10240
    v_mul_f32 v185, 0x3e0293ee, v153
    v_mfma_f32_16x16x32_bf16 v[172:175], a[132:135], v[20:23], v[172:175]
    buffer_load_dwordx4 v2, s[8:11], s22 offen offset:1024 lds
    v_mfma_f32_16x16x32_bf16 v[172:175], a[136:139], v[28:31], v[172:175]
    ds_read_b128 a[172:175], v4 offset:11264
    s_waitcnt lgkmcnt(6)
    v_mfma_f32_16x16x32_bf16 v[168:171], a[140:143], v[32:35], v[168:171]
    v_cvt_pk_bf16_f32 v186, v184, v185
    v_mfma_f32_16x16x32_bf16 v[168:171], a[144:147], v[40:43], v[168:171]
    ds_read_b128 a[128:131], v4 offset:12288
    v_mfma_f32_16x16x32_bf16 v[168:171], a[148:151], v[48:51], v[168:171]
    buffer_load_dwordx4 v2, s[8:11], s22 offen offset:2048 lds
    v_mfma_f32_16x16x32_bf16 v[172:175], a[140:143], v[36:39], v[172:175]
    ds_read_b128 a[132:135], v4 offset:13312
    v_mfma_f32_16x16x32_bf16 v[172:175], a[144:147], v[44:47], v[172:175]
    v_accvgpr_write_b32 a8, v186
    v_mul_f32 v187, 0x3e0293ee, v154
    v_mfma_f32_16x16x32_bf16 v[172:175], a[148:151], v[52:55], v[172:175]
    ds_read_b128 a[136:139], v4 offset:14336
    s_waitcnt lgkmcnt(6)
    v_mfma_f32_16x16x32_bf16 v[168:171], a[152:155], v[56:59], v[168:171]
    buffer_load_dwordx4 v2, s[8:11], s22 offen offset:3072 lds
    v_mfma_f32_16x16x32_bf16 v[168:171], a[156:159], v[64:67], v[168:171]
    ds_read_b128 a[140:143], v4 offset:15360
    v_mfma_f32_16x16x32_bf16 v[168:171], a[160:163], v[72:75], v[168:171]
    s_add_u32 m0, s21, 118784
    v_mfma_f32_16x16x32_bf16 v[172:175], a[152:155], v[60:63], v[172:175]
    ds_read_b128 a[144:147], v4 offset:16384
    v_mfma_f32_16x16x32_bf16 v[172:175], a[156:159], v[68:71], v[172:175]
    s_add_u32 s22, s20, 192512
    v_mul_f32 v188, 0x3e0293ee, v155
    v_mfma_f32_16x16x32_bf16 v[172:175], a[160:163], v[76:79], v[172:175]
    ds_read_b128 a[148:151], v4 offset:17408
    s_waitcnt lgkmcnt(6)
    v_mfma_f32_16x16x32_bf16 v[168:171], a[164:167], v[80:83], v[168:171]
    v_cvt_pk_bf16_f32 v189, v187, v188
    v_mfma_f32_16x16x32_bf16 v[168:171], a[168:171], v[88:91], v[168:171]
    ds_read_b128 a[152:155], v4 offset:18432
    v_mfma_f32_16x16x32_bf16 v[168:171], a[172:175], v[96:99], v[168:171]
    buffer_load_dwordx4 v2, s[8:11], s22 offen offset:0 lds
    v_mfma_f32_16x16x32_bf16 v[172:175], a[164:167], v[84:87], v[172:175]
    ds_read_b128 a[156:159], v4 offset:19456
    v_mfma_f32_16x16x32_bf16 v[172:175], a[168:171], v[92:95], v[172:175]
    v_accvgpr_write_b32 a9, v189
    v_mul_f32 v184, 0x3e0293ee, v160
    v_mfma_f32_16x16x32_bf16 v[172:175], a[172:175], v[100:103], v[172:175]
    ds_read_b128 a[160:163], v4 offset:20480
    s_waitcnt lgkmcnt(6)
    v_mfma_f32_16x16x32_bf16 v[168:171], a[128:131], v[104:107], v[168:171]
    v_mul_f32 v185, 0x3e0293ee, v161
    v_mfma_f32_16x16x32_bf16 v[168:171], a[132:135], v[112:115], v[168:171]
    ds_read_b128 a[164:167], v4 offset:21504
    v_mfma_f32_16x16x32_bf16 v[168:171], a[136:139], v[120:123], v[168:171]
    v_cvt_pk_bf16_f32 v186, v184, v185
    v_mfma_f32_16x16x32_bf16 v[172:175], a[128:131], v[108:111], v[172:175]
    ds_read_b128 a[168:171], v4 offset:22528
    v_mfma_f32_16x16x32_bf16 v[172:175], a[132:135], v[116:119], v[172:175]
    v_accvgpr_write_b32 a10, v186
    v_mul_f32 v187, 0x3e0293ee, v162
    v_mfma_f32_16x16x32_bf16 v[172:175], a[136:139], v[124:127], v[172:175]
    ds_read_b128 a[172:175], v4 offset:23552
    s_waitcnt lgkmcnt(6)
    v_mfma_f32_16x16x32_bf16 v[168:171], a[140:143], v[128:131], v[168:171]
    v_mul_f32 v188, 0x3e0293ee, v163
    v_mfma_f32_16x16x32_bf16 v[168:171], a[144:147], v[136:139], v[168:171]
    ds_read_b128 a[128:131], v4 offset:24576
    v_mfma_f32_16x16x32_bf16 v[168:171], a[148:151], v[144:147], v[168:171]
    v_cvt_pk_bf16_f32 v189, v187, v188
    v_mfma_f32_16x16x32_bf16 v[172:175], a[140:143], v[132:135], v[172:175]
    ds_read_b128 a[132:135], v4 offset:25600
    v_accvgpr_write_b32 a11, v189
    v_mfma_f32_16x16x32_bf16 v[172:175], a[144:147], v[140:143], v[172:175]
    v_mul_f32 v184, 0x3e0293ee, v156
    v_mfma_f32_16x16x32_bf16 v[172:175], a[148:151], v[148:151], v[172:175]
    ds_read_b128 a[136:139], v4 offset:26624
    s_waitcnt lgkmcnt(6)
    v_mfma_f32_16x16x32_bf16 v[176:179], a[152:155], v[8:11], 0
    v_mul_f32 v185, 0x3e0293ee, v157
    v_mfma_f32_16x16x32_bf16 v[176:179], a[156:159], v[16:19], v[176:179]
    ds_read_b128 a[140:143], v4 offset:27648
    v_mfma_f32_16x16x32_bf16 v[176:179], a[160:163], v[24:27], v[176:179]
    v_cvt_pk_bf16_f32 v186, v184, v185
    v_accvgpr_write_b32 a24, v186
    v_mfma_f32_16x16x32_bf16 v[180:183], a[152:155], v[12:15], 0
    ds_read_b128 a[144:147], v4 offset:28672
    v_mfma_f32_16x16x32_bf16 v[180:183], a[156:159], v[20:23], v[180:183]
    v_mul_f32 v187, 0x3e0293ee, v158
    v_mfma_f32_16x16x32_bf16 v[180:183], a[160:163], v[28:31], v[180:183]
    ds_read_b128 a[148:151], v4 offset:29696
    s_waitcnt lgkmcnt(6)
    v_mfma_f32_16x16x32_bf16 v[176:179], a[164:167], v[32:35], v[176:179]
    v_mul_f32 v188, 0x3e0293ee, v159
    v_mfma_f32_16x16x32_bf16 v[176:179], a[168:171], v[40:43], v[176:179]
    ds_read_b128 a[152:155], v4 offset:30720
    v_cvt_pk_bf16_f32 v189, v187, v188
    v_mfma_f32_16x16x32_bf16 v[176:179], a[172:175], v[48:51], v[176:179]
    v_accvgpr_write_b32 a25, v189
    v_mfma_f32_16x16x32_bf16 v[180:183], a[164:167], v[36:39], v[180:183]
    ds_read_b128 a[156:159], v4 offset:31744
    v_mfma_f32_16x16x32_bf16 v[180:183], a[168:171], v[44:47], v[180:183]
    v_mul_f32 v184, 0x3e0293ee, v164
    v_mfma_f32_16x16x32_bf16 v[180:183], a[172:175], v[52:55], v[180:183]
    ds_read_b128 a[160:163], v4 offset:32768
    s_waitcnt lgkmcnt(6)
    v_mfma_f32_16x16x32_bf16 v[176:179], a[128:131], v[56:59], v[176:179]
    v_mul_f32 v185, 0x3e0293ee, v165
    v_mfma_f32_16x16x32_bf16 v[176:179], a[132:135], v[64:67], v[176:179]
    ds_read_b128 a[164:167], v4 offset:33792
    v_cvt_pk_bf16_f32 v186, v184, v185
    v_mfma_f32_16x16x32_bf16 v[176:179], a[136:139], v[72:75], v[176:179]
    v_accvgpr_write_b32 a26, v186
    v_mfma_f32_16x16x32_bf16 v[180:183], a[128:131], v[60:63], v[180:183]
    ds_read_b128 a[168:171], v4 offset:34816
    v_mfma_f32_16x16x32_bf16 v[180:183], a[132:135], v[68:71], v[180:183]
    v_mul_f32 v187, 0x3e0293ee, v166
    v_mfma_f32_16x16x32_bf16 v[180:183], a[136:139], v[76:79], v[180:183]
    ds_read_b128 a[172:175], v4 offset:35840
    s_waitcnt lgkmcnt(6)
    v_mfma_f32_16x16x32_bf16 v[176:179], a[140:143], v[80:83], v[176:179]
    s_waitcnt vmcnt(9)
    s_barrier
    s_cmp_lg_u32 s3, 0
    s_cbranch_scc1 kmain_kernel_sg3_3
    v_mov_b32 v190, 1
    v_mov_b32 v191, 0
    v_cmp_eq_u32 vcc, 0, v1
    s_nop 3
    s_and_saveexec_b64 s[50:51], vcc
    buffer_atomic_add v190, v191, s[8:11], s52 offen
    s_mov_b64 exec, s[50:51]
kmain_kernel_sg3_3:
    v_mfma_f32_16x16x32_bf16 v[176:179], a[144:147], v[88:91], v[176:179]
    ds_read_b128 a[128:131], v5 offset:0
    v_mul_f32 v188, 0x3e0293ee, v167
    v_mfma_f32_16x16x32_bf16 v[176:179], a[148:151], v[96:99], v[176:179]
    s_add_u32 m0, s21, 0
    v_mfma_f32_16x16x32_bf16 v[180:183], a[140:143], v[84:87], v[180:183]
    ds_read_b128 a[132:135], v5 offset:1024
    v_mfma_f32_16x16x32_bf16 v[180:183], a[144:147], v[92:95], v[180:183]
    s_add_u32 s22, s20, 221184
    v_mfma_f32_16x16x32_bf16 v[180:183], a[148:151], v[100:103], v[180:183]
    ds_read_b128 a[136:139], v5 offset:2048
    s_waitcnt lgkmcnt(6)
    v_mfma_f32_16x16x32_bf16 v[176:179], a[152:155], v[104:107], v[176:179]
    buffer_load_dwordx4 v2, s[8:11], s22 offen offset:0 lds
    v_mfma_f32_16x16x32_bf16 v[176:179], a[156:159], v[112:115], v[176:179]
    ds_read_b128 a[140:143], v5 offset:3072
    v_cvt_pk_bf16_f32 v189, v187, v188
    v_mfma_f32_16x16x32_bf16 v[176:179], a[160:163], v[120:123], v[176:179]
    buffer_load_dwordx4 v2, s[8:11], s22 offen offset:1024 lds
    v_mfma_f32_16x16x32_bf16 v[180:183], a[152:155], v[108:111], v[180:183]
    ds_read_b128 a[144:147], v5 offset:4096
    v_mfma_f32_16x16x32_bf16 v[180:183], a[156:159], v[116:119], v[180:183]
    buffer_load_dwordx4 v2, s[8:11], s22 offen offset:2048 lds
    v_mfma_f32_16x16x32_bf16 v[180:183], a[160:163], v[124:127], v[180:183]
    ds_read_b128 a[148:151], v5 offset:5120
    s_waitcnt lgkmcnt(6)
    v_mfma_f32_16x16x32_bf16 v[176:179], a[164:167], v[128:131], v[176:179]
    buffer_load_dwordx4 v2, s[8:11], s22 offen offset:3072 lds
    v_mfma_f32_16x16x32_bf16 v[176:179], a[168:171], v[136:139], v[176:179]
    ds_read_b128 a[152:155], v5 offset:6144
    v_mfma_f32_16x16x32_bf16 v[176:179], a[172:175], v[144:147], v[176:179]
    s_add_u32 m0, s21, 4096
    v_mfma_f32_16x16x32_bf16 v[180:183], a[164:167], v[132:135], v[180:183]
    ds_read_b128 a[156:159], v5 offset:7168
    v_accvgpr_write_b32 a27, v189
    v_mfma_f32_16x16x32_bf16 v[180:183], a[168:171], v[140:143], v[180:183]
    s_add_u32 s22, s20, 225280
    v_mfma_f32_16x16x32_bf16 v[180:183], a[172:175], v[148:151], v[180:183]
    ds_read_b128 a[160:163], v5 offset:8192
    s_waitcnt lgkmcnt(6)
    v_mfma_f32_16x16x32_bf16 v[152:155], a[128:131], v[8:11], 0
    buffer_load_dwordx4 v2, s[8:11], s22 offen offset:0 lds
    v_mfma_f32_16x16x32_bf16 v[152:155], a[132:135], v[16:19], v[152:155]
    ds_read_b128 a[164:167], v5 offset:9216
    v_mfma_f32_16x16x32_bf16 v[152:155], a[136:139], v[24:27], v[152:155]
    v_mul_f32 v184, 0x3e0293ee, v168
    v_mul_f32 v185, 0x3e0293ee, v169
    v_mfma_f32_16x16x32_bf16 v[156:159], a[128:131], v[12:15], 0
    ds_read_b128 a[168:171], v5 offset:10240
    v_mfma_f32_16x16x32_bf16 v[156:159], a[132:135], v[20:23], v[156:159]
    buffer_load_dwordx4 v2, s[8:11], s22 offen offset:1024 lds
    v_mfma_f32_16x16x32_bf16 v[156:159], a[136:139], v[28:31], v[156:159]
    ds_read_b128 a[172:175], v5 offset:11264
    s_waitcnt lgkmcnt(6)
    v_mfma_f32_16x16x32_bf16 v[152:155], a[140:143], v[32:35], v[152:155]
    v_cvt_pk_bf16_f32 v186, v184, v185
    v_mfma_f32_16x16x32_bf16 v[152:155], a[144:147], v[40:43], v[152:155]
    ds_read_b128 a[128:131], v5 offset:12288
    v_mfma_f32_16x16x32_bf16 v[152:155], a[148:151], v[48:51], v[152:155]
    buffer_load_dwordx4 v2, s[8:11], s22 offen offset:2048 lds
    v_mfma_f32_16x16x32_bf16 v[156:159], a[140:143], v[36:39], v[156:159]
    ds_read_b128 a[132:135], v5 offset:13312
    v_accvgpr_write_b32 a12, v186
    v_mfma_f32_16x16x32_bf16 v[156:159], a[144:147], v[44:47], v[156:159]
    v_mul_f32 v187, 0x3e0293ee, v170
    v_mfma_f32_16x16x32_bf16 v[156:159], a[148:151], v[52:55], v[156:159]
    ds_read_b128 a[136:139], v5 offset:14336
    s_waitcnt lgkmcnt(6)
    v_mfma_f32_16x16x32_bf16 v[152:155], a[152:155], v[56:59], v[152:155]
    buffer_load_dwordx4 v2, s[8:11], s22 offen offset:3072 lds
    v_mfma_f32_16x16x32_bf16 v[152:155], a[156:159], v[64:67], v[152:155]
    ds_read_b128 a[140:143], v5 offset:15360
    v_mfma_f32_16x16x32_bf16 v[152:155], a[160:163], v[72:75], v[152:155]
    s_add_u32 m0, s21, 8192
    v_mfma_f32_16x16x32_bf16 v[156:159], a[152:155], v[60:63], v[156:159]
    ds_read_b128 a[144:147], v5 offset:16384
    v_mul_f32 v188, 0x3e0293ee, v171
    v_mfma_f32_16x16x32_bf16 v[156:159], a[156:159], v[68:71], v[156:159]
    s_add_u32 s22, s20, 229376
    v_mfma_f32_16x16x32_bf16 v[156:159], a[160:163], v[76:79], v[156:159]
    ds_read_b128 a[148:151], v5 offset:17408
    s_waitcnt lgkmcnt(6)
    v_mfma_f32_16x16x32_bf16 v[152:155], a[164:167], v[80:83], v[152:155]
    v_cvt_pk_bf16_f32 v189, v187, v188
    v_mfma_f32_16x16x32_bf16 v[152:155], a[168:171], v[88:91], v[152:155]
    ds_read_b128 a[152:155], v5 offset:18432
    v_mfma_f32_16x16x32_bf16 v[152:155], a[172:175], v[96:99], v[152:155]
    buffer_load_dwordx4 v2, s[8:11], s22 offen offset:0 lds
    v_mfma_f32_16x16x32_bf16 v[156:159], a[164:167], v[84:87], v[156:159]
    ds_read_b128 a[156:159], v5 offset:19456
    v_accvgpr_write_b32 a13, v189
    v_mfma_f32_16x16x32_bf16 v[156:159], a[168:171], v[92:95], v[156:159]
    v_mul_f32 v184, 0x3e0293ee, v176
    v_mfma_f32_16x16x32_bf16 v[156:159], a[172:175], v[100:103], v[156:159]
    ds_read_b128 a[160:163], v5 offset:20480
    s_waitcnt lgkmcnt(6)
    v_mfma_f32_16x16x32_bf16 v[152:155], a[128:131], v[104:107], v[152:155]
    v_mul_f32 v185, 0x3e0293ee, v177
    v_mfma_f32_16x16x32_bf16 v[152:155], a[132:135], v[112:115], v[152:155]
    ds_read_b128 a[164:167], v5 offset:21504
    v_mfma_f32_16x16x32_bf16 v[152:155], a[136:139], v[120:123], v[152:155]
    v_cvt_pk_bf16_f32 v186, v184, v185
    v_accvgpr_write_b32 a14, v186
    v_mfma_f32_16x16x32_bf16 v[156:159], a[128:131], v[108:111], v[156:159]
    ds_read_b128 a[168:171], v5 offset:22528
    v_mfma_f32_16x16x32_bf16 v[156:159], a[132:135], v[116:119], v[156:159]
    v_mul_f32 v187, 0x3e0293ee, v178
    v_mfma_f32_16x16x32_bf16 v[156:159], a[136:139], v[124:127], v[156:159]
    ds_read_b128 a[172:175], v5 offset:23552
    s_waitcnt lgkmcnt(6)
    v_mfma_f32_16x16x32_bf16 v[152:155], a[140:143], v[128:131], v[152:155]
    v_mul_f32 v188, 0x3e0293ee, v179
    v_mfma_f32_16x16x32_bf16 v[152:155], a[144:147], v[136:139], v[152:155]
    ds_read_b128 a[128:131], v5 offset:24576
    v_cvt_pk_bf16_f32 v189, v187, v188
    v_mfma_f32_16x16x32_bf16 v[152:155], a[148:151], v[144:147], v[152:155]
    v_accvgpr_write_b32 a15, v189
    v_mfma_f32_16x16x32_bf16 v[156:159], a[140:143], v[132:135], v[156:159]
    ds_read_b128 a[132:135], v5 offset:25600
    v_mfma_f32_16x16x32_bf16 v[156:159], a[144:147], v[140:143], v[156:159]
    v_mul_f32 v184, 0x3e0293ee, v172
    v_mul_f32 v185, 0x3e0293ee, v173
    v_mfma_f32_16x16x32_bf16 v[156:159], a[148:151], v[148:151], v[156:159]
    ds_read_b128 a[136:139], v5 offset:26624
    s_waitcnt lgkmcnt(6)
    v_mfma_f32_16x16x32_bf16 v[160:163], a[152:155], v[8:11], 0
    v_cvt_pk_bf16_f32 v186, v184, v185
    v_mfma_f32_16x16x32_bf16 v[160:163], a[156:159], v[16:19], v[160:163]
    ds_read_b128 a[140:143], v5 offset:27648
    v_mfma_f32_16x16x32_bf16 v[160:163], a[160:163], v[24:27], v[160:163]
    v_accvgpr_write_b32 a28, v186
    v_mfma_f32_16x16x32_bf16 v[164:167], a[152:155], v[12:15], 0
    ds_read_b128 a[144:147], v5 offset:28672
    v_mul_f32 v187, 0x3e0293ee, v174
    v_mfma_f32_16x16x32_bf16 v[164:167], a[156:159], v[20:23], v[164:167]
    v_mul_f32 v188, 0x3e0293ee, v175
    v_mfma_f32_16x16x32_bf16 v[164:167], a[160:163], v[28:31], v[164:167]
    ds_read_b128 a[148:151], v5 offset:29696
    s_waitcnt lgkmcnt(6)
    v_mfma_f32_16x16x32_bf16 v[160:163], a[164:167], v[32:35], v[160:163]
    v_cvt_pk_bf16_f32 v189, v187, v188
    v_mfma_f32_16x16x32_bf16 v[160:163], a[168:171], v[40:43], v[160:163]
    ds_read_b128 a[152:155], v5 offset:30720
    v_mfma_f32_16x16x32_bf16 v[160:163], a[172:175], v[48:51], v[160:163]
    buffer_load_dword v196, v194, s[8:11], 0 offen sc1
    v_mfma_f32_16x16x32_bf16 v[164:167], a[164:167], v[36:39], v[164:167]
    ds_read_b128 a[156:159], v5 offset:31744
    v_accvgpr_write_b32 a29, v189
    v_mfma_f32_16x16x32_bf16 v[164:167], a[168:171], v[44:47], v[164:167]
    v_mul_f32 v184, 0x3e0293ee, v180
    v_mfma_f32_16x16x32_bf16 v[164:167], a[172:175], v[52:55], v[164:167]
    ds_read_b128 a[160:163], v5 offset:32768
    s_waitcnt lgkmcnt(6)
    v_mfma_f32_16x16x32_bf16 v[160:163], a[128:131], v[56:59], v[160:163]
    v_mul_f32 v185, 0x3e0293ee, v181
    v_mfma_f32_16x16x32_bf16 v[160:163], a[132:135], v[64:67], v[160:163]
    ds_read_b128 a[164:167], v5 offset:33792
    v_mfma_f32_16x16x32_bf16 v[160:163], a[136:139], v[72:75], v[160:163]
    v_cvt_pk_bf16_f32 v186, v184, v185
    v_accvgpr_write_b32 a30, v186
    v_mfma_f32_16x16x32_bf16 v[164:167], a[128:131], v[60:63], v[164:167]
    ds_read_b128 a[168:171], v5 offset:34816
    v_mfma_f32_16x16x32_bf16 v[164:167], a[132:135], v[68:71], v[164:167]
    v_mul_f32 v187, 0x3e0293ee, v182
    v_mfma_f32_16x16x32_bf16 v[164:167], a[136:139], v[76:79], v[164:167]
    ds_read_b128 a[172:175], v5 offset:35840
    s_waitcnt lgkmcnt(6)
    v_mfma_f32_16x16x32_bf16 v[160:163], a[140:143], v[80:83], v[160:163]
    s_waitcnt vmcnt(10)
    s_barrier
    v_mfma_f32_16x16x32_bf16 v[160:163], a[144:147], v[88:91], v[160:163]
    ds_read_b128 a[128:131], v6 offset:0
    v_mfma_f32_16x16x32_bf16 v[160:163], a[148:151], v[96:99], v[160:163]
    s_add_u32 m0, s21, 36864
    v_mul_f32 v188, 0x3e0293ee, v183
    v_mfma_f32_16x16x32_bf16 v[164:167], a[140:143], v[84:87], v[164:167]
    ds_read_b128 a[132:135], v6 offset:1024
    v_mfma_f32_16x16x32_bf16 v[164:167], a[144:147], v[92:95], v[164:167]
    s_add_u32 s22, s20, 258048
    v_mfma_f32_16x16x32_bf16 v[164:167], a[148:151], v[100:103], v[164:167]
    ds_read_b128 a[136:139], v6 offset:2048
    s_waitcnt lgkmcnt(6)
    v_mfma_f32_16x16x32_bf16 v[160:163], a[152:155], v[104:107], v[160:163]
    buffer_load_dwordx4 v2, s[8:11], s22 offen offset:0 lds
    v_mfma_f32_16x16x32_bf16 v[160:163], a[156:159], v[112:115], v[160:163]
    ds_read_b128 a[140:143], v6 offset:3072
    v_mfma_f32_16x16x32_bf16 v[160:163], a[160:163], v[120:123], v[160:163]
    buffer_load_dwordx4 v2, s[8:11], s22 offen offset:1024 lds
    v_mfma_f32_16x16x32_bf16 v[164:167], a[152:155], v[108:111], v[164:167]
    ds_read_b128 a[144:147], v6 offset:4096
    v_cvt_pk_bf16_f32 v189, v187, v188
    v_mfma_f32_16x16x32_bf16 v[164:167], a[156:159], v[116:119], v[164:167]
    buffer_load_dwordx4 v2, s[8:11], s22 offen offset:2048 lds
    v_mfma_f32_16x16x32_bf16 v[164:167], a[160:163], v[124:127], v[164:167]
    ds_read_b128 a[148:151], v6 offset:5120
    s_waitcnt lgkmcnt(6)
    v_mfma_f32_16x16x32_bf16 v[160:163], a[164:167], v[128:131], v[160:163]
    buffer_load_dwordx4 v2, s[8:11], s22 offen offset:3072 lds
    v_mfma_f32_16x16x32_bf16 v[160:163], a[168:171], v[136:139], v[160:163]
    ds_read_b128 a[152:155], v6 offset:6144
    v_mfma_f32_16x16x32_bf16 v[160:163], a[172:175], v[144:147], v[160:163]
    s_add_u32 m0, s21, 40960
    v_mfma_f32_16x16x32_bf16 v[164:167], a[164:167], v[132:135], v[164:167]
    ds_read_b128 a[156:159], v6 offset:7168
    v_mfma_f32_16x16x32_bf16 v[164:167], a[168:171], v[140:143], v[164:167]
    s_add_u32 s22, s20, 262144
    v_accvgpr_write_b32 a31, v189
    v_mfma_f32_16x16x32_bf16 v[164:167], a[172:175], v[148:151], v[164:167]
    ds_read_b128 a[160:163], v6 offset:8192
    s_waitcnt lgkmcnt(6)
    v_mfma_f32_16x16x32_bf16 v[168:171], a[128:131], v[8:11], 0
    buffer_load_dwordx4 v2, s[8:11], s22 offen offset:0 lds
    v_mfma_f32_16x16x32_bf16 v[168:171], a[132:135], v[16:19], v[168:171]
    ds_read_b128 a[164:167], v6 offset:9216
    v_mfma_f32_16x16x32_bf16 v[168:171], a[136:139], v[24:27], v[168:171]
    v_mul_f32 v184, 0x3e0293ee, v152
    v_mfma_f32_16x16x32_bf16 v[172:175], a[128:131], v[12:15], 0
    ds_read_b128 a[168:171], v6 offset:10240
    v_mfma_f32_16x16x32_bf16 v[172:175], a[132:135], v[20:23], v[172:175]
    buffer_load_dwordx4 v2, s[8:11], s22 offen offset:1024 lds
    v_mfma_f32_16x16x32_bf16 v[172:175], a[136:139], v[28:31], v[172:175]
    ds_read_b128 a[172:175], v6 offset:11264
    s_waitcnt lgkmcnt(6)
    v_mfma_f32_16x16x32_bf16 v[168:171], a[140:143], v[32:35], v[168:171]
    v_mul_f32 v185, 0x3e0293ee, v153
    v_cvt_pk_bf16_f32 v186, v184, v185
    v_mfma_f32_16x16x32_bf16 v[168:171], a[144:147], v[40:43], v[168:171]
    ds_read_b128 a[128:131], v6 offset:12288
    v_mfma_f32_16x16x32_bf16 v[168:171], a[148:151], v[48:51], v[168:171]
    buffer_load_dwordx4 v2, s[8:11], s22 offen offset:2048 lds
    v_mfma_f32_16x16x32_bf16 v[172:175], a[140:143], v[36:39], v[172:175]
    ds_read_b128 a[132:135], v6 offset:13312
    v_mfma_f32_16x16x32_bf16 v[172:175], a[144:147], v[44:47], v[172:175]
    v_accvgpr_write_b32 a32, v186
    v_mfma_f32_16x16x32_bf16 v[172:175], a[148:151], v[52:55], v[172:175]
    ds_read_b128 a[136:139], v6 offset:14336
    s_waitcnt lgkmcnt(6)
    v_mfma_f32_16x16x32_bf16 v[168:171], a[152:155], v[56:59], v[168:171]
    buffer_load_dwordx4 v2, s[8:11], s22 offen offset:3072 lds
    v_mfma_f32_16x16x32_bf16 v[168:171], a[156:159], v[64:67], v[168:171]
    ds_read_b128 a[140:143], v6 offset:15360
    v_mfma_f32_16x16x32_bf16 v[168:171], a[160:163], v[72:75], v[168:171]
    s_add_u32 m0, s21, 45056
    v_mfma_f32_16x16x32_bf16 v[172:175], a[152:155], v[60:63], v[172:175]
    ds_read_b128 a[144:147], v6 offset:16384
    v_mul_f32 v187, 0x3e0293ee, v154
    v_mfma_f32_16x16x32_bf16 v[172:175], a[156:159], v[68:71], v[172:175]
    s_add_u32 s22, s20, 266240
    v_mfma_f32_16x16x32_bf16 v[172:175], a[160:163], v[76:79], v[172:175]
    ds_read_b128 a[148:151], v6 offset:17408
    s_waitcnt lgkmcnt(6)
    v_mfma_f32_16x16x32_bf16 v[168:171], a[164:167], v[80:83], v[168:171]
    v_mul_f32 v188, 0x3e0293ee, v155
    v_mfma_f32_16x16x32_bf16 v[168:171], a[168:171], v[88:91], v[168:171]
    ds_read_b128 a[152:155], v6 offset:18432
    v_mfma_f32_16x16x32_bf16 v[168:171], a[172:175], v[96:99], v[168:171]
    buffer_load_dwordx4 v2, s[8:11], s22 offen offset:0 lds
    v_mfma_f32_16x16x32_bf16 v[172:175], a[164:167], v[84:87], v[172:175]
    ds_read_b128 a[156:159], v6 offset:19456
    v_mfma_f32_16x16x32_bf16 v[172:175], a[168:171], v[92:95], v[172:175]
    v_cvt_pk_bf16_f32 v189, v187, v188
    v_mfma_f32_16x16x32_bf16 v[172:175], a[172:175], v[100:103], v[172:175]
    ds_read_b128 a[160:163], v6 offset:20480
    s_waitcnt lgkmcnt(6)
    v_mfma_f32_16x16x32_bf16 v[168:171], a[128:131], v[104:107], v[168:171]
    v_accvgpr_write_b32 a33, v189
    v_mfma_f32_16x16x32_bf16 v[168:171], a[132:135], v[112:115], v[168:171]
    ds_read_b128 a[164:167], v6 offset:21504
    v_mul_f32 v184, 0x3e0293ee, v160
    v_mfma_f32_16x16x32_bf16 v[168:171], a[136:139], v[120:123], v[168:171]
    v_mul_f32 v185, 0x3e0293ee, v161
    v_mfma_f32_16x16x32_bf16 v[172:175], a[128:131], v[108:111], v[172:175]
    ds_read_b128 a[168:171], v6 offset:22528
    v_mfma_f32_16x16x32_bf16 v[172:175], a[132:135], v[116:119], v[172:175]
    v_cvt_pk_bf16_f32 v186, v184, v185
    v_mfma_f32_16x16x32_bf16 v[172:175], a[136:139], v[124:127], v[172:175]
    ds_read_b128 a[172:175], v6 offset:23552
    s_waitcnt lgkmcnt(6)
    v_mfma_f32_16x16x32_bf16 v[168:171], a[140:143], v[128:131], v[168:171]
    v_accvgpr_write_b32 a34, v186
    v_mfma_f32_16x16x32_bf16 v[168:171], a[144:147], v[136:139], v[168:171]
    ds_read_b128 a[128:131], v6 offset:24576
    v_mfma_f32_16x16x32_bf16 v[168:171], a[148:151], v[144:147], v[168:171]
    v_mul_f32 v187, 0x3e0293ee, v162
    v_mul_f32 v188, 0x3e0293ee, v163
    v_mfma_f32_16x16x32_bf16 v[172:175], a[140:143], v[132:135], v[172:175]
    ds_read_b128 a[132:135], v6 offset:25600
    v_mfma_f32_16x16x32_bf16 v[172:175], a[144:147], v[140:143], v[172:175]
    v_cvt_pk_bf16_f32 v189, v187, v188
    v_mfma_f32_16x16x32_bf16 v[172:175], a[148:151], v[148:151], v[172:175]
    ds_read_b128 a[136:139], v6 offset:26624
    s_waitcnt lgkmcnt(6)
    v_mfma_f32_16x16x32_bf16 v[176:179], a[152:155], v[8:11], 0
    v_accvgpr_write_b32 a35, v189
    v_mfma_f32_16x16x32_bf16 v[176:179], a[156:159], v[16:19], v[176:179]
    ds_read_b128 a[140:143], v6 offset:27648
    v_mfma_f32_16x16x32_bf16 v[176:179], a[160:163], v[24:27], v[176:179]
    v_mul_f32 v184, 0x3e0293ee, v156
    v_mfma_f32_16x16x32_bf16 v[180:183], a[152:155], v[12:15], 0
    ds_read_b128 a[144:147], v6 offset:28672
    v_mfma_f32_16x16x32_bf16 v[180:183], a[156:159], v[20:23], v[180:183]
    v_mul_f32 v185, 0x3e0293ee, v157
    v_cvt_pk_bf16_f32 v186, v184, v185
    v_mfma_f32_16x16x32_bf16 v[180:183], a[160:163], v[28:31], v[180:183]
    ds_read_b128 a[148:151], v6 offset:29696
    s_waitcnt lgkmcnt(6)
    v_mfma_f32_16x16x32_bf16 v[176:179], a[164:167], v[32:35], v[176:179]
    v_accvgpr_write_b32 a48, v186
    v_mfma_f32_16x16x32_bf16 v[176:179], a[168:171], v[40:43], v[176:179]
    ds_read_b128 a[152:155], v6 offset:30720
    v_mfma_f32_16x16x32_bf16 v[176:179], a[172:175], v[48:51], v[176:179]
    v_mul_f32 v187, 0x3e0293ee, v158
    v_mfma_f32_16x16x32_bf16 v[180:183], a[164:167], v[36:39], v[180:183]
    ds_read_b128 a[156:159], v6 offset:31744
    v_mfma_f32_16x16x32_bf16 v[180:183], a[168:171], v[44:47], v[180:183]
    v_mul_f32 v188, 0x3e0293ee, v159
    v_mfma_f32_16x16x32_bf16 v[180:183], a[172:175], v[52:55], v[180:183]
    ds_read_b128 a[160:163], v6 offset:32768
    s_waitcnt lgkmcnt(6)
    v_mfma_f32_16x16x32_bf16 v[176:179], a[128:131], v[56:59], v[176:179]
    v_cvt_pk_bf16_f32 v189, v187, v188
    v_accvgpr_write_b32 a49, v189
    v_mfma_f32_16x16x32_bf16 v[176:179], a[132:135], v[64:67], v[176:179]
    ds_read_b128 a[164:167], v6 offset:33792
    v_mfma_f32_16x16x32_bf16 v[176:179], a[136:139], v[72:75], v[176:179]
    v_mul_f32 v184, 0x3e0293ee, v164
    v_mfma_f32_16x16x32_bf16 v[180:183], a[128:131], v[60:63], v[180:183]
    ds_read_b128 a[168:171], v6 offset:34816
    v_mfma_f32_16x16x32_bf16 v[180:183], a[132:135], v[68:71], v[180:183]
    v_mul_f32 v185, 0x3e0293ee, v165
    v_mfma_f32_16x16x32_bf16 v[180:183], a[136:139], v[76:79], v[180:183]
    ds_read_b128 a[172:175], v6 offset:35840
    s_waitcnt lgkmcnt(6)
    v_mfma_f32_16x16x32_bf16 v[176:179], a[140:143], v[80:83], v[176:179]
    s_waitcnt vmcnt(10)
    s_barrier
    v_mfma_f32_16x16x32_bf16 v[176:179], a[144:147], v[88:91], v[176:179]
    ds_read_b128 a[128:131], v3 offset:0
    v_mfma_f32_16x16x32_bf16 v[176:179], a[148:151], v[96:99], v[176:179]
    v_cvt_pk_bf16_f32 v186, v184, v185
    v_mfma_f32_16x16x32_bf16 v[180:183], a[140:143], v[84:87], v[180:183]
    ds_read_b128 a[132:135], v3 offset:1024
    s_waitcnt vmcnt(9)
    v_mfma_f32_16x16x32_bf16 v[180:183], a[144:147], v[92:95], v[180:183]
    v_cmp_lt_u32 vcc, v196, v195
    v_accvgpr_write_b32 a50, v186
    v_mfma_f32_16x16x32_bf16 v[180:183], a[148:151], v[100:103], v[180:183]
    ds_read_b128 a[136:139], v3 offset:2048
    s_waitcnt lgkmcnt(6)
    v_mfma_f32_16x16x32_bf16 v[176:179], a[152:155], v[104:107], v[176:179]
    v_mul_f32 v187, 0x3e0293ee, v166
    v_mfma_f32_16x16x32_bf16 v[176:179], a[156:159], v[112:115], v[176:179]
    ds_read_b128 a[140:143], v3 offset:3072
    v_mfma_f32_16x16x32_bf16 v[176:179], a[160:163], v[120:123], v[176:179]
    s_mul_i32 s44, s16, 18432
    s_add_u32 s44, s44, 2359296
    v_mfma_f32_16x16x32_bf16 v[180:183], a[152:155], v[108:111], v[180:183]
    ds_read_b128 a[144:147], v3 offset:4096
    v_mfma_f32_16x16x32_bf16 v[180:183], a[156:159], v[116:119], v[180:183]
    s_cmp_eq_u64 vcc, 0
    s_cselect_b32 s53, 1, 0
    s_cselect_b32 s44, s44, 2130706432
    v_mfma_f32_16x16x32_bf16 v[180:183], a[160:163], v[124:127], v[180:183]
    ds_read_b128 a[148:151], v3 offset:5120
    s_waitcnt lgkmcnt(6)
    v_mfma_f32_16x16x32_bf16 v[176:179], a[164:167], v[128:131], v[176:179]
    s_add_u32 s45, s44, 18432
    v_mfma_f32_16x16x32_bf16 v[176:179], a[168:171], v[136:139], v[176:179]
    ds_read_b128 a[152:155], v3 offset:6144
    v_mfma_f32_16x16x32_bf16 v[176:179], a[172:175], v[144:147], v[176:179]
    v_mul_f32 v188, 0x3e0293ee, v167
    v_cvt_pk_bf16_f32 v189, v187, v188
    v_mfma_f32_16x16x32_bf16 v[180:183], a[164:167], v[132:135], v[180:183]
    ds_read_b128 a[156:159], v3 offset:7168
    v_mfma_f32_16x16x32_bf16 v[180:183], a[168:171], v[140:143], v[180:183]
    v_accvgpr_write_b32 a51, v189
    v_mfma_f32_16x16x32_bf16 v[180:183], a[172:175], v[148:151], v[180:183]
    ds_read_b128 a[160:163], v3 offset:8192
    s_waitcnt lgkmcnt(6)
    v_mfma_f32_16x16x32_bf16 v[152:155], a[128:131], v[8:11], 0
    v_mfma_f32_16x16x32_bf16 v[152:155], a[132:135], v[16:19], v[152:155]
    ds_read_b128 a[164:167], v3 offset:9216
    buffer_load_dwordx4 a[64:67], v2, s[8:11], s44 offen offset:0 sc1
    v_mfma_f32_16x16x32_bf16 v[152:155], a[136:139], v[24:27], v[152:155]
    buffer_load_dwordx4 a[68:71], v2, s[8:11], s45 offen offset:0 sc1
    v_mul_f32 v184, 0x3e0293ee, v168
    v_mfma_f32_16x16x32_bf16 v[156:159], a[128:131], v[12:15], 0
    ds_read_b128 a[168:171], v3 offset:10240
    buffer_load_dwordx4 a[72:75], v2, s[8:11], s44 offen offset:1024 sc1
    s_add_u32 m0, s21, 73728
    v_mfma_f32_16x16x32_bf16 v[156:159], a[132:135], v[20:23], v[156:159]
    buffer_load_dwordx4 a[76:79], v2, s[8:11], s45 offen offset:1024 sc1
    v_mfma_f32_16x16x32_bf16 v[156:159], a[136:139], v[28:31], v[156:159]
    ds_read_b128 a[172:175], v3 offset:11264
    s_waitcnt lgkmcnt(6)
    v_mfma_f32_16x16x32_bf16 v[152:155], a[140:143], v[32:35], v[152:155]
    buffer_load_dwordx4 a[80:83], v2, s[8:11], s44 offen offset:2048 sc1
    s_add_u32 s22, s64, 0
    v_mfma_f32_16x16x32_bf16 v[152:155], a[144:147], v[40:43], v[152:155]
    ds_read_b128 a[128:131], v3 offset:12288
    buffer_load_dwordx4 a[84:87], v2, s[8:11], s45 offen offset:2048 sc1
    v_mfma_f32_16x16x32_bf16 v[152:155], a[148:151], v[48:51], v[152:155]
    buffer_load_dwordx4 a[88:91], v2, s[8:11], s44 offen offset:3072 sc1
    v_mul_f32 v185, 0x3e0293ee, v169
    v_mfma_f32_16x16x32_bf16 v[156:159], a[140:143], v[36:39], v[156:159]
    ds_read_b128 a[132:135], v3 offset:13312
    buffer_load_dwordx4 a[92:95], v2, s[8:11], s45 offen offset:3072 sc1
    buffer_load_dwordx4 v2, s[8:11], s22 offen offset:0 lds
    v_mfma_f32_16x16x32_bf16 v[156:159], a[144:147], v[44:47], v[156:159]
    v_cvt_pk_bf16_f32 v186, v184, v185
    v_accvgpr_write_b32 a36, v186
    v_mfma_f32_16x16x32_bf16 v[156:159], a[148:151], v[52:55], v[156:159]
    ds_read_b128 a[136:139], v3 offset:14336
    s_add_u32 s44, s44, 4096
    s_add_u32 s45, s45, 4096
    s_waitcnt lgkmcnt(6)
    v_mfma_f32_16x16x32_bf16 v[152:155], a[152:155], v[56:59], v[152:155]
    buffer_load_dwordx4 a[96:99], v2, s[8:11], s44 offen offset:0 sc1
    buffer_load_dwordx4 v2, s[8:11], s22 offen offset:1024 lds
    v_mfma_f32_16x16x32_bf16 v[152:155], a[156:159], v[64:67], v[152:155]
    ds_read_b128 a[140:143], v3 offset:15360
    buffer_load_dwordx4 a[100:103], v2, s[8:11], s45 offen offset:0 sc1
    v_mfma_f32_16x16x32_bf16 v[152:155], a[160:163], v[72:75], v[152:155]
    v_mul_f32 v187, 0x3e0293ee, v170
    v_mul_f32 v188, 0x3e0293ee, v171
    v_mfma_f32_16x16x32_bf16 v[156:159], a[152:155], v[60:63], v[156:159]
    ds_read_b128 a[144:147], v3 offset:16384
    buffer_load_dwordx4 a[104:107], v2, s[8:11], s44 offen offset:1024 sc1
    buffer_load_dwordx4 v2, s[8:11], s22 offen offset:2048 lds
    v_mfma_f32_16x16x32_bf16 v[156:159], a[156:159], v[68:71], v[156:159]
    buffer_load_dwordx4 a[108:111], v2, s[8:11], s45 offen offset:1024 sc1
    v_cvt_pk_bf16_f32 v189, v187, v188
    v_mfma_f32_16x16x32_bf16 v[156:159], a[160:163], v[76:79], v[156:159]
    ds_read_b128 a[148:151], v3 offset:17408
    buffer_load_dwordx4 a[112:115], v2, s[8:11], s44 offen offset:2048 sc1
    s_waitcnt lgkmcnt(6)
    v_mfma_f32_16x16x32_bf16 v[152:155], a[164:167], v[80:83], v[152:155]
    buffer_load_dwordx4 a[116:119], v2, s[8:11], s45 offen offset:2048 sc1
    buffer_load_dwordx4 v2, s[8:11], s22 offen offset:3072 lds
    v_mfma_f32_16x16x32_bf16 v[152:155], a[168:171], v[88:91], v[152:155]
    ds_read_b128 a[152:155], v3 offset:18432
    v_accvgpr_write_b32 a37, v189
    v_mfma_f32_16x16x32_bf16 v[152:155], a[172:175], v[96:99], v[152:155]
    buffer_load_dwordx4 a[120:123], v2, s[8:11], s44 offen offset:3072 sc1
    v_mfma_f32_16x16x32_bf16 v[156:159], a[164:167], v[84:87], v[156:159]
    ds_read_b128 a[156:159], v3 offset:19456
    buffer_load_dwordx4 a[124:127], v2, s[8:11], s45 offen offset:3072 sc1
    s_add_u32 m0, s21, 77824
    v_mfma_f32_16x16x32_bf16 v[156:159], a[168:171], v[92:95], v[156:159]
    s_add_u32 s44, s44, 4096
    s_add_u32 s45, s45, 4096
    v_mfma_f32_16x16x32_bf16 v[156:159], a[172:175], v[100:103], v[156:159]
    ds_read_b128 a[160:163], v3 offset:20480
    buffer_load_dwordx4 a[176:179], v2, s[8:11], s44 offen offset:0 sc1
    s_waitcnt lgkmcnt(6)
    v_mfma_f32_16x16x32_bf16 v[152:155], a[128:131], v[104:107], v[152:155]
    s_add_u32 s22, s64, 4096
    v_mul_f32 v184, 0x3e0293ee, v176
    v_mfma_f32_16x16x32_bf16 v[152:155], a[132:135], v[112:115], v[152:155]
    ds_read_b128 a[164:167], v3 offset:21504
    buffer_load_dwordx4 a[180:183], v2, s[8:11], s45 offen offset:0 sc1
    v_mfma_f32_16x16x32_bf16 v[152:155], a[136:139], v[120:123], v[152:155]
    buffer_load_dwordx4 a[184:187], v2, s[8:11], s44 offen offset:1024 sc1
    v_mul_f32 v185, 0x3e0293ee, v177
    v_mfma_f32_16x16x32_bf16 v[156:159], a[128:131], v[108:111], v[156:159]
    ds_read_b128 a[168:171], v3 offset:22528
    buffer_load_dwordx4 a[188:191], v2, s[8:11], s45 offen offset:1024 sc1
    v_mfma_f32_16x16x32_bf16 v[156:159], a[132:135], v[116:119], v[156:159]
    buffer_load_dwordx4 v2, s[8:11], s22 offen offset:0 lds
    v_cvt_pk_bf16_f32 v186, v184, v185
    v_mfma_f32_16x16x32_bf16 v[156:159], a[136:139], v[124:127], v[156:159]
    ds_read_b128 a[172:175], v3 offset:23552
    buffer_load_dwordx4 a[192:195], v2, s[8:11], s44 offen offset:2048 sc1
    s_waitcnt lgkmcnt(6)
    v_mfma_f32_16x16x32_bf16 v[152:155], a[140:143], v[128:131], v[152:155]
    buffer_load_dwordx4 a[196:199], v2, s[8:11], s45 offen offset:2048 sc1
    v_mfma_f32_16x16x32_bf16 v[152:155], a[144:147], v[136:139], v[152:155]
    ds_read_b128 a[128:131], v3 offset:24576
    buffer_load_dwordx4 a[200:203], v2, s[8:11], s44 offen offset:3072 sc1
    buffer_load_dwordx4 v2, s[8:11], s22 offen offset:1024 lds
    v_mfma_f32_16x16x32_bf16 v[152:155], a[148:151], v[144:147], v[152:155]
    buffer_load_dwordx4 a[204:207], v2, s[8:11], s45 offen offset:3072 sc1
    v_accvgpr_write_b32 a38, v186
    v_mfma_f32_16x16x32_bf16 v[156:159], a[140:143], v[132:135], v[156:159]
    ds_read_b128 a[132:135], v3 offset:25600
    v_mul_f32 v187, 0x3e0293ee, v178
    v_mfma_f32_16x16x32_bf16 v[156:159], a[144:147], v[140:143], v[156:159]
    s_add_u32 s44, s44, 4096
    s_add_u32 s45, s45, 4096
    buffer_load_dwordx4 v2, s[8:11], s22 offen offset:2048 lds
    v_mfma_f32_16x16x32_bf16 v[156:159], a[148:151], v[148:151], v[156:159]
    ds_read_b128 a[136:139], v3 offset:26624
    buffer_load_dwordx4 a[208:211], v2, s[8:11], s44 offen offset:0 sc1
    s_waitcnt lgkmcnt(6)
    v_mfma_f32_16x16x32_bf16 v[160:163], a[152:155], v[8:11], 0
    buffer_load_dwordx4 a[212:215], v2, s[8:11], s45 offen offset:0 sc1
    v_mfma_f32_16x16x32_bf16 v[160:163], a[156:159], v[16:19], v[160:163]
    ds_read_b128 a[140:143], v3 offset:27648
    buffer_load_dwordx4 a[216:219], v2, s[8:11], s44 offen offset:1024 sc1
    buffer_load_dwordx4 v2, s[8:11], s22 offen offset:3072 lds
    v_mfma_f32_16x16x32_bf16 v[160:163], a[160:163], v[24:27], v[160:163]
    v_mul_f32 v188, 0x3e0293ee, v179
    v_cvt_pk_bf16_f32 v189, v187, v188
    v_mfma_f32_16x16x32_bf16 v[164:167], a[152:155], v[12:15], 0
    ds_read_b128 a[144:147], v3 offset:28672
    buffer_load_dwordx4 a[220:223], v2, s[8:11], s45 offen offset:1024 sc1
    v_mfma_f32_16x16x32_bf16 v[164:167], a[156:159], v[20:23], v[164:167]
    buffer_load_dwordx4 a[224:227], v2, s[8:11], s44 offen offset:2048 sc1
    s_add_u32 m0, s21, 81920
    v_mfma_f32_16x16x32_bf16 v[164:167], a[160:163], v[28:31], v[164:167]
    ds_read_b128 a[148:151], v3 offset:29696
    buffer_load_dwordx4 a[228:231], v2, s[8:11], s45 offen offset:2048 sc1
    s_waitcnt lgkmcnt(6)
    v_mfma_f32_16x16x32_bf16 v[160:163], a[164:167], v[32:35], v[160:163]
    v_accvgpr_write_b32 a39, v189
    v_mul_f32 v184, 0x3e0293ee, v172
    v_mfma_f32_16x16x32_bf16 v[160:163], a[168:171], v[40:43], v[160:163]
    ds_read_b128 a[152:155], v3 offset:30720
    buffer_load_dwordx4 a[232:235], v2, s[8:11], s44 offen offset:3072 sc1
    s_add_u32 s22, s64, 8192
    v_mfma_f32_16x16x32_bf16 v[160:163], a[172:175], v[48:51], v[160:163]
    buffer_load_dwordx4 a[236:239], v2, s[8:11], s45 offen offset:3072 sc1
    v_mul_f32 v185, 0x3e0293ee, v173
    v_mfma_f32_16x16x32_bf16 v[164:167], a[164:167], v[36:39], v[164:167]
    ds_read_b128 a[156:159], v3 offset:31744
    s_add_u32 s44, s44, 4096
    s_add_u32 s45, s45, 4096
    v_mfma_f32_16x16x32_bf16 v[164:167], a[168:171], v[44:47], v[164:167]
    buffer_load_dwordx4 a[240:243], v2, s[8:11], s44 offen offset:0 sc1
    buffer_load_dwordx4 v2, s[8:11], s22 offen offset:0 lds
    v_mfma_f32_16x16x32_bf16 v[164:167], a[172:175], v[52:55], v[164:167]
    ds_read_b128 a[160:163], v3 offset:32768
    s_waitcnt lgkmcnt(6)
    v_mfma_f32_16x16x32_bf16 v[160:163], a[128:131], v[56:59], v[160:163]
    buffer_load_dwordx4 a[244:247], v2, s[8:11], s45 offen offset:0 sc1
    v_cvt_pk_bf16_f32 v186, v184, v185
    v_mfma_f32_16x16x32_bf16 v[160:163], a[132:135], v[64:67], v[160:163]
    ds_read_b128 a[164:167], v3 offset:33792
    buffer_load_dwordx4 a[248:251], v2, s[8:11], s44 offen offset:1024 sc1
    v_mfma_f32_16x16x32_bf16 v[160:163], a[136:139], v[72:75], v[160:163]
    buffer_load_dwordx4 a[252:255], v2, s[8:11], s45 offen offset:1024 sc1
    v_mfma_f32_16x16x32_bf16 v[164:167], a[128:131], v[60:63], v[164:167]
    ds_read_b128 a[168:171], v3 offset:34816
    v_accvgpr_write_b32 a52, v186
    v_mfma_f32_16x16x32_bf16 v[164:167], a[132:135], v[68:71], v[164:167]
    v_mul_f32 v187, 0x3e0293ee, v174
    v_mul_f32 v188, 0x3e0293ee, v175
    v_mfma_f32_16x16x32_bf16 v[164:167], a[136:139], v[76:79], v[164:167]
    ds_read_b128 a[172:175], v3 offset:35840
    v_cvt_pk_bf16_f32 v189, v187, v188
    s_waitcnt lgkmcnt(6)
    v_mfma_f32_16x16x32_bf16 v[160:163], a[140:143], v[80:83], v[160:163]
    s_waitcnt vmcnt(45)
    s_barrier
    v_mfma_f32_16x16x32_bf16 v[160:163], a[144:147], v[88:91], v[160:163]
    ds_read_b128 a[128:131], v4 offset:0
    v_accvgpr_write_b32 a53, v189
    v_mfma_f32_16x16x32_bf16 v[160:163], a[148:151], v[96:99], v[160:163]
    v_mul_f32 v184, 0x3e0293ee, v180
    v_mul_f32 v185, 0x3e0293ee, v181
    v_mfma_f32_16x16x32_bf16 v[164:167], a[140:143], v[84:87], v[164:167]
    ds_read_b128 a[132:135], v4 offset:1024
    s_add_u32 m0, s21, 110592
    s_add_u32 s22, s65, 0
    v_mfma_f32_16x16x32_bf16 v[164:167], a[144:147], v[92:95], v[164:167]
    buffer_load_dwordx4 v2, s[8:11], s22 offen offset:0 lds
    v_mfma_f32_16x16x32_bf16 v[164:167], a[148:151], v[100:103], v[164:167]
    ds_read_b128 a[136:139], v4 offset:2048
    buffer_load_dwordx4 v2, s[8:11], s22 offen offset:1024 lds
    s_waitcnt lgkmcnt(6)
    v_mfma_f32_16x16x32_bf16 v[160:163], a[152:155], v[104:107], v[160:163]
    buffer_load_dwordx4 v2, s[8:11], s22 offen offset:2048 lds
    v_cvt_pk_bf16_f32 v186, v184, v185
    v_mfma_f32_16x16x32_bf16 v[160:163], a[156:159], v[112:115], v[160:163]
    ds_read_b128 a[140:143], v4 offset:3072
    buffer_load_dwordx4 v2, s[8:11], s22 offen offset:3072 lds
    v_mfma_f32_16x16x32_bf16 v[160:163], a[160:163], v[120:123], v[160:163]
    s_add_u32 m0, s21, 114688
    v_accvgpr_write_b32 a54, v186
    v_mfma_f32_16x16x32_bf16 v[164:167], a[152:155], v[108:111], v[164:167]
    ds_read_b128 a[144:147], v4 offset:4096
    s_add_u32 s22, s65, 4096
    v_mfma_f32_16x16x32_bf16 v[164:167], a[156:159], v[116:119], v[164:167]
    buffer_load_dwordx4 v2, s[8:11], s22 offen offset:0 lds
    v_mul_f32 v187, 0x3e0293ee, v182
    v_mfma_f32_16x16x32_bf16 v[164:167], a[160:163], v[124:127], v[164:167]
    ds_read_b128 a[148:151], v4 offset:5120
    buffer_load_dwordx4 v2, s[8:11], s22 offen offset:1024 lds
    s_waitcnt lgkmcnt(6)
    v_mfma_f32_16x16x32_bf16 v[160:163], a[164:167], v[128:131], v[160:163]
    buffer_load_dwordx4 v2, s[8:11], s22 offen offset:2048 lds
    v_mfma_f32_16x16x32_bf16 v[160:163], a[168:171], v[136:139], v[160:163]
    ds_read_b128 a[152:155], v4 offset:6144
    buffer_load_dwordx4 v2, s[8:11], s22 offen offset:3072 lds
    v_mfma_f32_16x16x32_bf16 v[160:163], a[172:175], v[144:147], v[160:163]
    s_add_u32 m0, s21, 118784
    v_mul_f32 v188, 0x3e0293ee, v183
    v_mfma_f32_16x16x32_bf16 v[164:167], a[164:167], v[132:135], v[164:167]
    ds_read_b128 a[156:159], v4 offset:7168
    s_add_u32 s22, s65, 8192
    v_mfma_f32_16x16x32_bf16 v[164:167], a[168:171], v[140:143], v[164:167]
    buffer_load_dwordx4 v2, s[8:11], s22 offen offset:0 lds
    v_cvt_pk_bf16_f32 v189, v187, v188
    v_mfma_f32_16x16x32_bf16 v[164:167], a[172:175], v[148:151], v[164:167]
    ds_read_b128 a[160:163], v4 offset:8192
    v_accvgpr_write_b32 a55, v189
    s_waitcnt lgkmcnt(6)
    v_mfma_f32_16x16x32_bf16 v[168:171], a[128:131], v[8:11], 0
    v_mfma_f32_16x16x32_bf16 v[168:171], a[132:135], v[16:19], v[168:171]
    ds_read_b128 a[164:167], v4 offset:9216
    v_mfma_f32_16x16x32_bf16 v[168:171], a[136:139], v[24:27], v[168:171]
    s_mul_i32 s17, s16, 18432
    v_mfma_f32_16x16x32_bf16 v[172:175], a[128:131], v[12:15], 0
    ds_read_b128 a[168:171], v4 offset:10240
    v_mfma_f32_16x16x32_bf16 v[172:175], a[132:135], v[20:23], v[172:175]
    s_add_u32 s18, s17, 0
    v_mfma_f32_16x16x32_bf16 v[172:175], a[136:139], v[28:31], v[172:175]
    ds_read_b128 a[172:175], v4 offset:11264
    s_waitcnt lgkmcnt(6)
    v_mfma_f32_16x16x32_bf16 v[168:171], a[140:143], v[32:35], v[168:171]
    v_mul_f32 v184, 0x3e0293ee, v152
    v_mfma_f32_16x16x32_bf16 v[168:171], a[144:147], v[40:43], v[168:171]
    ds_read_b128 a[128:131], v4 offset:12288
    s_add_u32 s19, s17, 4718592
    v_mfma_f32_16x16x32_bf16 v[168:171], a[148:151], v[48:51], v[168:171]
    v_mul_f32 v185, 0x3e0293ee, v153
    v_mfma_f32_16x16x32_bf16 v[172:175], a[140:143], v[36:39], v[172:175]
    ds_read_b128 a[132:135], v4 offset:13312
    s_lshl_b32 s23, s4, 10
    v_mfma_f32_16x16x32_bf16 v[172:175], a[144:147], v[44:47], v[172:175]
    v_cvt_pk_bf16_f32 v186, v184, v185
    v_mfma_f32_16x16x32_bf16 v[172:175], a[148:151], v[52:55], v[172:175]
    ds_read_b128 a[136:139], v4 offset:14336
    s_waitcnt lgkmcnt(6)
    v_mfma_f32_16x16x32_bf16 v[168:171], a[152:155], v[56:59], v[168:171]
    s_add_u32 s18, s18, s23
    v_mfma_f32_16x16x32_bf16 v[168:171], a[156:159], v[64:67], v[168:171]
    ds_read_b128 a[140:143], v4 offset:15360
    v_accvgpr_write_b32 a40, v186
    v_mfma_f32_16x16x32_bf16 v[168:171], a[160:163], v[72:75], v[168:171]
    s_add_u32 s19, s19, s23
    v_mfma_f32_16x16x32_bf16 v[172:175], a[152:155], v[60:63], v[172:175]
    ds_read_b128 a[144:147], v4 offset:16384
    v_mfma_f32_16x16x32_bf16 v[172:175], a[156:159], v[68:71], v[172:175]
    v_mul_f32 v187, 0x3e0293ee, v154
    v_mfma_f32_16x16x32_bf16 v[172:175], a[160:163], v[76:79], v[172:175]
    ds_read_b128 a[148:151], v4 offset:17408
    s_add_u32 s44, s18, 18432
    s_waitcnt lgkmcnt(6)
    v_mfma_f32_16x16x32_bf16 v[168:171], a[164:167], v[80:83], v[168:171]
    v_mul_f32 v188, 0x3e0293ee, v155
    v_mfma_f32_16x16x32_bf16 v[168:171], a[168:171], v[88:91], v[168:171]
    ds_read_b128 a[152:155], v4 offset:18432
    s_add_u32 s45, s19, 18432
    v_mfma_f32_16x16x32_bf16 v[168:171], a[172:175], v[96:99], v[168:171]
    v_cvt_pk_bf16_f32 v189, v187, v188
    v_mfma_f32_16x16x32_bf16 v[172:175], a[164:167], v[84:87], v[172:175]
    ds_read_b128 a[156:159], v4 offset:19456
    v_mfma_f32_16x16x32_bf16 v[172:175], a[168:171], v[92:95], v[172:175]
    s_add_u32 s46, s18, 14336
    v_mfma_f32_16x16x32_bf16 v[172:175], a[172:175], v[100:103], v[172:175]
    ds_read_b128 a[160:163], v4 offset:20480
    s_waitcnt lgkmcnt(6)
    v_mfma_f32_16x16x32_bf16 v[168:171], a[128:131], v[104:107], v[168:171]
    s_add_u32 s47, s44, 14336
    v_mfma_f32_16x16x32_bf16 v[168:171], a[132:135], v[112:115], v[168:171]
    ds_read_b128 a[164:167], v4 offset:21504
    v_mfma_f32_16x16x32_bf16 v[168:171], a[136:139], v[120:123], v[168:171]
    v_accvgpr_write_b32 a41, v189
    v_mfma_f32_16x16x32_bf16 v[172:175], a[128:131], v[108:111], v[172:175]
    ds_read_b128 a[168:171], v4 offset:22528
    s_add_u32 s48, s19, 14336
    v_mfma_f32_16x16x32_bf16 v[172:175], a[132:135], v[116:119], v[172:175]
    v_mul_f32 v184, 0x3e0293ee, v160
    v_mfma_f32_16x16x32_bf16 v[172:175], a[136:139], v[124:127], v[172:175]
    ds_read_b128 a[172:175], v4 offset:23552
    s_add_u32 s49, s45, 14336
    s_waitcnt lgkmcnt(6)
    v_mfma_f32_16x16x32_bf16 v[168:171], a[140:143], v[128:131], v[168:171]
    v_mul_f32 v185, 0x3e0293ee, v161
    v_mfma_f32_16x16x32_bf16 v[168:171], a[144:147], v[136:139], v[168:171]
    ds_read_b128 a[128:131], v4 offset:24576
    v_mfma_f32_16x16x32_bf16 v[168:171], a[148:151], v[144:147], v[168:171]
    buffer_load_dwordx4 v[232:235], v2, s[8:11], s18 offen
    v_mfma_f32_16x16x32_bf16 v[172:175], a[140:143], v[132:135], v[172:175]
    ds_read_b128 a[132:135], v4 offset:25600
    v_mfma_f32_16x16x32_bf16 v[172:175], a[144:147], v[140:143], v[172:175]
    buffer_load_dwordx4 v[236:239], v2, s[8:11], s44 offen
    v_mfma_f32_16x16x32_bf16 v[172:175], a[148:151], v[148:151], v[172:175]
    ds_read_b128 a[136:139], v4 offset:26624
    s_waitcnt lgkmcnt(6)
    v_mfma_f32_16x16x32_bf16 v[176:179], a[152:155], v[8:11], 0
    v_cvt_pk_bf16_f32 v186, v184, v185
    v_mfma_f32_16x16x32_bf16 v[176:179], a[156:159], v[16:19], v[176:179]
    ds_read_b128 a[140:143], v4 offset:27648
    buffer_load_dwordx4 v[240:243], v2, s[8:11], s46 offen
    v_mfma_f32_16x16x32_bf16 v[176:179], a[160:163], v[24:27], v[176:179]
    v_accvgpr_write_b32 a42, v186
    v_mfma_f32_16x16x32_bf16 v[180:183], a[152:155], v[12:15], 0
    ds_read_b128 a[144:147], v4 offset:28672
    buffer_load_dwordx4 v[244:247], v2, s[8:11], s47 offen
    v_mfma_f32_16x16x32_bf16 v[180:183], a[156:159], v[20:23], v[180:183]
    v_mul_f32 v187, 0x3e0293ee, v162
    v_mul_f32 v188, 0x3e0293ee, v163
    v_mfma_f32_16x16x32_bf16 v[180:183], a[160:163], v[28:31], v[180:183]
    ds_read_b128 a[148:151], v4 offset:29696
    s_waitcnt lgkmcnt(6)
    v_mfma_f32_16x16x32_bf16 v[176:179], a[164:167], v[32:35], v[176:179]
    v_lshlrev_b32 v197, 7, v1
    v_mfma_f32_16x16x32_bf16 v[176:179], a[168:171], v[40:43], v[176:179]
    ds_read_b128 a[152:155], v4 offset:30720
    v_mfma_f32_16x16x32_bf16 v[176:179], a[172:175], v[48:51], v[176:179]
    s_lshl_b32 s23, s3, 13
    v_mfma_f32_16x16x32_bf16 v[180:183], a[164:167], v[36:39], v[180:183]
    ds_read_b128 a[156:159], v4 offset:31744
    v_mfma_f32_16x16x32_bf16 v[180:183], a[168:171], v[44:47], v[180:183]
    v_cvt_pk_bf16_f32 v189, v187, v188
    v_mfma_f32_16x16x32_bf16 v[180:183], a[172:175], v[52:55], v[180:183]
    ds_read_b128 a[160:163], v4 offset:32768
    v_add_u32 v197, s23, v197
    s_waitcnt lgkmcnt(6)
    v_mfma_f32_16x16x32_bf16 v[176:179], a[128:131], v[56:59], v[176:179]
    v_accvgpr_write_b32 a43, v189
    v_mfma_f32_16x16x32_bf16 v[176:179], a[132:135], v[64:67], v[176:179]
    ds_read_b128 a[164:167], v4 offset:33792
    buffer_load_dword v198, v197, s[28:31], 0 offen
    v_mfma_f32_16x16x32_bf16 v[176:179], a[136:139], v[72:75], v[176:179]
    v_mul_f32 v184, 0x3e0293ee, v156
    v_mfma_f32_16x16x32_bf16 v[180:183], a[128:131], v[60:63], v[180:183]
    ds_read_b128 a[168:171], v4 offset:34816
    v_mfma_f32_16x16x32_bf16 v[180:183], a[132:135], v[68:71], v[180:183]
    buffer_load_dword v199, v197, s[32:35], 0 offen
    v_mfma_f32_16x16x32_bf16 v[180:183], a[136:139], v[76:79], v[180:183]
    ds_read_b128 a[172:175], v4 offset:35840
    s_waitcnt lgkmcnt(6)
    v_mfma_f32_16x16x32_bf16 v[176:179], a[140:143], v[80:83], v[176:179]
    v_add_u32 v197, 32768, v197
    v_mfma_f32_16x16x32_bf16 v[176:179], a[144:147], v[88:91], v[176:179]
    v_mul_f32 v185, 0x3e0293ee, v157
    v_mfma_f32_16x16x32_bf16 v[176:179], a[148:151], v[96:99], v[176:179]
    v_cvt_pk_bf16_f32 v186, v184, v185
    v_mfma_f32_16x16x32_bf16 v[180:183], a[140:143], v[84:87], v[180:183]
    buffer_load_dword v218, v197, s[28:31], 0 offen
    v_mfma_f32_16x16x32_bf16 v[180:183], a[144:147], v[92:95], v[180:183]
    v_accvgpr_write_b32 a56, v186
    v_mfma_f32_16x16x32_bf16 v[180:183], a[148:151], v[100:103], v[180:183]
    s_waitcnt lgkmcnt(3)
    v_mfma_f32_16x16x32_bf16 v[176:179], a[152:155], v[104:107], v[176:179]
    v_mul_f32 v187, 0x3e0293ee, v158
    v_mfma_f32_16x16x32_bf16 v[176:179], a[156:159], v[112:115], v[176:179]
    v_mul_f32 v188, 0x3e0293ee, v159
    v_mfma_f32_16x16x32_bf16 v[176:179], a[160:163], v[120:123], v[176:179]
    v_cvt_pk_bf16_f32 v189, v187, v188
    v_mfma_f32_16x16x32_bf16 v[180:183], a[152:155], v[108:111], v[180:183]
    v_accvgpr_write_b32 a57, v189
    v_mul_f32 v184, 0x3e0293ee, v164
    v_mfma_f32_16x16x32_bf16 v[180:183], a[156:159], v[116:119], v[180:183]
    v_mul_f32 v185, 0x3e0293ee, v165
    v_mfma_f32_16x16x32_bf16 v[180:183], a[160:163], v[124:127], v[180:183]
    s_waitcnt lgkmcnt(0)
    v_mfma_f32_16x16x32_bf16 v[176:179], a[164:167], v[128:131], v[176:179]
    v_cvt_pk_bf16_f32 v186, v184, v185
    v_mfma_f32_16x16x32_bf16 v[176:179], a[168:171], v[136:139], v[176:179]
    v_accvgpr_write_b32 a58, v186
    v_mfma_f32_16x16x32_bf16 v[176:179], a[172:175], v[144:147], v[176:179]
    v_mul_f32 v187, 0x3e0293ee, v166
    v_mfma_f32_16x16x32_bf16 v[180:183], a[164:167], v[132:135], v[180:183]
    v_mul_f32 v188, 0x3e0293ee, v167
    v_mfma_f32_16x16x32_bf16 v[180:183], a[168:171], v[140:143], v[180:183]
    v_cvt_pk_bf16_f32 v189, v187, v188
    v_mfma_f32_16x16x32_bf16 v[180:183], a[172:175], v[148:151], v[180:183]
    v_accvgpr_write_b32 a59, v189
    v_mul_f32 v184, 0x3e0293ee, v168
    v_mul_f32 v185, 0x3e0293ee, v169
    v_cvt_pk_bf16_f32 v186, v184, v185
    v_accvgpr_write_b32 a44, v186
    v_mul_f32 v187, 0x3e0293ee, v170
    v_mul_f32 v188, 0x3e0293ee, v171
    v_cvt_pk_bf16_f32 v189, v187, v188
    v_accvgpr_write_b32 a45, v189
    v_mul_f32 v184, 0x3e0293ee, v176
    v_mul_f32 v185, 0x3e0293ee, v177
    v_cvt_pk_bf16_f32 v186, v184, v185
    v_accvgpr_write_b32 a46, v186
    v_mul_f32 v187, 0x3e0293ee, v178
    v_mul_f32 v188, 0x3e0293ee, v179
    v_cvt_pk_bf16_f32 v189, v187, v188
    v_accvgpr_write_b32 a47, v189
    v_mul_f32 v184, 0x3e0293ee, v172
    v_mul_f32 v185, 0x3e0293ee, v173
    v_cvt_pk_bf16_f32 v186, v184, v185
    v_accvgpr_write_b32 a60, v186
    v_mul_f32 v187, 0x3e0293ee, v174
    v_mul_f32 v188, 0x3e0293ee, v175
    v_cvt_pk_bf16_f32 v189, v187, v188
    v_accvgpr_write_b32 a61, v189
    v_mul_f32 v184, 0x3e0293ee, v180
    v_mul_f32 v185, 0x3e0293ee, v181
    v_cvt_pk_bf16_f32 v186, v184, v185
    v_accvgpr_write_b32 a62, v186
    v_mul_f32 v187, 0x3e0293ee, v182
    v_mul_f32 v188, 0x3e0293ee, v183
    v_cvt_pk_bf16_f32 v189, v187, v188
    v_accvgpr_write_b32 a63, v189
    s_barrier
    s_cmp_lg_u32 s53, 0
    s_cbranch_scc1 kmain_kernel_hsok
    s_mov_b32 s60, 0
kmain_kernel_w1_4:
    buffer_load_dword v196, v194, s[8:11], 0 offen sc1
    s_waitcnt vmcnt(0)
    v_cmp_lt_u32 vcc, v196, v195
    s_cbranch_vccz kmain_kernel_w1_4_o
    s_add_u32 s60, s60, 1
    s_cmp_ge_u32 s60, 0x20000
    s_cbranch_scc1 kmain_kernel_w1_4_o
    s_sleep 8
    s_branch kmain_kernel_w1_4
kmain_kernel_w1_4_o:
    s_mul_i32 s17, s16, 18432
    s_add_u32 s17, s17, 2359296
    s_add_u32 s23, s17, 18432
    buffer_load_dwordx4 a[64:67], v2, s[8:11], s17 offen offset:0 sc1
    buffer_load_dwordx4 a[68:71], v2, s[8:11], s23 offen offset:0 sc1
    buffer_load_dwordx4 a[72:75], v2, s[8:11], s17 offen offset:1024 sc1
    buffer_load_dwordx4 a[76:79], v2, s[8:11], s23 offen offset:1024 sc1
    buffer_load_dwordx4 a[80:83], v2, s[8:11], s17 offen offset:2048 sc1
    buffer_load_dwordx4 a[84:87], v2, s[8:11], s23 offen offset:2048 sc1
    buffer_load_dwordx4 a[88:91], v2, s[8:11], s17 offen offset:3072 sc1
    buffer_load_dwordx4 a[92:95], v2, s[8:11], s23 offen offset:3072 sc1
    s_add_u32 s17, s17, 4096
    s_add_u32 s23, s23, 4096
    buffer_load_dwordx4 a[96:99], v2, s[8:11], s17 offen offset:0 sc1
    buffer_load_dwordx4 a[100:103], v2, s[8:11], s23 offen offset:0 sc1
    buffer_load_dwordx4 a[104:107], v2, s[8:11], s17 offen offset:1024 sc1
    buffer_load_dwordx4 a[108:111], v2, s[8:11], s23 offen offset:1024 sc1
    buffer_load_dwordx4 a[112:115], v2, s[8:11], s17 offen offset:2048 sc1
    buffer_load_dwordx4 a[116:119], v2, s[8:11], s23 offen offset:2048 sc1
    buffer_load_dwordx4 a[120:123], v2, s[8:11], s17 offen offset:3072 sc1
    buffer_load_dwordx4 a[124:127], v2, s[8:11], s23 offen offset:3072 sc1
    s_add_u32 s17, s17, 4096
    s_add_u32 s23, s23, 4096
    buffer_load_dwordx4 a[176:179], v2, s[8:11], s17 offen offset:0 sc1
    buffer_load_dwordx4 a[180:183], v2, s[8:11], s23 offen offset:0 sc1
    buffer_load_dwordx4 a[184:187], v2, s[8:11], s17 offen offset:1024 sc1
    buffer_load_dwordx4 a[188:191], v2, s[8:11], s23 offen offset:1024 sc1
    buffer_load_dwordx4 a[192:195], v2, s[8:11], s17 offen offset:2048 sc1
    buffer_load_dwordx4 a[196:199], v2, s[8:11], s23 offen offset:2048 sc1
    buffer_load_dwordx4 a[200:203], v2, s[8:11], s17 offen offset:3072 sc1
    buffer_load_dwordx4 a[204:207], v2, s[8:11], s23 offen offset:3072 sc1
    s_add_u32 s17, s17, 4096
    s_add_u32 s23, s23, 4096
    buffer_load_dwordx4 a[208:211], v2, s[8:11], s17 offen offset:0 sc1
    buffer_load_dwordx4 a[212:215], v2, s[8:11], s23 offen offset:0 sc1
    buffer_load_dwordx4 a[216:219], v2, s[8:11], s17 offen offset:1024 sc1
    buffer_load_dwordx4 a[220:223], v2, s[8:11], s23 offen offset:1024 sc1
    buffer_load_dwordx4 a[224:227], v2, s[8:11], s17 offen offset:2048 sc1
    buffer_load_dwordx4 a[228:231], v2, s[8:11], s23 offen offset:2048 sc1
    buffer_load_dwordx4 a[232:235], v2, s[8:11], s17 offen offset:3072 sc1
    buffer_load_dwordx4 a[236:239], v2, s[8:11], s23 offen offset:3072 sc1
    s_add_u32 s17, s17, 4096
    s_add_u32 s23, s23, 4096
    buffer_load_dwordx4 a[240:243], v2, s[8:11], s17 offen offset:0 sc1
    buffer_load_dwordx4 a[244:247], v2, s[8:11], s23 offen offset:0 sc1
    buffer_load_dwordx4 a[248:251], v2, s[8:11], s17 offen offset:1024 sc1
    buffer_load_dwordx4 a[252:255], v2, s[8:11], s23 offen offset:1024 sc1
    s_waitcnt vmcnt(0)
kmain_kernel_hsok:
    v_mov_b32 v56, v200
    v_mov_b32 v57, v201
    v_mov_b32 v58, v202
    v_mov_b32 v59, v203
    v_mov_b32 v60, v204
    v_mov_b32 v61, v205
    v_mov_b32 v62, v206
    v_mov_b32 v63, v207
    v_mov_b32 v64, v208
    v_mov_b32 v65, v209
    v_mov_b32 v66, v210
    v_mov_b32 v67, v211
    v_mov_b32 v68, v212
    v_mov_b32 v69, v213
    v_mov_b32 v70, v214
    v_mov_b32 v71, v215
    v_mov_b32 v72, v216
    v_mov_b32 v73, v217
    s_mov_b32 s36, 0
    s_mov_b32 s37, 0
    s_add_u32 m0, s38, 0
    s_nop 0
    buffer_load_dwordx4 v68, s[28:31], s36 offen offset:0 lds
    buffer_load_dwordx4 v69, s[28:31], s36 offen offset:1024 lds
    buffer_load_dwordx4 v70, s[28:31], s36 offen offset:2048 lds
    buffer_load_dwordx4 v71, s[28:31], s36 offen offset:3072 lds
    s_add_u32 s36, s36, 16384
    s_min_u32 s36, s36, 507904
    s_add_u32 m0, s38, 16384
    s_nop 0
    buffer_load_dwordx4 v68, s[28:31], s36 offen offset:0 lds
    buffer_load_dwordx4 v69, s[28:31], s36 offen offset:1024 lds
    buffer_load_dwordx4 v70, s[28:31], s36 offen offset:2048 lds
    buffer_load_dwordx4 v71, s[28:31], s36 offen offset:3072 lds
    s_add_u32 s36, s36, 16384
    s_min_u32 s36, s36, 507904
    s_add_u32 m0, s38, 32768
    s_nop 0
    buffer_load_dwordx4 v68, s[28:31], s36 offen offset:0 lds
    buffer_load_dwordx4 v69, s[28:31], s36 offen offset:1024 lds
    buffer_load_dwordx4 v70, s[28:31], s36 offen offset:2048 lds
    buffer_load_dwordx4 v71, s[28:31], s36 offen offset:3072 lds
    s_mul_i32 s52, s16, 20
    s_add_u32 s52, s52, s4
    s_lshl_b32 s52, s52, 7
    s_add_u32 s52, s52, 9445376
    s_sub_u32 s23, s4, 2
    s_cmp_lt_u32 s23, 2
    s_cbranch_scc1 kmain_kernel_x2
    s_waitcnt vmcnt(12)
    s_barrier
    ds_read_b128 a[128:131], v5 offset:0
    ds_read_b128 a[132:135], v5 offset:1024
    ds_read_b128 a[136:139], v5 offset:2048
    ds_read_b128 a[140:143], v5 offset:3072
    ds_read_b128 a[144:147], v5 offset:4096
    ds_read_b128 a[148:151], v5 offset:5120
    ds_read_b128 a[152:155], v5 offset:6144
    ds_read_b128 a[156:159], v5 offset:7168
    ds_read_b128 a[160:163], v5 offset:8192
    s_waitcnt lgkmcnt(6)
    v_mfma_f32_16x16x32_bf16 v[152:155], a[128:131], a[64:67], 0
    v_mfma_f32_16x16x32_bf16 v[152:155], a[132:135], a[72:75], v[152:155]
    ds_read_b128 a[164:167], v5 offset:9216
    v_mfma_f32_16x16x32_bf16 v[152:155], a[136:139], a[80:83], v[152:155]
    v_mfma_f32_16x16x32_bf16 v[156:159], a[128:131], a[68:71], 0
    ds_read_b128 a[168:171], v5 offset:10240
    v_mfma_f32_16x16x32_bf16 v[156:159], a[132:135], a[76:79], v[156:159]
    v_mfma_f32_16x16x32_bf16 v[156:159], a[136:139], a[84:87], v[156:159]
    ds_read_b128 a[172:175], v5 offset:11264
    s_waitcnt lgkmcnt(6)
    v_mfma_f32_16x16x32_bf16 v[152:155], a[140:143], a[88:91], v[152:155]
    v_mfma_f32_16x16x32_bf16 v[152:155], a[144:147], a[96:99], v[152:155]
    ds_read_b128 a[128:131], v5 offset:12288
    v_mfma_f32_16x16x32_bf16 v[152:155], a[148:151], a[104:107], v[152:155]
    v_mfma_f32_16x16x32_bf16 v[156:159], a[140:143], a[92:95], v[156:159]
    ds_read_b128 a[132:135], v5 offset:13312
    v_mfma_f32_16x16x32_bf16 v[156:159], a[144:147], a[100:103], v[156:159]
    v_mfma_f32_16x16x32_bf16 v[156:159], a[148:151], a[108:111], v[156:159]
    ds_read_b128 a[136:139], v5 offset:14336
    s_waitcnt lgkmcnt(6)
    v_mfma_f32_16x16x32_bf16 v[152:155], a[152:155], a[112:115], v[152:155]
    v_mfma_f32_16x16x32_bf16 v[152:155], a[156:159], a[120:123], v[152:155]
    ds_read_b128 a[140:143], v5 offset:15360
    v_mfma_f32_16x16x32_bf16 v[152:155], a[160:163], a[176:179], v[152:155]
    v_mfma_f32_16x16x32_bf16 v[156:159], a[152:155], a[116:119], v[156:159]
    ds_read_b128 a[144:147], v5 offset:16384
    v_mfma_f32_16x16x32_bf16 v[156:159], a[156:159], a[124:127], v[156:159]
    v_mfma_f32_16x16x32_bf16 v[156:159], a[160:163], a[180:183], v[156:159]
    ds_read_b128 a[148:151], v5 offset:17408
    s_waitcnt lgkmcnt(6)
    v_mfma_f32_16x16x32_bf16 v[152:155], a[164:167], a[184:187], v[152:155]
    v_mfma_f32_16x16x32_bf16 v[152:155], a[168:171], a[192:195], v[152:155]
    ds_read_b128 a[152:155], v5 offset:18432
    v_mfma_f32_16x16x32_bf16 v[152:155], a[172:175], a[200:203], v[152:155]
    v_mfma_f32_16x16x32_bf16 v[156:159], a[164:167], a[188:191], v[156:159]
    ds_read_b128 a[156:159], v5 offset:19456
    v_mfma_f32_16x16x32_bf16 v[156:159], a[168:171], a[196:199], v[156:159]
    v_mfma_f32_16x16x32_bf16 v[156:159], a[172:175], a[204:207], v[156:159]
    ds_read_b128 a[160:163], v5 offset:20480
    s_waitcnt lgkmcnt(6)
    v_mfma_f32_16x16x32_bf16 v[152:155], a[128:131], a[208:211], v[152:155]
    v_mfma_f32_16x16x32_bf16 v[152:155], a[132:135], a[216:219], v[152:155]
    ds_read_b128 a[164:167], v5 offset:21504
    v_mfma_f32_16x16x32_bf16 v[152:155], a[136:139], a[224:227], v[152:155]
    v_mfma_f32_16x16x32_bf16 v[156:159], a[128:131], a[212:215], v[156:159]
    ds_read_b128 a[168:171], v5 offset:22528
    v_mfma_f32_16x16x32_bf16 v[156:159], a[132:135], a[220:223], v[156:159]
    v_mfma_f32_16x16x32_bf16 v[156:159], a[136:139], a[228:231], v[156:159]
    ds_read_b128 a[172:175], v5 offset:23552
    s_waitcnt lgkmcnt(6)
    v_mfma_f32_16x16x32_bf16 v[152:155], a[140:143], a[232:235], v[152:155]
    v_mfma_f32_16x16x32_bf16 v[152:155], a[144:147], a[240:243], v[152:155]
    ds_read_b128 a[128:131], v5 offset:24576
    v_mfma_f32_16x16x32_bf16 v[152:155], a[148:151], a[248:251], v[152:155]
    v_mfma_f32_16x16x32_bf16 v[156:159], a[140:143], a[236:239], v[156:159]
    ds_read_b128 a[132:135], v5 offset:25600
    v_mfma_f32_16x16x32_bf16 v[156:159], a[144:147], a[244:247], v[156:159]
    v_mfma_f32_16x16x32_bf16 v[156:159], a[148:151], a[252:255], v[156:159]
    ds_read_b128 a[136:139], v5 offset:26624
    s_waitcnt lgkmcnt(6)
    v_mfma_f32_16x16x32_bf16 v[160:163], a[152:155], a[64:67], 0
    v_mfma_f32_16x16x32_bf16 v[160:163], a[156:159], a[72:75], v[160:163]
    ds_read_b128 a[140:143], v5 offset:27648
    v_mfma_f32_16x16x32_bf16 v[160:163], a[160:163], a[80:83], v[160:163]
    v_mfma_f32_16x16x32_bf16 v[164:167], a[152:155], a[68:71], 0
    ds_read_b128 a[144:147], v5 offset:28672
    v_mfma_f32_16x16x32_bf16 v[164:167], a[156:159], a[76:79], v[164:167]
    v_mfma_f32_16x16x32_bf16 v[164:167], a[160:163], a[84:87], v[164:167]
    ds_read_b128 a[148:151], v5 offset:29696
    s_waitcnt lgkmcnt(6)
    v_mfma_f32_16x16x32_bf16 v[160:163], a[164:167], a[88:91], v[160:163]
    v_mfma_f32_16x16x32_bf16 v[160:163], a[168:171], a[96:99], v[160:163]
    ds_read_b128 a[152:155], v5 offset:30720
    v_mfma_f32_16x16x32_bf16 v[160:163], a[172:175], a[104:107], v[160:163]
    v_mfma_f32_16x16x32_bf16 v[164:167], a[164:167], a[92:95], v[164:167]
    ds_read_b128 a[156:159], v5 offset:31744
    v_mfma_f32_16x16x32_bf16 v[164:167], a[168:171], a[100:103], v[164:167]
    v_mfma_f32_16x16x32_bf16 v[164:167], a[172:175], a[108:111], v[164:167]
    ds_read_b128 a[160:163], v5 offset:32768
    s_waitcnt lgkmcnt(6)
    v_mfma_f32_16x16x32_bf16 v[160:163], a[128:131], a[112:115], v[160:163]
    v_mfma_f32_16x16x32_bf16 v[160:163], a[132:135], a[120:123], v[160:163]
    ds_read_b128 a[164:167], v5 offset:33792
    v_mfma_f32_16x16x32_bf16 v[160:163], a[136:139], a[176:179], v[160:163]
    v_mfma_f32_16x16x32_bf16 v[164:167], a[128:131], a[116:119], v[164:167]
    ds_read_b128 a[168:171], v5 offset:34816
    v_mfma_f32_16x16x32_bf16 v[164:167], a[132:135], a[124:127], v[164:167]
    v_mfma_f32_16x16x32_bf16 v[164:167], a[136:139], a[180:183], v[164:167]
    ds_read_b128 a[172:175], v5 offset:35840
    s_waitcnt lgkmcnt(6)
    v_mfma_f32_16x16x32_bf16 v[160:163], a[140:143], a[184:187], v[160:163]
    v_mfma_f32_16x16x32_bf16 v[160:163], a[144:147], a[192:195], v[160:163]
    v_mfma_f32_16x16x32_bf16 v[160:163], a[148:151], a[200:203], v[160:163]
    v_mfma_f32_16x16x32_bf16 v[164:167], a[140:143], a[188:191], v[164:167]
    v_mfma_f32_16x16x32_bf16 v[164:167], a[144:147], a[196:199], v[164:167]
    v_mfma_f32_16x16x32_bf16 v[164:167], a[148:151], a[204:207], v[164:167]
    s_waitcnt lgkmcnt(3)
    v_mfma_f32_16x16x32_bf16 v[160:163], a[152:155], a[208:211], v[160:163]
    v_mfma_f32_16x16x32_bf16 v[160:163], a[156:159], a[216:219], v[160:163]
    v_mfma_f32_16x16x32_bf16 v[160:163], a[160:163], a[224:227], v[160:163]
    v_mfma_f32_16x16x32_bf16 v[164:167], a[152:155], a[212:215], v[164:167]
    v_mfma_f32_16x16x32_bf16 v[164:167], a[156:159], a[220:223], v[164:167]
    v_mfma_f32_16x16x32_bf16 v[164:167], a[160:163], a[228:231], v[164:167]
    s_waitcnt lgkmcnt(0)
    v_mfma_f32_16x16x32_bf16 v[160:163], a[164:167], a[232:235], v[160:163]
    v_mfma_f32_16x16x32_bf16 v[160:163], a[168:171], a[240:243], v[160:163]
    v_mfma_f32_16x16x32_bf16 v[160:163], a[172:175], a[248:251], v[160:163]
    v_mfma_f32_16x16x32_bf16 v[164:167], a[164:167], a[236:239], v[164:167]
    v_mfma_f32_16x16x32_bf16 v[164:167], a[168:171], a[244:247], v[164:167]
    v_mfma_f32_16x16x32_bf16 v[164:167], a[172:175], a[252:255], v[164:167]
    s_barrier
    s_add_u32 m0, s39, 0
    s_nop 0
    buffer_load_dwordx4 v72, s[32:35], s37 offen offset:0 lds
    buffer_load_dwordx4 v73, s[32:35], s37 offen offset:1024 lds
    buffer_load_dwordx4 v72, s[32:35], s37 offen offset:2048 lds
    buffer_load_dwordx4 v73, s[32:35], s37 offen offset:3072 lds
    s_add_u32 s37, s37, 16384
    s_min_u32 s37, s37, 507904
    s_add_u32 m0, s39, 16384
    s_nop 0
    buffer_load_dwordx4 v72, s[32:35], s37 offen offset:0 lds
    buffer_load_dwordx4 v73, s[32:35], s37 offen offset:1024 lds
    buffer_load_dwordx4 v72, s[32:35], s37 offen offset:2048 lds
    buffer_load_dwordx4 v73, s[32:35], s37 offen offset:3072 lds
    s_add_u32 s37, s37, 16384
    s_min_u32 s37, s37, 507904
    v_mov_b32 v248, 0
    v_mov_b32 v249, 0
    v_lshlrev_b32 v252, 16, v232
    v_and_b32 v253, 0xffff0000, v232
    v_add_f32 v252, v252, v152
    v_add_f32 v253, v253, v153
    v_cvt_pk_bf16_f32 v232, v252, v253
    v_add_f32 v248, v248, v252
    v_fmac_f32 v249, v252, v252
    v_add_f32 v248, v248, v253
    v_fmac_f32 v249, v253, v253
    v_lshlrev_b32 v254, 16, v233
    v_and_b32 v255, 0xffff0000, v233
    v_add_f32 v254, v254, v154
    v_add_f32 v255, v255, v155
    v_cvt_pk_bf16_f32 v233, v254, v255
    v_add_f32 v248, v248, v254
    v_fmac_f32 v249, v254, v254
    v_add_f32 v248, v248, v255
    v_fmac_f32 v249, v255, v255
    v_lshlrev_b32 v252, 16, v234
    v_and_b32 v253, 0xffff0000, v234
    v_add_f32 v252, v252, v160
    v_add_f32 v253, v253, v161
    v_cvt_pk_bf16_f32 v234, v252, v253
    v_add_f32 v248, v248, v252
    v_fmac_f32 v249, v252, v252
    v_add_f32 v248, v248, v253
    v_fmac_f32 v249, v253, v253
    v_lshlrev_b32 v254, 16, v235
    v_and_b32 v255, 0xffff0000, v235
    v_add_f32 v254, v254, v162
    v_add_f32 v255, v255, v163
    v_cvt_pk_bf16_f32 v235, v254, v255
    v_add_f32 v248, v248, v254
    v_fmac_f32 v249, v254, v254
    v_add_f32 v248, v248, v255
    v_fmac_f32 v249, v255, v255
    buffer_store_dwordx4 v[232:235], v2, s[8:11], s19 offen sc1
    v_mov_b32 v250, v248
    s_nop 1
    v_permlane16_swap_b32 v248, v250
    v_add_f32 v248, v248, v250
    v_mov_b32 v250, v248
    s_nop 1
    v_permlane32_swap_b32 v248, v250
    v_add_f32 v248, v248, v250
    v_mov_b32 v250, v249
    s_nop 1
    v_permlane16_swap_b32 v249, v250
    v_add_f32 v249, v249, v250
    v_mov_b32 v250, v249
    s_nop 1
    v_permlane32_swap_b32 v249, v250
    v_add_f32 v249, v249, v250
    v_and_b32 v251, 15, v1
    v_lshlrev_b32 v251, 3, v251
    s_add_u32 s53, s52, 0
    buffer_store_dwordx2 v[248:249], v251, s[8:11], s53 offen sc1
    v_mov_b32 v248, 0
    v_mov_b32 v249, 0
    v_lshlrev_b32 v252, 16, v236
    v_and_b32 v253, 0xffff0000, v236
    v_add_f32 v252, v252, v156
    v_add_f32 v253, v253, v157
    v_cvt_pk_bf16_f32 v236, v252, v253
    v_add_f32 v248, v248, v252
    v_fmac_f32 v249, v252, v252
    v_add_f32 v248, v248, v253
    v_fmac_f32 v249, v253, v253
    v_lshlrev_b32 v254, 16, v237
    v_and_b32 v255, 0xffff0000, v237
    v_add_f32 v254, v254, v158
    v_add_f32 v255, v255, v159
    v_cvt_pk_bf16_f32 v237, v254, v255
    v_add_f32 v248, v248, v254
    v_fmac_f32 v249, v254, v254
    v_add_f32 v248, v248, v255
    v_fmac_f32 v249, v255, v255
    v_lshlrev_b32 v252, 16, v238
    v_and_b32 v253, 0xffff0000, v238
    v_add_f32 v252, v252, v164
    v_add_f32 v253, v253, v165
    v_cvt_pk_bf16_f32 v238, v252, v253
    v_add_f32 v248, v248, v252
    v_fmac_f32 v249, v252, v252
    v_add_f32 v248, v248, v253
    v_fmac_f32 v249, v253, v253
    v_lshlrev_b32 v254, 16, v239
    v_and_b32 v255, 0xffff0000, v239
    v_add_f32 v254, v254, v166
    v_add_f32 v255, v255, v167
    v_cvt_pk_bf16_f32 v239, v254, v255
    v_add_f32 v248, v248, v254
    v_fmac_f32 v249, v254, v254
    v_add_f32 v248, v248, v255
    v_fmac_f32 v249, v255, v255
    buffer_store_dwordx4 v[236:239], v2, s[8:11], s45 offen sc1
    v_mov_b32 v250, v248
    s_nop 1
    v_permlane16_swap_b32 v248, v250
    v_add_f32 v248, v248, v250
    v_mov_b32 v250, v248
    s_nop 1
    v_permlane32_swap_b32 v248, v250
    v_add_f32 v248, v248, v250
    v_mov_b32 v250, v249
    s_nop 1
    v_permlane16_swap_b32 v249, v250
    v_add_f32 v249, v249, v250
    v_mov_b32 v250, v249
    s_nop 1
    v_permlane32_swap_b32 v249, v250
    v_add_f32 v249, v249, v250
    v_and_b32 v251, 15, v1
    v_lshlrev_b32 v251, 3, v251
    s_add_u32 s53, s52, 2560
    buffer_store_dwordx2 v[248:249], v251, s[8:11], s53 offen sc1
    s_mov_b32 s43, 1
    s_branch kmain_kernel_xq
kmain_kernel_x2:
    s_waitcnt vmcnt(12)
    s_barrier
    ds_read_b128 a[128:131], v5 offset:0
    ds_read_b128 a[132:135], v5 offset:1024
    ds_read_b128 a[136:139], v5 offset:2048
    ds_read_b128 a[140:143], v5 offset:3072
    ds_read_b128 a[144:147], v5 offset:4096
    ds_read_b128 a[148:151], v5 offset:5120
    ds_read_b128 a[152:155], v5 offset:6144
    ds_read_b128 a[156:159], v5 offset:7168
    ds_read_b128 a[160:163], v5 offset:8192
    s_waitcnt lgkmcnt(6)
    v_mfma_f32_16x16x32_bf16 v[152:155], a[128:131], a[64:67], 0
    v_mfma_f32_16x16x32_bf16 v[152:155], a[132:135], a[72:75], v[152:155]
    ds_read_b128 a[164:167], v5 offset:9216
    v_mfma_f32_16x16x32_bf16 v[152:155], a[136:139], a[80:83], v[152:155]
    v_mfma_f32_16x16x32_bf16 v[156:159], a[128:131], a[68:71], 0
    ds_read_b128 a[168:171], v5 offset:10240
    v_mfma_f32_16x16x32_bf16 v[156:159], a[132:135], a[76:79], v[156:159]
    v_mfma_f32_16x16x32_bf16 v[156:159], a[136:139], a[84:87], v[156:159]
    ds_read_b128 a[172:175], v5 offset:11264
    s_waitcnt lgkmcnt(6)
    v_mfma_f32_16x16x32_bf16 v[152:155], a[140:143], a[88:91], v[152:155]
    v_mfma_f32_16x16x32_bf16 v[152:155], a[144:147], a[96:99], v[152:155]
    ds_read_b128 a[128:131], v5 offset:12288
    v_mfma_f32_16x16x32_bf16 v[152:155], a[148:151], a[104:107], v[152:155]
    v_mfma_f32_16x16x32_bf16 v[156:159], a[140:143], a[92:95], v[156:159]
    ds_read_b128 a[132:135], v5 offset:13312
    v_mfma_f32_16x16x32_bf16 v[156:159], a[144:147], a[100:103], v[156:159]
    v_mfma_f32_16x16x32_bf16 v[156:159], a[148:151], a[108:111], v[156:159]
    ds_read_b128 a[136:139], v5 offset:14336
    s_waitcnt lgkmcnt(6)
    v_mfma_f32_16x16x32_bf16 v[152:155], a[152:155], a[112:115], v[152:155]
    v_mfma_f32_16x16x32_bf16 v[152:155], a[156:159], a[120:123], v[152:155]
    ds_read_b128 a[140:143], v5 offset:15360
    v_mfma_f32_16x16x32_bf16 v[152:155], a[160:163], a[176:179], v[152:155]
    v_mfma_f32_16x16x32_bf16 v[156:159], a[152:155], a[116:119], v[156:159]
    ds_read_b128 a[144:147], v5 offset:16384
    v_mfma_f32_16x16x32_bf16 v[156:159], a[156:159], a[124:127], v[156:159]
    v_mfma_f32_16x16x32_bf16 v[156:159], a[160:163], a[180:183], v[156:159]
    ds_read_b128 a[148:151], v5 offset:17408
    s_waitcnt lgkmcnt(6)
    v_mfma_f32_16x16x32_bf16 v[152:155], a[164:167], a[184:187], v[152:155]
    v_mfma_f32_16x16x32_bf16 v[152:155], a[168:171], a[192:195], v[152:155]
    ds_read_b128 a[152:155], v5 offset:18432
    v_mfma_f32_16x16x32_bf16 v[152:155], a[172:175], a[200:203], v[152:155]
    v_mfma_f32_16x16x32_bf16 v[156:159], a[164:167], a[188:191], v[156:159]
    ds_read_b128 a[156:159], v5 offset:19456
    v_mfma_f32_16x16x32_bf16 v[156:159], a[168:171], a[196:199], v[156:159]
    v_mfma_f32_16x16x32_bf16 v[156:159], a[172:175], a[204:207], v[156:159]
    ds_read_b128 a[160:163], v5 offset:20480
    s_waitcnt lgkmcnt(6)
    v_mfma_f32_16x16x32_bf16 v[152:155], a[128:131], a[208:211], v[152:155]
    v_mfma_f32_16x16x32_bf16 v[152:155], a[132:135], a[216:219], v[152:155]
    ds_read_b128 a[164:167], v5 offset:21504
    v_mfma_f32_16x16x32_bf16 v[152:155], a[136:139], a[224:227], v[152:155]
    v_mfma_f32_16x16x32_bf16 v[156:159], a[128:131], a[212:215], v[156:159]
    ds_read_b128 a[168:171], v5 offset:22528
    v_mfma_f32_16x16x32_bf16 v[156:159], a[132:135], a[220:223], v[156:159]
    v_mfma_f32_16x16x32_bf16 v[156:159], a[136:139], a[228:231], v[156:159]
    ds_read_b128 a[172:175], v5 offset:23552
    s_waitcnt lgkmcnt(6)
    v_mfma_f32_16x16x32_bf16 v[152:155], a[140:143], a[232:235], v[152:155]
    v_mfma_f32_16x16x32_bf16 v[152:155], a[144:147], a[240:243], v[152:155]
    ds_read_b128 a[128:131], v5 offset:24576
    v_mfma_f32_16x16x32_bf16 v[152:155], a[148:151], a[248:251], v[152:155]
    v_mfma_f32_16x16x32_bf16 v[156:159], a[140:143], a[236:239], v[156:159]
    ds_read_b128 a[132:135], v5 offset:25600
    v_mfma_f32_16x16x32_bf16 v[156:159], a[144:147], a[244:247], v[156:159]
    v_mfma_f32_16x16x32_bf16 v[156:159], a[148:151], a[252:255], v[156:159]
    ds_read_b128 a[136:139], v5 offset:26624
    s_waitcnt lgkmcnt(6)
    v_mfma_f32_16x16x32_bf16 v[160:163], a[152:155], a[64:67], 0
    v_mfma_f32_16x16x32_bf16 v[160:163], a[156:159], a[72:75], v[160:163]
    ds_read_b128 a[140:143], v5 offset:27648
    v_mfma_f32_16x16x32_bf16 v[160:163], a[160:163], a[80:83], v[160:163]
    v_mfma_f32_16x16x32_bf16 v[164:167], a[152:155], a[68:71], 0
    ds_read_b128 a[144:147], v5 offset:28672
    v_mfma_f32_16x16x32_bf16 v[164:167], a[156:159], a[76:79], v[164:167]
    v_mfma_f32_16x16x32_bf16 v[164:167], a[160:163], a[84:87], v[164:167]
    ds_read_b128 a[148:151], v5 offset:29696
    s_waitcnt lgkmcnt(6)
    v_mfma_f32_16x16x32_bf16 v[160:163], a[164:167], a[88:91], v[160:163]
    v_mfma_f32_16x16x32_bf16 v[160:163], a[168:171], a[96:99], v[160:163]
    ds_read_b128 a[152:155], v5 offset:30720
    v_mfma_f32_16x16x32_bf16 v[160:163], a[172:175], a[104:107], v[160:163]
    v_mfma_f32_16x16x32_bf16 v[164:167], a[164:167], a[92:95], v[164:167]
    ds_read_b128 a[156:159], v5 offset:31744
    v_mfma_f32_16x16x32_bf16 v[164:167], a[168:171], a[100:103], v[164:167]
    v_mfma_f32_16x16x32_bf16 v[164:167], a[172:175], a[108:111], v[164:167]
    ds_read_b128 a[160:163], v5 offset:32768
    s_waitcnt lgkmcnt(6)
    v_mfma_f32_16x16x32_bf16 v[160:163], a[128:131], a[112:115], v[160:163]
    v_mfma_f32_16x16x32_bf16 v[160:163], a[132:135], a[120:123], v[160:163]
    ds_read_b128 a[164:167], v5 offset:33792
    v_mfma_f32_16x16x32_bf16 v[160:163], a[136:139], a[176:179], v[160:163]
    v_mfma_f32_16x16x32_bf16 v[164:167], a[128:131], a[116:119], v[164:167]
    ds_read_b128 a[168:171], v5 offset:34816
    v_mfma_f32_16x16x32_bf16 v[164:167], a[132:135], a[124:127], v[164:167]
    v_mfma_f32_16x16x32_bf16 v[164:167], a[136:139], a[180:183], v[164:167]
    ds_read_b128 a[172:175], v5 offset:35840
    s_waitcnt lgkmcnt(6)
    v_mfma_f32_16x16x32_bf16 v[160:163], a[140:143], a[184:187], v[160:163]
    s_waitcnt vmcnt(16)
    s_barrier
    v_mfma_f32_16x16x32_bf16 v[160:163], a[144:147], a[192:195], v[160:163]
    ds_read_b128 a[128:131], v6 offset:0
    v_mfma_f32_16x16x32_bf16 v[160:163], a[148:151], a[200:203], v[160:163]
    v_mfma_f32_16x16x32_bf16 v[164:167], a[140:143], a[188:191], v[164:167]
    ds_read_b128 a[132:135], v6 offset:1024
    v_mfma_f32_16x16x32_bf16 v[164:167], a[144:147], a[196:199], v[164:167]
    v_mfma_f32_16x16x32_bf16 v[164:167], a[148:151], a[204:207], v[164:167]
    ds_read_b128 a[136:139], v6 offset:2048
    s_waitcnt lgkmcnt(6)
    v_mfma_f32_16x16x32_bf16 v[160:163], a[152:155], a[208:211], v[160:163]
    v_mfma_f32_16x16x32_bf16 v[160:163], a[156:159], a[216:219], v[160:163]
    ds_read_b128 a[140:143], v6 offset:3072
    v_mfma_f32_16x16x32_bf16 v[160:163], a[160:163], a[224:227], v[160:163]
    v_mfma_f32_16x16x32_bf16 v[164:167], a[152:155], a[212:215], v[164:167]
    ds_read_b128 a[144:147], v6 offset:4096
    v_mfma_f32_16x16x32_bf16 v[164:167], a[156:159], a[220:223], v[164:167]
    v_mfma_f32_16x16x32_bf16 v[164:167], a[160:163], a[228:231], v[164:167]
    ds_read_b128 a[148:151], v6 offset:5120
    s_waitcnt lgkmcnt(6)
    v_mfma_f32_16x16x32_bf16 v[160:163], a[164:167], a[232:235], v[160:163]
    v_mfma_f32_16x16x32_bf16 v[160:163], a[168:171], a[240:243], v[160:163]
    ds_read_b128 a[152:155], v6 offset:6144
    v_mfma_f32_16x16x32_bf16 v[160:163], a[172:175], a[248:251], v[160:163]
    v_mfma_f32_16x16x32_bf16 v[164:167], a[164:167], a[236:239], v[164:167]
    ds_read_b128 a[156:159], v6 offset:7168
    v_mfma_f32_16x16x32_bf16 v[164:167], a[168:171], a[244:247], v[164:167]
    v_mfma_f32_16x16x32_bf16 v[164:167], a[172:175], a[252:255], v[164:167]
    ds_read_b128 a[160:163], v6 offset:8192
    s_waitcnt lgkmcnt(6)
    v_mfma_f32_16x16x32_bf16 v[168:171], a[128:131], a[64:67], 0
    v_mfma_f32_16x16x32_bf16 v[168:171], a[132:135], a[72:75], v[168:171]
    ds_read_b128 a[164:167], v6 offset:9216
    v_mov_b32 v248, 0
    v_mfma_f32_16x16x32_bf16 v[168:171], a[136:139], a[80:83], v[168:171]
    v_mov_b32 v249, 0
    v_lshlrev_b32 v252, 16, v232
    v_and_b32 v253, 0xffff0000, v232
    v_mfma_f32_16x16x32_bf16 v[172:175], a[128:131], a[68:71], 0
    ds_read_b128 a[168:171], v6 offset:10240
    v_add_f32 v252, v252, v152
    v_mfma_f32_16x16x32_bf16 v[172:175], a[132:135], a[76:79], v[172:175]
    v_add_f32 v253, v253, v153
    v_cvt_pk_bf16_f32 v232, v252, v253
    v_mfma_f32_16x16x32_bf16 v[172:175], a[136:139], a[84:87], v[172:175]
    ds_read_b128 a[172:175], v6 offset:11264
    v_add_f32 v248, v248, v252
    s_waitcnt lgkmcnt(6)
    v_mfma_f32_16x16x32_bf16 v[168:171], a[140:143], a[88:91], v[168:171]
    v_fmac_f32 v249, v252, v252
    v_add_f32 v248, v248, v253
    v_mfma_f32_16x16x32_bf16 v[168:171], a[144:147], a[96:99], v[168:171]
    ds_read_b128 a[128:131], v6 offset:12288
    v_fmac_f32 v249, v253, v253
    v_mfma_f32_16x16x32_bf16 v[168:171], a[148:151], a[104:107], v[168:171]
    v_lshlrev_b32 v254, 16, v233
    v_and_b32 v255, 0xffff0000, v233
    v_mfma_f32_16x16x32_bf16 v[172:175], a[140:143], a[92:95], v[172:175]
    ds_read_b128 a[132:135], v6 offset:13312
    v_add_f32 v254, v254, v154
    v_add_f32 v255, v255, v155
    v_mfma_f32_16x16x32_bf16 v[172:175], a[144:147], a[100:103], v[172:175]
    v_cvt_pk_bf16_f32 v233, v254, v255
    v_add_f32 v248, v248, v254
    v_mfma_f32_16x16x32_bf16 v[172:175], a[148:151], a[108:111], v[172:175]
    ds_read_b128 a[136:139], v6 offset:14336
    s_waitcnt lgkmcnt(6)
    v_mfma_f32_16x16x32_bf16 v[168:171], a[152:155], a[112:115], v[168:171]
    v_fmac_f32 v249, v254, v254
    v_add_f32 v248, v248, v255
    v_fmac_f32 v249, v255, v255
    v_mfma_f32_16x16x32_bf16 v[168:171], a[156:159], a[120:123], v[168:171]
    ds_read_b128 a[140:143], v6 offset:15360
    v_lshlrev_b32 v252, 16, v234
    v_mfma_f32_16x16x32_bf16 v[168:171], a[160:163], a[176:179], v[168:171]
    v_and_b32 v253, 0xffff0000, v234
    v_add_f32 v252, v252, v160
    v_mfma_f32_16x16x32_bf16 v[172:175], a[152:155], a[116:119], v[172:175]
    ds_read_b128 a[144:147], v6 offset:16384
    v_add_f32 v253, v253, v161
    v_cvt_pk_bf16_f32 v234, v252, v253
    v_mfma_f32_16x16x32_bf16 v[172:175], a[156:159], a[124:127], v[172:175]
    v_add_f32 v248, v248, v252
    v_fmac_f32 v249, v252, v252
    v_mfma_f32_16x16x32_bf16 v[172:175], a[160:163], a[180:183], v[172:175]
    ds_read_b128 a[148:151], v6 offset:17408
    s_waitcnt lgkmcnt(6)
    v_mfma_f32_16x16x32_bf16 v[168:171], a[164:167], a[184:187], v[168:171]
    v_add_f32 v248, v248, v253
    v_fmac_f32 v249, v253, v253
    v_lshlrev_b32 v254, 16, v235
    v_mfma_f32_16x16x32_bf16 v[168:171], a[168:171], a[192:195], v[168:171]
    ds_read_b128 a[152:155], v6 offset:18432
    v_and_b32 v255, 0xffff0000, v235
    v_mfma_f32_16x16x32_bf16 v[168:171], a[172:175], a[200:203], v[168:171]
    v_add_f32 v254, v254, v162
    v_add_f32 v255, v255, v163
    v_mfma_f32_16x16x32_bf16 v[172:175], a[164:167], a[188:191], v[172:175]
    ds_read_b128 a[156:159], v6 offset:19456
    v_cvt_pk_bf16_f32 v235, v254, v255
    v_add_f32 v248, v248, v254
    v_mfma_f32_16x16x32_bf16 v[172:175], a[168:171], a[196:199], v[172:175]
    v_fmac_f32 v249, v254, v254
    v_add_f32 v248, v248, v255
    v_mfma_f32_16x16x32_bf16 v[172:175], a[172:175], a[204:207], v[172:175]
    ds_read_b128 a[160:163], v6 offset:20480
    s_waitcnt lgkmcnt(6)
    v_mfma_f32_16x16x32_bf16 v[168:171], a[128:131], a[208:211], v[168:171]
    v_fmac_f32 v249, v255, v255
    v_mfma_f32_16x16x32_bf16 v[168:171], a[132:135], a[216:219], v[168:171]
    ds_read_b128 a[164:167], v6 offset:21504
    buffer_store_dwordx4 v[232:235], v2, s[8:11], s19 offen sc1
    v_mfma_f32_16x16x32_bf16 v[168:171], a[136:139], a[224:227], v[168:171]
    v_mov_b32 v250, v248
    s_nop 1
    v_mfma_f32_16x16x32_bf16 v[172:175], a[128:131], a[212:215], v[172:175]
    ds_read_b128 a[168:171], v6 offset:22528
    v_permlane16_swap_b32 v248, v250
    v_mfma_f32_16x16x32_bf16 v[172:175], a[132:135], a[220:223], v[172:175]
    v_add_f32 v248, v248, v250
    v_mov_b32 v250, v248
    s_nop 1
    v_mfma_f32_16x16x32_bf16 v[172:175], a[136:139], a[228:231], v[172:175]
    ds_read_b128 a[172:175], v6 offset:23552
    s_waitcnt lgkmcnt(6)
    v_mfma_f32_16x16x32_bf16 v[168:171], a[140:143], a[232:235], v[168:171]
    v_permlane32_swap_b32 v248, v250
    v_add_f32 v248, v248, v250
    v_mfma_f32_16x16x32_bf16 v[168:171], a[144:147], a[240:243], v[168:171]
    ds_read_b128 a[128:131], v6 offset:24576
    v_mov_b32 v250, v249
    s_nop 1
    v_mfma_f32_16x16x32_bf16 v[168:171], a[148:151], a[248:251], v[168:171]
    v_permlane16_swap_b32 v249, v250
    v_add_f32 v249, v249, v250
    v_mfma_f32_16x16x32_bf16 v[172:175], a[140:143], a[236:239], v[172:175]
    ds_read_b128 a[132:135], v6 offset:25600
    v_mov_b32 v250, v249
    v_mfma_f32_16x16x32_bf16 v[172:175], a[144:147], a[244:247], v[172:175]
    s_nop 1
    v_permlane32_swap_b32 v249, v250
    v_add_f32 v249, v249, v250
    v_mfma_f32_16x16x32_bf16 v[172:175], a[148:151], a[252:255], v[172:175]
    ds_read_b128 a[136:139], v6 offset:26624
    s_waitcnt lgkmcnt(6)
    v_mfma_f32_16x16x32_bf16 v[176:179], a[152:155], a[64:67], 0
    v_and_b32 v251, 15, v1
    v_lshlrev_b32 v251, 3, v251
    v_mfma_f32_16x16x32_bf16 v[176:179], a[156:159], a[72:75], v[176:179]
    ds_read_b128 a[140:143], v6 offset:27648
    s_add_u32 s53, s52, 0
    v_mfma_f32_16x16x32_bf16 v[176:179], a[160:163], a[80:83], v[176:179]
    buffer_store_dwordx2 v[248:249], v251, s[8:11], s53 offen sc1
    v_mfma_f32_16x16x32_bf16 v[180:183], a[152:155], a[68:71], 0
    ds_read_b128 a[144:147], v6 offset:28672
    v_mov_b32 v248, 0
    v_mfma_f32_16x16x32_bf16 v[180:183], a[156:159], a[76:79], v[180:183]
    v_mov_b32 v249, 0
    v_lshlrev_b32 v252, 16, v236
    v_mfma_f32_16x16x32_bf16 v[180:183], a[160:163], a[84:87], v[180:183]
    ds_read_b128 a[148:151], v6 offset:29696
    v_and_b32 v253, 0xffff0000, v236
    s_waitcnt lgkmcnt(6)
    v_mfma_f32_16x16x32_bf16 v[176:179], a[164:167], a[88:91], v[176:179]
    v_add_f32 v252, v252, v156
    v_add_f32 v253, v253, v157
    v_mfma_f32_16x16x32_bf16 v[176:179], a[168:171], a[96:99], v[176:179]
    ds_read_b128 a[152:155], v6 offset:30720
    v_cvt_pk_bf16_f32 v236, v252, v253
    v_mfma_f32_16x16x32_bf16 v[176:179], a[172:175], a[104:107], v[176:179]
    v_add_f32 v248, v248, v252
    v_fmac_f32 v249, v252, v252
    v_add_f32 v248, v248, v253
    v_mfma_f32_16x16x32_bf16 v[180:183], a[164:167], a[92:95], v[180:183]
    ds_read_b128 a[156:159], v6 offset:31744
    v_fmac_f32 v249, v253, v253
    v_mfma_f32_16x16x32_bf16 v[180:183], a[168:171], a[100:103], v[180:183]
    v_lshlrev_b32 v254, 16, v237
    v_and_b32 v255, 0xffff0000, v237
    v_mfma_f32_16x16x32_bf16 v[180:183], a[172:175], a[108:111], v[180:183]
    ds_read_b128 a[160:163], v6 offset:32768
    v_add_f32 v254, v254, v158
    s_waitcnt lgkmcnt(6)
    v_mfma_f32_16x16x32_bf16 v[176:179], a[128:131], a[112:115], v[176:179]
    v_add_f32 v255, v255, v159
    v_cvt_pk_bf16_f32 v237, v254, v255
    v_mfma_f32_16x16x32_bf16 v[176:179], a[132:135], a[120:123], v[176:179]
    ds_read_b128 a[164:167], v6 offset:33792
    v_add_f32 v248, v248, v254
    v_mfma_f32_16x16x32_bf16 v[176:179], a[136:139], a[176:179], v[176:179]
    v_fmac_f32 v249, v254, v254
    v_add_f32 v248, v248, v255
    v_mfma_f32_16x16x32_bf16 v[180:183], a[128:131], a[116:119], v[180:183]
    ds_read_b128 a[168:171], v6 offset:34816
    v_fmac_f32 v249, v255, v255
    v_lshlrev_b32 v252, 16, v238
    v_mfma_f32_16x16x32_bf16 v[180:183], a[132:135], a[124:127], v[180:183]
    v_and_b32 v253, 0xffff0000, v238
    v_add_f32 v252, v252, v164
    v_mfma_f32_16x16x32_bf16 v[180:183], a[136:139], a[180:183], v[180:183]
    ds_read_b128 a[172:175], v6 offset:35840
    s_waitcnt lgkmcnt(6)
    v_mfma_f32_16x16x32_bf16 v[176:179], a[140:143], a[184:187], v[176:179]
    v_add_f32 v253, v253, v165
    v_cvt_pk_bf16_f32 v238, v252, v253
    v_add_f32 v248, v248, v252
    v_mfma_f32_16x16x32_bf16 v[176:179], a[144:147], a[192:195], v[176:179]
    v_fmac_f32 v249, v252, v252
    v_add_f32 v248, v248, v253
    v_mfma_f32_16x16x32_bf16 v[176:179], a[148:151], a[200:203], v[176:179]
    v_fmac_f32 v249, v253, v253
    v_lshlrev_b32 v254, 16, v239
    v_mfma_f32_16x16x32_bf16 v[180:183], a[140:143], a[188:191], v[180:183]
    v_and_b32 v255, 0xffff0000, v239
    v_add_f32 v254, v254, v166
    v_add_f32 v255, v255, v167
    v_mfma_f32_16x16x32_bf16 v[180:183], a[144:147], a[196:199], v[180:183]
    v_cvt_pk_bf16_f32 v239, v254, v255
    v_add_f32 v248, v248, v254
    v_mfma_f32_16x16x32_bf16 v[180:183], a[148:151], a[204:207], v[180:183]
    v_fmac_f32 v249, v254, v254
    s_waitcnt lgkmcnt(3)
    v_mfma_f32_16x16x32_bf16 v[176:179], a[152:155], a[208:211], v[176:179]
    v_add_f32 v248, v248, v255
    v_fmac_f32 v249, v255, v255
    v_mfma_f32_16x16x32_bf16 v[176:179], a[156:159], a[216:219], v[176:179]
    buffer_store_dwordx4 v[236:239], v2, s[8:11], s45 offen sc1
    v_mfma_f32_16x16x32_bf16 v[176:179], a[160:163], a[224:227], v[176:179]
    v_mov_b32 v250, v248
    s_nop 1
    v_mfma_f32_16x16x32_bf16 v[180:183], a[152:155], a[212:215], v[180:183]
    v_permlane16_swap_b32 v248, v250
    v_add_f32 v248, v248, v250
    v_mov_b32 v250, v248
    v_mfma_f32_16x16x32_bf16 v[180:183], a[156:159], a[220:223], v[180:183]
    s_nop 1
    v_permlane32_swap_b32 v248, v250
    v_mfma_f32_16x16x32_bf16 v[180:183], a[160:163], a[228:231], v[180:183]
    v_add_f32 v248, v248, v250
    s_waitcnt lgkmcnt(0)
    v_mfma_f32_16x16x32_bf16 v[176:179], a[164:167], a[232:235], v[176:179]
    v_mov_b32 v250, v249
    s_nop 1
    v_mfma_f32_16x16x32_bf16 v[176:179], a[168:171], a[240:243], v[176:179]
    v_permlane16_swap_b32 v249, v250
    v_add_f32 v249, v249, v250
    v_mov_b32 v250, v249
    v_mfma_f32_16x16x32_bf16 v[176:179], a[172:175], a[248:251], v[176:179]
    s_nop 1
    v_permlane32_swap_b32 v249, v250
    v_mfma_f32_16x16x32_bf16 v[180:183], a[164:167], a[236:239], v[180:183]
    v_add_f32 v249, v249, v250
    v_and_b32 v251, 15, v1
    v_mfma_f32_16x16x32_bf16 v[180:183], a[168:171], a[244:247], v[180:183]
    v_lshlrev_b32 v251, 3, v251
    s_add_u32 s53, s52, 2560
    v_mfma_f32_16x16x32_bf16 v[180:183], a[172:175], a[252:255], v[180:183]
    buffer_store_dwordx2 v[248:249], v251, s[8:11], s53 offen sc1
    s_barrier
    s_add_u32 m0, s39, 0
    s_nop 0
    buffer_load_dwordx4 v72, s[32:35], s37 offen offset:0 lds
    buffer_load_dwordx4 v73, s[32:35], s37 offen offset:1024 lds
    buffer_load_dwordx4 v72, s[32:35], s37 offen offset:2048 lds
    buffer_load_dwordx4 v73, s[32:35], s37 offen offset:3072 lds
    s_add_u32 s37, s37, 16384
    s_min_u32 s37, s37, 507904
    s_add_u32 m0, s39, 16384
    s_nop 0
    buffer_load_dwordx4 v72, s[32:35], s37 offen offset:0 lds
    buffer_load_dwordx4 v73, s[32:35], s37 offen offset:1024 lds
    buffer_load_dwordx4 v72, s[32:35], s37 offen offset:2048 lds
    buffer_load_dwordx4 v73, s[32:35], s37 offen offset:3072 lds
    s_add_u32 s37, s37, 16384
    s_min_u32 s37, s37, 507904
    v_mov_b32 v248, 0
    v_mov_b32 v249, 0
    v_lshlrev_b32 v252, 16, v240
    v_and_b32 v253, 0xffff0000, v240
    v_add_f32 v252, v252, v168
    v_add_f32 v253, v253, v169
    v_cvt_pk_bf16_f32 v240, v252, v253
    v_add_f32 v248, v248, v252
    v_fmac_f32 v249, v252, v252
    v_add_f32 v248, v248, v253
    v_fmac_f32 v249, v253, v253
    v_lshlrev_b32 v254, 16, v241
    v_and_b32 v255, 0xffff0000, v241
    v_add_f32 v254, v254, v170
    v_add_f32 v255, v255, v171
    v_cvt_pk_bf16_f32 v241, v254, v255
    v_add_f32 v248, v248, v254
    v_fmac_f32 v249, v254, v254
    v_add_f32 v248, v248, v255
    v_fmac_f32 v249, v255, v255
    v_lshlrev_b32 v252, 16, v242
    v_and_b32 v253, 0xffff0000, v242
    v_add_f32 v252, v252, v176
    v_add_f32 v253, v253, v177
    v_cvt_pk_bf16_f32 v242, v252, v253
    v_add_f32 v248, v248, v252
    v_fmac_f32 v249, v252, v252
    v_add_f32 v248, v248, v253
    v_fmac_f32 v249, v253, v253
    v_lshlrev_b32 v254, 16, v243
    v_and_b32 v255, 0xffff0000, v243
    v_add_f32 v254, v254, v178
    v_add_f32 v255, v255, v179
    v_cvt_pk_bf16_f32 v243, v254, v255
    v_add_f32 v248, v248, v254
    v_fmac_f32 v249, v254, v254
    v_add_f32 v248, v248, v255
    v_fmac_f32 v249, v255, v255
    buffer_store_dwordx4 v[240:243], v2, s[8:11], s48 offen sc1
    v_mov_b32 v250, v248
    s_nop 1
    v_permlane16_swap_b32 v248, v250
    v_add_f32 v248, v248, v250
    v_mov_b32 v250, v248
    s_nop 1
    v_permlane32_swap_b32 v248, v250
    v_add_f32 v248, v248, v250
    v_mov_b32 v250, v249
    s_nop 1
    v_permlane16_swap_b32 v249, v250
    v_add_f32 v249, v249, v250
    v_mov_b32 v250, v249
    s_nop 1
    v_permlane32_swap_b32 v249, v250
    v_add_f32 v249, v249, v250
    v_and_b32 v251, 15, v1
    v_lshlrev_b32 v251, 3, v251
    s_add_u32 s53, s52, 1792
    buffer_store_dwordx2 v[248:249], v251, s[8:11], s53 offen sc1
    v_mov_b32 v248, 0
    v_mov_b32 v249, 0
    v_lshlrev_b32 v252, 16, v244
    v_and_b32 v253, 0xffff0000, v244
    v_add_f32 v252, v252, v172
    v_add_f32 v253, v253, v173
    v_cvt_pk_bf16_f32 v244, v252, v253
    v_add_f32 v248, v248, v252
    v_fmac_f32 v249, v252, v252
    v_add_f32 v248, v248, v253
    v_fmac_f32 v249, v253, v253
    v_lshlrev_b32 v254, 16, v245
    v_and_b32 v255, 0xffff0000, v245
    v_add_f32 v254, v254, v174
    v_add_f32 v255, v255, v175
    v_cvt_pk_bf16_f32 v245, v254, v255
    v_add_f32 v248, v248, v254
    v_fmac_f32 v249, v254, v254
    v_add_f32 v248, v248, v255
    v_fmac_f32 v249, v255, v255
    v_lshlrev_b32 v252, 16, v246
    v_and_b32 v253, 0xffff0000, v246
    v_add_f32 v252, v252, v180
    v_add_f32 v253, v253, v181
    v_cvt_pk_bf16_f32 v246, v252, v253
    v_add_f32 v248, v248, v252
    v_fmac_f32 v249, v252, v252
    v_add_f32 v248, v248, v253
    v_fmac_f32 v249, v253, v253
    v_lshlrev_b32 v254, 16, v247
    v_and_b32 v255, 0xffff0000, v247
    v_add_f32 v254, v254, v182
    v_add_f32 v255, v255, v183
    v_cvt_pk_bf16_f32 v247, v254, v255
    v_add_f32 v248, v248, v254
    v_fmac_f32 v249, v254, v254
    v_add_f32 v248, v248, v255
    v_fmac_f32 v249, v255, v255
    buffer_store_dwordx4 v[244:247], v2, s[8:11], s49 offen sc1
    v_mov_b32 v250, v248
    s_nop 1
    v_permlane16_swap_b32 v248, v250
    v_add_f32 v248, v248, v250
    v_mov_b32 v250, v248
    s_nop 1
    v_permlane32_swap_b32 v248, v250
    v_add_f32 v248, v248, v250
    v_mov_b32 v250, v249
    s_nop 1
    v_permlane16_swap_b32 v249, v250
    v_add_f32 v249, v249, v250
    v_mov_b32 v250, v249
    s_nop 1
    v_permlane32_swap_b32 v249, v250
    v_add_f32 v249, v249, v250
    v_and_b32 v251, 15, v1
    v_lshlrev_b32 v251, 3, v251
    s_add_u32 s53, s52, 4352
    buffer_store_dwordx2 v[248:249], v251, s[8:11], s53 offen sc1
    s_mov_b32 s43, 2
kmain_kernel_xq:
    s_lshl_b32 s23, s5, 6
    s_add_u32 s22, s23, 104826880
    s_add_u32 s23, s23, 104818688
    v_mov_b32 v3, 104819712
    v_mov_b32 v4, 0x100
    v_mov_b32 v5, 0
    v_cmp_eq_u32 vcc, 0, v1
    v_mov_b32 v6, s23
    s_nop 0
    v_cndmask_b32 v3, v3, v6, vcc
    v_cndmask_b32 v4, v4, 18, vcc
    v_cmp_eq_u32 vcc, 1, v1
    v_mov_b32 v6, s22
    s_nop 0
    v_cndmask_b32 v3, v3, v6, vcc
    v_cndmask_b32 v4, v4, 16, vcc
    v_mov_b32 v40, 0
    v_mov_b32 v41, 0
    v_mov_b32 v42, 0
    v_mov_b32 v43, 0
    v_mov_b32 v44, 0
    v_mov_b32 v45, 0
    v_mov_b32 v46, 0
    v_mov_b32 v47, 0
    v_mov_b32 v48, 0
    v_mov_b32 v49, 0
    v_mov_b32 v50, 0
    v_mov_b32 v51, 0
    v_mov_b32 v52, 0
    v_mov_b32 v53, 0
    v_mov_b32 v54, 0
    v_mov_b32 v55, 0
    v_mov_b32 v76, 0x3f803f80
    v_accvgpr_write_b32 a208, v76
    v_accvgpr_write_b32 a209, v76
    v_accvgpr_write_b32 a210, v76
    v_accvgpr_write_b32 a211, v76
    s_mov_b32 s41, 0
    s_branch kmain_kernel_first
kmain_kernel_retry:
    s_barrier
    s_mov_b32 s36, 0
    s_mov_b32 s37, 0
    s_add_u32 m0, s38, 0
    s_nop 0
    buffer_load_dwordx4 v68, s[28:31], s36 offen offset:0 lds
    buffer_load_dwordx4 v69, s[28:31], s36 offen offset:1024 lds
    buffer_load_dwordx4 v70, s[28:31], s36 offen offset:2048 lds
    buffer_load_dwordx4 v71, s[28:31], s36 offen offset:3072 lds
    s_add_u32 s36, s36, 16384
    s_min_u32 s36, s36, 507904
    s_add_u32 m0, s39, 0
    s_nop 0
    buffer_load_dwordx4 v72, s[32:35], s37 offen offset:0 lds
    buffer_load_dwordx4 v73, s[32:35], s37 offen offset:1024 lds
    buffer_load_dwordx4 v72, s[32:35], s37 offen offset:2048 lds
    buffer_load_dwordx4 v73, s[32:35], s37 offen offset:3072 lds
    s_add_u32 s37, s37, 16384
    s_min_u32 s37, s37, 507904
    s_add_u32 m0, s38, 16384
    s_nop 0
    buffer_load_dwordx4 v68, s[28:31], s36 offen offset:0 lds
    buffer_load_dwordx4 v69, s[28:31], s36 offen offset:1024 lds
    buffer_load_dwordx4 v70, s[28:31], s36 offen offset:2048 lds
    buffer_load_dwordx4 v71, s[28:31], s36 offen offset:3072 lds
    s_add_u32 s36, s36, 16384
    s_min_u32 s36, s36, 507904
    s_add_u32 m0, s39, 16384
    s_nop 0
    buffer_load_dwordx4 v72, s[32:35], s37 offen offset:0 lds
    buffer_load_dwordx4 v73, s[32:35], s37 offen offset:1024 lds
    buffer_load_dwordx4 v72, s[32:35], s37 offen offset:2048 lds
    buffer_load_dwordx4 v73, s[32:35], s37 offen offset:3072 lds
    s_add_u32 s37, s37, 16384
    s_min_u32 s37, s37, 507904
    s_add_u32 m0, s38, 32768
    s_nop 0
    buffer_load_dwordx4 v68, s[28:31], s36 offen offset:0 lds
    buffer_load_dwordx4 v69, s[28:31], s36 offen offset:1024 lds
    buffer_load_dwordx4 v70, s[28:31], s36 offen offset:2048 lds
    buffer_load_dwordx4 v71, s[28:31], s36 offen offset:3072 lds
kmain_kernel_first:
    v_mov_b32 v128, 0
    v_mov_b32 v129, 0
    v_mov_b32 v130, 0
    v_mov_b32 v131, 0
    v_mov_b32 v132, 0
    v_mov_b32 v133, 0
    v_mov_b32 v134, 0
    v_mov_b32 v135, 0
    v_mov_b32 v136, 0
    v_mov_b32 v137, 0
    v_mov_b32 v138, 0
    v_mov_b32 v139, 0
    v_mov_b32 v140, 0
    v_mov_b32 v141, 0
    v_mov_b32 v142, 0
    v_mov_b32 v143, 0
    v_mov_b32 v144, 0
    v_mov_b32 v145, 0
    v_mov_b32 v146, 0
    v_mov_b32 v147, 0
    v_mov_b32 v148, 0
    v_mov_b32 v149, 0
    v_mov_b32 v150, 0
    v_mov_b32 v151, 0
    v_mov_b32 v152, 0
    v_mov_b32 v153, 0
    v_mov_b32 v154, 0
    v_mov_b32 v155, 0
    v_mov_b32 v156, 0
    v_mov_b32 v157, 0
    v_mov_b32 v158, 0
    v_mov_b32 v159, 0
    v_mov_b32 v160, 0
    v_mov_b32 v161, 0
    v_mov_b32 v162, 0
    v_mov_b32 v163, 0
    v_mov_b32 v164, 0
    v_mov_b32 v165, 0
    v_mov_b32 v166, 0
    v_mov_b32 v167, 0
    v_mov_b32 v168, 0
    v_mov_b32 v169, 0
    v_mov_b32 v170, 0
    v_mov_b32 v171, 0
    v_mov_b32 v172, 0
    v_mov_b32 v173, 0
    v_mov_b32 v174, 0
    v_mov_b32 v175, 0
    v_mov_b32 v176, 0
    v_mov_b32 v177, 0
    v_mov_b32 v178, 0
    v_mov_b32 v179, 0
    v_mov_b32 v180, 0
    v_mov_b32 v181, 0
    v_mov_b32 v182, 0
    v_mov_b32 v183, 0
    v_mov_b32 v184, 0
    v_mov_b32 v185, 0
    v_mov_b32 v186, 0
    v_mov_b32 v187, 0
    v_mov_b32 v188, 0
    v_mov_b32 v189, 0
    v_mov_b32 v190, 0
    v_mov_b32 v191, 0
    v_mov_b32 v192, 0
    v_mov_b32 v193, 0
    v_mov_b32 v194, 0
    v_mov_b32 v195, 0
    v_mov_b32 v196, 0
    v_mov_b32 v197, 0
    v_mov_b32 v198, 0
    v_mov_b32 v199, 0
    v_mov_b32 v200, 0
    v_mov_b32 v201, 0
    v_mov_b32 v202, 0
    v_mov_b32 v203, 0
    v_mov_b32 v204, 0
    v_mov_b32 v205, 0
    v_mov_b32 v206, 0
    v_mov_b32 v207, 0
    v_mov_b32 v208, 0
    v_mov_b32 v209, 0
    v_mov_b32 v210, 0
    v_mov_b32 v211, 0
    v_mov_b32 v212, 0
    v_mov_b32 v213, 0
    v_mov_b32 v214, 0
    v_mov_b32 v215, 0
    v_mov_b32 v216, 0
    v_mov_b32 v217, 0
    v_mov_b32 v218, 0
    v_mov_b32 v219, 0
    v_mov_b32 v220, 0
    v_mov_b32 v221, 0
    v_mov_b32 v222, 0
    v_mov_b32 v223, 0
    v_mov_b32 v224, 0
    v_mov_b32 v225, 0
    v_mov_b32 v226, 0
    v_mov_b32 v227, 0
    v_mov_b32 v228, 0
    v_mov_b32 v229, 0
    v_mov_b32 v230, 0
    v_mov_b32 v231, 0
    v_mov_b32 v232, 0
    v_mov_b32 v233, 0
    v_mov_b32 v234, 0
    v_mov_b32 v235, 0
    v_mov_b32 v236, 0
    v_mov_b32 v237, 0
    v_mov_b32 v238, 0
    v_mov_b32 v239, 0
    v_mov_b32 v240, 0
    v_mov_b32 v241, 0
    v_mov_b32 v242, 0
    v_mov_b32 v243, 0
    v_mov_b32 v244, 0
    v_mov_b32 v245, 0
    v_mov_b32 v246, 0
    v_mov_b32 v247, 0
    v_mov_b32 v248, 0
    v_mov_b32 v249, 0
    v_mov_b32 v250, 0
    v_mov_b32 v251, 0
    v_mov_b32 v252, 0
    v_mov_b32 v253, 0
    v_mov_b32 v254, 0
    v_mov_b32 v255, 0
    v_accvgpr_write_b32 a160, 0
    v_accvgpr_write_b32 a161, 0
    v_accvgpr_write_b32 a162, 0
    v_accvgpr_write_b32 a163, 0
    v_accvgpr_write_b32 a164, 0
    v_accvgpr_write_b32 a165, 0
    v_accvgpr_write_b32 a166, 0
    v_accvgpr_write_b32 a167, 0
    v_accvgpr_write_b32 a168, 0
    v_accvgpr_write_b32 a169, 0
    v_accvgpr_write_b32 a170, 0
    v_accvgpr_write_b32 a171, 0
    v_accvgpr_write_b32 a172, 0
    v_accvgpr_write_b32 a173, 0
    v_accvgpr_write_b32 a174, 0
    v_accvgpr_write_b32 a175, 0
    v_accvgpr_write_b32 a176, 0
    v_accvgpr_write_b32 a177, 0
    v_accvgpr_write_b32 a178, 0
    v_accvgpr_write_b32 a179, 0
    v_accvgpr_write_b32 a180, 0
    v_accvgpr_write_b32 a181, 0
    v_accvgpr_write_b32 a182, 0
    v_accvgpr_write_b32 a183, 0
    v_accvgpr_write_b32 a184, 0
    v_accvgpr_write_b32 a185, 0
    v_accvgpr_write_b32 a186, 0
    v_accvgpr_write_b32 a187, 0
    v_accvgpr_write_b32 a188, 0
    v_accvgpr_write_b32 a189, 0
    v_accvgpr_write_b32 a190, 0
    v_accvgpr_write_b32 a191, 0
    v_accvgpr_write_b32 a192, 0
    v_accvgpr_write_b32 a193, 0
    v_accvgpr_write_b32 a194, 0
    v_accvgpr_write_b32 a195, 0
    v_accvgpr_write_b32 a196, 0
    v_accvgpr_write_b32 a197, 0
    v_accvgpr_write_b32 a198, 0
    v_accvgpr_write_b32 a199, 0
    v_accvgpr_write_b32 a200, 0
    v_accvgpr_write_b32 a201, 0
    v_accvgpr_write_b32 a202, 0
    v_accvgpr_write_b32 a203, 0
    v_accvgpr_write_b32 a204, 0
    v_accvgpr_write_b32 a205, 0
    v_accvgpr_write_b32 a206, 0
    v_accvgpr_write_b32 a207, 0
    v_mov_b32 v24, 0xff800000
    v_mov_b32 v25, 0xff800000
    v_mov_b32 v26, 0xff800000
    v_mov_b32 v27, 0xff800000
    v_mov_b32 v28, 0xff800000
    v_mov_b32 v29, 0xff800000
    v_mov_b32 v30, 0xff800000
    v_mov_b32 v31, 0xff800000
    v_mov_b32 v32, 0
    v_mov_b32 v33, 0
    v_mov_b32 v34, 0
    v_mov_b32 v35, 0
    s_cmp_lg_u32 s41, 0
    s_cbranch_scc1 kmain_kernel_fs2
    s_waitcnt vmcnt(0)
    s_barrier
    s_cmp_lg_u32 s3, 0
    s_cbranch_scc1 kmain_kernel_sg2_5
    v_mov_b32 v76, s43
    v_mov_b32 v77, 0
    v_cmp_eq_u32 vcc, 0, v1
    s_nop 3
    s_and_saveexec_b64 s[50:51], vcc
    buffer_atomic_add v76, v77, s[8:11], s42 offen
    s_mov_b64 exec, s[50:51]
kmain_kernel_sg2_5:
    s_branch kmain_kernel_fs3
kmain_kernel_fs2:
    s_waitcnt vmcnt(12)
    s_barrier
kmain_kernel_fs3:
    ds_read_b128 a[64:67], v56 offset:0
    ds_read_b128 a[68:71], v57 offset:0
    ds_read_b128 a[72:75], v58 offset:0
    ds_read_b128 a[76:79], v59 offset:0
    ds_read_b128 a[80:83], v56 offset:4096
    ds_read_b128 a[84:87], v57 offset:4096
    ds_read_b128 a[88:91], v58 offset:4096
    ds_read_b128 a[92:95], v59 offset:4096
    ds_read_b64_tr_b16 a[128:129], v60 offset:0
    ds_read_b64_tr_b16 a[130:131], v60 offset:4096
    ds_read_b64_tr_b16 a[132:133], v61 offset:0
    ds_read_b64_tr_b16 a[134:135], v61 offset:4096
    ds_read_b64_tr_b16 a[136:137], v62 offset:0
    ds_read_b64_tr_b16 a[138:139], v62 offset:4096
    s_waitcnt lgkmcnt(6)
    ds_read_b64_tr_b16 a[140:141], v63 offset:0
    ds_read_b64_tr_b16 a[142:143], v63 offset:4096
    ds_read_b64_tr_b16 a[144:145], v64 offset:0
    ds_read_b64_tr_b16 a[146:147], v64 offset:4096
    ds_read_b64_tr_b16 a[148:149], v65 offset:0
    ds_read_b64_tr_b16 a[150:151], v65 offset:4096
    s_mov_b32 s40, 0
    s_mul_i32 s57, s41, 99
    s_mov_b32 s58, 0
    s_waitcnt lgkmcnt(0)
.p2align 6
kmain_kernel_loop:
    v_mfma_f32_16x16x32_bf16 v[16:19], a[64:67], a[0:3], v[40:43]
    v_exp_f32 v24, v24
    v_mfma_f32_16x16x32_bf16 v[16:19], a[68:71], a[4:7], v[16:19]
    ds_read_b128 a[96:99], v56 offset:8192
    ds_read_b128 a[100:103], v57 offset:8192
    v_mfma_f32_16x16x32_bf16 v[16:19], a[72:75], a[8:11], v[16:19]
    v_exp_f32 v25, v25
    v_mfma_f32_16x16x32_bf16 v[16:19], a[76:79], a[12:15], v[16:19]
    v_cvt_pk_bf16_f32 v36, v24, v25
    v_mfma_f32_16x16x32_bf16 v[20:23], a[80:83], a[0:3], v[40:43]
    v_exp_f32 v26, v26
    v_mfma_f32_16x16x32_bf16 v[20:23], a[84:87], a[4:7], v[20:23]
    ds_read_b128 a[104:107], v58 offset:8192
    ds_read_b128 a[108:111], v59 offset:8192
    v_mfma_f32_16x16x32_bf16 v[20:23], a[88:91], a[8:11], v[20:23]
    v_exp_f32 v27, v27
    v_mfma_f32_16x16x32_bf16 v[20:23], a[92:95], a[12:15], v[20:23]
    v_cvt_pk_bf16_f32 v37, v26, v27
    v_mfma_f32_16x16x32_bf16 v[192:195], a[160:163], v[32:35], v[192:195]
    v_exp_f32 v28, v28
    v_mfma_f32_16x16x32_bf16 v[196:199], a[164:167], v[32:35], v[196:199]
    ds_read_b64_tr_b16 a[152:153], v66 offset:0
    s_add_u32 m0, s39, 32768
    v_mfma_f32_16x16x32_bf16 v[200:203], a[168:171], v[32:35], v[200:203]
    v_exp_f32 v29, v29
    v_mfma_f32_16x16x32_bf16 v[204:207], a[172:175], v[32:35], v[204:207]
    v_cvt_pk_bf16_f32 v38, v28, v29
    v_mfma_f32_16x16x32_bf16 v[208:211], a[176:179], v[32:35], v[208:211]
    v_exp_f32 v30, v30
    v_mfma_f32_16x16x32_bf16 v[212:215], a[180:183], v[32:35], v[212:215]
    ds_read_b64_tr_b16 a[154:155], v66 offset:4096
    v_mfma_f32_16x16x32_bf16 v[216:219], a[184:187], v[32:35], v[216:219]
    v_exp_f32 v31, v31
    v_mfma_f32_16x16x32_bf16 v[220:223], a[188:191], v[32:35], v[220:223]
    v_cvt_pk_bf16_f32 v39, v30, v31
    v_mfma_f32_16x16x32_bf16 a[200:203], a[208:211], v[32:35], a[200:203]
    buffer_load_dwordx4 v72, s[32:35], s37 offen offset:0 lds
    v_mfma_f32_16x16x32_bf16 v[24:27], a[64:67], a[16:19], v[44:47]
    v_exp_f32 v16, v16
    v_mfma_f32_16x16x32_bf16 v[24:27], a[68:71], a[20:23], v[24:27]
    ds_read_b128 a[112:115], v56 offset:12288
    ds_read_b128 a[116:119], v57 offset:12288
    v_mfma_f32_16x16x32_bf16 v[24:27], a[72:75], a[24:27], v[24:27]
    v_exp_f32 v17, v17
    v_mfma_f32_16x16x32_bf16 v[24:27], a[76:79], a[28:31], v[24:27]
    v_cvt_pk_bf16_f32 v32, v16, v17
    v_mfma_f32_16x16x32_bf16 v[28:31], a[80:83], a[16:19], v[44:47]
    v_exp_f32 v18, v18
    v_mfma_f32_16x16x32_bf16 v[28:31], a[84:87], a[20:23], v[28:31]
    ds_read_b128 a[120:123], v58 offset:12288
    ds_read_b128 a[124:127], v59 offset:12288
    v_mfma_f32_16x16x32_bf16 v[28:31], a[88:91], a[24:27], v[28:31]
    v_exp_f32 v19, v19
    v_mfma_f32_16x16x32_bf16 v[28:31], a[92:95], a[28:31], v[28:31]
    v_cvt_pk_bf16_f32 v33, v18, v19
    v_mfma_f32_16x16x32_bf16 v[224:227], a[160:163], v[36:39], v[224:227]
    v_exp_f32 v20, v20
    v_mfma_f32_16x16x32_bf16 v[228:231], a[164:167], v[36:39], v[228:231]
    ds_read_b64_tr_b16 a[156:157], v67 offset:0
    s_add_u32 s36, s36, 16384
    v_mfma_f32_16x16x32_bf16 v[232:235], a[168:171], v[36:39], v[232:235]
    v_exp_f32 v21, v21
    v_mfma_f32_16x16x32_bf16 v[236:239], a[172:175], v[36:39], v[236:239]
    v_cvt_pk_bf16_f32 v34, v20, v21
    v_mfma_f32_16x16x32_bf16 v[240:243], a[176:179], v[36:39], v[240:243]
    v_exp_f32 v22, v22
    v_mfma_f32_16x16x32_bf16 v[244:247], a[180:183], v[36:39], v[244:247]
    ds_read_b64_tr_b16 a[158:159], v67 offset:4096
    s_min_u32 s36, s36, 507904
    v_mfma_f32_16x16x32_bf16 v[248:251], a[184:187], v[36:39], v[248:251]
    v_exp_f32 v23, v23
    v_mfma_f32_16x16x32_bf16 v[252:255], a[188:191], v[36:39], v[252:255]
    v_cvt_pk_bf16_f32 v35, v22, v23
    v_mfma_f32_16x16x32_bf16 a[204:207], a[208:211], v[36:39], a[204:207]
    buffer_load_dwordx4 v73, s[32:35], s37 offen offset:1024 lds
    v_mfma_f32_16x16x32_bf16 v[16:19], a[64:67], a[32:35], v[48:51]
    v_exp_f32 v24, v24
    v_mfma_f32_16x16x32_bf16 v[16:19], a[68:71], a[36:39], v[16:19]
    ds_read_b64_tr_b16 a[160:161], v60 offset:8192
    ds_read_b64_tr_b16 a[162:163], v60 offset:12288
    v_mfma_f32_16x16x32_bf16 v[16:19], a[72:75], a[40:43], v[16:19]
    v_exp_f32 v25, v25
    v_mfma_f32_16x16x32_bf16 v[16:19], a[76:79], a[44:47], v[16:19]
    v_cvt_pk_bf16_f32 v36, v24, v25
    v_mfma_f32_16x16x32_bf16 v[20:23], a[80:83], a[32:35], v[48:51]
    v_exp_f32 v26, v26
    v_mfma_f32_16x16x32_bf16 v[20:23], a[84:87], a[36:39], v[20:23]
    ds_read_b64_tr_b16 a[164:165], v61 offset:8192
    ds_read_b64_tr_b16 a[166:167], v61 offset:12288
    v_mfma_f32_16x16x32_bf16 v[20:23], a[88:91], a[40:43], v[20:23]
    v_exp_f32 v27, v27
    v_mfma_f32_16x16x32_bf16 v[20:23], a[92:95], a[44:47], v[20:23]
    v_cvt_pk_bf16_f32 v37, v26, v27
    s_waitcnt lgkmcnt(4)
    v_mfma_f32_16x16x32_bf16 v[128:131], a[128:131], v[32:35], v[128:131]
    v_exp_f32 v28, v28
    v_mfma_f32_16x16x32_bf16 v[132:135], a[132:135], v[32:35], v[132:135]
    ds_read_b64_tr_b16 a[168:169], v62 offset:8192
    v_mfma_f32_16x16x32_bf16 v[136:139], a[136:139], v[32:35], v[136:139]
    v_exp_f32 v29, v29
    v_mfma_f32_16x16x32_bf16 v[140:143], a[140:143], v[32:35], v[140:143]
    v_cvt_pk_bf16_f32 v38, v28, v29
    v_mfma_f32_16x16x32_bf16 v[144:147], a[144:147], v[32:35], v[144:147]
    v_exp_f32 v30, v30
    v_mfma_f32_16x16x32_bf16 v[148:151], a[148:151], v[32:35], v[148:151]
    ds_read_b64_tr_b16 a[170:171], v62 offset:12288
    v_mfma_f32_16x16x32_bf16 v[152:155], a[152:155], v[32:35], v[152:155]
    v_exp_f32 v31, v31
    v_mfma_f32_16x16x32_bf16 v[156:159], a[156:159], v[32:35], v[156:159]
    v_cvt_pk_bf16_f32 v39, v30, v31
    v_mfma_f32_16x16x32_bf16 a[192:195], a[208:211], v[32:35], a[192:195]
    buffer_load_dwordx4 v72, s[32:35], s37 offen offset:2048 lds
    v_mfma_f32_16x16x32_bf16 v[24:27], a[64:67], a[48:51], v[52:55]
    v_exp_f32 v16, v16
    v_mfma_f32_16x16x32_bf16 v[24:27], a[68:71], a[52:55], v[24:27]
    ds_read_b64_tr_b16 a[172:173], v63 offset:8192
    ds_read_b64_tr_b16 a[174:175], v63 offset:12288
    v_mfma_f32_16x16x32_bf16 v[24:27], a[72:75], a[56:59], v[24:27]
    v_exp_f32 v17, v17
    v_mfma_f32_16x16x32_bf16 v[24:27], a[76:79], a[60:63], v[24:27]
    v_cvt_pk_bf16_f32 v32, v16, v17
    v_mfma_f32_16x16x32_bf16 v[28:31], a[80:83], a[48:51], v[52:55]
    v_exp_f32 v18, v18
    v_mfma_f32_16x16x32_bf16 v[28:31], a[84:87], a[52:55], v[28:31]
    ds_read_b64_tr_b16 a[176:177], v64 offset:8192
    ds_read_b64_tr_b16 a[178:179], v64 offset:12288
    v_mfma_f32_16x16x32_bf16 v[28:31], a[88:91], a[56:59], v[28:31]
    v_exp_f32 v19, v19
    v_mfma_f32_16x16x32_bf16 v[28:31], a[92:95], a[60:63], v[28:31]
    v_cvt_pk_bf16_f32 v33, v18, v19
    v_mfma_f32_16x16x32_bf16 v[160:163], a[128:131], v[36:39], v[160:163]
    v_exp_f32 v20, v20
    v_mfma_f32_16x16x32_bf16 v[164:167], a[132:135], v[36:39], v[164:167]
    ds_read_b64_tr_b16 a[180:181], v65 offset:8192
    v_mfma_f32_16x16x32_bf16 v[168:171], a[136:139], v[36:39], v[168:171]
    v_exp_f32 v21, v21
    v_mfma_f32_16x16x32_bf16 v[172:175], a[140:143], v[36:39], v[172:175]
    v_cvt_pk_bf16_f32 v34, v20, v21
    v_mfma_f32_16x16x32_bf16 v[176:179], a[144:147], v[36:39], v[176:179]
    v_exp_f32 v22, v22
    v_mfma_f32_16x16x32_bf16 v[180:183], a[148:151], v[36:39], v[180:183]
    ds_read_b64_tr_b16 a[182:183], v65 offset:12288
    s_waitcnt vmcnt(7)
    v_mfma_f32_16x16x32_bf16 v[184:187], a[152:155], v[36:39], v[184:187]
    v_exp_f32 v23, v23
    v_mfma_f32_16x16x32_bf16 v[188:191], a[156:159], v[36:39], v[188:191]
    v_cvt_pk_bf16_f32 v35, v22, v23
    s_barrier
    v_mfma_f32_16x16x32_bf16 a[196:199], a[208:211], v[36:39], a[196:199]
    buffer_load_dwordx4 v73, s[32:35], s37 offen offset:3072 lds
    s_cmp_le_u32 s57, 3
    s_cbranch_scc1 kmain_kernel_sideany
kmain_kernel_sideback:
    v_mfma_f32_16x16x32_bf16 v[16:19], a[96:99], a[0:3], v[40:43]
    v_exp_f32 v24, v24
    v_mfma_f32_16x16x32_bf16 v[16:19], a[100:103], a[4:7], v[16:19]
    ds_read_b128 a[64:67], v56 offset:16384
    ds_read_b128 a[68:71], v57 offset:16384
    v_mfma_f32_16x16x32_bf16 v[16:19], a[104:107], a[8:11], v[16:19]
    v_exp_f32 v25, v25
    v_mfma_f32_16x16x32_bf16 v[16:19], a[108:111], a[12:15], v[16:19]
    v_cvt_pk_bf16_f32 v36, v24, v25
    v_mfma_f32_16x16x32_bf16 v[20:23], a[112:115], a[0:3], v[40:43]
    v_exp_f32 v26, v26
    v_mfma_f32_16x16x32_bf16 v[20:23], a[116:119], a[4:7], v[20:23]
    ds_read_b128 a[72:75], v58 offset:16384
    ds_read_b128 a[76:79], v59 offset:16384
    v_mfma_f32_16x16x32_bf16 v[20:23], a[120:123], a[8:11], v[20:23]
    v_exp_f32 v27, v27
    v_mfma_f32_16x16x32_bf16 v[20:23], a[124:127], a[12:15], v[20:23]
    v_cvt_pk_bf16_f32 v37, v26, v27
    v_mfma_f32_16x16x32_bf16 v[192:195], a[128:131], v[32:35], v[192:195]
    v_exp_f32 v28, v28
    v_mfma_f32_16x16x32_bf16 v[196:199], a[132:135], v[32:35], v[196:199]
    ds_read_b64_tr_b16 a[184:185], v66 offset:8192
    s_add_u32 m0, s38, 49152
    v_mfma_f32_16x16x32_bf16 v[200:203], a[136:139], v[32:35], v[200:203]
    v_exp_f32 v29, v29
    v_mfma_f32_16x16x32_bf16 v[204:207], a[140:143], v[32:35], v[204:207]
    v_cvt_pk_bf16_f32 v38, v28, v29
    v_mfma_f32_16x16x32_bf16 v[208:211], a[144:147], v[32:35], v[208:211]
    v_exp_f32 v30, v30
    v_mfma_f32_16x16x32_bf16 v[212:215], a[148:151], v[32:35], v[212:215]
    ds_read_b64_tr_b16 a[186:187], v66 offset:12288
    v_mfma_f32_16x16x32_bf16 v[216:219], a[152:155], v[32:35], v[216:219]
    v_exp_f32 v31, v31
    v_mfma_f32_16x16x32_bf16 v[220:223], a[156:159], v[32:35], v[220:223]
    v_cvt_pk_bf16_f32 v39, v30, v31
    v_mfma_f32_16x16x32_bf16 a[200:203], a[208:211], v[32:35], a[200:203]
    buffer_load_dwordx4 v68, s[28:31], s36 offen offset:0 lds
    v_mfma_f32_16x16x32_bf16 v[24:27], a[96:99], a[16:19], v[44:47]
    v_exp_f32 v16, v16
    v_mfma_f32_16x16x32_bf16 v[24:27], a[100:103], a[20:23], v[24:27]
    ds_read_b128 a[80:83], v56 offset:20480
    ds_read_b128 a[84:87], v57 offset:20480
    v_mfma_f32_16x16x32_bf16 v[24:27], a[104:107], a[24:27], v[24:27]
    v_exp_f32 v17, v17
    v_mfma_f32_16x16x32_bf16 v[24:27], a[108:111], a[28:31], v[24:27]
    v_cvt_pk_bf16_f32 v32, v16, v17
    v_mfma_f32_16x16x32_bf16 v[28:31], a[112:115], a[16:19], v[44:47]
    v_exp_f32 v18, v18
    v_mfma_f32_16x16x32_bf16 v[28:31], a[116:119], a[20:23], v[28:31]
    ds_read_b128 a[88:91], v58 offset:20480
    ds_read_b128 a[92:95], v59 offset:20480
    v_mfma_f32_16x16x32_bf16 v[28:31], a[120:123], a[24:27], v[28:31]
    v_exp_f32 v19, v19
    v_mfma_f32_16x16x32_bf16 v[28:31], a[124:127], a[28:31], v[28:31]
    v_cvt_pk_bf16_f32 v33, v18, v19
    v_mfma_f32_16x16x32_bf16 v[224:227], a[128:131], v[36:39], v[224:227]
    v_exp_f32 v20, v20
    v_mfma_f32_16x16x32_bf16 v[228:231], a[132:135], v[36:39], v[228:231]
    ds_read_b64_tr_b16 a[188:189], v67 offset:8192
    s_add_u32 s37, s37, 16384
    v_mfma_f32_16x16x32_bf16 v[232:235], a[136:139], v[36:39], v[232:235]
    v_exp_f32 v21, v21
    v_mfma_f32_16x16x32_bf16 v[236:239], a[140:143], v[36:39], v[236:239]
    v_cvt_pk_bf16_f32 v34, v20, v21
    v_mfma_f32_16x16x32_bf16 v[240:243], a[144:147], v[36:39], v[240:243]
    v_exp_f32 v22, v22
    v_mfma_f32_16x16x32_bf16 v[244:247], a[148:151], v[36:39], v[244:247]
    ds_read_b64_tr_b16 a[190:191], v67 offset:12288
    s_min_u32 s37, s37, 507904
    v_mfma_f32_16x16x32_bf16 v[248:251], a[152:155], v[36:39], v[248:251]
    v_exp_f32 v23, v23
    v_mfma_f32_16x16x32_bf16 v[252:255], a[156:159], v[36:39], v[252:255]
    v_cvt_pk_bf16_f32 v35, v22, v23
    v_mfma_f32_16x16x32_bf16 a[204:207], a[208:211], v[36:39], a[204:207]
    buffer_load_dwordx4 v69, s[28:31], s36 offen offset:1024 lds
    v_mfma_f32_16x16x32_bf16 v[16:19], a[96:99], a[32:35], v[48:51]
    v_exp_f32 v24, v24
    v_mfma_f32_16x16x32_bf16 v[16:19], a[100:103], a[36:39], v[16:19]
    ds_read_b64_tr_b16 a[128:129], v60 offset:16384
    ds_read_b64_tr_b16 a[130:131], v60 offset:20480
    v_mfma_f32_16x16x32_bf16 v[16:19], a[104:107], a[40:43], v[16:19]
    v_exp_f32 v25, v25
    v_mfma_f32_16x16x32_bf16 v[16:19], a[108:111], a[44:47], v[16:19]
    v_cvt_pk_bf16_f32 v36, v24, v25
    v_mfma_f32_16x16x32_bf16 v[20:23], a[112:115], a[32:35], v[48:51]
    v_exp_f32 v26, v26
    v_mfma_f32_16x16x32_bf16 v[20:23], a[116:119], a[36:39], v[20:23]
    ds_read_b64_tr_b16 a[132:133], v61 offset:16384
    ds_read_b64_tr_b16 a[134:135], v61 offset:20480
    v_mfma_f32_16x16x32_bf16 v[20:23], a[120:123], a[40:43], v[20:23]
    v_exp_f32 v27, v27
    v_mfma_f32_16x16x32_bf16 v[20:23], a[124:127], a[44:47], v[20:23]
    v_cvt_pk_bf16_f32 v37, v26, v27
    s_waitcnt lgkmcnt(4)
    v_mfma_f32_16x16x32_bf16 v[128:131], a[160:163], v[32:35], v[128:131]
    v_exp_f32 v28, v28
    v_mfma_f32_16x16x32_bf16 v[132:135], a[164:167], v[32:35], v[132:135]
    ds_read_b64_tr_b16 a[136:137], v62 offset:16384
    v_mfma_f32_16x16x32_bf16 v[136:139], a[168:171], v[32:35], v[136:139]
    v_exp_f32 v29, v29
    v_mfma_f32_16x16x32_bf16 v[140:143], a[172:175], v[32:35], v[140:143]
    v_cvt_pk_bf16_f32 v38, v28, v29
    v_mfma_f32_16x16x32_bf16 v[144:147], a[176:179], v[32:35], v[144:147]
    v_exp_f32 v30, v30
    v_mfma_f32_16x16x32_bf16 v[148:151], a[180:183], v[32:35], v[148:151]
    ds_read_b64_tr_b16 a[138:139], v62 offset:20480
    v_mfma_f32_16x16x32_bf16 v[152:155], a[184:187], v[32:35], v[152:155]
    v_exp_f32 v31, v31
    v_mfma_f32_16x16x32_bf16 v[156:159], a[188:191], v[32:35], v[156:159]
    v_cvt_pk_bf16_f32 v39, v30, v31
    v_mfma_f32_16x16x32_bf16 a[192:195], a[208:211], v[32:35], a[192:195]
    buffer_load_dwordx4 v70, s[28:31], s36 offen offset:2048 lds
    v_mfma_f32_16x16x32_bf16 v[24:27], a[96:99], a[48:51], v[52:55]
    v_exp_f32 v16, v16
    v_mfma_f32_16x16x32_bf16 v[24:27], a[100:103], a[52:55], v[24:27]
    ds_read_b64_tr_b16 a[140:141], v63 offset:16384
    ds_read_b64_tr_b16 a[142:143], v63 offset:20480
    v_mfma_f32_16x16x32_bf16 v[24:27], a[104:107], a[56:59], v[24:27]
    v_exp_f32 v17, v17
    v_mfma_f32_16x16x32_bf16 v[24:27], a[108:111], a[60:63], v[24:27]
    v_cvt_pk_bf16_f32 v32, v16, v17
    v_mfma_f32_16x16x32_bf16 v[28:31], a[112:115], a[48:51], v[52:55]
    v_exp_f32 v18, v18
    v_mfma_f32_16x16x32_bf16 v[28:31], a[116:119], a[52:55], v[28:31]
    ds_read_b64_tr_b16 a[144:145], v64 offset:16384
    ds_read_b64_tr_b16 a[146:147], v64 offset:20480
    v_mfma_f32_16x16x32_bf16 v[28:31], a[120:123], a[56:59], v[28:31]
    v_exp_f32 v19, v19
    v_mfma_f32_16x16x32_bf16 v[28:31], a[124:127], a[60:63], v[28:31]
    v_cvt_pk_bf16_f32 v33, v18, v19
    v_mfma_f32_16x16x32_bf16 v[160:163], a[160:163], v[36:39], v[160:163]
    v_exp_f32 v20, v20
    v_mfma_f32_16x16x32_bf16 v[164:167], a[164:167], v[36:39], v[164:167]
    ds_read_b64_tr_b16 a[148:149], v65 offset:16384
    v_mfma_f32_16x16x32_bf16 v[168:171], a[168:171], v[36:39], v[168:171]
    v_exp_f32 v21, v21
    v_mfma_f32_16x16x32_bf16 v[172:175], a[172:175], v[36:39], v[172:175]
    v_cvt_pk_bf16_f32 v34, v20, v21
    v_mfma_f32_16x16x32_bf16 v[176:179], a[176:179], v[36:39], v[176:179]
    v_exp_f32 v22, v22
    v_mfma_f32_16x16x32_bf16 v[180:183], a[180:183], v[36:39], v[180:183]
    ds_read_b64_tr_b16 a[150:151], v65 offset:20480
    v_mfma_f32_16x16x32_bf16 v[184:187], a[184:187], v[36:39], v[184:187]
    v_exp_f32 v23, v23
    v_mfma_f32_16x16x32_bf16 v[188:191], a[188:191], v[36:39], v[188:191]
    v_cvt_pk_bf16_f32 v35, v22, v23
    v_mfma_f32_16x16x32_bf16 a[196:199], a[208:211], v[36:39], a[196:199]
    buffer_load_dwordx4 v71, s[28:31], s36 offen offset:3072 lds
    v_mfma_f32_16x16x32_bf16 v[16:19], a[64:67], a[0:3], v[40:43]
    v_exp_f32 v24, v24
    v_mfma_f32_16x16x32_bf16 v[16:19], a[68:71], a[4:7], v[16:19]
    ds_read_b128 a[96:99], v56 offset:24576
    ds_read_b128 a[100:103], v57 offset:24576
    v_mfma_f32_16x16x32_bf16 v[16:19], a[72:75], a[8:11], v[16:19]
    v_exp_f32 v25, v25
    v_mfma_f32_16x16x32_bf16 v[16:19], a[76:79], a[12:15], v[16:19]
    v_cvt_pk_bf16_f32 v36, v24, v25
    v_mfma_f32_16x16x32_bf16 v[20:23], a[80:83], a[0:3], v[40:43]
    v_exp_f32 v26, v26
    v_mfma_f32_16x16x32_bf16 v[20:23], a[84:87], a[4:7], v[20:23]
    ds_read_b128 a[104:107], v58 offset:24576
    ds_read_b128 a[108:111], v59 offset:24576
    v_mfma_f32_16x16x32_bf16 v[20:23], a[88:91], a[8:11], v[20:23]
    v_exp_f32 v27, v27
    v_mfma_f32_16x16x32_bf16 v[20:23], a[92:95], a[12:15], v[20:23]
    v_cvt_pk_bf16_f32 v37, v26, v27
    v_mfma_f32_16x16x32_bf16 v[192:195], a[160:163], v[32:35], v[192:195]
    v_exp_f32 v28, v28
    v_mfma_f32_16x16x32_bf16 v[196:199], a[164:167], v[32:35], v[196:199]
    ds_read_b64_tr_b16 a[152:153], v66 offset:16384
    s_add_u32 m0, s39, 49152
    v_mfma_f32_16x16x32_bf16 v[200:203], a[168:171], v[32:35], v[200:203]
    v_exp_f32 v29, v29
    v_mfma_f32_16x16x32_bf16 v[204:207], a[172:175], v[32:35], v[204:207]
    v_cvt_pk_bf16_f32 v38, v28, v29
    v_mfma_f32_16x16x32_bf16 v[208:211], a[176:179], v[32:35], v[208:211]
    v_exp_f32 v30, v30
    v_mfma_f32_16x16x32_bf16 v[212:215], a[180:183], v[32:35], v[212:215]
    ds_read_b64_tr_b16 a[154:155], v66 offset:20480
    v_mfma_f32_16x16x32_bf16 v[216:219], a[184:187], v[32:35], v[216:219]
    v_exp_f32 v31, v31
    v_mfma_f32_16x16x32_bf16 v[220:223], a[188:191], v[32:35], v[220:223]
    v_cvt_pk_bf16_f32 v39, v30, v31
    v_mfma_f32_16x16x32_bf16 a[200:203], a[208:211], v[32:35], a[200:203]
    buffer_load_dwordx4 v72, s[32:35], s37 offen offset:0 lds
    v_mfma_f32_16x16x32_bf16 v[24:27], a[64:67], a[16:19], v[44:47]
    v_exp_f32 v16, v16
    v_mfma_f32_16x16x32_bf16 v[24:27], a[68:71], a[20:23], v[24:27]
    ds_read_b128 a[112:115], v56 offset:28672
    ds_read_b128 a[116:119], v57 offset:28672
    v_mfma_f32_16x16x32_bf16 v[24:27], a[72:75], a[24:27], v[24:27]
    v_exp_f32 v17, v17
    v_mfma_f32_16x16x32_bf16 v[24:27], a[76:79], a[28:31], v[24:27]
    v_cvt_pk_bf16_f32 v32, v16, v17
    v_mfma_f32_16x16x32_bf16 v[28:31], a[80:83], a[16:19], v[44:47]
    v_exp_f32 v18, v18
    v_mfma_f32_16x16x32_bf16 v[28:31], a[84:87], a[20:23], v[28:31]
    ds_read_b128 a[120:123], v58 offset:28672
    ds_read_b128 a[124:127], v59 offset:28672
    v_mfma_f32_16x16x32_bf16 v[28:31], a[88:91], a[24:27], v[28:31]
    v_exp_f32 v19, v19
    v_mfma_f32_16x16x32_bf16 v[28:31], a[92:95], a[28:31], v[28:31]
    v_cvt_pk_bf16_f32 v33, v18, v19
    v_mfma_f32_16x16x32_bf16 v[224:227], a[160:163], v[36:39], v[224:227]
    v_exp_f32 v20, v20
    v_mfma_f32_16x16x32_bf16 v[228:231], a[164:167], v[36:39], v[228:231]
    ds_read_b64_tr_b16 a[156:157], v67 offset:16384
    s_add_u32 s36, s36, 16384
    v_mfma_f32_16x16x32_bf16 v[232:235], a[168:171], v[36:39], v[232:235]
    v_exp_f32 v21, v21
    v_mfma_f32_16x16x32_bf16 v[236:239], a[172:175], v[36:39], v[236:239]
    v_cvt_pk_bf16_f32 v34, v20, v21
    v_mfma_f32_16x16x32_bf16 v[240:243], a[176:179], v[36:39], v[240:243]
    v_exp_f32 v22, v22
    v_mfma_f32_16x16x32_bf16 v[244:247], a[180:183], v[36:39], v[244:247]
    ds_read_b64_tr_b16 a[158:159], v67 offset:20480
    s_min_u32 s36, s36, 507904
    v_mfma_f32_16x16x32_bf16 v[248:251], a[184:187], v[36:39], v[248:251]
    v_exp_f32 v23, v23
    v_mfma_f32_16x16x32_bf16 v[252:255], a[188:191], v[36:39], v[252:255]
    v_cvt_pk_bf16_f32 v35, v22, v23
    v_mfma_f32_16x16x32_bf16 a[204:207], a[208:211], v[36:39], a[204:207]
    buffer_load_dwordx4 v73, s[32:35], s37 offen offset:1024 lds
    v_mfma_f32_16x16x32_bf16 v[16:19], a[64:67], a[32:35], v[48:51]
    v_exp_f32 v24, v24
    v_mfma_f32_16x16x32_bf16 v[16:19], a[68:71], a[36:39], v[16:19]
    ds_read_b64_tr_b16 a[160:161], v60 offset:24576
    ds_read_b64_tr_b16 a[162:163], v60 offset:28672
    v_mfma_f32_16x16x32_bf16 v[16:19], a[72:75], a[40:43], v[16:19]
    v_exp_f32 v25, v25
    v_mfma_f32_16x16x32_bf16 v[16:19], a[76:79], a[44:47], v[16:19]
    v_cvt_pk_bf16_f32 v36, v24, v25
    v_mfma_f32_16x16x32_bf16 v[20:23], a[80:83], a[32:35], v[48:51]
    v_exp_f32 v26, v26
    v_mfma_f32_16x16x32_bf16 v[20:23], a[84:87], a[36:39], v[20:23]
    ds_read_b64_tr_b16 a[164:165], v61 offset:24576
    ds_read_b64_tr_b16 a[166:167], v61 offset:28672
    v_mfma_f32_16x16x32_bf16 v[20:23], a[88:91], a[40:43], v[20:23]
    v_exp_f32 v27, v27
    v_mfma_f32_16x16x32_bf16 v[20:23], a[92:95], a[44:47], v[20:23]
    v_cvt_pk_bf16_f32 v37, v26, v27
    s_waitcnt lgkmcnt(4)
    v_mfma_f32_16x16x32_bf16 v[128:131], a[128:131], v[32:35], v[128:131]
    v_exp_f32 v28, v28
    v_mfma_f32_16x16x32_bf16 v[132:135], a[132:135], v[32:35], v[132:135]
    ds_read_b64_tr_b16 a[168:169], v62 offset:24576
    v_mfma_f32_16x16x32_bf16 v[136:139], a[136:139], v[32:35], v[136:139]
    v_exp_f32 v29, v29
    v_mfma_f32_16x16x32_bf16 v[140:143], a[140:143], v[32:35], v[140:143]
    v_cvt_pk_bf16_f32 v38, v28, v29
    v_mfma_f32_16x16x32_bf16 v[144:147], a[144:147], v[32:35], v[144:147]
    v_exp_f32 v30, v30
    v_mfma_f32_16x16x32_bf16 v[148:151], a[148:151], v[32:35], v[148:151]
    ds_read_b64_tr_b16 a[170:171], v62 offset:28672
    v_mfma_f32_16x16x32_bf16 v[152:155], a[152:155], v[32:35], v[152:155]
    v_exp_f32 v31, v31
    v_mfma_f32_16x16x32_bf16 v[156:159], a[156:159], v[32:35], v[156:159]
    v_cvt_pk_bf16_f32 v39, v30, v31
    v_mfma_f32_16x16x32_bf16 a[192:195], a[208:211], v[32:35], a[192:195]
    buffer_load_dwordx4 v72, s[32:35], s37 offen offset:2048 lds
    v_mfma_f32_16x16x32_bf16 v[24:27], a[64:67], a[48:51], v[52:55]
    v_exp_f32 v16, v16
    v_mfma_f32_16x16x32_bf16 v[24:27], a[68:71], a[52:55], v[24:27]
    ds_read_b64_tr_b16 a[172:173], v63 offset:24576
    ds_read_b64_tr_b16 a[174:175], v63 offset:28672
    v_mfma_f32_16x16x32_bf16 v[24:27], a[72:75], a[56:59], v[24:27]
    v_exp_f32 v17, v17
    v_mfma_f32_16x16x32_bf16 v[24:27], a[76:79], a[60:63], v[24:27]
    v_cvt_pk_bf16_f32 v32, v16, v17
    v_mfma_f32_16x16x32_bf16 v[28:31], a[80:83], a[48:51], v[52:55]
    v_exp_f32 v18, v18
    v_mfma_f32_16x16x32_bf16 v[28:31], a[84:87], a[52:55], v[28:31]
    ds_read_b64_tr_b16 a[176:177], v64 offset:24576
    ds_read_b64_tr_b16 a[178:179], v64 offset:28672
    v_mfma_f32_16x16x32_bf16 v[28:31], a[88:91], a[56:59], v[28:31]
    v_exp_f32 v19, v19
    v_mfma_f32_16x16x32_bf16 v[28:31], a[92:95], a[60:63], v[28:31]
    v_cvt_pk_bf16_f32 v33, v18, v19
    v_mfma_f32_16x16x32_bf16 v[160:163], a[128:131], v[36:39], v[160:163]
    v_exp_f32 v20, v20
    v_mfma_f32_16x16x32_bf16 v[164:167], a[132:135], v[36:39], v[164:167]
    ds_read_b64_tr_b16 a[180:181], v65 offset:24576
    v_mfma_f32_16x16x32_bf16 v[168:171], a[136:139], v[36:39], v[168:171]
    v_exp_f32 v21, v21
    v_mfma_f32_16x16x32_bf16 v[172:175], a[140:143], v[36:39], v[172:175]
    v_cvt_pk_bf16_f32 v34, v20, v21
    v_mfma_f32_16x16x32_bf16 v[176:179], a[144:147], v[36:39], v[176:179]
    v_exp_f32 v22, v22
    v_mfma_f32_16x16x32_bf16 v[180:183], a[148:151], v[36:39], v[180:183]
    ds_read_b64_tr_b16 a[182:183], v65 offset:28672
    s_cmp_lg_u32 s58, 0
    s_cbranch_scc1 kmain_kernel_dynout
    s_waitcnt vmcnt(7)
kmain_kernel_dynback:
    v_mfma_f32_16x16x32_bf16 v[184:187], a[152:155], v[36:39], v[184:187]
    v_exp_f32 v23, v23
    v_mfma_f32_16x16x32_bf16 v[188:191], a[156:159], v[36:39], v[188:191]
    v_cvt_pk_bf16_f32 v35, v22, v23
    s_barrier
    v_mfma_f32_16x16x32_bf16 a[196:199], a[208:211], v[36:39], a[196:199]
    buffer_load_dwordx4 v73, s[32:35], s37 offen offset:3072 lds
    v_mfma_f32_16x16x32_bf16 v[16:19], a[96:99], a[0:3], v[40:43]
    v_exp_f32 v24, v24
    v_mfma_f32_16x16x32_bf16 v[16:19], a[100:103], a[4:7], v[16:19]
    ds_read_b128 a[64:67], v56 offset:32768
    ds_read_b128 a[68:71], v57 offset:32768
    v_mfma_f32_16x16x32_bf16 v[16:19], a[104:107], a[8:11], v[16:19]
    v_exp_f32 v25, v25
    v_mfma_f32_16x16x32_bf16 v[16:19], a[108:111], a[12:15], v[16:19]
    v_cvt_pk_bf16_f32 v36, v24, v25
    v_mfma_f32_16x16x32_bf16 v[20:23], a[112:115], a[0:3], v[40:43]
    v_exp_f32 v26, v26
    v_mfma_f32_16x16x32_bf16 v[20:23], a[116:119], a[4:7], v[20:23]
    ds_read_b128 a[72:75], v58 offset:32768
    ds_read_b128 a[76:79], v59 offset:32768
    v_mfma_f32_16x16x32_bf16 v[20:23], a[120:123], a[8:11], v[20:23]
    v_exp_f32 v27, v27
    v_mfma_f32_16x16x32_bf16 v[20:23], a[124:127], a[12:15], v[20:23]
    v_cvt_pk_bf16_f32 v37, v26, v27
    v_mfma_f32_16x16x32_bf16 v[192:195], a[128:131], v[32:35], v[192:195]
    v_exp_f32 v28, v28
    v_mfma_f32_16x16x32_bf16 v[196:199], a[132:135], v[32:35], v[196:199]
    ds_read_b64_tr_b16 a[184:185], v66 offset:24576
    s_add_u32 m0, s38, 0
    v_mfma_f32_16x16x32_bf16 v[200:203], a[136:139], v[32:35], v[200:203]
    v_exp_f32 v29, v29
    v_mfma_f32_16x16x32_bf16 v[204:207], a[140:143], v[32:35], v[204:207]
    v_cvt_pk_bf16_f32 v38, v28, v29
    v_mfma_f32_16x16x32_bf16 v[208:211], a[144:147], v[32:35], v[208:211]
    v_exp_f32 v30, v30
    v_mfma_f32_16x16x32_bf16 v[212:215], a[148:151], v[32:35], v[212:215]
    ds_read_b64_tr_b16 a[186:187], v66 offset:28672
    buffer_load_dword v5, v3, s[8:11], 0 offen sc1
    v_mfma_f32_16x16x32_bf16 v[216:219], a[152:155], v[32:35], v[216:219]
    v_exp_f32 v31, v31
    v_mfma_f32_16x16x32_bf16 v[220:223], a[156:159], v[32:35], v[220:223]
    v_cvt_pk_bf16_f32 v39, v30, v31
    v_mfma_f32_16x16x32_bf16 a[200:203], a[208:211], v[32:35], a[200:203]
    buffer_load_dwordx4 v68, s[28:31], s36 offen offset:0 lds
    v_mfma_f32_16x16x32_bf16 v[24:27], a[96:99], a[16:19], v[44:47]
    v_exp_f32 v16, v16
    v_mfma_f32_16x16x32_bf16 v[24:27], a[100:103], a[20:23], v[24:27]
    ds_read_b128 a[80:83], v56 offset:36864
    ds_read_b128 a[84:87], v57 offset:36864
    v_mfma_f32_16x16x32_bf16 v[24:27], a[104:107], a[24:27], v[24:27]
    v_exp_f32 v17, v17
    v_mfma_f32_16x16x32_bf16 v[24:27], a[108:111], a[28:31], v[24:27]
    v_cvt_pk_bf16_f32 v32, v16, v17
    v_mfma_f32_16x16x32_bf16 v[28:31], a[112:115], a[16:19], v[44:47]
    v_exp_f32 v18, v18
    v_mfma_f32_16x16x32_bf16 v[28:31], a[116:119], a[20:23], v[28:31]
    ds_read_b128 a[88:91], v58 offset:36864
    ds_read_b128 a[92:95], v59 offset:36864
    v_mfma_f32_16x16x32_bf16 v[28:31], a[120:123], a[24:27], v[28:31]
    v_exp_f32 v19, v19
    v_mfma_f32_16x16x32_bf16 v[28:31], a[124:127], a[28:31], v[28:31]
    v_cvt_pk_bf16_f32 v33, v18, v19
    v_mfma_f32_16x16x32_bf16 v[224:227], a[128:131], v[36:39], v[224:227]
    v_exp_f32 v20, v20
    v_mfma_f32_16x16x32_bf16 v[228:231], a[132:135], v[36:39], v[228:231]
    ds_read_b64_tr_b16 a[188:189], v67 offset:24576
    s_add_u32 s37, s37, 16384
    v_mfma_f32_16x16x32_bf16 v[232:235], a[136:139], v[36:39], v[232:235]
    v_exp_f32 v21, v21
    v_mfma_f32_16x16x32_bf16 v[236:239], a[140:143], v[36:39], v[236:239]
    v_cvt_pk_bf16_f32 v34, v20, v21
    v_mfma_f32_16x16x32_bf16 v[240:243], a[144:147], v[36:39], v[240:243]
    v_exp_f32 v22, v22
    v_mfma_f32_16x16x32_bf16 v[244:247], a[148:151], v[36:39], v[244:247]
    ds_read_b64_tr_b16 a[190:191], v67 offset:28672
    s_min_u32 s37, s37, 507904
    v_mfma_f32_16x16x32_bf16 v[248:251], a[152:155], v[36:39], v[248:251]
    v_exp_f32 v23, v23
    v_mfma_f32_16x16x32_bf16 v[252:255], a[156:159], v[36:39], v[252:255]
    v_cvt_pk_bf16_f32 v35, v22, v23
    v_mfma_f32_16x16x32_bf16 a[204:207], a[208:211], v[36:39], a[204:207]
    buffer_load_dwordx4 v69, s[28:31], s36 offen offset:1024 lds
    v_mfma_f32_16x16x32_bf16 v[16:19], a[96:99], a[32:35], v[48:51]
    v_exp_f32 v24, v24
    v_mfma_f32_16x16x32_bf16 v[16:19], a[100:103], a[36:39], v[16:19]
    ds_read_b64_tr_b16 a[128:129], v60 offset:32768
    ds_read_b64_tr_b16 a[130:131], v60 offset:36864
    v_mfma_f32_16x16x32_bf16 v[16:19], a[104:107], a[40:43], v[16:19]
    v_exp_f32 v25, v25
    v_mfma_f32_16x16x32_bf16 v[16:19], a[108:111], a[44:47], v[16:19]
    v_cvt_pk_bf16_f32 v36, v24, v25
    v_mfma_f32_16x16x32_bf16 v[20:23], a[112:115], a[32:35], v[48:51]
    v_exp_f32 v26, v26
    v_mfma_f32_16x16x32_bf16 v[20:23], a[116:119], a[36:39], v[20:23]
    ds_read_b64_tr_b16 a[132:133], v61 offset:32768
    ds_read_b64_tr_b16 a[134:135], v61 offset:36864
    v_mfma_f32_16x16x32_bf16 v[20:23], a[120:123], a[40:43], v[20:23]
    v_exp_f32 v27, v27
    v_mfma_f32_16x16x32_bf16 v[20:23], a[124:127], a[44:47], v[20:23]
    v_cvt_pk_bf16_f32 v37, v26, v27
    s_waitcnt lgkmcnt(4)
    v_mfma_f32_16x16x32_bf16 v[128:131], a[160:163], v[32:35], v[128:131]
    v_exp_f32 v28, v28
    v_mfma_f32_16x16x32_bf16 v[132:135], a[164:167], v[32:35], v[132:135]
    ds_read_b64_tr_b16 a[136:137], v62 offset:32768
    v_mfma_f32_16x16x32_bf16 v[136:139], a[168:171], v[32:35], v[136:139]
    v_exp_f32 v29, v29
    v_mfma_f32_16x16x32_bf16 v[140:143], a[172:175], v[32:35], v[140:143]
    v_cvt_pk_bf16_f32 v38, v28, v29
    v_mfma_f32_16x16x32_bf16 v[144:147], a[176:179], v[32:35], v[144:147]
    v_exp_f32 v30, v30
    v_mfma_f32_16x16x32_bf16 v[148:151], a[180:183], v[32:35], v[148:151]
    ds_read_b64_tr_b16 a[138:139], v62 offset:36864
    v_mfma_f32_16x16x32_bf16 v[152:155], a[184:187], v[32:35], v[152:155]
    v_exp_f32 v31, v31
    v_mfma_f32_16x16x32_bf16 v[156:159], a[188:191], v[32:35], v[156:159]
    v_cvt_pk_bf16_f32 v39, v30, v31
    v_mfma_f32_16x16x32_bf16 a[192:195], a[208:211], v[32:35], a[192:195]
    buffer_load_dwordx4 v70, s[28:31], s36 offen offset:2048 lds
    v_mfma_f32_16x16x32_bf16 v[24:27], a[96:99], a[48:51], v[52:55]
    v_exp_f32 v16, v16
    v_mfma_f32_16x16x32_bf16 v[24:27], a[100:103], a[52:55], v[24:27]
    ds_read_b64_tr_b16 a[140:141], v63 offset:32768
    ds_read_b64_tr_b16 a[142:143], v63 offset:36864
    v_mfma_f32_16x16x32_bf16 v[24:27], a[104:107], a[56:59], v[24:27]
    v_exp_f32 v17, v17
    v_mfma_f32_16x16x32_bf16 v[24:27], a[108:111], a[60:63], v[24:27]
    v_cvt_pk_bf16_f32 v32, v16, v17
    v_mfma_f32_16x16x32_bf16 v[28:31], a[112:115], a[48:51], v[52:55]
    v_exp_f32 v18, v18
    v_mfma_f32_16x16x32_bf16 v[28:31], a[116:119], a[52:55], v[28:31]
    ds_read_b64_tr_b16 a[144:145], v64 offset:32768
    ds_read_b64_tr_b16 a[146:147], v64 offset:36864
    v_mfma_f32_16x16x32_bf16 v[28:31], a[120:123], a[56:59], v[28:31]
    v_exp_f32 v19, v19
    v_mfma_f32_16x16x32_bf16 v[28:31], a[124:127], a[60:63], v[28:31]
    v_cvt_pk_bf16_f32 v33, v18, v19
    v_mfma_f32_16x16x32_bf16 v[160:163], a[160:163], v[36:39], v[160:163]
    v_exp_f32 v20, v20
    v_mfma_f32_16x16x32_bf16 v[164:167], a[164:167], v[36:39], v[164:167]
    ds_read_b64_tr_b16 a[148:149], v65 offset:32768
    v_mfma_f32_16x16x32_bf16 v[168:171], a[168:171], v[36:39], v[168:171]
    v_exp_f32 v21, v21
    v_mfma_f32_16x16x32_bf16 v[172:175], a[172:175], v[36:39], v[172:175]
    v_cvt_pk_bf16_f32 v34, v20, v21
    v_mfma_f32_16x16x32_bf16 v[176:179], a[176:179], v[36:39], v[176:179]
    v_exp_f32 v22, v22
    v_mfma_f32_16x16x32_bf16 v[180:183], a[180:183], v[36:39], v[180:183]
    ds_read_b64_tr_b16 a[150:151], v65 offset:36864
    v_mfma_f32_16x16x32_bf16 v[184:187], a[184:187], v[36:39], v[184:187]
    v_exp_f32 v23, v23
    v_mfma_f32_16x16x32_bf16 v[188:191], a[188:191], v[36:39], v[188:191]
    v_cvt_pk_bf16_f32 v35, v22, v23
    v_mfma_f32_16x16x32_bf16 a[196:199], a[208:211], v[36:39], a[196:199]
    buffer_load_dwordx4 v71, s[28:31], s36 offen offset:3072 lds
    v_mfma_f32_16x16x32_bf16 v[16:19], a[64:67], a[0:3], v[40:43]
    v_exp_f32 v24, v24
    v_mfma_f32_16x16x32_bf16 v[16:19], a[68:71], a[4:7], v[16:19]
    ds_read_b128 a[96:99], v56 offset:40960
    ds_read_b128 a[100:103], v57 offset:40960
    v_mfma_f32_16x16x32_bf16 v[16:19], a[72:75], a[8:11], v[16:19]
    v_exp_f32 v25, v25
    v_mfma_f32_16x16x32_bf16 v[16:19], a[76:79], a[12:15], v[16:19]
    v_cvt_pk_bf16_f32 v36, v24, v25
    v_mfma_f32_16x16x32_bf16 v[20:23], a[80:83], a[0:3], v[40:43]
    v_exp_f32 v26, v26
    v_mfma_f32_16x16x32_bf16 v[20:23], a[84:87], a[4:7], v[20:23]
    ds_read_b128 a[104:107], v58 offset:40960
    ds_read_b128 a[108:111], v59 offset:40960
    v_mfma_f32_16x16x32_bf16 v[20:23], a[88:91], a[8:11], v[20:23]
    v_exp_f32 v27, v27
    v_mfma_f32_16x16x32_bf16 v[20:23], a[92:95], a[12:15], v[20:23]
    v_cvt_pk_bf16_f32 v37, v26, v27
    v_mfma_f32_16x16x32_bf16 v[192:195], a[160:163], v[32:35], v[192:195]
    v_exp_f32 v28, v28
    v_mfma_f32_16x16x32_bf16 v[196:199], a[164:167], v[32:35], v[196:199]
    ds_read_b64_tr_b16 a[152:153], v66 offset:32768
    s_add_u32 m0, s39, 0
    v_mfma_f32_16x16x32_bf16 v[200:203], a[168:171], v[32:35], v[200:203]
    v_exp_f32 v29, v29
    v_mfma_f32_16x16x32_bf16 v[204:207], a[172:175], v[32:35], v[204:207]
    v_cvt_pk_bf16_f32 v38, v28, v29
    v_mfma_f32_16x16x32_bf16 v[208:211], a[176:179], v[32:35], v[208:211]
    v_exp_f32 v30, v30
    v_mfma_f32_16x16x32_bf16 v[212:215], a[180:183], v[32:35], v[212:215]
    ds_read_b64_tr_b16 a[154:155], v66 offset:36864
    v_mfma_f32_16x16x32_bf16 v[216:219], a[184:187], v[32:35], v[216:219]
    v_exp_f32 v31, v31
    v_mfma_f32_16x16x32_bf16 v[220:223], a[188:191], v[32:35], v[220:223]
    v_cvt_pk_bf16_f32 v39, v30, v31
    v_mfma_f32_16x16x32_bf16 a[200:203], a[208:211], v[32:35], a[200:203]
    buffer_load_dwordx4 v72, s[32:35], s37 offen offset:0 lds
    v_mfma_f32_16x16x32_bf16 v[24:27], a[64:67], a[16:19], v[44:47]
    v_exp_f32 v16, v16
    v_mfma_f32_16x16x32_bf16 v[24:27], a[68:71], a[20:23], v[24:27]
    ds_read_b128 a[112:115], v56 offset:45056
    ds_read_b128 a[116:119], v57 offset:45056
    v_mfma_f32_16x16x32_bf16 v[24:27], a[72:75], a[24:27], v[24:27]
    v_exp_f32 v17, v17
    v_mfma_f32_16x16x32_bf16 v[24:27], a[76:79], a[28:31], v[24:27]
    v_cvt_pk_bf16_f32 v32, v16, v17
    v_mfma_f32_16x16x32_bf16 v[28:31], a[80:83], a[16:19], v[44:47]
    v_exp_f32 v18, v18
    v_mfma_f32_16x16x32_bf16 v[28:31], a[84:87], a[20:23], v[28:31]
    ds_read_b128 a[120:123], v58 offset:45056
    ds_read_b128 a[124:127], v59 offset:45056
    v_mfma_f32_16x16x32_bf16 v[28:31], a[88:91], a[24:27], v[28:31]
    v_exp_f32 v19, v19
    v_mfma_f32_16x16x32_bf16 v[28:31], a[92:95], a[28:31], v[28:31]
    v_cvt_pk_bf16_f32 v33, v18, v19
    v_mfma_f32_16x16x32_bf16 v[224:227], a[160:163], v[36:39], v[224:227]
    v_exp_f32 v20, v20
    v_mfma_f32_16x16x32_bf16 v[228:231], a[164:167], v[36:39], v[228:231]
    ds_read_b64_tr_b16 a[156:157], v67 offset:32768
    s_add_u32 s36, s36, 16384
    v_mfma_f32_16x16x32_bf16 v[232:235], a[168:171], v[36:39], v[232:235]
    v_exp_f32 v21, v21
    v_mfma_f32_16x16x32_bf16 v[236:239], a[172:175], v[36:39], v[236:239]
    v_cvt_pk_bf16_f32 v34, v20, v21
    v_mfma_f32_16x16x32_bf16 v[240:243], a[176:179], v[36:39], v[240:243]
    v_exp_f32 v22, v22
    v_mfma_f32_16x16x32_bf16 v[244:247], a[180:183], v[36:39], v[244:247]
    ds_read_b64_tr_b16 a[158:159], v67 offset:36864
    s_min_u32 s36, s36, 507904
    v_mfma_f32_16x16x32_bf16 v[248:251], a[184:187], v[36:39], v[248:251]
    v_exp_f32 v23, v23
    v_mfma_f32_16x16x32_bf16 v[252:255], a[188:191], v[36:39], v[252:255]
    v_cvt_pk_bf16_f32 v35, v22, v23
    v_mfma_f32_16x16x32_bf16 a[204:207], a[208:211], v[36:39], a[204:207]
    buffer_load_dwordx4 v73, s[32:35], s37 offen offset:1024 lds
    v_mfma_f32_16x16x32_bf16 v[16:19], a[64:67], a[32:35], v[48:51]
    v_exp_f32 v24, v24
    v_mfma_f32_16x16x32_bf16 v[16:19], a[68:71], a[36:39], v[16:19]
    ds_read_b64_tr_b16 a[160:161], v60 offset:40960
    ds_read_b64_tr_b16 a[162:163], v60 offset:45056
    v_mfma_f32_16x16x32_bf16 v[16:19], a[72:75], a[40:43], v[16:19]
    v_exp_f32 v25, v25
    v_mfma_f32_16x16x32_bf16 v[16:19], a[76:79], a[44:47], v[16:19]
    v_cvt_pk_bf16_f32 v36, v24, v25
    v_mfma_f32_16x16x32_bf16 v[20:23], a[80:83], a[32:35], v[48:51]
    v_exp_f32 v26, v26
    v_mfma_f32_16x16x32_bf16 v[20:23], a[84:87], a[36:39], v[20:23]
    ds_read_b64_tr_b16 a[164:165], v61 offset:40960
    ds_read_b64_tr_b16 a[166:167], v61 offset:45056
    v_mfma_f32_16x16x32_bf16 v[20:23], a[88:91], a[40:43], v[20:23]
    v_exp_f32 v27, v27
    v_mfma_f32_16x16x32_bf16 v[20:23], a[92:95], a[44:47], v[20:23]
    v_cvt_pk_bf16_f32 v37, v26, v27
    s_waitcnt lgkmcnt(4)
    v_mfma_f32_16x16x32_bf16 v[128:131], a[128:131], v[32:35], v[128:131]
    v_exp_f32 v28, v28
    v_mfma_f32_16x16x32_bf16 v[132:135], a[132:135], v[32:35], v[132:135]
    ds_read_b64_tr_b16 a[168:169], v62 offset:40960
    v_mfma_f32_16x16x32_bf16 v[136:139], a[136:139], v[32:35], v[136:139]
    v_exp_f32 v29, v29
    v_mfma_f32_16x16x32_bf16 v[140:143], a[140:143], v[32:35], v[140:143]
    v_cvt_pk_bf16_f32 v38, v28, v29
    v_mfma_f32_16x16x32_bf16 v[144:147], a[144:147], v[32:35], v[144:147]
    v_exp_f32 v30, v30
    v_mfma_f32_16x16x32_bf16 v[148:151], a[148:151], v[32:35], v[148:151]
    ds_read_b64_tr_b16 a[170:171], v62 offset:45056
    v_mfma_f32_16x16x32_bf16 v[152:155], a[152:155], v[32:35], v[152:155]
    v_exp_f32 v31, v31
    v_mfma_f32_16x16x32_bf16 v[156:159], a[156:159], v[32:35], v[156:159]
    v_cvt_pk_bf16_f32 v39, v30, v31
    v_mfma_f32_16x16x32_bf16 a[192:195], a[208:211], v[32:35], a[192:195]
    buffer_load_dwordx4 v72, s[32:35], s37 offen offset:2048 lds
    v_mfma_f32_16x16x32_bf16 v[24:27], a[64:67], a[48:51], v[52:55]
    v_exp_f32 v16, v16
    v_mfma_f32_16x16x32_bf16 v[24:27], a[68:71], a[52:55], v[24:27]
    ds_read_b64_tr_b16 a[172:173], v63 offset:40960
    ds_read_b64_tr_b16 a[174:175], v63 offset:45056
    v_mfma_f32_16x16x32_bf16 v[24:27], a[72:75], a[56:59], v[24:27]
    v_exp_f32 v17, v17
    v_mfma_f32_16x16x32_bf16 v[24:27], a[76:79], a[60:63], v[24:27]
    v_cvt_pk_bf16_f32 v32, v16, v17
    v_mfma_f32_16x16x32_bf16 v[28:31], a[80:83], a[48:51], v[52:55]
    v_exp_f32 v18, v18
    v_mfma_f32_16x16x32_bf16 v[28:31], a[84:87], a[52:55], v[28:31]
    ds_read_b64_tr_b16 a[176:177], v64 offset:40960
    ds_read_b64_tr_b16 a[178:179], v64 offset:45056
    v_mfma_f32_16x16x32_bf16 v[28:31], a[88:91], a[56:59], v[28:31]
    v_exp_f32 v19, v19
    v_mfma_f32_16x16x32_bf16 v[28:31], a[92:95], a[60:63], v[28:31]
    v_cvt_pk_bf16_f32 v33, v18, v19
    v_mfma_f32_16x16x32_bf16 v[160:163], a[128:131], v[36:39], v[160:163]
    v_exp_f32 v20, v20
    v_mfma_f32_16x16x32_bf16 v[164:167], a[132:135], v[36:39], v[164:167]
    ds_read_b64_tr_b16 a[180:181], v65 offset:40960
    v_mfma_f32_16x16x32_bf16 v[168:171], a[136:139], v[36:39], v[168:171]
    v_exp_f32 v21, v21
    v_mfma_f32_16x16x32_bf16 v[172:175], a[140:143], v[36:39], v[172:175]
    v_cvt_pk_bf16_f32 v34, v20, v21
    v_mfma_f32_16x16x32_bf16 v[176:179], a[144:147], v[36:39], v[176:179]
    v_exp_f32 v22, v22
    v_mfma_f32_16x16x32_bf16 v[180:183], a[148:151], v[36:39], v[180:183]
    ds_read_b64_tr_b16 a[182:183], v65 offset:45056
    s_waitcnt vmcnt(7)
    v_mfma_f32_16x16x32_bf16 v[184:187], a[152:155], v[36:39], v[184:187]
    v_exp_f32 v23, v23
    v_mfma_f32_16x16x32_bf16 v[188:191], a[156:159], v[36:39], v[188:191]
    v_cvt_pk_bf16_f32 v35, v22, v23
    s_barrier
    v_mfma_f32_16x16x32_bf16 a[196:199], a[208:211], v[36:39], a[196:199]
    buffer_load_dwordx4 v73, s[32:35], s37 offen offset:3072 lds
    v_mfma_f32_16x16x32_bf16 v[16:19], a[96:99], a[0:3], v[40:43]
    v_exp_f32 v24, v24
    v_mfma_f32_16x16x32_bf16 v[16:19], a[100:103], a[4:7], v[16:19]
    ds_read_b128 a[64:67], v56 offset:49152
    ds_read_b128 a[68:71], v57 offset:49152
    v_mfma_f32_16x16x32_bf16 v[16:19], a[104:107], a[8:11], v[16:19]
    v_exp_f32 v25, v25
    v_mfma_f32_16x16x32_bf16 v[16:19], a[108:111], a[12:15], v[16:19]
    v_cvt_pk_bf16_f32 v36, v24, v25
    v_mfma_f32_16x16x32_bf16 v[20:23], a[112:115], a[0:3], v[40:43]
    v_exp_f32 v26, v26
    v_mfma_f32_16x16x32_bf16 v[20:23], a[116:119], a[4:7], v[20:23]
    ds_read_b128 a[72:75], v58 offset:49152
    ds_read_b128 a[76:79], v59 offset:49152
    v_mfma_f32_16x16x32_bf16 v[20:23], a[120:123], a[8:11], v[20:23]
    v_exp_f32 v27, v27
    v_mfma_f32_16x16x32_bf16 v[20:23], a[124:127], a[12:15], v[20:23]
    v_cvt_pk_bf16_f32 v37, v26, v27
    v_mfma_f32_16x16x32_bf16 v[192:195], a[128:131], v[32:35], v[192:195]
    v_exp_f32 v28, v28
    v_mfma_f32_16x16x32_bf16 v[196:199], a[132:135], v[32:35], v[196:199]
    ds_read_b64_tr_b16 a[184:185], v66 offset:40960
    s_add_u32 m0, s38, 16384
    v_mfma_f32_16x16x32_bf16 v[200:203], a[136:139], v[32:35], v[200:203]
    v_exp_f32 v29, v29
    v_mfma_f32_16x16x32_bf16 v[204:207], a[140:143], v[32:35], v[204:207]
    v_cvt_pk_bf16_f32 v38, v28, v29
    v_mfma_f32_16x16x32_bf16 v[208:211], a[144:147], v[32:35], v[208:211]
    v_exp_f32 v30, v30
    v_mfma_f32_16x16x32_bf16 v[212:215], a[148:151], v[32:35], v[212:215]
    ds_read_b64_tr_b16 a[186:187], v66 offset:45056
    v_mfma_f32_16x16x32_bf16 v[216:219], a[152:155], v[32:35], v[216:219]
    v_exp_f32 v31, v31
    v_mfma_f32_16x16x32_bf16 v[220:223], a[156:159], v[32:35], v[220:223]
    v_cvt_pk_bf16_f32 v39, v30, v31
    v_mfma_f32_16x16x32_bf16 a[200:203], a[208:211], v[32:35], a[200:203]
    buffer_load_dwordx4 v68, s[28:31], s36 offen offset:0 lds
    v_mfma_f32_16x16x32_bf16 v[24:27], a[96:99], a[16:19], v[44:47]
    v_exp_f32 v16, v16
    v_mfma_f32_16x16x32_bf16 v[24:27], a[100:103], a[20:23], v[24:27]
    ds_read_b128 a[80:83], v56 offset:53248
    ds_read_b128 a[84:87], v57 offset:53248
    v_mfma_f32_16x16x32_bf16 v[24:27], a[104:107], a[24:27], v[24:27]
    v_exp_f32 v17, v17
    v_mfma_f32_16x16x32_bf16 v[24:27], a[108:111], a[28:31], v[24:27]
    v_cvt_pk_bf16_f32 v32, v16, v17
    v_mfma_f32_16x16x32_bf16 v[28:31], a[112:115], a[16:19], v[44:47]
    v_exp_f32 v18, v18
    v_mfma_f32_16x16x32_bf16 v[28:31], a[116:119], a[20:23], v[28:31]
    ds_read_b128 a[88:91], v58 offset:53248
    ds_read_b128 a[92:95], v59 offset:53248
    v_mfma_f32_16x16x32_bf16 v[28:31], a[120:123], a[24:27], v[28:31]
    v_exp_f32 v19, v19
    v_mfma_f32_16x16x32_bf16 v[28:31], a[124:127], a[28:31], v[28:31]
    v_cvt_pk_bf16_f32 v33, v18, v19
    v_mfma_f32_16x16x32_bf16 v[224:227], a[128:131], v[36:39], v[224:227]
    v_exp_f32 v20, v20
    v_mfma_f32_16x16x32_bf16 v[228:231], a[132:135], v[36:39], v[228:231]
    ds_read_b64_tr_b16 a[188:189], v67 offset:40960
    s_add_u32 s37, s37, 16384
    v_mfma_f32_16x16x32_bf16 v[232:235], a[136:139], v[36:39], v[232:235]
    v_exp_f32 v21, v21
    v_mfma_f32_16x16x32_bf16 v[236:239], a[140:143], v[36:39], v[236:239]
    v_cvt_pk_bf16_f32 v34, v20, v21
    v_mfma_f32_16x16x32_bf16 v[240:243], a[144:147], v[36:39], v[240:243]
    v_exp_f32 v22, v22
    v_mfma_f32_16x16x32_bf16 v[244:247], a[148:151], v[36:39], v[244:247]
    ds_read_b64_tr_b16 a[190:191], v67 offset:45056
    s_min_u32 s37, s37, 507904
    v_mfma_f32_16x16x32_bf16 v[248:251], a[152:155], v[36:39], v[248:251]
    v_exp_f32 v23, v23
    v_mfma_f32_16x16x32_bf16 v[252:255], a[156:159], v[36:39], v[252:255]
    v_cvt_pk_bf16_f32 v35, v22, v23
    v_mfma_f32_16x16x32_bf16 a[204:207], a[208:211], v[36:39], a[204:207]
    buffer_load_dwordx4 v69, s[28:31], s36 offen offset:1024 lds
    v_mfma_f32_16x16x32_bf16 v[16:19], a[96:99], a[32:35], v[48:51]
    v_exp_f32 v24, v24
    v_mfma_f32_16x16x32_bf16 v[16:19], a[100:103], a[36:39], v[16:19]
    ds_read_b64_tr_b16 a[128:129], v60 offset:49152
    ds_read_b64_tr_b16 a[130:131], v60 offset:53248
    v_mfma_f32_16x16x32_bf16 v[16:19], a[104:107], a[40:43], v[16:19]
    v_exp_f32 v25, v25
    v_mfma_f32_16x16x32_bf16 v[16:19], a[108:111], a[44:47], v[16:19]
    v_cvt_pk_bf16_f32 v36, v24, v25
    v_mfma_f32_16x16x32_bf16 v[20:23], a[112:115], a[32:35], v[48:51]
    v_exp_f32 v26, v26
    v_mfma_f32_16x16x32_bf16 v[20:23], a[116:119], a[36:39], v[20:23]
    ds_read_b64_tr_b16 a[132:133], v61 offset:49152
    ds_read_b64_tr_b16 a[134:135], v61 offset:53248
    v_mfma_f32_16x16x32_bf16 v[20:23], a[120:123], a[40:43], v[20:23]
    v_exp_f32 v27, v27
    v_mfma_f32_16x16x32_bf16 v[20:23], a[124:127], a[44:47], v[20:23]
    v_cvt_pk_bf16_f32 v37, v26, v27
    s_waitcnt lgkmcnt(4)
    v_mfma_f32_16x16x32_bf16 v[128:131], a[160:163], v[32:35], v[128:131]
    v_exp_f32 v28, v28
    v_mfma_f32_16x16x32_bf16 v[132:135], a[164:167], v[32:35], v[132:135]
    ds_read_b64_tr_b16 a[136:137], v62 offset:49152
    v_mfma_f32_16x16x32_bf16 v[136:139], a[168:171], v[32:35], v[136:139]
    v_exp_f32 v29, v29
    v_mfma_f32_16x16x32_bf16 v[140:143], a[172:175], v[32:35], v[140:143]
    v_cvt_pk_bf16_f32 v38, v28, v29
    v_mfma_f32_16x16x32_bf16 v[144:147], a[176:179], v[32:35], v[144:147]
    v_exp_f32 v30, v30
    v_mfma_f32_16x16x32_bf16 v[148:151], a[180:183], v[32:35], v[148:151]
    ds_read_b64_tr_b16 a[138:139], v62 offset:53248
    v_mfma_f32_16x16x32_bf16 v[152:155], a[184:187], v[32:35], v[152:155]
    v_exp_f32 v31, v31
    v_mfma_f32_16x16x32_bf16 v[156:159], a[188:191], v[32:35], v[156:159]
    v_cvt_pk_bf16_f32 v39, v30, v31
    v_mfma_f32_16x16x32_bf16 a[192:195], a[208:211], v[32:35], a[192:195]
    buffer_load_dwordx4 v70, s[28:31], s36 offen offset:2048 lds
    v_mfma_f32_16x16x32_bf16 v[24:27], a[96:99], a[48:51], v[52:55]
    v_exp_f32 v16, v16
    v_mfma_f32_16x16x32_bf16 v[24:27], a[100:103], a[52:55], v[24:27]
    ds_read_b64_tr_b16 a[140:141], v63 offset:49152
    ds_read_b64_tr_b16 a[142:143], v63 offset:53248
    v_mfma_f32_16x16x32_bf16 v[24:27], a[104:107], a[56:59], v[24:27]
    v_exp_f32 v17, v17
    v_mfma_f32_16x16x32_bf16 v[24:27], a[108:111], a[60:63], v[24:27]
    v_cvt_pk_bf16_f32 v32, v16, v17
    v_mfma_f32_16x16x32_bf16 v[28:31], a[112:115], a[48:51], v[52:55]
    v_exp_f32 v18, v18
    v_mfma_f32_16x16x32_bf16 v[28:31], a[116:119], a[52:55], v[28:31]
    ds_read_b64_tr_b16 a[144:145], v64 offset:49152
    ds_read_b64_tr_b16 a[146:147], v64 offset:53248
    v_mfma_f32_16x16x32_bf16 v[28:31], a[120:123], a[56:59], v[28:31]
    v_exp_f32 v19, v19
    v_mfma_f32_16x16x32_bf16 v[28:31], a[124:127], a[60:63], v[28:31]
    v_cvt_pk_bf16_f32 v33, v18, v19
    v_mfma_f32_16x16x32_bf16 v[160:163], a[160:163], v[36:39], v[160:163]
    v_exp_f32 v20, v20
    v_mfma_f32_16x16x32_bf16 v[164:167], a[164:167], v[36:39], v[164:167]
    ds_read_b64_tr_b16 a[148:149], v65 offset:49152
    v_mfma_f32_16x16x32_bf16 v[168:171], a[168:171], v[36:39], v[168:171]
    v_exp_f32 v21, v21
    v_mfma_f32_16x16x32_bf16 v[172:175], a[172:175], v[36:39], v[172:175]
    v_cvt_pk_bf16_f32 v34, v20, v21
    v_mfma_f32_16x16x32_bf16 v[176:179], a[176:179], v[36:39], v[176:179]
    v_exp_f32 v22, v22
    v_mfma_f32_16x16x32_bf16 v[180:183], a[180:183], v[36:39], v[180:183]
    ds_read_b64_tr_b16 a[150:151], v65 offset:53248
    v_mfma_f32_16x16x32_bf16 v[184:187], a[184:187], v[36:39], v[184:187]
    v_exp_f32 v23, v23
    v_mfma_f32_16x16x32_bf16 v[188:191], a[188:191], v[36:39], v[188:191]
    v_cvt_pk_bf16_f32 v35, v22, v23
    v_mfma_f32_16x16x32_bf16 a[196:199], a[208:211], v[36:39], a[196:199]
    buffer_load_dwordx4 v71, s[28:31], s36 offen offset:3072 lds
    v_mfma_f32_16x16x32_bf16 v[16:19], a[64:67], a[0:3], v[40:43]
    v_exp_f32 v24, v24
    v_mfma_f32_16x16x32_bf16 v[16:19], a[68:71], a[4:7], v[16:19]
    ds_read_b128 a[96:99], v56 offset:57344
    ds_read_b128 a[100:103], v57 offset:57344
    v_mfma_f32_16x16x32_bf16 v[16:19], a[72:75], a[8:11], v[16:19]
    v_exp_f32 v25, v25
    v_mfma_f32_16x16x32_bf16 v[16:19], a[76:79], a[12:15], v[16:19]
    v_cvt_pk_bf16_f32 v36, v24, v25
    v_mfma_f32_16x16x32_bf16 v[20:23], a[80:83], a[0:3], v[40:43]
    v_exp_f32 v26, v26
    v_mfma_f32_16x16x32_bf16 v[20:23], a[84:87], a[4:7], v[20:23]
    ds_read_b128 a[104:107], v58 offset:57344
    ds_read_b128 a[108:111], v59 offset:57344
    v_mfma_f32_16x16x32_bf16 v[20:23], a[88:91], a[8:11], v[20:23]
    v_exp_f32 v27, v27
    v_mfma_f32_16x16x32_bf16 v[20:23], a[92:95], a[12:15], v[20:23]
    v_cvt_pk_bf16_f32 v37, v26, v27
    v_mfma_f32_16x16x32_bf16 v[192:195], a[160:163], v[32:35], v[192:195]
    v_exp_f32 v28, v28
    v_mfma_f32_16x16x32_bf16 v[196:199], a[164:167], v[32:35], v[196:199]
    ds_read_b64_tr_b16 a[152:153], v66 offset:49152
    s_add_u32 m0, s39, 16384
    v_mfma_f32_16x16x32_bf16 v[200:203], a[168:171], v[32:35], v[200:203]
    v_exp_f32 v29, v29
    v_mfma_f32_16x16x32_bf16 v[204:207], a[172:175], v[32:35], v[204:207]
    v_cvt_pk_bf16_f32 v38, v28, v29
    v_mfma_f32_16x16x32_bf16 v[208:211], a[176:179], v[32:35], v[208:211]
    v_exp_f32 v30, v30
    v_mfma_f32_16x16x32_bf16 v[212:215], a[180:183], v[32:35], v[212:215]
    ds_read_b64_tr_b16 a[154:155], v66 offset:53248
    v_mfma_f32_16x16x32_bf16 v[216:219], a[184:187], v[32:35], v[216:219]
    v_exp_f32 v31, v31
    v_mfma_f32_16x16x32_bf16 v[220:223], a[188:191], v[32:35], v[220:223]
    v_cvt_pk_bf16_f32 v39, v30, v31
    v_mfma_f32_16x16x32_bf16 a[200:203], a[208:211], v[32:35], a[200:203]
    buffer_load_dwordx4 v72, s[32:35], s37 offen offset:0 lds
    v_mfma_f32_16x16x32_bf16 v[24:27], a[64:67], a[16:19], v[44:47]
    v_exp_f32 v16, v16
    v_mfma_f32_16x16x32_bf16 v[24:27], a[68:71], a[20:23], v[24:27]
    ds_read_b128 a[112:115], v56 offset:61440
    ds_read_b128 a[116:119], v57 offset:61440
    v_mfma_f32_16x16x32_bf16 v[24:27], a[72:75], a[24:27], v[24:27]
    v_exp_f32 v17, v17
    v_mfma_f32_16x16x32_bf16 v[24:27], a[76:79], a[28:31], v[24:27]
    v_cvt_pk_bf16_f32 v32, v16, v17
    v_mfma_f32_16x16x32_bf16 v[28:31], a[80:83], a[16:19], v[44:47]
    v_exp_f32 v18, v18
    v_mfma_f32_16x16x32_bf16 v[28:31], a[84:87], a[20:23], v[28:31]
    ds_read_b128 a[120:123], v58 offset:61440
    ds_read_b128 a[124:127], v59 offset:61440
    v_mfma_f32_16x16x32_bf16 v[28:31], a[88:91], a[24:27], v[28:31]
    v_exp_f32 v19, v19
    v_mfma_f32_16x16x32_bf16 v[28:31], a[92:95], a[28:31], v[28:31]
    v_cvt_pk_bf16_f32 v33, v18, v19
    v_mfma_f32_16x16x32_bf16 v[224:227], a[160:163], v[36:39], v[224:227]
    v_exp_f32 v20, v20
    v_mfma_f32_16x16x32_bf16 v[228:231], a[164:167], v[36:39], v[228:231]
    ds_read_b64_tr_b16 a[156:157], v67 offset:49152
    s_add_u32 s36, s36, 16384
    v_mfma_f32_16x16x32_bf16 v[232:235], a[168:171], v[36:39], v[232:235]
    v_exp_f32 v21, v21
    v_mfma_f32_16x16x32_bf16 v[236:239], a[172:175], v[36:39], v[236:239]
    v_cvt_pk_bf16_f32 v34, v20, v21
    v_mfma_f32_16x16x32_bf16 v[240:243], a[176:179], v[36:39], v[240:243]
    v_exp_f32 v22, v22
    v_mfma_f32_16x16x32_bf16 v[244:247], a[180:183], v[36:39], v[244:247]
    ds_read_b64_tr_b16 a[158:159], v67 offset:53248
    s_min_u32 s36, s36, 507904
    v_mfma_f32_16x16x32_bf16 v[248:251], a[184:187], v[36:39], v[248:251]
    v_exp_f32 v23, v23
    v_mfma_f32_16x16x32_bf16 v[252:255], a[188:191], v[36:39], v[252:255]
    v_cvt_pk_bf16_f32 v35, v22, v23
    v_mfma_f32_16x16x32_bf16 a[204:207], a[208:211], v[36:39], a[204:207]
    buffer_load_dwordx4 v73, s[32:35], s37 offen offset:1024 lds
    v_mfma_f32_16x16x32_bf16 v[16:19], a[64:67], a[32:35], v[48:51]
    v_exp_f32 v24, v24
    v_mfma_f32_16x16x32_bf16 v[16:19], a[68:71], a[36:39], v[16:19]
    ds_read_b64_tr_b16 a[160:161], v60 offset:57344
    ds_read_b64_tr_b16 a[162:163], v60 offset:61440
    v_mfma_f32_16x16x32_bf16 v[16:19], a[72:75], a[40:43], v[16:19]
    v_exp_f32 v25, v25
    v_mfma_f32_16x16x32_bf16 v[16:19], a[76:79], a[44:47], v[16:19]
    v_cvt_pk_bf16_f32 v36, v24, v25
    v_mfma_f32_16x16x32_bf16 v[20:23], a[80:83], a[32:35], v[48:51]
    v_exp_f32 v26, v26
    v_mfma_f32_16x16x32_bf16 v[20:23], a[84:87], a[36:39], v[20:23]
    ds_read_b64_tr_b16 a[164:165], v61 offset:57344
    ds_read_b64_tr_b16 a[166:167], v61 offset:61440
    v_mfma_f32_16x16x32_bf16 v[20:23], a[88:91], a[40:43], v[20:23]
    v_exp_f32 v27, v27
    v_mfma_f32_16x16x32_bf16 v[20:23], a[92:95], a[44:47], v[20:23]
    v_cvt_pk_bf16_f32 v37, v26, v27
    s_waitcnt lgkmcnt(4)
    v_mfma_f32_16x16x32_bf16 v[128:131], a[128:131], v[32:35], v[128:131]
    v_exp_f32 v28, v28
    v_mfma_f32_16x16x32_bf16 v[132:135], a[132:135], v[32:35], v[132:135]
    ds_read_b64_tr_b16 a[168:169], v62 offset:57344
    v_mfma_f32_16x16x32_bf16 v[136:139], a[136:139], v[32:35], v[136:139]
    v_exp_f32 v29, v29
    v_mfma_f32_16x16x32_bf16 v[140:143], a[140:143], v[32:35], v[140:143]
    v_cvt_pk_bf16_f32 v38, v28, v29
    v_mfma_f32_16x16x32_bf16 v[144:147], a[144:147], v[32:35], v[144:147]
    v_exp_f32 v30, v30
    v_mfma_f32_16x16x32_bf16 v[148:151], a[148:151], v[32:35], v[148:151]
    ds_read_b64_tr_b16 a[170:171], v62 offset:61440
    v_mfma_f32_16x16x32_bf16 v[152:155], a[152:155], v[32:35], v[152:155]
    v_exp_f32 v31, v31
    v_mfma_f32_16x16x32_bf16 v[156:159], a[156:159], v[32:35], v[156:159]
    v_cvt_pk_bf16_f32 v39, v30, v31
    v_mfma_f32_16x16x32_bf16 a[192:195], a[208:211], v[32:35], a[192:195]
    buffer_load_dwordx4 v72, s[32:35], s37 offen offset:2048 lds
    v_mfma_f32_16x16x32_bf16 v[24:27], a[64:67], a[48:51], v[52:55]
    v_exp_f32 v16, v16
    v_mfma_f32_16x16x32_bf16 v[24:27], a[68:71], a[52:55], v[24:27]
    ds_read_b64_tr_b16 a[172:173], v63 offset:57344
    ds_read_b64_tr_b16 a[174:175], v63 offset:61440
    v_mfma_f32_16x16x32_bf16 v[24:27], a[72:75], a[56:59], v[24:27]
    v_exp_f32 v17, v17
    v_mfma_f32_16x16x32_bf16 v[24:27], a[76:79], a[60:63], v[24:27]
    v_cvt_pk_bf16_f32 v32, v16, v17
    v_mfma_f32_16x16x32_bf16 v[28:31], a[80:83], a[48:51], v[52:55]
    v_exp_f32 v18, v18
    v_mfma_f32_16x16x32_bf16 v[28:31], a[84:87], a[52:55], v[28:31]
    ds_read_b64_tr_b16 a[176:177], v64 offset:57344
    ds_read_b64_tr_b16 a[178:179], v64 offset:61440
    v_mfma_f32_16x16x32_bf16 v[28:31], a[88:91], a[56:59], v[28:31]
    v_exp_f32 v19, v19
    v_mfma_f32_16x16x32_bf16 v[28:31], a[92:95], a[60:63], v[28:31]
    v_cvt_pk_bf16_f32 v33, v18, v19
    v_mfma_f32_16x16x32_bf16 v[160:163], a[128:131], v[36:39], v[160:163]
    v_exp_f32 v20, v20
    v_mfma_f32_16x16x32_bf16 v[164:167], a[132:135], v[36:39], v[164:167]
    ds_read_b64_tr_b16 a[180:181], v65 offset:57344
    v_mfma_f32_16x16x32_bf16 v[168:171], a[136:139], v[36:39], v[168:171]
    v_exp_f32 v21, v21
    v_mfma_f32_16x16x32_bf16 v[172:175], a[140:143], v[36:39], v[172:175]
    v_cvt_pk_bf16_f32 v34, v20, v21
    v_mfma_f32_16x16x32_bf16 v[176:179], a[144:147], v[36:39], v[176:179]
    v_exp_f32 v22, v22
    v_mfma_f32_16x16x32_bf16 v[180:183], a[148:151], v[36:39], v[180:183]
    ds_read_b64_tr_b16 a[182:183], v65 offset:61440
    s_waitcnt vmcnt(7)
    v_mfma_f32_16x16x32_bf16 v[184:187], a[152:155], v[36:39], v[184:187]
    v_exp_f32 v23, v23
    v_mfma_f32_16x16x32_bf16 v[188:191], a[156:159], v[36:39], v[188:191]
    v_cvt_pk_bf16_f32 v35, v22, v23
    s_barrier
    v_mfma_f32_16x16x32_bf16 a[196:199], a[208:211], v[36:39], a[196:199]
    buffer_load_dwordx4 v73, s[32:35], s37 offen offset:3072 lds
    v_mfma_f32_16x16x32_bf16 v[16:19], a[96:99], a[0:3], v[40:43]
    v_exp_f32 v24, v24
    v_mfma_f32_16x16x32_bf16 v[16:19], a[100:103], a[4:7], v[16:19]
    ds_read_b128 a[64:67], v56 offset:0
    ds_read_b128 a[68:71], v57 offset:0
    v_mfma_f32_16x16x32_bf16 v[16:19], a[104:107], a[8:11], v[16:19]
    v_exp_f32 v25, v25
    v_mfma_f32_16x16x32_bf16 v[16:19], a[108:111], a[12:15], v[16:19]
    v_cvt_pk_bf16_f32 v36, v24, v25
    v_mfma_f32_16x16x32_bf16 v[20:23], a[112:115], a[0:3], v[40:43]
    v_exp_f32 v26, v26
    v_mfma_f32_16x16x32_bf16 v[20:23], a[116:119], a[4:7], v[20:23]
    ds_read_b128 a[72:75], v58 offset:0
    ds_read_b128 a[76:79], v59 offset:0
    v_mfma_f32_16x16x32_bf16 v[20:23], a[120:123], a[8:11], v[20:23]
    v_exp_f32 v27, v27
    v_mfma_f32_16x16x32_bf16 v[20:23], a[124:127], a[12:15], v[20:23]
    v_cvt_pk_bf16_f32 v37, v26, v27
    v_mfma_f32_16x16x32_bf16 v[192:195], a[128:131], v[32:35], v[192:195]
    v_exp_f32 v28, v28
    v_mfma_f32_16x16x32_bf16 v[196:199], a[132:135], v[32:35], v[196:199]
    ds_read_b64_tr_b16 a[184:185], v66 offset:57344
    s_add_u32 m0, s38, 32768
    v_mfma_f32_16x16x32_bf16 v[200:203], a[136:139], v[32:35], v[200:203]
    v_exp_f32 v29, v29
    v_mfma_f32_16x16x32_bf16 v[204:207], a[140:143], v[32:35], v[204:207]
    v_cvt_pk_bf16_f32 v38, v28, v29
    v_mfma_f32_16x16x32_bf16 v[208:211], a[144:147], v[32:35], v[208:211]
    v_exp_f32 v30, v30
    v_mfma_f32_16x16x32_bf16 v[212:215], a[148:151], v[32:35], v[212:215]
    ds_read_b64_tr_b16 a[186:187], v66 offset:61440
    v_mfma_f32_16x16x32_bf16 v[216:219], a[152:155], v[32:35], v[216:219]
    v_exp_f32 v31, v31
    v_mfma_f32_16x16x32_bf16 v[220:223], a[156:159], v[32:35], v[220:223]
    v_cvt_pk_bf16_f32 v39, v30, v31
    v_mfma_f32_16x16x32_bf16 a[200:203], a[208:211], v[32:35], a[200:203]
    buffer_load_dwordx4 v68, s[28:31], s36 offen offset:0 lds
    v_mfma_f32_16x16x32_bf16 v[24:27], a[96:99], a[16:19], v[44:47]
    v_exp_f32 v16, v16
    v_mfma_f32_16x16x32_bf16 v[24:27], a[100:103], a[20:23], v[24:27]
    ds_read_b128 a[80:83], v56 offset:4096
    ds_read_b128 a[84:87], v57 offset:4096
    v_mfma_f32_16x16x32_bf16 v[24:27], a[104:107], a[24:27], v[24:27]
    v_exp_f32 v17, v17
    v_mfma_f32_16x16x32_bf16 v[24:27], a[108:111], a[28:31], v[24:27]
    v_cvt_pk_bf16_f32 v32, v16, v17
    v_mfma_f32_16x16x32_bf16 v[28:31], a[112:115], a[16:19], v[44:47]
    v_exp_f32 v18, v18
    v_mfma_f32_16x16x32_bf16 v[28:31], a[116:119], a[20:23], v[28:31]
    ds_read_b128 a[88:91], v58 offset:4096
    ds_read_b128 a[92:95], v59 offset:4096
    v_mfma_f32_16x16x32_bf16 v[28:31], a[120:123], a[24:27], v[28:31]
    v_exp_f32 v19, v19
    v_mfma_f32_16x16x32_bf16 v[28:31], a[124:127], a[28:31], v[28:31]
    v_cvt_pk_bf16_f32 v33, v18, v19
    v_mfma_f32_16x16x32_bf16 v[224:227], a[128:131], v[36:39], v[224:227]
    v_exp_f32 v20, v20
    v_mfma_f32_16x16x32_bf16 v[228:231], a[132:135], v[36:39], v[228:231]
    ds_read_b64_tr_b16 a[188:189], v67 offset:57344
    s_add_u32 s37, s37, 16384
    v_mfma_f32_16x16x32_bf16 v[232:235], a[136:139], v[36:39], v[232:235]
    v_exp_f32 v21, v21
    v_mfma_f32_16x16x32_bf16 v[236:239], a[140:143], v[36:39], v[236:239]
    v_cvt_pk_bf16_f32 v34, v20, v21
    v_mfma_f32_16x16x32_bf16 v[240:243], a[144:147], v[36:39], v[240:243]
    v_exp_f32 v22, v22
    v_mfma_f32_16x16x32_bf16 v[244:247], a[148:151], v[36:39], v[244:247]
    ds_read_b64_tr_b16 a[190:191], v67 offset:61440
    s_min_u32 s37, s37, 507904
    v_mfma_f32_16x16x32_bf16 v[248:251], a[152:155], v[36:39], v[248:251]
    v_exp_f32 v23, v23
    v_mfma_f32_16x16x32_bf16 v[252:255], a[156:159], v[36:39], v[252:255]
    v_cvt_pk_bf16_f32 v35, v22, v23
    v_mfma_f32_16x16x32_bf16 a[204:207], a[208:211], v[36:39], a[204:207]
    buffer_load_dwordx4 v69, s[28:31], s36 offen offset:1024 lds
    v_mfma_f32_16x16x32_bf16 v[16:19], a[96:99], a[32:35], v[48:51]
    v_exp_f32 v24, v24
    v_mfma_f32_16x16x32_bf16 v[16:19], a[100:103], a[36:39], v[16:19]
    ds_read_b64_tr_b16 a[128:129], v60 offset:0
    ds_read_b64_tr_b16 a[130:131], v60 offset:4096
    v_mfma_f32_16x16x32_bf16 v[16:19], a[104:107], a[40:43], v[16:19]
    v_exp_f32 v25, v25
    v_mfma_f32_16x16x32_bf16 v[16:19], a[108:111], a[44:47], v[16:19]
    v_cvt_pk_bf16_f32 v36, v24, v25
    v_mfma_f32_16x16x32_bf16 v[20:23], a[112:115], a[32:35], v[48:51]
    v_exp_f32 v26, v26
    v_mfma_f32_16x16x32_bf16 v[20:23], a[116:119], a[36:39], v[20:23]
    ds_read_b64_tr_b16 a[132:133], v61 offset:0
    ds_read_b64_tr_b16 a[134:135], v61 offset:4096
    v_mfma_f32_16x16x32_bf16 v[20:23], a[120:123], a[40:43], v[20:23]
    v_exp_f32 v27, v27
    v_mfma_f32_16x16x32_bf16 v[20:23], a[124:127], a[44:47], v[20:23]
    v_cvt_pk_bf16_f32 v37, v26, v27
    s_waitcnt lgkmcnt(4)
    v_mfma_f32_16x16x32_bf16 v[128:131], a[160:163], v[32:35], v[128:131]
    v_exp_f32 v28, v28
    v_mfma_f32_16x16x32_bf16 v[132:135], a[164:167], v[32:35], v[132:135]
    ds_read_b64_tr_b16 a[136:137], v62 offset:0
    v_mfma_f32_16x16x32_bf16 v[136:139], a[168:171], v[32:35], v[136:139]
    v_exp_f32 v29, v29
    v_mfma_f32_16x16x32_bf16 v[140:143], a[172:175], v[32:35], v[140:143]
    v_cvt_pk_bf16_f32 v38, v28, v29
    v_mfma_f32_16x16x32_bf16 v[144:147], a[176:179], v[32:35], v[144:147]
    v_exp_f32 v30, v30
    v_mfma_f32_16x16x32_bf16 v[148:151], a[180:183], v[32:35], v[148:151]
    ds_read_b64_tr_b16 a[138:139], v62 offset:4096
    v_mfma_f32_16x16x32_bf16 v[152:155], a[184:187], v[32:35], v[152:155]
    v_exp_f32 v31, v31
    v_mfma_f32_16x16x32_bf16 v[156:159], a[188:191], v[32:35], v[156:159]
    v_cvt_pk_bf16_f32 v39, v30, v31
    v_mfma_f32_16x16x32_bf16 a[192:195], a[208:211], v[32:35], a[192:195]
    buffer_load_dwordx4 v70, s[28:31], s36 offen offset:2048 lds
    v_mfma_f32_16x16x32_bf16 v[24:27], a[96:99], a[48:51], v[52:55]
    v_exp_f32 v16, v16
    v_mfma_f32_16x16x32_bf16 v[24:27], a[100:103], a[52:55], v[24:27]
    ds_read_b64_tr_b16 a[140:141], v63 offset:0
    ds_read_b64_tr_b16 a[142:143], v63 offset:4096
    v_mfma_f32_16x16x32_bf16 v[24:27], a[104:107], a[56:59], v[24:27]
    v_exp_f32 v17, v17
    v_mfma_f32_16x16x32_bf16 v[24:27], a[108:111], a[60:63], v[24:27]
    v_cvt_pk_bf16_f32 v32, v16, v17
    v_mfma_f32_16x16x32_bf16 v[28:31], a[112:115], a[48:51], v[52:55]
    v_exp_f32 v18, v18
    v_mfma_f32_16x16x32_bf16 v[28:31], a[116:119], a[52:55], v[28:31]
    ds_read_b64_tr_b16 a[144:145], v64 offset:0
    ds_read_b64_tr_b16 a[146:147], v64 offset:4096
    v_mfma_f32_16x16x32_bf16 v[28:31], a[120:123], a[56:59], v[28:31]
    v_exp_f32 v19, v19
    v_mfma_f32_16x16x32_bf16 v[28:31], a[124:127], a[60:63], v[28:31]
    v_cvt_pk_bf16_f32 v33, v18, v19
    v_mfma_f32_16x16x32_bf16 v[160:163], a[160:163], v[36:39], v[160:163]
    v_exp_f32 v20, v20
    v_mfma_f32_16x16x32_bf16 v[164:167], a[164:167], v[36:39], v[164:167]
    ds_read_b64_tr_b16 a[148:149], v65 offset:0
    v_mfma_f32_16x16x32_bf16 v[168:171], a[168:171], v[36:39], v[168:171]
    v_exp_f32 v21, v21
    v_mfma_f32_16x16x32_bf16 v[172:175], a[172:175], v[36:39], v[172:175]
    v_cvt_pk_bf16_f32 v34, v20, v21
    v_mfma_f32_16x16x32_bf16 v[176:179], a[176:179], v[36:39], v[176:179]
    v_exp_f32 v22, v22
    v_mfma_f32_16x16x32_bf16 v[180:183], a[180:183], v[36:39], v[180:183]
    ds_read_b64_tr_b16 a[150:151], v65 offset:4096
    v_mfma_f32_16x16x32_bf16 v[184:187], a[184:187], v[36:39], v[184:187]
    v_exp_f32 v23, v23
    v_mfma_f32_16x16x32_bf16 v[188:191], a[188:191], v[36:39], v[188:191]
    v_cvt_pk_bf16_f32 v35, v22, v23
    v_mfma_f32_16x16x32_bf16 a[196:199], a[208:211], v[36:39], a[196:199]
    buffer_load_dwordx4 v71, s[28:31], s36 offen offset:3072 lds
    s_add_u32 s40, s40, 1
    s_add_u32 s57, s57, 1
    s_cmp_lt_u32 s40, 8
    s_cbranch_scc1 kmain_kernel_loop
    s_branch kmain_kernel_sideover
kmain_kernel_dynout:
    s_cmp_eq_u32 s58, 2
    s_cbranch_scc1 kmain_kernel_dync
    s_waitcnt vmcnt(15)
    s_mov_b32 s58, 0
    s_branch kmain_kernel_dynback
kmain_kernel_dync:
    s_waitcnt vmcnt(9)
    s_mov_b32 s58, 0
    s_branch kmain_kernel_dynback
kmain_kernel_sideany:
    s_cmp_eq_u32 s57, 1
    s_cbranch_scc1 kmain_kernel_side1
    s_cmp_eq_u32 s57, 2
    s_cbranch_scc1 kmain_kernel_side2
    s_cmp_eq_u32 s57, 3
    s_cbranch_scc1 kmain_kernel_side3
    s_branch kmain_kernel_sideback
kmain_kernel_side1:
    v_readfirstlane_b32 s52, v5
    s_mov_b32 s54, 0
kmain_kernel_n1sp:
    s_nop 2
    s_cmp_ge_u32 s52, 18
    s_cbranch_scc1 kmain_kernel_n1ok
    s_add_u32 s54, s54, 1
    s_cmp_ge_u32 s54, 0x20000
    s_cbranch_scc1 kmain_kernel_n1ok
    s_sleep 4
    buffer_load_dword v5, v3, s[8:11], 0 offen sc1
    s_waitcnt vmcnt(0)
    v_readfirstlane_b32 s52, v5
    s_branch kmain_kernel_n1sp
kmain_kernel_n1ok:
    v_and_b32 v112, 15, v1
    v_lshlrev_b32 v112, 3, v112
    v_lshrrev_b32 v113, 4, v1
    v_lshl_add_u32 v112, v113, 7, v112
    s_mul_i32 s52, s16, 2560
    s_add_u32 s52, s52, 9445376
    buffer_load_dwordx2 v[76:77], v112, s[8:11], s52 offen offset:0 sc1
    buffer_load_dwordx2 v[78:79], v112, s[8:11], s52 offen offset:512 sc1
    buffer_load_dwordx2 v[80:81], v112, s[8:11], s52 offen offset:1024 sc1
    buffer_load_dwordx2 v[82:83], v112, s[8:11], s52 offen offset:1536 sc1
    buffer_load_dwordx2 v[84:85], v112, s[8:11], s52 offen offset:2048 sc1
    s_add_u32 s52, s52, 2560
    buffer_load_dwordx2 v[86:87], v112, s[8:11], s52 offen offset:0 sc1
    buffer_load_dwordx2 v[88:89], v112, s[8:11], s52 offen offset:512 sc1
    buffer_load_dwordx2 v[90:91], v112, s[8:11], s52 offen offset:1024 sc1
    buffer_load_dwordx2 v[92:93], v112, s[8:11], s52 offen offset:1536 sc1
    buffer_load_dwordx2 v[94:95], v112, s[8:11], s52 offen offset:2048 sc1
    s_mul_i32 s52, s16, 18
    s_add_u32 s52, s52, s4
    s_lshl_b32 s52, s52, 10
    s_add_u32 s52, s52, 4718592
    s_add_u32 s54, s52, 0
    buffer_load_dwordx4 v[96:99], v2, s[8:11], s54 offen sc1
    s_add_u32 s54, s52, 18432
    buffer_load_dwordx4 v[100:103], v2, s[8:11], s54 offen sc1
    s_add_u32 s54, s52, 16384
    buffer_load_dwordx4 v[104:107], v2, s[8:11], s54 offen sc1
    s_add_u32 s54, s52, 34816
    buffer_load_dwordx4 v[108:111], v2, s[8:11], s54 offen sc1
    s_mov_b32 s58, 1
    s_branch kmain_kernel_sideback
kmain_kernel_side2:
    v_lshrrev_b32 v116, 4, v1
    v_cmp_gt_u32 vcc, 2, v116
    s_nop 1
    v_cndmask_b32 v84, 0, v84, vcc
    v_cndmask_b32 v85, 0, v85, vcc
    v_add_f32 v116, v76, v78
    v_add_f32 v117, v77, v79
    v_add_f32 v116, v116, v80
    v_add_f32 v117, v117, v81
    v_add_f32 v116, v116, v82
    v_add_f32 v117, v117, v83
    v_add_f32 v116, v116, v84
    v_add_f32 v117, v117, v85
    v_mov_b32 v118, v116
    s_nop 1
    v_permlane16_swap_b32 v116, v118
    v_add_f32 v116, v116, v118
    v_mov_b32 v118, v116
    s_nop 1
    v_permlane32_swap_b32 v116, v118
    v_add_f32 v116, v116, v118
    v_mov_b32 v118, v117
    s_nop 1
    v_permlane16_swap_b32 v117, v118
    v_add_f32 v117, v117, v118
    v_mov_b32 v118, v117
    s_nop 1
    v_permlane32_swap_b32 v117, v118
    v_add_f32 v117, v117, v118
    v_mul_f32 v116, 0x3ae38e39, v116
    v_mul_f32 v117, 0x3ae38e39, v117
    v_fma_f32 v117, -v116, v116, v117
    v_max_f32 v117, 0, v117
    v_add_f32 v117, 0x3727c5ac, v117
    v_rsq_f32 v117, v117
    s_nop 0
    v_mul_f32 v112, 0xbeeff558, v117
    v_mul_f32 v116, v116, v112
    v_sub_f32 v114, 0, v116
    v_cndmask_b32 v94, 0, v94, vcc
    v_cndmask_b32 v95, 0, v95, vcc
    v_add_f32 v116, v86, v88
    v_add_f32 v117, v87, v89
    v_add_f32 v116, v116, v90
    v_add_f32 v117, v117, v91
    v_add_f32 v116, v116, v92
    v_add_f32 v117, v117, v93
    v_add_f32 v116, v116, v94
    v_add_f32 v117, v117, v95
    v_mov_b32 v118, v116
    s_nop 1
    v_permlane16_swap_b32 v116, v118
    v_add_f32 v116, v116, v118
    v_mov_b32 v118, v116
    s_nop 1
    v_permlane32_swap_b32 v116, v118
    v_add_f32 v116, v116, v118
    v_mov_b32 v118, v117
    s_nop 1
    v_permlane16_swap_b32 v117, v118
    v_add_f32 v117, v117, v118
    v_mov_b32 v118, v117
    s_nop 1
    v_permlane32_swap_b32 v117, v118
    v_add_f32 v117, v117, v118
    v_mul_f32 v116, 0x3ae38e39, v116
    v_mul_f32 v117, 0x3ae38e39, v117
    v_fma_f32 v117, -v116, v116, v117
    v_max_f32 v117, 0, v117
    v_add_f32 v117, 0x3727c5ac, v117
    v_rsq_f32 v117, v117
    s_nop 0
    v_mul_f32 v113, 0xbeeff558, v117
    v_mul_f32 v116, v116, v113
    v_sub_f32 v115, 0, v116
    s_mul_i32 s52, s16, 18
    s_add_u32 s52, s52, s4
    s_lshl_b32 s52, s52, 10
    s_add_u32 s52, s52, 7077888
    v_lshlrev_b32 v120, 16, v96
    v_and_b32 v121, 0xffff0000, v96
    v_pk_fma_f32 v[120:121], v[120:121], v[112:113], v[114:115] op_sel:[0,0,0] op_sel_hi:[1,0,0]
    v_cvt_pk_bf16_f32 v96, v120, v121
    v_lshlrev_b32 v122, 16, v97
    v_and_b32 v123, 0xffff0000, v97
    v_pk_fma_f32 v[122:123], v[122:123], v[112:113], v[114:115] op_sel:[0,0,0] op_sel_hi:[1,0,0]
    v_cvt_pk_bf16_f32 v97, v122, v123
    v_lshlrev_b32 v120, 16, v98
    v_and_b32 v121, 0xffff0000, v98
    v_pk_fma_f32 v[120:121], v[120:121], v[112:113], v[114:115] op_sel:[0,0,0] op_sel_hi:[1,0,0]
    v_cvt_pk_bf16_f32 v98, v120, v121
    v_lshlrev_b32 v122, 16, v99
    v_and_b32 v123, 0xffff0000, v99
    v_pk_fma_f32 v[122:123], v[122:123], v[112:113], v[114:115] op_sel:[0,0,0] op_sel_hi:[1,0,0]
    v_cvt_pk_bf16_f32 v99, v122, v123
    s_add_u32 s54, s52, 0
    buffer_store_dwordx4 v[96:99], v2, s[8:11], s54 offen sc1
    v_lshlrev_b32 v120, 16, v100
    v_and_b32 v121, 0xffff0000, v100
    v_pk_fma_f32 v[120:121], v[120:121], v[112:113], v[114:115] op_sel:[0,1,1] op_sel_hi:[1,1,1]
    v_cvt_pk_bf16_f32 v100, v120, v121
    v_lshlrev_b32 v122, 16, v101
    v_and_b32 v123, 0xffff0000, v101
    v_pk_fma_f32 v[122:123], v[122:123], v[112:113], v[114:115] op_sel:[0,1,1] op_sel_hi:[1,1,1]
    v_cvt_pk_bf16_f32 v101, v122, v123
    v_lshlrev_b32 v120, 16, v102
    v_and_b32 v121, 0xffff0000, v102
    v_pk_fma_f32 v[120:121], v[120:121], v[112:113], v[114:115] op_sel:[0,1,1] op_sel_hi:[1,1,1]
    v_cvt_pk_bf16_f32 v102, v120, v121
    v_lshlrev_b32 v122, 16, v103
    v_and_b32 v123, 0xffff0000, v103
    v_pk_fma_f32 v[122:123], v[122:123], v[112:113], v[114:115] op_sel:[0,1,1] op_sel_hi:[1,1,1]
    v_cvt_pk_bf16_f32 v103, v122, v123
    s_add_u32 s54, s52, 18432
    buffer_store_dwordx4 v[100:103], v2, s[8:11], s54 offen sc1
    s_cmp_ge_u32 s4, 2
    s_cbranch_scc1 kmain_kernel_n2one
    v_lshlrev_b32 v120, 16, v104
    v_and_b32 v121, 0xffff0000, v104
    v_pk_fma_f32 v[120:121], v[120:121], v[112:113], v[114:115] op_sel:[0,0,0] op_sel_hi:[1,0,0]
    v_cvt_pk_bf16_f32 v104, v120, v121
    v_lshlrev_b32 v122, 16, v105
    v_and_b32 v123, 0xffff0000, v105
    v_pk_fma_f32 v[122:123], v[122:123], v[112:113], v[114:115] op_sel:[0,0,0] op_sel_hi:[1,0,0]
    v_cvt_pk_bf16_f32 v105, v122, v123
    v_lshlrev_b32 v120, 16, v106
    v_and_b32 v121, 0xffff0000, v106
    v_pk_fma_f32 v[120:121], v[120:121], v[112:113], v[114:115] op_sel:[0,0,0] op_sel_hi:[1,0,0]
    v_cvt_pk_bf16_f32 v106, v120, v121
    v_lshlrev_b32 v122, 16, v107
    v_and_b32 v123, 0xffff0000, v107
    v_pk_fma_f32 v[122:123], v[122:123], v[112:113], v[114:115] op_sel:[0,0,0] op_sel_hi:[1,0,0]
    v_cvt_pk_bf16_f32 v107, v122, v123
    s_add_u32 s54, s52, 16384
    buffer_store_dwordx4 v[104:107], v2, s[8:11], s54 offen sc1
    v_lshlrev_b32 v120, 16, v108
    v_and_b32 v121, 0xffff0000, v108
    v_pk_fma_f32 v[120:121], v[120:121], v[112:113], v[114:115] op_sel:[0,1,1] op_sel_hi:[1,1,1]
    v_cvt_pk_bf16_f32 v108, v120, v121
    v_lshlrev_b32 v122, 16, v109
    v_and_b32 v123, 0xffff0000, v109
    v_pk_fma_f32 v[122:123], v[122:123], v[112:113], v[114:115] op_sel:[0,1,1] op_sel_hi:[1,1,1]
    v_cvt_pk_bf16_f32 v109, v122, v123
    v_lshlrev_b32 v120, 16, v110
    v_and_b32 v121, 0xffff0000, v110
    v_pk_fma_f32 v[120:121], v[120:121], v[112:113], v[114:115] op_sel:[0,1,1] op_sel_hi:[1,1,1]
    v_cvt_pk_bf16_f32 v110, v120, v121
    v_lshlrev_b32 v122, 16, v111
    v_and_b32 v123, 0xffff0000, v111
    v_pk_fma_f32 v[122:123], v[122:123], v[112:113], v[114:115] op_sel:[0,1,1] op_sel_hi:[1,1,1]
    v_cvt_pk_bf16_f32 v111, v122, v123
    s_add_u32 s54, s52, 34816
    buffer_store_dwordx4 v[108:111], v2, s[8:11], s54 offen sc1
kmain_kernel_n2one:
    s_mov_b32 s58, 2
    s_branch kmain_kernel_sideback
kmain_kernel_side3:
    s_lshl_b32 s52, s5, 6
    s_add_u32 s52, s52, 104826880
    s_cmp_lg_u32 s3, 0
    s_cbranch_scc1 kmain_kernel_sg4_6
    v_mov_b32 v112, 1
    v_mov_b32 v113, 0
    v_cmp_eq_u32 vcc, 0, v1
    s_nop 3
    s_and_saveexec_b64 s[50:51], vcc
    buffer_atomic_add v112, v113, s[8:11], s52 offen
    s_mov_b64 exec, s[50:51]
kmain_kernel_sg4_6:
    s_branch kmain_kernel_sideback
kmain_kernel_sideover:
    v_exp_f32 v24, v24
    v_exp_f32 v25, v25
    v_exp_f32 v26, v26
    v_exp_f32 v27, v27
    v_exp_f32 v28, v28
    v_exp_f32 v29, v29
    v_exp_f32 v30, v30
    v_exp_f32 v31, v31
    v_mfma_f32_16x16x32_bf16 v[192:195], a[160:163], v[32:35], v[192:195]
    v_mfma_f32_16x16x32_bf16 v[196:199], a[164:167], v[32:35], v[196:199]
    v_mfma_f32_16x16x32_bf16 v[200:203], a[168:171], v[32:35], v[200:203]
    v_mfma_f32_16x16x32_bf16 v[204:207], a[172:175], v[32:35], v[204:207]
    v_mfma_f32_16x16x32_bf16 v[208:211], a[176:179], v[32:35], v[208:211]
    v_mfma_f32_16x16x32_bf16 v[212:215], a[180:183], v[32:35], v[212:215]
    v_mfma_f32_16x16x32_bf16 v[216:219], a[184:187], v[32:35], v[216:219]
    v_mfma_f32_16x16x32_bf16 v[220:223], a[188:191], v[32:35], v[220:223]
    v_mfma_f32_16x16x32_bf16 a[200:203], a[208:211], v[32:35], a[200:203]
    v_cvt_pk_bf16_f32 v36, v24, v25
    v_cvt_pk_bf16_f32 v37, v26, v27
    v_cvt_pk_bf16_f32 v38, v28, v29
    v_cvt_pk_bf16_f32 v39, v30, v31
    s_nop 1
    v_mfma_f32_16x16x32_bf16 v[224:227], a[160:163], v[36:39], v[224:227]
    v_mfma_f32_16x16x32_bf16 v[228:231], a[164:167], v[36:39], v[228:231]
    v_mfma_f32_16x16x32_bf16 v[232:235], a[168:171], v[36:39], v[232:235]
    v_mfma_f32_16x16x32_bf16 v[236:239], a[172:175], v[36:39], v[236:239]
    v_mfma_f32_16x16x32_bf16 v[240:243], a[176:179], v[36:39], v[240:243]
    v_mfma_f32_16x16x32_bf16 v[244:247], a[180:183], v[36:39], v[244:247]
    v_mfma_f32_16x16x32_bf16 v[248:251], a[184:187], v[36:39], v[248:251]
    v_mfma_f32_16x16x32_bf16 v[252:255], a[188:191], v[36:39], v[252:255]
    v_mfma_f32_16x16x32_bf16 a[204:207], a[208:211], v[36:39], a[204:207]
    s_waitcnt vmcnt(0) lgkmcnt(0)
    v_accvgpr_read_b32 v8, a192
    v_accvgpr_read_b32 v9, a196
    v_accvgpr_read_b32 v10, a200
    s_nop 3
    v_accvgpr_read_b32 v11, a204
    v_cmp_lt_u32 vcc, v5, v4
    s_mul_i32 s54, s16, 18432
    s_add_u32 s54, s54, 7077888
    s_nop 1
    s_cmp_eq_u64 vcc, 0
    s_cselect_b32 s53, 1, 0
    s_cselect_b32 s54, s54, 2130706432
    s_add_u32 s55, s54, 18432
    s_barrier
    s_add_u32 m0, s21, 0
    s_add_u32 s22, s66, 0
    buffer_load_dwordx4 v2, s[8:11], s22 offen offset:0 lds
    buffer_load_dwordx4 v2, s[8:11], s22 offen offset:1024 lds
    buffer_load_dwordx4 v2, s[8:11], s22 offen offset:2048 lds
    buffer_load_dwordx4 v2, s[8:11], s22 offen offset:3072 lds
    s_add_u32 m0, s21, 4096
    s_add_u32 s22, s66, 4096
    buffer_load_dwordx4 v2, s[8:11], s22 offen offset:0 lds
    buffer_load_dwordx4 v2, s[8:11], s22 offen offset:1024 lds
    buffer_load_dwordx4 v2, s[8:11], s22 offen offset:2048 lds
    buffer_load_dwordx4 v2, s[8:11], s22 offen offset:3072 lds
    s_add_u32 m0, s21, 8192
    s_add_u32 s22, s66, 8192
    buffer_load_dwordx4 v2, s[8:11], s22 offen offset:0 lds
    buffer_load_dwordx4 a[64:67], v2, s[8:11], s54 offen offset:0 sc1
    buffer_load_dwordx4 a[68:71], v2, s[8:11], s55 offen offset:0 sc1
    buffer_load_dwordx4 a[72:75], v2, s[8:11], s54 offen offset:1024 sc1
    buffer_load_dwordx4 a[76:79], v2, s[8:11], s55 offen offset:1024 sc1
    buffer_load_dwordx4 a[80:83], v2, s[8:11], s54 offen offset:2048 sc1
    buffer_load_dwordx4 a[84:87], v2, s[8:11], s55 offen offset:2048 sc1
    buffer_load_dwordx4 a[88:91], v2, s[8:11], s54 offen offset:3072 sc1
    buffer_load_dwordx4 a[92:95], v2, s[8:11], s55 offen offset:3072 sc1
    s_add_u32 s54, s54, 4096
    s_add_u32 s55, s55, 4096
    buffer_load_dwordx4 a[96:99], v2, s[8:11], s54 offen offset:0 sc1
    buffer_load_dwordx4 a[100:103], v2, s[8:11], s55 offen offset:0 sc1
    buffer_load_dwordx4 a[104:107], v2, s[8:11], s54 offen offset:1024 sc1
    buffer_load_dwordx4 a[108:111], v2, s[8:11], s55 offen offset:1024 sc1
    buffer_load_dwordx4 a[112:115], v2, s[8:11], s54 offen offset:2048 sc1
    buffer_load_dwordx4 a[116:119], v2, s[8:11], s55 offen offset:2048 sc1
    buffer_load_dwordx4 a[120:123], v2, s[8:11], s54 offen offset:3072 sc1
    buffer_load_dwordx4 a[124:127], v2, s[8:11], s55 offen offset:3072 sc1
    s_add_u32 s54, s54, 4096
    s_add_u32 s55, s55, 4096
    buffer_load_dwordx4 a[128:131], v2, s[8:11], s54 offen offset:0 sc1
    buffer_load_dwordx4 a[132:135], v2, s[8:11], s55 offen offset:0 sc1
    buffer_load_dwordx4 a[136:139], v2, s[8:11], s54 offen offset:1024 sc1
    buffer_load_dwordx4 a[140:143], v2, s[8:11], s55 offen offset:1024 sc1
    buffer_load_dwordx4 a[144:147], v2, s[8:11], s54 offen offset:2048 sc1
    buffer_load_dwordx4 a[148:151], v2, s[8:11], s55 offen offset:2048 sc1
    buffer_load_dwordx4 a[152:155], v2, s[8:11], s54 offen offset:3072 sc1
    buffer_load_dwordx4 a[156:159], v2, s[8:11], s55 offen offset:3072 sc1
    s_add_u32 s54, s54, 4096
    s_add_u32 s55, s55, 4096
    buffer_load_dwordx4 a[160:163], v2, s[8:11], s54 offen offset:0 sc1
    buffer_load_dwordx4 a[164:167], v2, s[8:11], s55 offen offset:0 sc1
    buffer_load_dwordx4 a[168:171], v2, s[8:11], s54 offen offset:1024 sc1
    buffer_load_dwordx4 a[172:175], v2, s[8:11], s55 offen offset:1024 sc1
    buffer_load_dwordx4 a[176:179], v2, s[8:11], s54 offen offset:2048 sc1
    buffer_load_dwordx4 a[180:183], v2, s[8:11], s55 offen offset:2048 sc1
    buffer_load_dwordx4 a[184:187], v2, s[8:11], s54 offen offset:3072 sc1
    buffer_load_dwordx4 a[188:191], v2, s[8:11], s55 offen offset:3072 sc1
    s_add_u32 s54, s54, 4096
    s_add_u32 s55, s55, 4096
    buffer_load_dwordx4 a[192:195], v2, s[8:11], s54 offen offset:0 sc1
    buffer_load_dwordx4 a[196:199], v2, s[8:11], s55 offen offset:0 sc1
    buffer_load_dwordx4 a[200:203], v2, s[8:11], s54 offen offset:1024 sc1
    buffer_load_dwordx4 a[204:207], v2, s[8:11], s55 offen offset:1024 sc1
    s_add_u32 m0, s21, 36864
    s_add_u32 s22, s66, 36864
    buffer_load_dwordx4 v2, s[8:11], s22 offen offset:0 lds
    buffer_load_dwordx4 v2, s[8:11], s22 offen offset:1024 lds
    buffer_load_dwordx4 v2, s[8:11], s22 offen offset:2048 lds
    buffer_load_dwordx4 v2, s[8:11], s22 offen offset:3072 lds
    s_add_u32 m0, s21, 40960
    s_add_u32 s22, s66, 40960
    buffer_load_dwordx4 v2, s[8:11], s22 offen offset:0 lds
    buffer_load_dwordx4 v2, s[8:11], s22 offen offset:1024 lds
    buffer_load_dwordx4 v2, s[8:11], s22 offen offset:2048 lds
    buffer_load_dwordx4 v2, s[8:11], s22 offen offset:3072 lds
    s_add_u32 m0, s21, 45056
    s_add_u32 s22, s66, 45056
    buffer_load_dwordx4 v2, s[8:11], s22 offen offset:0 lds
    v_mov_b32 v0, 0x30800000
    v_mov_b32 v3, 0x4e800000
    s_mov_b64 s[42:43], exec
    v_cmp_ge_f32 s[44:45], v8, v0
    v_cmp_le_f32 s[46:47], v8, v3
    s_nop 2
    s_and_b64 s[42:43], s[42:43], s[44:45]
    s_and_b64 s[42:43], s[42:43], s[46:47]
    v_cmp_ge_f32 s[44:45], v9, v0
    v_cmp_le_f32 s[46:47], v9, v3
    s_nop 2
    s_and_b64 s[42:43], s[42:43], s[44:45]
    s_and_b64 s[42:43], s[42:43], s[46:47]
    v_cmp_ge_f32 s[44:45], v10, v0
    v_cmp_le_f32 s[46:47], v10, v3
    s_nop 2
    s_and_b64 s[42:43], s[42:43], s[44:45]
    s_and_b64 s[42:43], s[42:43], s[46:47]
    v_cmp_ge_f32 s[44:45], v11, v0
    v_cmp_le_f32 s[46:47], v11, v3
    s_nop 2
    s_and_b64 s[42:43], s[42:43], s[44:45]
    s_and_b64 s[42:43], s[42:43], s[46:47]
    v_rcp_f32 v8, v8
    v_rcp_f32 v9, v9
    v_rcp_f32 v10, v10
    v_rcp_f32 v11, v11
    s_lshl_b32 s18, s16, 7
    s_lshl_b32 s19, s4, 3
    s_add_u32 s18, s18, s19
    s_lshl_b32 s18, s18, 10
    s_add_u32 s18, s18, 28909568
    v_mov_b32 v12, 0
    v_mov_b32 v4, 0
    v_mov_b32 v13, 0
    v_mov_b32 v5, 0
    v_mov_b32 v14, 0
    v_mov_b32 v6, 0
    v_mov_b32 v15, 0
    v_mov_b32 v7, 0
    s_add_u32 s19, s18, 0
    v_pk_mul_f32 v[128:129], v[128:129], v[8:9] op_sel:[0,0] op_sel_hi:[1,0]
    v_pk_mul_f32 v[130:131], v[130:131], v[8:9] op_sel:[0,0] op_sel_hi:[1,0]
    v_pk_mul_f32 v[132:133], v[132:133], v[8:9] op_sel:[0,0] op_sel_hi:[1,0]
    v_pk_mul_f32 v[134:135], v[134:135], v[8:9] op_sel:[0,0] op_sel_hi:[1,0]
    v_cvt_pk_bf16_f32 v128, v128, v129
    v_cvt_pk_bf16_f32 v129, v130, v131
    v_cvt_pk_bf16_f32 v130, v132, v133
    v_cvt_pk_bf16_f32 v131, v134, v135
    buffer_store_dwordx4 v[128:131], v2, s[8:11], s19 offen offset:0 sc1
    s_nop 0
    v_mfma_f32_16x16x32_bf16 v[4:7], v[12:15], v[128:131], v[4:7]
    v_pk_mul_f32 v[136:137], v[136:137], v[8:9] op_sel:[0,0] op_sel_hi:[1,0]
    v_pk_mul_f32 v[138:139], v[138:139], v[8:9] op_sel:[0,0] op_sel_hi:[1,0]
    v_pk_mul_f32 v[140:141], v[140:141], v[8:9] op_sel:[0,0] op_sel_hi:[1,0]
    v_pk_mul_f32 v[142:143], v[142:143], v[8:9] op_sel:[0,0] op_sel_hi:[1,0]
    v_cvt_pk_bf16_f32 v136, v136, v137
    v_cvt_pk_bf16_f32 v137, v138, v139
    v_cvt_pk_bf16_f32 v138, v140, v141
    v_cvt_pk_bf16_f32 v139, v142, v143
    buffer_store_dwordx4 v[136:139], v2, s[8:11], s19 offen offset:1024 sc1
    s_nop 0
    v_mfma_f32_16x16x32_bf16 v[4:7], v[12:15], v[136:139], v[4:7]
    v_pk_mul_f32 v[144:145], v[144:145], v[8:9] op_sel:[0,0] op_sel_hi:[1,0]
    v_pk_mul_f32 v[146:147], v[146:147], v[8:9] op_sel:[0,0] op_sel_hi:[1,0]
    v_pk_mul_f32 v[148:149], v[148:149], v[8:9] op_sel:[0,0] op_sel_hi:[1,0]
    v_pk_mul_f32 v[150:151], v[150:151], v[8:9] op_sel:[0,0] op_sel_hi:[1,0]
    v_cvt_pk_bf16_f32 v144, v144, v145
    v_cvt_pk_bf16_f32 v145, v146, v147
    v_cvt_pk_bf16_f32 v146, v148, v149
    v_cvt_pk_bf16_f32 v147, v150, v151
    buffer_store_dwordx4 v[144:147], v2, s[8:11], s19 offen offset:2048 sc1
    s_nop 0
    v_mfma_f32_16x16x32_bf16 v[4:7], v[12:15], v[144:147], v[4:7]
    v_pk_mul_f32 v[152:153], v[152:153], v[8:9] op_sel:[0,0] op_sel_hi:[1,0]
    v_pk_mul_f32 v[154:155], v[154:155], v[8:9] op_sel:[0,0] op_sel_hi:[1,0]
    v_pk_mul_f32 v[156:157], v[156:157], v[8:9] op_sel:[0,0] op_sel_hi:[1,0]
    v_pk_mul_f32 v[158:159], v[158:159], v[8:9] op_sel:[0,0] op_sel_hi:[1,0]
    v_cvt_pk_bf16_f32 v152, v152, v153
    v_cvt_pk_bf16_f32 v153, v154, v155
    v_cvt_pk_bf16_f32 v154, v156, v157
    v_cvt_pk_bf16_f32 v155, v158, v159
    buffer_store_dwordx4 v[152:155], v2, s[8:11], s19 offen offset:3072 sc1
    s_nop 0
    v_mfma_f32_16x16x32_bf16 v[4:7], v[12:15], v[152:155], v[4:7]
    s_add_u32 s19, s18, 131072
    v_pk_mul_f32 v[160:161], v[160:161], v[8:9] op_sel:[0,1] op_sel_hi:[1,1]
    v_pk_mul_f32 v[162:163], v[162:163], v[8:9] op_sel:[0,1] op_sel_hi:[1,1]
    v_pk_mul_f32 v[164:165], v[164:165], v[8:9] op_sel:[0,1] op_sel_hi:[1,1]
    v_pk_mul_f32 v[166:167], v[166:167], v[8:9] op_sel:[0,1] op_sel_hi:[1,1]
    v_cvt_pk_bf16_f32 v160, v160, v161
    v_cvt_pk_bf16_f32 v161, v162, v163
    v_cvt_pk_bf16_f32 v162, v164, v165
    v_cvt_pk_bf16_f32 v163, v166, v167
    buffer_store_dwordx4 v[160:163], v2, s[8:11], s19 offen offset:0 sc1
    s_nop 0
    v_mfma_f32_16x16x32_bf16 v[4:7], v[12:15], v[160:163], v[4:7]
    v_pk_mul_f32 v[168:169], v[168:169], v[8:9] op_sel:[0,1] op_sel_hi:[1,1]
    v_pk_mul_f32 v[170:171], v[170:171], v[8:9] op_sel:[0,1] op_sel_hi:[1,1]
    v_pk_mul_f32 v[172:173], v[172:173], v[8:9] op_sel:[0,1] op_sel_hi:[1,1]
    v_pk_mul_f32 v[174:175], v[174:175], v[8:9] op_sel:[0,1] op_sel_hi:[1,1]
    v_cvt_pk_bf16_f32 v168, v168, v169
    v_cvt_pk_bf16_f32 v169, v170, v171
    v_cvt_pk_bf16_f32 v170, v172, v173
    v_cvt_pk_bf16_f32 v171, v174, v175
    buffer_store_dwordx4 v[168:171], v2, s[8:11], s19 offen offset:1024 sc1
    s_nop 0
    v_mfma_f32_16x16x32_bf16 v[4:7], v[12:15], v[168:171], v[4:7]
    v_pk_mul_f32 v[176:177], v[176:177], v[8:9] op_sel:[0,1] op_sel_hi:[1,1]
    v_pk_mul_f32 v[178:179], v[178:179], v[8:9] op_sel:[0,1] op_sel_hi:[1,1]
    v_pk_mul_f32 v[180:181], v[180:181], v[8:9] op_sel:[0,1] op_sel_hi:[1,1]
    v_pk_mul_f32 v[182:183], v[182:183], v[8:9] op_sel:[0,1] op_sel_hi:[1,1]
    v_cvt_pk_bf16_f32 v176, v176, v177
    v_cvt_pk_bf16_f32 v177, v178, v179
    v_cvt_pk_bf16_f32 v178, v180, v181
    v_cvt_pk_bf16_f32 v179, v182, v183
    buffer_store_dwordx4 v[176:179], v2, s[8:11], s19 offen offset:2048 sc1
    s_nop 0
    v_mfma_f32_16x16x32_bf16 v[4:7], v[12:15], v[176:179], v[4:7]
    v_pk_mul_f32 v[184:185], v[184:185], v[8:9] op_sel:[0,1] op_sel_hi:[1,1]
    v_pk_mul_f32 v[186:187], v[186:187], v[8:9] op_sel:[0,1] op_sel_hi:[1,1]
    v_pk_mul_f32 v[188:189], v[188:189], v[8:9] op_sel:[0,1] op_sel_hi:[1,1]
    v_pk_mul_f32 v[190:191], v[190:191], v[8:9] op_sel:[0,1] op_sel_hi:[1,1]
    v_cvt_pk_bf16_f32 v184, v184, v185
    v_cvt_pk_bf16_f32 v185, v186, v187
    v_cvt_pk_bf16_f32 v186, v188, v189
    v_cvt_pk_bf16_f32 v187, v190, v191
    buffer_store_dwordx4 v[184:187], v2, s[8:11], s19 offen offset:3072 sc1
    s_nop 0
    v_mfma_f32_16x16x32_bf16 v[4:7], v[12:15], v[184:187], v[4:7]
    s_add_u32 s19, s18, 4096
    v_pk_mul_f32 v[192:193], v[192:193], v[10:11] op_sel:[0,0] op_sel_hi:[1,0]
    v_pk_mul_f32 v[194:195], v[194:195], v[10:11] op_sel:[0,0] op_sel_hi:[1,0]
    v_pk_mul_f32 v[196:197], v[196:197], v[10:11] op_sel:[0,0] op_sel_hi:[1,0]
    v_pk_mul_f32 v[198:199], v[198:199], v[10:11] op_sel:[0,0] op_sel_hi:[1,0]
    v_cvt_pk_bf16_f32 v192, v192, v193
    v_cvt_pk_bf16_f32 v193, v194, v195
    v_cvt_pk_bf16_f32 v194, v196, v197
    v_cvt_pk_bf16_f32 v195, v198, v199
    buffer_store_dwordx4 v[192:195], v2, s[8:11], s19 offen offset:0 sc1
    s_nop 0
    v_mfma_f32_16x16x32_bf16 v[4:7], v[12:15], v[192:195], v[4:7]
    v_pk_mul_f32 v[200:201], v[200:201], v[10:11] op_sel:[0,0] op_sel_hi:[1,0]
    v_pk_mul_f32 v[202:203], v[202:203], v[10:11] op_sel:[0,0] op_sel_hi:[1,0]
    v_pk_mul_f32 v[204:205], v[204:205], v[10:11] op_sel:[0,0] op_sel_hi:[1,0]
    v_pk_mul_f32 v[206:207], v[206:207], v[10:11] op_sel:[0,0] op_sel_hi:[1,0]
    v_cvt_pk_bf16_f32 v200, v200, v201
    v_cvt_pk_bf16_f32 v201, v202, v203
    v_cvt_pk_bf16_f32 v202, v204, v205
    v_cvt_pk_bf16_f32 v203, v206, v207
    buffer_store_dwordx4 v[200:203], v2, s[8:11], s19 offen offset:1024 sc1
    s_nop 0
    v_mfma_f32_16x16x32_bf16 v[4:7], v[12:15], v[200:203], v[4:7]
    v_pk_mul_f32 v[208:209], v[208:209], v[10:11] op_sel:[0,0] op_sel_hi:[1,0]
    v_pk_mul_f32 v[210:211], v[210:211], v[10:11] op_sel:[0,0] op_sel_hi:[1,0]
    v_pk_mul_f32 v[212:213], v[212:213], v[10:11] op_sel:[0,0] op_sel_hi:[1,0]
    v_pk_mul_f32 v[214:215], v[214:215], v[10:11] op_sel:[0,0] op_sel_hi:[1,0]
    v_cvt_pk_bf16_f32 v208, v208, v209
    v_cvt_pk_bf16_f32 v209, v210, v211
    v_cvt_pk_bf16_f32 v210, v212, v213
    v_cvt_pk_bf16_f32 v211, v214, v215
    buffer_store_dwordx4 v[208:211], v2, s[8:11], s19 offen offset:2048 sc1
    s_nop 0
    v_mfma_f32_16x16x32_bf16 v[4:7], v[12:15], v[208:211], v[4:7]
    v_pk_mul_f32 v[216:217], v[216:217], v[10:11] op_sel:[0,0] op_sel_hi:[1,0]
    v_pk_mul_f32 v[218:219], v[218:219], v[10:11] op_sel:[0,0] op_sel_hi:[1,0]
    v_pk_mul_f32 v[220:221], v[220:221], v[10:11] op_sel:[0,0] op_sel_hi:[1,0]
    v_pk_mul_f32 v[222:223], v[222:223], v[10:11] op_sel:[0,0] op_sel_hi:[1,0]
    v_cvt_pk_bf16_f32 v216, v216, v217
    v_cvt_pk_bf16_f32 v217, v218, v219
    v_cvt_pk_bf16_f32 v218, v220, v221
    v_cvt_pk_bf16_f32 v219, v222, v223
    buffer_store_dwordx4 v[216:219], v2, s[8:11], s19 offen offset:3072 sc1
    s_nop 0
    v_mfma_f32_16x16x32_bf16 v[4:7], v[12:15], v[216:219], v[4:7]
    s_add_u32 s19, s18, 135168
    v_pk_mul_f32 v[224:225], v[224:225], v[10:11] op_sel:[0,1] op_sel_hi:[1,1]
    v_pk_mul_f32 v[226:227], v[226:227], v[10:11] op_sel:[0,1] op_sel_hi:[1,1]
    v_pk_mul_f32 v[228:229], v[228:229], v[10:11] op_sel:[0,1] op_sel_hi:[1,1]
    v_pk_mul_f32 v[230:231], v[230:231], v[10:11] op_sel:[0,1] op_sel_hi:[1,1]
    v_cvt_pk_bf16_f32 v224, v224, v225
    v_cvt_pk_bf16_f32 v225, v226, v227
    v_cvt_pk_bf16_f32 v226, v228, v229
    v_cvt_pk_bf16_f32 v227, v230, v231
    buffer_store_dwordx4 v[224:227], v2, s[8:11], s19 offen offset:0 sc1
    s_nop 0
    v_mfma_f32_16x16x32_bf16 v[4:7], v[12:15], v[224:227], v[4:7]
    v_pk_mul_f32 v[232:233], v[232:233], v[10:11] op_sel:[0,1] op_sel_hi:[1,1]
    v_pk_mul_f32 v[234:235], v[234:235], v[10:11] op_sel:[0,1] op_sel_hi:[1,1]
    v_pk_mul_f32 v[236:237], v[236:237], v[10:11] op_sel:[0,1] op_sel_hi:[1,1]
    v_pk_mul_f32 v[238:239], v[238:239], v[10:11] op_sel:[0,1] op_sel_hi:[1,1]
    v_cvt_pk_bf16_f32 v232, v232, v233
    v_cvt_pk_bf16_f32 v233, v234, v235
    v_cvt_pk_bf16_f32 v234, v236, v237
    v_cvt_pk_bf16_f32 v235, v238, v239
    buffer_store_dwordx4 v[232:235], v2, s[8:11], s19 offen offset:1024 sc1
    s_nop 0
    v_mfma_f32_16x16x32_bf16 v[4:7], v[12:15], v[232:235], v[4:7]
    v_pk_mul_f32 v[240:241], v[240:241], v[10:11] op_sel:[0,1] op_sel_hi:[1,1]
    v_pk_mul_f32 v[242:243], v[242:243], v[10:11] op_sel:[0,1] op_sel_hi:[1,1]
    v_pk_mul_f32 v[244:245], v[244:245], v[10:11] op_sel:[0,1] op_sel_hi:[1,1]
    v_pk_mul_f32 v[246:247], v[246:247], v[10:11] op_sel:[0,1] op_sel_hi:[1,1]
    v_cvt_pk_bf16_f32 v240, v240, v241
    v_cvt_pk_bf16_f32 v241, v242, v243
    v_cvt_pk_bf16_f32 v242, v244, v245
    v_cvt_pk_bf16_f32 v243, v246, v247
    buffer_store_dwordx4 v[240:243], v2, s[8:11], s19 offen offset:2048 sc1
    s_nop 0
    v_mfma_f32_16x16x32_bf16 v[4:7], v[12:15], v[240:243], v[4:7]
    v_pk_mul_f32 v[248:249], v[248:249], v[10:11] op_sel:[0,1] op_sel_hi:[1,1]
    v_pk_mul_f32 v[250:251], v[250:251], v[10:11] op_sel:[0,1] op_sel_hi:[1,1]
    v_pk_mul_f32 v[252:253], v[252:253], v[10:11] op_sel:[0,1] op_sel_hi:[1,1]
    v_pk_mul_f32 v[254:255], v[254:255], v[10:11] op_sel:[0,1] op_sel_hi:[1,1]
    v_cvt_pk_bf16_f32 v248, v248, v249
    v_cvt_pk_bf16_f32 v249, v250, v251
    v_cvt_pk_bf16_f32 v250, v252, v253
    v_cvt_pk_bf16_f32 v251, v254, v255
    buffer_store_dwordx4 v[248:251], v2, s[8:11], s19 offen offset:3072 sc1
    s_nop 0
    v_mfma_f32_16x16x32_bf16 v[4:7], v[12:15], v[248:251], v[4:7]
    s_nop 7
    v_add_f32 v4, v4, v5
    v_add_f32 v6, v6, v7
    v_add_f32 v4, v4, v6
    v_cmp_o_f32 s[44:45], v4, v4
    s_nop 3
    s_and_b64 s[42:43], s[42:43], s[44:45]
    s_cmp_eq_u64 s[42:43], exec
    s_cselect_b32 s44, 0, 1
    v_mov_b32 v0, s44
    s_lshl_b32 s45, s3, 2
    s_add_u32 s45, s45, 147456
    v_mov_b32 v3, s45
    ds_write_b32 v3, v0
    s_waitcnt lgkmcnt(0)
    s_barrier
    v_mov_b32 v3, 147456
    ds_read_b128 v[12:15], v3
    s_waitcnt lgkmcnt(0)
    v_or_b32 v12, v12, v13
    v_or_b32 v14, v14, v15
    v_or_b32 v12, v12, v14
    s_nop 0
    v_readfirstlane_b32 s44, v12
    s_nop 3
    s_cmp_eq_u32 s44, 0
    s_cbranch_scc1 kmain_kernel_done
    s_cmp_lg_u32 s41, 0
    s_cbranch_scc1 kmain_kernel_done
    s_mov_b32 s41, 1
    s_waitcnt vmcnt(0)
    v_lshrrev_b32 v104, 4, v1
    v_and_b32 v105, 15, v1
    s_lshl_b32 s18, s3, 4
    v_add_u32 v106, s18, v104
    v_lshlrev_b32 v106, 8, v106
    v_add_u32 v107, 0, v104
    v_xor_b32 v107, v107, v105
    v_lshl_add_u32 v68, v107, 4, v106
    v_add_u32 v107, 4, v104
    v_xor_b32 v107, v107, v105
    v_lshl_add_u32 v69, v107, 4, v106
    v_add_u32 v107, 8, v104
    v_xor_b32 v107, v107, v105
    v_lshl_add_u32 v70, v107, 4, v106
    v_add_u32 v107, 12, v104
    v_xor_b32 v107, v107, v105
    v_lshl_add_u32 v71, v107, 4, v106
    v_add_u32 v107, 0, v104
    v_lshlrev_b32 v107, 1, v107
    v_xor_b32 v107, v107, v105
    v_lshl_add_u32 v72, v107, 4, v106
    v_add_u32 v107, 4, v104
    v_lshlrev_b32 v107, 1, v107
    v_xor_b32 v107, v107, v105
    v_lshl_add_u32 v73, v107, 4, v106
    v_lshlrev_b32 v106, 8, v105
    v_add_u32 v107, 0, v104
    v_xor_b32 v107, v107, v105
    v_lshl_add_u32 v56, v107, 4, v106
    v_add_u32 v107, 4, v104
    v_xor_b32 v107, v107, v105
    v_lshl_add_u32 v57, v107, 4, v106
    v_add_u32 v107, 8, v104
    v_xor_b32 v107, v107, v105
    v_lshl_add_u32 v58, v107, 4, v106
    v_add_u32 v107, 12, v104
    v_xor_b32 v107, v107, v105
    v_lshl_add_u32 v59, v107, 4, v106
    v_lshrrev_b32 v106, 2, v1
    v_and_b32 v106, 3, v106
    v_lshl_add_u32 v106, v104, 2, v106
    v_and_b32 v105, 7, v106
    v_lshlrev_b32 v106, 8, v106
    v_and_b32 v107, 3, v1
    v_lshl_add_u32 v106, v107, 3, v106
    v_add_u32 v106, 0x10000, v106
    v_xor_b32 v107, 0, v105
    v_lshl_add_u32 v60, v107, 5, v106
    v_xor_b32 v107, 1, v105
    v_lshl_add_u32 v61, v107, 5, v106
    v_xor_b32 v107, 2, v105
    v_lshl_add_u32 v62, v107, 5, v106
    v_xor_b32 v107, 3, v105
    v_lshl_add_u32 v63, v107, 5, v106
    v_xor_b32 v107, 4, v105
    v_lshl_add_u32 v64, v107, 5, v106
    v_xor_b32 v107, 5, v105
    v_lshl_add_u32 v65, v107, 5, v106
    v_xor_b32 v107, 6, v105
    v_lshl_add_u32 v66, v107, 5, v106
    v_xor_b32 v107, 7, v105
    v_lshl_add_u32 v67, v107, 5, v106
    s_lshl_b32 s38, s3, 12
    s_add_u32 s39, s38, 0x10000
    s_lshl_b32 s23, s5, 6
    s_add_u32 s22, s23, 104826880
    s_add_u32 s23, s23, 104818688
    v_mov_b32 v3, 104819712
    v_mov_b32 v4, 0x100
    v_mov_b32 v5, 0
    v_cmp_eq_u32 vcc, 0, v1
    v_mov_b32 v6, s23
    s_nop 0
    v_cndmask_b32 v3, v3, v6, vcc
    v_cndmask_b32 v4, v4, 18, vcc
    v_cmp_eq_u32 vcc, 1, v1
    v_mov_b32 v6, s22
    s_nop 0
    v_cndmask_b32 v3, v3, v6, vcc
    v_cndmask_b32 v4, v4, 16, vcc
    v_mov_b32 v84, 0xff800000
    v_mov_b32 v85, 0xff800000
    v_mov_b32 v86, 0xff800000
    v_mov_b32 v87, 0xff800000
    v_and_b32 v76, 15, v1
    v_lshlrev_b32 v76, 8, v76
    v_lshrrev_b32 v77, 4, v1
    v_lshl_add_u32 v76, v77, 4, v76
    s_mov_b32 s46, 0
kmain_kernel_mx:
    buffer_load_dwordx4 a[64:67], v76, s[28:31], s46 offen offset:0
    buffer_load_dwordx4 a[68:71], v76, s[28:31], s46 offen offset:64
    buffer_load_dwordx4 a[72:75], v76, s[28:31], s46 offen offset:128
    buffer_load_dwordx4 a[76:79], v76, s[28:31], s46 offen offset:192
    s_waitcnt vmcnt(0)
    v_mfma_f32_16x16x32_bf16 v[88:91], a[64:67], a[0:3], 0
    v_mfma_f32_16x16x32_bf16 v[88:91], a[68:71], a[4:7], v[88:91]
    v_mfma_f32_16x16x32_bf16 v[88:91], a[72:75], a[8:11], v[88:91]
    v_mfma_f32_16x16x32_bf16 v[88:91], a[76:79], a[12:15], v[88:91]
    v_mfma_f32_16x16x32_bf16 v[92:95], a[64:67], a[16:19], 0
    v_mfma_f32_16x16x32_bf16 v[92:95], a[68:71], a[20:23], v[92:95]
    v_mfma_f32_16x16x32_bf16 v[92:95], a[72:75], a[24:27], v[92:95]
    v_mfma_f32_16x16x32_bf16 v[92:95], a[76:79], a[28:31], v[92:95]
    v_mfma_f32_16x16x32_bf16 v[96:99], a[64:67], a[32:35], 0
    v_mfma_f32_16x16x32_bf16 v[96:99], a[68:71], a[36:39], v[96:99]
    v_mfma_f32_16x16x32_bf16 v[96:99], a[72:75], a[40:43], v[96:99]
    v_mfma_f32_16x16x32_bf16 v[96:99], a[76:79], a[44:47], v[96:99]
    v_mfma_f32_16x16x32_bf16 v[100:103], a[64:67], a[48:51], 0
    v_mfma_f32_16x16x32_bf16 v[100:103], a[68:71], a[52:55], v[100:103]
    v_mfma_f32_16x16x32_bf16 v[100:103], a[72:75], a[56:59], v[100:103]
    v_mfma_f32_16x16x32_bf16 v[100:103], a[76:79], a[60:63], v[100:103]
    s_nop 7
    v_max3_f32 v84, v88, v89, v84
    v_max3_f32 v84, v90, v91, v84
    v_max3_f32 v85, v92, v93, v85
    v_max3_f32 v85, v94, v95, v85
    v_max3_f32 v86, v96, v97, v86
    v_max3_f32 v86, v98, v99, v86
    v_max3_f32 v87, v100, v101, v87
    v_max3_f32 v87, v102, v103, v87
    s_add_u32 s46, s46, 4096
    s_cmp_lt_u32 s46, 0x80000
    s_cbranch_scc1 kmain_kernel_mx
    v_mov_b32 v76, v84
    s_nop 1
    v_permlane16_swap_b32 v84, v76
    v_max_f32 v84, v84, v76
    v_mov_b32 v76, v84
    s_nop 1
    v_permlane32_swap_b32 v84, v76
    v_max_f32 v84, v84, v76
    v_sub_f32 v84, 0, v84
    v_mov_b32 v40, v84
    v_mov_b32 v41, v84
    v_mov_b32 v42, v84
    v_mov_b32 v43, v84
    v_mov_b32 v76, v85
    s_nop 1
    v_permlane16_swap_b32 v85, v76
    v_max_f32 v85, v85, v76
    v_mov_b32 v76, v85
    s_nop 1
    v_permlane32_swap_b32 v85, v76
    v_max_f32 v85, v85, v76
    v_sub_f32 v85, 0, v85
    v_mov_b32 v44, v85
    v_mov_b32 v45, v85
    v_mov_b32 v46, v85
    v_mov_b32 v47, v85
    v_mov_b32 v76, v86
    s_nop 1
    v_permlane16_swap_b32 v86, v76
    v_max_f32 v86, v86, v76
    v_mov_b32 v76, v86
    s_nop 1
    v_permlane32_swap_b32 v86, v76
    v_max_f32 v86, v86, v76
    v_sub_f32 v86, 0, v86
    v_mov_b32 v48, v86
    v_mov_b32 v49, v86
    v_mov_b32 v50, v86
    v_mov_b32 v51, v86
    v_mov_b32 v76, v87
    s_nop 1
    v_permlane16_swap_b32 v87, v76
    v_max_f32 v87, v87, v76
    v_mov_b32 v76, v87
    s_nop 1
    v_permlane32_swap_b32 v87, v76
    v_max_f32 v87, v87, v76
    v_sub_f32 v87, 0, v87
    v_mov_b32 v52, v87
    v_mov_b32 v53, v87
    v_mov_b32 v54, v87
    v_mov_b32 v55, v87
    s_branch kmain_kernel_retry
kmain_kernel_done:
    s_cmp_lg_u32 s53, 0
    s_cbranch_scc1 kmain_kernel_p1ok
    s_lshl_b32 s23, s5, 6
    s_add_u32 s22, s23, 104826880
    s_add_u32 s23, s23, 104818688
    v_mov_b32 v3, 104819712
    v_mov_b32 v4, 0x100
    v_mov_b32 v5, 0
    v_cmp_eq_u32 vcc, 0, v1
    v_mov_b32 v6, s23
    s_nop 0
    v_cndmask_b32 v3, v3, v6, vcc
    v_cndmask_b32 v4, v4, 18, vcc
    v_cmp_eq_u32 vcc, 1, v1
    v_mov_b32 v6, s22
    s_nop 0
    v_cndmask_b32 v3, v3, v6, vcc
    v_cndmask_b32 v4, v4, 16, vcc
    s_mov_b32 s60, 0
kmain_kernel_w2_7:
    buffer_load_dword v5, v3, s[8:11], 0 offen sc1
    s_waitcnt vmcnt(0)
    v_cmp_lt_u32 vcc, v5, v4
    s_cbranch_vccz kmain_kernel_w2_7_o
    s_add_u32 s60, s60, 1
    s_cmp_ge_u32 s60, 0x20000
    s_cbranch_scc1 kmain_kernel_w2_7_o
    s_sleep 8
    s_branch kmain_kernel_w2_7
kmain_kernel_w2_7_o:
    s_mul_i32 s54, s16, 18432
    s_add_u32 s54, s54, 7077888
    s_add_u32 s55, s54, 18432
    s_add_u32 m0, s21, 0
    s_add_u32 s22, s66, 0
    buffer_load_dwordx4 v2, s[8:11], s22 offen offset:0 lds
    buffer_load_dwordx4 v2, s[8:11], s22 offen offset:1024 lds
    buffer_load_dwordx4 v2, s[8:11], s22 offen offset:2048 lds
    buffer_load_dwordx4 v2, s[8:11], s22 offen offset:3072 lds
    s_add_u32 m0, s21, 4096
    s_add_u32 s22, s66, 4096
    buffer_load_dwordx4 v2, s[8:11], s22 offen offset:0 lds
    buffer_load_dwordx4 v2, s[8:11], s22 offen offset:1024 lds
    buffer_load_dwordx4 v2, s[8:11], s22 offen offset:2048 lds
    buffer_load_dwordx4 v2, s[8:11], s22 offen offset:3072 lds
    s_add_u32 m0, s21, 8192
    s_add_u32 s22, s66, 8192
    buffer_load_dwordx4 v2, s[8:11], s22 offen offset:0 lds
    s_add_u32 m0, s21, 36864
    s_add_u32 s22, s66, 36864
    buffer_load_dwordx4 v2, s[8:11], s22 offen offset:0 lds
    buffer_load_dwordx4 v2, s[8:11], s22 offen offset:1024 lds
    buffer_load_dwordx4 v2, s[8:11], s22 offen offset:2048 lds
    buffer_load_dwordx4 v2, s[8:11], s22 offen offset:3072 lds
    s_add_u32 m0, s21, 40960
    s_add_u32 s22, s66, 40960
    buffer_load_dwordx4 v2, s[8:11], s22 offen offset:0 lds
    buffer_load_dwordx4 v2, s[8:11], s22 offen offset:1024 lds
    buffer_load_dwordx4 v2, s[8:11], s22 offen offset:2048 lds
    buffer_load_dwordx4 v2, s[8:11], s22 offen offset:3072 lds
    s_add_u32 m0, s21, 45056
    s_add_u32 s22, s66, 45056
    buffer_load_dwordx4 v2, s[8:11], s22 offen offset:0 lds
    buffer_load_dwordx4 a[64:67], v2, s[8:11], s54 offen offset:0 sc1
    buffer_load_dwordx4 a[68:71], v2, s[8:11], s55 offen offset:0 sc1
    buffer_load_dwordx4 a[72:75], v2, s[8:11], s54 offen offset:1024 sc1
    buffer_load_dwordx4 a[76:79], v2, s[8:11], s55 offen offset:1024 sc1
    buffer_load_dwordx4 a[80:83], v2, s[8:11], s54 offen offset:2048 sc1
    buffer_load_dwordx4 a[84:87], v2, s[8:11], s55 offen offset:2048 sc1
    buffer_load_dwordx4 a[88:91], v2, s[8:11], s54 offen offset:3072 sc1
    buffer_load_dwordx4 a[92:95], v2, s[8:11], s55 offen offset:3072 sc1
    s_add_u32 s54, s54, 4096
    s_add_u32 s55, s55, 4096
    buffer_load_dwordx4 a[96:99], v2, s[8:11], s54 offen offset:0 sc1
    buffer_load_dwordx4 a[100:103], v2, s[8:11], s55 offen offset:0 sc1
    buffer_load_dwordx4 a[104:107], v2, s[8:11], s54 offen offset:1024 sc1
    buffer_load_dwordx4 a[108:111], v2, s[8:11], s55 offen offset:1024 sc1
    buffer_load_dwordx4 a[112:115], v2, s[8:11], s54 offen offset:2048 sc1
    buffer_load_dwordx4 a[116:119], v2, s[8:11], s55 offen offset:2048 sc1
    buffer_load_dwordx4 a[120:123], v2, s[8:11], s54 offen offset:3072 sc1
    buffer_load_dwordx4 a[124:127], v2, s[8:11], s55 offen offset:3072 sc1
    s_add_u32 s54, s54, 4096
    s_add_u32 s55, s55, 4096
    buffer_load_dwordx4 a[128:131], v2, s[8:11], s54 offen offset:0 sc1
    buffer_load_dwordx4 a[132:135], v2, s[8:11], s55 offen offset:0 sc1
    buffer_load_dwordx4 a[136:139], v2, s[8:11], s54 offen offset:1024 sc1
    buffer_load_dwordx4 a[140:143], v2, s[8:11], s55 offen offset:1024 sc1
    buffer_load_dwordx4 a[144:147], v2, s[8:11], s54 offen offset:2048 sc1
    buffer_load_dwordx4 a[148:151], v2, s[8:11], s55 offen offset:2048 sc1
    buffer_load_dwordx4 a[152:155], v2, s[8:11], s54 offen offset:3072 sc1
    buffer_load_dwordx4 a[156:159], v2, s[8:11], s55 offen offset:3072 sc1
    s_add_u32 s54, s54, 4096
    s_add_u32 s55, s55, 4096
    buffer_load_dwordx4 a[160:163], v2, s[8:11], s54 offen offset:0 sc1
    buffer_load_dwordx4 a[164:167], v2, s[8:11], s55 offen offset:0 sc1
    buffer_load_dwordx4 a[168:171], v2, s[8:11], s54 offen offset:1024 sc1
    buffer_load_dwordx4 a[172:175], v2, s[8:11], s55 offen offset:1024 sc1
    buffer_load_dwordx4 a[176:179], v2, s[8:11], s54 offen offset:2048 sc1
    buffer_load_dwordx4 a[180:183], v2, s[8:11], s55 offen offset:2048 sc1
    buffer_load_dwordx4 a[184:187], v2, s[8:11], s54 offen offset:3072 sc1
    buffer_load_dwordx4 a[188:191], v2, s[8:11], s55 offen offset:3072 sc1
    s_add_u32 s54, s54, 4096
    s_add_u32 s55, s55, 4096
    buffer_load_dwordx4 a[192:195], v2, s[8:11], s54 offen offset:0 sc1
    buffer_load_dwordx4 a[196:199], v2, s[8:11], s55 offen offset:0 sc1
    buffer_load_dwordx4 a[200:203], v2, s[8:11], s54 offen offset:1024 sc1
    buffer_load_dwordx4 a[204:207], v2, s[8:11], s55 offen offset:1024 sc1
    s_waitcnt vmcnt(0)
kmain_kernel_p1ok:
    v_mov_b32 v3, v2
    v_add_u32 v4, 36864, v2
    v_add_u32 v5, 73728, v2
    v_add_u32 v6, 110592, v2
    s_lshl_b32 s61, s2, 2
    s_add_u32 s61, s61, s3
    s_lshl_b32 s75, s3, 13
    s_add_u32 s75, s75, 110592
    s_cmp_ge_u32 s61, 400
    s_cbranch_scc1 kmain_kernel_pb_n0
    s_load_dwordx2 s[24:25], s[0:1], 72
    s_add_u32 s61, s61, 248
    s_mul_hi_u32 s57, s61, 477218589
    s_mul_i32 s58, s57, 9
    s_sub_u32 s58, s61, s58
    s_mov_b32 s60, 1152
    s_mov_b32 s54, 1
    s_mov_b32 s26, 5308416
    s_mov_b32 s56, 147456
    s_mul_i32 s55, s58, 576
    s_lshl_b32 s59, s57, 1
    s_add_u32 s55, s55, s59
    s_lshl_b32 s55, s55, 10
    s_add_u32 s55, s55, 61759488
    s_mul_i32 s57, s57, 73728
    s_lshl_b32 s58, s58, 7
    s_add_u32 s57, s57, s58
    s_branch kmain_kernel_pb_go
kmain_kernel_pb_n0:
    s_cmp_ge_u32 s61, 976
    s_cbranch_scc1 kmain_kernel_pb_n1
    s_load_dwordx2 s[24:25], s[0:1], 32
    s_sub_u32 s61, s61, 400
    s_mul_hi_u32 s57, s61, 477218589
    s_mul_i32 s58, s57, 9
    s_sub_u32 s58, s61, s58
    s_mov_b32 s60, 1152
    s_mov_b32 s54, 2
    s_mov_b32 s26, 4718592
    s_mov_b32 s56, 131072
    s_mul_i32 s55, s58, 512
    s_lshl_b32 s59, s57, 1
    s_add_u32 s55, s55, s59
    s_lshl_b32 s55, s55, 10
    s_add_u32 s55, s55, 57040896
    s_mul_i32 s57, s57, 73728
    s_lshl_b32 s58, s58, 7
    s_add_u32 s57, s57, s58
    s_branch kmain_kernel_pb_go
kmain_kernel_pb_n1:
    s_load_dwordx2 s[24:25], s[0:1], 64
    s_mov_b32 s60, 0
    s_mov_b32 s54, 3
    s_mov_b32 s26, 0
    s_mov_b32 s55, 0
    s_mov_b32 s56, 0
    s_mov_b32 s57, 0
kmain_kernel_pb_go:
    s_mov_b32 s27, 0x20000
    v_lshrrev_b32 v192, 3, v1
    v_mul_lo_u32 v192, v192, s60
    v_and_b32 v193, 7, v1
    v_lshl_add_u32 v192, v193, 4, v192
    s_lshl_b32 s60, s60, 3
    s_waitcnt lgkmcnt(0)
    s_add_u32 m0, s75, 0
    s_nop 0
    buffer_load_dwordx4 v192, s[24:27], s57 offen lds
    s_add_u32 s57, s57, s60
    s_add_u32 m0, s75, 1024
    s_nop 0
    buffer_load_dwordx4 v192, s[24:27], s57 offen lds
    s_add_u32 s57, s57, s60
    s_add_u32 m0, s75, 2048
    s_nop 0
    buffer_load_dwordx4 v192, s[24:27], s57 offen lds
    s_add_u32 s57, s57, s60
    s_add_u32 m0, s75, 3072
    s_nop 0
    buffer_load_dwordx4 v192, s[24:27], s57 offen lds
    s_add_u32 s57, s57, s60
    s_add_u32 m0, s75, 4096
    s_nop 0
    buffer_load_dwordx4 v192, s[24:27], s57 offen lds
    s_add_u32 s57, s57, s60
    s_add_u32 m0, s75, 5120
    s_nop 0
    buffer_load_dwordx4 v192, s[24:27], s57 offen lds
    s_add_u32 s57, s57, s60
    s_add_u32 m0, s75, 6144
    s_nop 0
    buffer_load_dwordx4 v192, s[24:27], s57 offen lds
    s_add_u32 s57, s57, s60
    s_add_u32 m0, s75, 7168
    s_nop 0
    buffer_load_dwordx4 v192, s[24:27], s57 offen lds
    s_mul_i32 s19, s16, 144
    s_mul_i32 s23, s4, 9
    s_add_u32 s19, s19, s23
    s_lshl_b32 s19, s19, 10
    s_add_u32 s19, s19, 10035200
    v_mov_b32 v255, 0xbeeff558
    s_lshl_b32 s44, s5, 6
    s_add_u32 s46, s44, 104825856
    s_add_u32 s44, s44, 104824832
    s_mov_b32 s45, 104819776
    s_and_b32 s47, s2, 1
    s_lshl_b32 s47, s47, 3
    s_lshr_b32 s48, s2, 5
    s_add_u32 s47, s47, s48
    s_lshl_b32 s47, s47, 6
    s_waitcnt vmcnt(63)
    s_barrier
    ds_read_b128 v[16:19], v3 offset:0
    ds_read_b128 v[20:23], v3 offset:1024
    ds_read_b128 v[24:27], v3 offset:2048
    ds_read_b128 v[28:31], v3 offset:3072
    ds_read_b128 v[32:35], v3 offset:4096
    ds_read_b128 v[36:39], v3 offset:5120
    ds_read_b128 v[40:43], v3 offset:6144
    ds_read_b128 v[44:47], v3 offset:7168
    ds_read_b128 v[48:51], v3 offset:8192
    ds_read_b128 v[52:55], v3 offset:9216
    ds_read_b128 v[56:59], v3 offset:10240
    ds_read_b128 v[60:63], v3 offset:11264
    s_waitcnt vmcnt(57)
    s_waitcnt lgkmcnt(6)
    v_mfma_f32_16x16x32_bf16 v[160:163], v[16:19], a[64:67], 0
    s_add_u32 m0, s21, 73728
    v_mfma_f32_16x16x32_bf16 v[160:163], v[20:23], a[72:75], v[160:163]
    ds_read_b128 v[64:67], v3 offset:12288
    s_add_u32 s22, s66, 73728
    v_mfma_f32_16x16x32_bf16 v[160:163], v[24:27], a[80:83], v[160:163]
    buffer_load_dwordx4 v2, s[8:11], s22 offen offset:0 lds
    v_mfma_f32_16x16x32_bf16 v[160:163], v[28:31], a[88:91], v[160:163]
    ds_read_b128 v[68:71], v3 offset:13312
    v_mfma_f32_16x16x32_bf16 v[160:163], v[32:35], a[96:99], v[160:163]
    buffer_load_dwordx4 v2, s[8:11], s22 offen offset:1024 lds
    v_mfma_f32_16x16x32_bf16 v[160:163], v[36:39], a[104:107], v[160:163]
    ds_read_b128 v[72:75], v3 offset:14336
    v_mfma_f32_16x16x32_bf16 v[164:167], v[16:19], a[68:71], 0
    buffer_load_dwordx4 v2, s[8:11], s22 offen offset:2048 lds
    v_mfma_f32_16x16x32_bf16 v[164:167], v[20:23], a[76:79], v[164:167]
    ds_read_b128 v[76:79], v3 offset:15360
    buffer_load_dwordx4 v2, s[8:11], s22 offen offset:3072 lds
    v_mfma_f32_16x16x32_bf16 v[164:167], v[24:27], a[84:87], v[164:167]
    s_add_u32 m0, s21, 77824
    v_mfma_f32_16x16x32_bf16 v[164:167], v[28:31], a[92:95], v[164:167]
    ds_read_b128 v[80:83], v3 offset:16384
    v_mfma_f32_16x16x32_bf16 v[164:167], v[32:35], a[100:103], v[164:167]
    s_add_u32 s22, s66, 77824
    v_mfma_f32_16x16x32_bf16 v[164:167], v[36:39], a[108:111], v[164:167]
    ds_read_b128 v[84:87], v3 offset:17408
    s_waitcnt vmcnt(49)
    s_waitcnt lgkmcnt(6)
    v_mfma_f32_16x16x32_bf16 v[160:163], v[40:43], a[112:115], v[160:163]
    buffer_load_dwordx4 v2, s[8:11], s22 offen offset:0 lds
    v_mfma_f32_16x16x32_bf16 v[160:163], v[44:47], a[120:123], v[160:163]
    ds_read_b128 v[16:19], v3 offset:18432
    buffer_load_dwordx4 v2, s[8:11], s22 offen offset:1024 lds
    v_mfma_f32_16x16x32_bf16 v[160:163], v[48:51], a[128:131], v[160:163]
    buffer_load_dwordx4 v2, s[8:11], s22 offen offset:2048 lds
    v_mfma_f32_16x16x32_bf16 v[160:163], v[52:55], a[136:139], v[160:163]
    ds_read_b128 v[20:23], v3 offset:19456
    v_mfma_f32_16x16x32_bf16 v[160:163], v[56:59], a[144:147], v[160:163]
    buffer_load_dwordx4 v2, s[8:11], s22 offen offset:3072 lds
    v_mfma_f32_16x16x32_bf16 v[160:163], v[60:63], a[152:155], v[160:163]
    ds_read_b128 v[24:27], v3 offset:20480
    v_mfma_f32_16x16x32_bf16 v[164:167], v[40:43], a[116:119], v[164:167]
    s_add_u32 m0, s21, 81920
    s_add_u32 s22, s66, 81920
    v_mfma_f32_16x16x32_bf16 v[164:167], v[44:47], a[124:127], v[164:167]
    ds_read_b128 v[28:31], v3 offset:21504
    v_mfma_f32_16x16x32_bf16 v[164:167], v[48:51], a[132:135], v[164:167]
    buffer_load_dwordx4 v2, s[8:11], s22 offen offset:0 lds
    v_mfma_f32_16x16x32_bf16 v[164:167], v[52:55], a[140:143], v[164:167]
    ds_read_b128 v[32:35], v3 offset:22528
    v_mfma_f32_16x16x32_bf16 v[164:167], v[56:59], a[148:151], v[164:167]
    v_mfma_f32_16x16x32_bf16 v[164:167], v[60:63], a[156:159], v[164:167]
    ds_read_b128 v[36:39], v3 offset:23552
    s_waitcnt vmcnt(42)
    s_waitcnt lgkmcnt(6)
    v_mfma_f32_16x16x32_bf16 v[160:163], v[64:67], a[160:163], v[160:163]
    v_mfma_f32_16x16x32_bf16 v[160:163], v[68:71], a[168:171], v[160:163]
    ds_read_b128 v[40:43], v3 offset:24576
    v_mfma_f32_16x16x32_bf16 v[160:163], v[72:75], a[176:179], v[160:163]
    v_mfma_f32_16x16x32_bf16 v[160:163], v[76:79], a[184:187], v[160:163]
    ds_read_b128 v[44:47], v3 offset:25600
    v_mfma_f32_16x16x32_bf16 v[160:163], v[80:83], a[192:195], v[160:163]
    v_mfma_f32_16x16x32_bf16 v[160:163], v[84:87], a[200:203], v[160:163]
    ds_read_b128 v[48:51], v3 offset:26624
    v_mfma_f32_16x16x32_bf16 v[164:167], v[64:67], a[164:167], v[164:167]
    v_mfma_f32_16x16x32_bf16 v[164:167], v[68:71], a[172:175], v[164:167]
    ds_read_b128 v[52:55], v3 offset:27648
    v_mfma_f32_16x16x32_bf16 v[164:167], v[72:75], a[180:183], v[164:167]
    v_mfma_f32_16x16x32_bf16 v[164:167], v[76:79], a[188:191], v[164:167]
    ds_read_b128 v[56:59], v3 offset:28672
    v_mfma_f32_16x16x32_bf16 v[164:167], v[80:83], a[196:199], v[164:167]
    v_mfma_f32_16x16x32_bf16 v[164:167], v[84:87], a[204:207], v[164:167]
    ds_read_b128 v[60:63], v3 offset:29696
    s_waitcnt lgkmcnt(6)
    v_mfma_f32_16x16x32_bf16 v[168:171], v[16:19], a[64:67], 0
    v_mfma_f32_16x16x32_bf16 v[168:171], v[20:23], a[72:75], v[168:171]
    ds_read_b128 v[64:67], v3 offset:30720
    v_mfma_f32_16x16x32_bf16 v[168:171], v[24:27], a[80:83], v[168:171]
    v_mfma_f32_16x16x32_bf16 v[168:171], v[28:31], a[88:91], v[168:171]
    ds_read_b128 v[68:71], v3 offset:31744
    v_mfma_f32_16x16x32_bf16 v[168:171], v[32:35], a[96:99], v[168:171]
    v_mfma_f32_16x16x32_bf16 v[168:171], v[36:39], a[104:107], v[168:171]
    ds_read_b128 v[72:75], v3 offset:32768
    v_mfma_f32_16x16x32_bf16 v[172:175], v[16:19], a[68:71], 0
    v_mfma_f32_16x16x32_bf16 v[172:175], v[20:23], a[76:79], v[172:175]
    ds_read_b128 v[76:79], v3 offset:33792
    v_mfma_f32_16x16x32_bf16 v[172:175], v[24:27], a[84:87], v[172:175]
    v_mfma_f32_16x16x32_bf16 v[172:175], v[28:31], a[92:95], v[172:175]
    ds_read_b128 v[80:83], v3 offset:34816
    v_mfma_f32_16x16x32_bf16 v[172:175], v[32:35], a[100:103], v[172:175]
    v_mfma_f32_16x16x32_bf16 v[172:175], v[36:39], a[108:111], v[172:175]
    ds_read_b128 v[84:87], v3 offset:35840
    s_waitcnt lgkmcnt(6)
    v_mfma_f32_16x16x32_bf16 v[168:171], v[40:43], a[112:115], v[168:171]
    s_waitcnt vmcnt(9)
    s_cmp_eq_u32 s54, 3
    s_cbranch_scc1 kmain_kernel_pb_fi
    v_lshrrev_b32 v190, 2, v1
    v_and_b32 v190, 3, v190
    v_and_b32 v191, 3, v1
    v_lshrrev_b32 v192, 4, v1
    s_cmp_eq_u32 s54, 1
    s_cbranch_scc1 kmain_kernel_pb_fn
    s_cmp_eq_u32 s54, 2
    s_cbranch_scc1 kmain_kernel_pb_fk
    v_lshl_add_u32 v193, v192, 3, v190
    v_lshlrev_b32 v193, 7, v193
    v_lshl_add_u32 v193, v191, 4, v193
    v_add_u32 v193, s75, v193
    ds_read_b64_tr_b16 v[196:197], v193 offset:0
    ds_read_b64_tr_b16 v[198:199], v193 offset:512
    ds_read_b64_tr_b16 v[200:201], v193 offset:4096
    ds_read_b64_tr_b16 v[202:203], v193 offset:4608
    ds_read_b64_tr_b16 v[204:205], v193 offset:8
    ds_read_b64_tr_b16 v[206:207], v193 offset:520
    ds_read_b64_tr_b16 v[208:209], v193 offset:4104
    ds_read_b64_tr_b16 v[210:211], v193 offset:4616
    ds_read_b64_tr_b16 v[212:213], v193 offset:64
    ds_read_b64_tr_b16 v[214:215], v193 offset:576
    ds_read_b64_tr_b16 v[216:217], v193 offset:4160
    ds_read_b64_tr_b16 v[218:219], v193 offset:4672
    ds_read_b64_tr_b16 v[220:221], v193 offset:72
    ds_read_b64_tr_b16 v[222:223], v193 offset:584
    ds_read_b64_tr_b16 v[224:225], v193 offset:4168
    ds_read_b64_tr_b16 v[226:227], v193 offset:4680
    s_mov_b32 s57, s55
    s_waitcnt lgkmcnt(0)
    buffer_store_dwordx4 v[196:199], v2, s[8:11], s57 offen offset:0 sc1
    buffer_store_dwordx4 v[200:203], v2, s[8:11], s57 offen offset:1024 sc1
    s_add_u32 s57, s57, 18432
    buffer_store_dwordx4 v[204:207], v2, s[8:11], s57 offen offset:0 sc1
    buffer_store_dwordx4 v[208:211], v2, s[8:11], s57 offen offset:1024 sc1
    s_add_u32 s57, s57, 18432
    buffer_store_dwordx4 v[212:215], v2, s[8:11], s57 offen offset:0 sc1
    buffer_store_dwordx4 v[216:219], v2, s[8:11], s57 offen offset:1024 sc1
    s_add_u32 s57, s57, 18432
    buffer_store_dwordx4 v[220:223], v2, s[8:11], s57 offen offset:0 sc1
    buffer_store_dwordx4 v[224:227], v2, s[8:11], s57 offen offset:1024 sc1
    s_branch kmain_kernel_pb_fe
kmain_kernel_pb_fn:
    v_lshl_add_u32 v193, v192, 3, v190
    v_lshlrev_b32 v193, 7, v193
    v_lshl_add_u32 v193, v191, 3, v193
    v_add_u32 v193, s75, v193
    ds_read_b64_tr_b16 v[196:197], v193 offset:0
    ds_read_b64_tr_b16 v[198:199], v193 offset:512
    ds_read_b64_tr_b16 v[200:201], v193 offset:4096
    ds_read_b64_tr_b16 v[202:203], v193 offset:4608
    ds_read_b64_tr_b16 v[204:205], v193 offset:32
    ds_read_b64_tr_b16 v[206:207], v193 offset:544
    ds_read_b64_tr_b16 v[208:209], v193 offset:4128
    ds_read_b64_tr_b16 v[210:211], v193 offset:4640
    ds_read_b64_tr_b16 v[212:213], v193 offset:64
    ds_read_b64_tr_b16 v[214:215], v193 offset:576
    ds_read_b64_tr_b16 v[216:217], v193 offset:4160
    ds_read_b64_tr_b16 v[218:219], v193 offset:4672
    ds_read_b64_tr_b16 v[220:221], v193 offset:96
    ds_read_b64_tr_b16 v[222:223], v193 offset:608
    ds_read_b64_tr_b16 v[224:225], v193 offset:4192
    ds_read_b64_tr_b16 v[226:227], v193 offset:4704
    s_mov_b32 s57, s55
    s_waitcnt lgkmcnt(0)
    buffer_store_dwordx4 v[196:199], v2, s[8:11], s57 offen offset:0 sc1
    buffer_store_dwordx4 v[200:203], v2, s[8:11], s57 offen offset:1024 sc1
    s_add_u32 s57, s57, s56
    buffer_store_dwordx4 v[204:207], v2, s[8:11], s57 offen offset:0 sc1
    buffer_store_dwordx4 v[208:211], v2, s[8:11], s57 offen offset:1024 sc1
    s_add_u32 s57, s57, s56
    buffer_store_dwordx4 v[212:215], v2, s[8:11], s57 offen offset:0 sc1
    buffer_store_dwordx4 v[216:219], v2, s[8:11], s57 offen offset:1024 sc1
    s_add_u32 s57, s57, s56
    buffer_store_dwordx4 v[220:223], v2, s[8:11], s57 offen offset:0 sc1
    buffer_store_dwordx4 v[224:227], v2, s[8:11], s57 offen offset:1024 sc1
    s_branch kmain_kernel_pb_fe
kmain_kernel_pb_fk:
    v_lshl_add_u32 v193, v192, 2, v190
    v_lshlrev_b32 v193, 7, v193
    v_lshl_add_u32 v193, v191, 3, v193
    v_add_u32 v193, s75, v193
    ds_read_b64_tr_b16 v[196:197], v193 offset:0
    ds_read_b64_tr_b16 v[198:199], v193 offset:2048
    ds_read_b64_tr_b16 v[200:201], v193 offset:4096
    ds_read_b64_tr_b16 v[202:203], v193 offset:6144
    ds_read_b64_tr_b16 v[204:205], v193 offset:32
    ds_read_b64_tr_b16 v[206:207], v193 offset:2080
    ds_read_b64_tr_b16 v[208:209], v193 offset:4128
    ds_read_b64_tr_b16 v[210:211], v193 offset:6176
    ds_read_b64_tr_b16 v[212:213], v193 offset:64
    ds_read_b64_tr_b16 v[214:215], v193 offset:2112
    ds_read_b64_tr_b16 v[216:217], v193 offset:4160
    ds_read_b64_tr_b16 v[218:219], v193 offset:6208
    ds_read_b64_tr_b16 v[220:221], v193 offset:96
    ds_read_b64_tr_b16 v[222:223], v193 offset:2144
    ds_read_b64_tr_b16 v[224:225], v193 offset:4192
    ds_read_b64_tr_b16 v[226:227], v193 offset:6240
    s_mov_b32 s57, s55
    s_waitcnt lgkmcnt(0)
    buffer_store_dwordx4 v[196:199], v2, s[8:11], s57 offen offset:0 sc1
    buffer_store_dwordx4 v[200:203], v2, s[8:11], s57 offen offset:1024 sc1
    s_add_u32 s57, s57, s56
    buffer_store_dwordx4 v[204:207], v2, s[8:11], s57 offen offset:0 sc1
    buffer_store_dwordx4 v[208:211], v2, s[8:11], s57 offen offset:1024 sc1
    s_add_u32 s57, s57, s56
    buffer_store_dwordx4 v[212:215], v2, s[8:11], s57 offen offset:0 sc1
    buffer_store_dwordx4 v[216:219], v2, s[8:11], s57 offen offset:1024 sc1
    s_add_u32 s57, s57, s56
    buffer_store_dwordx4 v[220:223], v2, s[8:11], s57 offen offset:0 sc1
    buffer_store_dwordx4 v[224:227], v2, s[8:11], s57 offen offset:1024 sc1
    s_branch kmain_kernel_pb_fe
kmain_kernel_pb_fi:
    s_mov_b32 s57, 0x7f000000
    buffer_store_dwordx4 v[196:199], v2, s[8:11], s57 offen
    buffer_store_dwordx4 v[196:199], v2, s[8:11], s57 offen
    buffer_store_dwordx4 v[196:199], v2, s[8:11], s57 offen
    buffer_store_dwordx4 v[196:199], v2, s[8:11], s57 offen
    buffer_store_dwordx4 v[196:199], v2, s[8:11], s57 offen
    buffer_store_dwordx4 v[196:199], v2, s[8:11], s57 offen
    buffer_store_dwordx4 v[196:199], v2, s[8:11], s57 offen
    buffer_store_dwordx4 v[196:199], v2, s[8:11], s57 offen
kmain_kernel_pb_fe:
    s_waitcnt vmcnt(41)
    s_barrier
    v_mfma_f32_16x16x32_bf16 v[168:171], v[44:47], a[120:123], v[168:171]
    ds_read_b128 v[16:19], v4 offset:0
    v_mfma_f32_16x16x32_bf16 v[168:171], v[48:51], a[128:131], v[168:171]
    s_add_u32 m0, s21, 110592
    v_mfma_f32_16x16x32_bf16 v[168:171], v[52:55], a[136:139], v[168:171]
    ds_read_b128 v[20:23], v4 offset:1024
    v_mfma_f32_16x16x32_bf16 v[168:171], v[56:59], a[144:147], v[168:171]
    s_add_u32 s22, s66, 110592
    v_mfma_f32_16x16x32_bf16 v[168:171], v[60:63], a[152:155], v[168:171]
    ds_read_b128 v[24:27], v4 offset:2048
    v_mfma_f32_16x16x32_bf16 v[172:175], v[40:43], a[116:119], v[172:175]
    v_mfma_f32_16x16x32_bf16 v[172:175], v[44:47], a[124:127], v[172:175]
    ds_read_b128 v[28:31], v4 offset:3072
    v_mfma_f32_16x16x32_bf16 v[172:175], v[48:51], a[132:135], v[172:175]
    buffer_load_dwordx4 v2, s[8:11], s22 offen offset:0 lds
    v_mfma_f32_16x16x32_bf16 v[172:175], v[52:55], a[140:143], v[172:175]
    ds_read_b128 v[32:35], v4 offset:4096
    v_mfma_f32_16x16x32_bf16 v[172:175], v[56:59], a[148:151], v[172:175]
    buffer_load_dwordx4 v2, s[8:11], s22 offen offset:1024 lds
    v_mfma_f32_16x16x32_bf16 v[172:175], v[60:63], a[156:159], v[172:175]
    ds_read_b128 v[36:39], v4 offset:5120
    s_waitcnt lgkmcnt(6)
    v_mfma_f32_16x16x32_bf16 v[168:171], v[64:67], a[160:163], v[168:171]
    v_mfma_f32_16x16x32_bf16 v[168:171], v[68:71], a[168:171], v[168:171]
    ds_read_b128 v[40:43], v4 offset:6144
    v_mfma_f32_16x16x32_bf16 v[168:171], v[72:75], a[176:179], v[168:171]
    buffer_load_dwordx4 v2, s[8:11], s22 offen offset:2048 lds
    v_mfma_f32_16x16x32_bf16 v[168:171], v[76:79], a[184:187], v[168:171]
    ds_read_b128 v[44:47], v4 offset:7168
    v_mfma_f32_16x16x32_bf16 v[168:171], v[80:83], a[192:195], v[168:171]
    buffer_load_dwordx4 v2, s[8:11], s22 offen offset:3072 lds
    v_mfma_f32_16x16x32_bf16 v[168:171], v[84:87], a[200:203], v[168:171]
    ds_read_b128 v[48:51], v4 offset:8192
    v_mfma_f32_16x16x32_bf16 v[172:175], v[64:67], a[164:167], v[172:175]
    v_mfma_f32_16x16x32_bf16 v[172:175], v[68:71], a[172:175], v[172:175]
    ds_read_b128 v[52:55], v4 offset:9216
    v_mfma_f32_16x16x32_bf16 v[172:175], v[72:75], a[180:183], v[172:175]
    s_add_u32 m0, s21, 114688
    v_mfma_f32_16x16x32_bf16 v[172:175], v[76:79], a[188:191], v[172:175]
    ds_read_b128 v[56:59], v4 offset:10240
    v_mfma_f32_16x16x32_bf16 v[172:175], v[80:83], a[196:199], v[172:175]
    s_add_u32 s22, s66, 114688
    v_mfma_f32_16x16x32_bf16 v[172:175], v[84:87], a[204:207], v[172:175]
    ds_read_b128 v[60:63], v4 offset:11264
    s_waitcnt lgkmcnt(6)
    v_mfma_f32_16x16x32_bf16 v[176:179], v[16:19], a[64:67], 0
    buffer_load_dwordx4 v2, s[8:11], s22 offen offset:0 lds
    v_mfma_f32_16x16x32_bf16 v[176:179], v[20:23], a[72:75], v[176:179]
    ds_read_b128 v[64:67], v4 offset:12288
    s_add_u32 s23, s19, 0
    s_add_u32 s18, s19, 147456
    v_mfma_f32_16x16x32_bf16 v[176:179], v[24:27], a[80:83], v[176:179]
    v_fmaak_f32 v248, v160, v160, 0x409d30fc
    v_fmaak_f32 v249, v161, v161, 0x409d30fc
    v_fmaak_f32 v250, v162, v162, 0x409d30fc
    v_mfma_f32_16x16x32_bf16 v[176:179], v[28:31], a[88:91], v[176:179]
    ds_read_b128 v[68:71], v4 offset:13312
    v_fmaak_f32 v251, v163, v163, 0x409d30fc
    v_mul_f32 v248, v248, v160
    v_mfma_f32_16x16x32_bf16 v[176:179], v[32:35], a[96:99], v[176:179]
    buffer_load_dwordx4 v2, s[8:11], s22 offen offset:1024 lds
    v_mul_f32 v249, v249, v161
    v_mfma_f32_16x16x32_bf16 v[176:179], v[36:39], a[104:107], v[176:179]
    ds_read_b128 v[72:75], v4 offset:14336
    v_mul_f32 v250, v250, v162
    v_mul_f32 v251, v251, v163
    v_mfma_f32_16x16x32_bf16 v[180:183], v[16:19], a[68:71], 0
    v_exp_f32 v248, v248
    v_mfma_f32_16x16x32_bf16 v[180:183], v[20:23], a[76:79], v[180:183]
    ds_read_b128 v[76:79], v4 offset:15360
    v_exp_f32 v249, v249
    v_mfma_f32_16x16x32_bf16 v[180:183], v[24:27], a[84:87], v[180:183]
    buffer_load_dwordx4 v2, s[8:11], s22 offen offset:2048 lds
    v_exp_f32 v250, v250
    v_mfma_f32_16x16x32_bf16 v[180:183], v[28:31], a[92:95], v[180:183]
    ds_read_b128 v[80:83], v4 offset:16384
    v_exp_f32 v251, v251
    v_mfma_f32_16x16x32_bf16 v[180:183], v[32:35], a[100:103], v[180:183]
    v_fma_f32 v248, v248, v255, v255
    v_fma_f32 v249, v249, v255, v255
    v_fma_f32 v250, v250, v255, v255
    v_mfma_f32_16x16x32_bf16 v[180:183], v[36:39], a[108:111], v[180:183]
    ds_read_b128 v[84:87], v4 offset:17408
    v_fma_f32 v251, v251, v255, v255
    s_waitcnt lgkmcnt(6)
    v_mfma_f32_16x16x32_bf16 v[176:179], v[40:43], a[112:115], v[176:179]
    buffer_load_dwordx4 v2, s[8:11], s22 offen offset:3072 lds
    v_rcp_f32 v248, v248
    v_mfma_f32_16x16x32_bf16 v[176:179], v[44:47], a[120:123], v[176:179]
    ds_read_b128 v[16:19], v4 offset:18432
    v_rcp_f32 v249, v249
    v_mfma_f32_16x16x32_bf16 v[176:179], v[48:51], a[128:131], v[176:179]
    s_add_u32 m0, s21, 118784
    v_mfma_f32_16x16x32_bf16 v[176:179], v[52:55], a[136:139], v[176:179]
    ds_read_b128 v[20:23], v4 offset:19456
    v_rcp_f32 v250, v250
    v_mfma_f32_16x16x32_bf16 v[176:179], v[56:59], a[144:147], v[176:179]
    s_add_u32 s22, s66, 118784
    v_rcp_f32 v251, v251
    v_mul_f32 v248, v248, v160
    v_mfma_f32_16x16x32_bf16 v[176:179], v[60:63], a[152:155], v[176:179]
    ds_read_b128 v[24:27], v4 offset:20480
    v_mul_f32 v249, v249, v161
    v_mul_f32 v250, v250, v162
    v_mfma_f32_16x16x32_bf16 v[180:183], v[40:43], a[116:119], v[180:183]
    v_mul_f32 v251, v251, v163
    v_cvt_pk_bf16_f32 v240, v248, v249
    v_mfma_f32_16x16x32_bf16 v[180:183], v[44:47], a[124:127], v[180:183]
    ds_read_b128 v[28:31], v4 offset:21504
    v_cvt_pk_bf16_f32 v241, v250, v251
    v_fmaak_f32 v248, v168, v168, 0x409d30fc
    v_mfma_f32_16x16x32_bf16 v[180:183], v[48:51], a[132:135], v[180:183]
    buffer_load_dwordx4 v2, s[8:11], s22 offen offset:0 lds
    v_fmaak_f32 v249, v169, v169, 0x409d30fc
    v_fmaak_f32 v250, v170, v170, 0x409d30fc
    v_mfma_f32_16x16x32_bf16 v[180:183], v[52:55], a[140:143], v[180:183]
    ds_read_b128 v[32:35], v4 offset:22528
    v_fmaak_f32 v251, v171, v171, 0x409d30fc
    v_mul_f32 v248, v248, v168
    v_mfma_f32_16x16x32_bf16 v[180:183], v[56:59], a[148:151], v[180:183]
    v_mul_f32 v249, v249, v169
    v_mul_f32 v250, v250, v170
    v_mul_f32 v251, v251, v171
    v_mfma_f32_16x16x32_bf16 v[180:183], v[60:63], a[156:159], v[180:183]
    ds_read_b128 v[36:39], v4 offset:23552
    s_waitcnt lgkmcnt(6)
    v_mfma_f32_16x16x32_bf16 v[176:179], v[64:67], a[160:163], v[176:179]
    v_exp_f32 v248, v248
    v_exp_f32 v249, v249
    v_mfma_f32_16x16x32_bf16 v[176:179], v[68:71], a[168:171], v[176:179]
    ds_read_b128 v[40:43], v4 offset:24576
    v_exp_f32 v250, v250
    v_mfma_f32_16x16x32_bf16 v[176:179], v[72:75], a[176:179], v[176:179]
    v_exp_f32 v251, v251
    v_mfma_f32_16x16x32_bf16 v[176:179], v[76:79], a[184:187], v[176:179]
    ds_read_b128 v[44:47], v4 offset:25600
    v_fma_f32 v248, v248, v255, v255
    v_fma_f32 v249, v249, v255, v255
    v_mfma_f32_16x16x32_bf16 v[176:179], v[80:83], a[192:195], v[176:179]
    v_fma_f32 v250, v250, v255, v255
    v_fma_f32 v251, v251, v255, v255
    v_mfma_f32_16x16x32_bf16 v[176:179], v[84:87], a[200:203], v[176:179]
    ds_read_b128 v[48:51], v4 offset:26624
    v_rcp_f32 v248, v248
    v_mfma_f32_16x16x32_bf16 v[180:183], v[64:67], a[164:167], v[180:183]
    v_rcp_f32 v249, v249
    v_rcp_f32 v250, v250
    v_mfma_f32_16x16x32_bf16 v[180:183], v[68:71], a[172:175], v[180:183]
    ds_read_b128 v[52:55], v4 offset:27648
    v_rcp_f32 v251, v251
    v_mfma_f32_16x16x32_bf16 v[180:183], v[72:75], a[180:183], v[180:183]
    v_mul_f32 v248, v248, v168
    v_mul_f32 v249, v249, v169
    v_mfma_f32_16x16x32_bf16 v[180:183], v[76:79], a[188:191], v[180:183]
    ds_read_b128 v[56:59], v4 offset:28672
    v_mul_f32 v250, v250, v170
    v_mul_f32 v251, v251, v171
    v_mfma_f32_16x16x32_bf16 v[180:183], v[80:83], a[196:199], v[180:183]
    v_cvt_pk_bf16_f32 v242, v248, v249
    v_cvt_pk_bf16_f32 v243, v250, v251
    v_mfma_f32_16x16x32_bf16 v[180:183], v[84:87], a[204:207], v[180:183]
    ds_read_b128 v[60:63], v4 offset:29696
    buffer_store_dwordx4 v[240:243], v2, s[8:11], s23 offen sc1
    s_waitcnt lgkmcnt(6)
    v_mfma_f32_16x16x32_bf16 v[184:187], v[16:19], a[64:67], 0
    v_fmaak_f32 v248, v164, v164, 0x409d30fc
    v_fmaak_f32 v249, v165, v165, 0x409d30fc
    v_mfma_f32_16x16x32_bf16 v[184:187], v[20:23], a[72:75], v[184:187]
    ds_read_b128 v[64:67], v4 offset:30720
    v_fmaak_f32 v250, v166, v166, 0x409d30fc
    v_fmaak_f32 v251, v167, v167, 0x409d30fc
    v_mfma_f32_16x16x32_bf16 v[184:187], v[24:27], a[80:83], v[184:187]
    v_mul_f32 v248, v248, v164
    v_mul_f32 v249, v249, v165
    v_mul_f32 v250, v250, v166
    v_mfma_f32_16x16x32_bf16 v[184:187], v[28:31], a[88:91], v[184:187]
    ds_read_b128 v[68:71], v4 offset:31744
    v_mul_f32 v251, v251, v167
    v_mfma_f32_16x16x32_bf16 v[184:187], v[32:35], a[96:99], v[184:187]
    v_exp_f32 v248, v248
    v_exp_f32 v249, v249
    v_mfma_f32_16x16x32_bf16 v[184:187], v[36:39], a[104:107], v[184:187]
    ds_read_b128 v[72:75], v4 offset:32768
    v_exp_f32 v250, v250
    v_mfma_f32_16x16x32_bf16 v[188:191], v[16:19], a[68:71], 0
    v_exp_f32 v251, v251
    v_mfma_f32_16x16x32_bf16 v[188:191], v[20:23], a[76:79], v[188:191]
    ds_read_b128 v[76:79], v4 offset:33792
    v_fma_f32 v248, v248, v255, v255
    v_fma_f32 v249, v249, v255, v255
    v_mfma_f32_16x16x32_bf16 v[188:191], v[24:27], a[84:87], v[188:191]
    v_fma_f32 v250, v250, v255, v255
    v_fma_f32 v251, v251, v255, v255
    v_rcp_f32 v248, v248
    v_mfma_f32_16x16x32_bf16 v[188:191], v[28:31], a[92:95], v[188:191]
    ds_read_b128 v[80:83], v4 offset:34816
    v_mfma_f32_16x16x32_bf16 v[188:191], v[32:35], a[100:103], v[188:191]
    v_rcp_f32 v249, v249
    v_rcp_f32 v250, v250
    v_mfma_f32_16x16x32_bf16 v[188:191], v[36:39], a[108:111], v[188:191]
    ds_read_b128 v[84:87], v4 offset:35840
    s_waitcnt lgkmcnt(6)
    v_mfma_f32_16x16x32_bf16 v[184:187], v[40:43], a[112:115], v[184:187]
    s_waitcnt vmcnt(18)
    s_barrier
    s_cmp_lg_u32 s3, 0
    s_cbranch_scc1 kmain_kernel_sgo_8
    v_mov_b32 v228, 1
    v_mov_b32 v229, 0
    v_cmp_eq_u32 vcc, 0, v1
    s_nop 3
    s_and_saveexec_b64 s[50:51], vcc
    buffer_atomic_add v228, v229, s[8:11], s44 offen
    s_mov_b64 exec, s[50:51]
kmain_kernel_sgo_8:
    v_rcp_f32 v251, v251
    v_mfma_f32_16x16x32_bf16 v[184:187], v[44:47], a[120:123], v[184:187]
    ds_read_b128 v[16:19], v5 offset:0
    v_mul_f32 v248, v248, v164
    v_mfma_f32_16x16x32_bf16 v[184:187], v[48:51], a[128:131], v[184:187]
    s_add_u32 m0, s21, 0
    v_mul_f32 v249, v249, v165
    v_mul_f32 v250, v250, v166
    v_mfma_f32_16x16x32_bf16 v[184:187], v[52:55], a[136:139], v[184:187]
    ds_read_b128 v[20:23], v5 offset:1024
    v_mul_f32 v251, v251, v167
    v_cvt_pk_bf16_f32 v244, v248, v249
    v_mfma_f32_16x16x32_bf16 v[184:187], v[56:59], a[144:147], v[184:187]
    s_add_u32 s22, s66, 147456
    v_cvt_pk_bf16_f32 v245, v250, v251
    v_fmaak_f32 v248, v172, v172, 0x409d30fc
    v_mfma_f32_16x16x32_bf16 v[184:187], v[60:63], a[152:155], v[184:187]
    ds_read_b128 v[24:27], v5 offset:2048
    v_fmaak_f32 v249, v173, v173, 0x409d30fc
    v_fmaak_f32 v250, v174, v174, 0x409d30fc
    v_mfma_f32_16x16x32_bf16 v[188:191], v[40:43], a[116:119], v[188:191]
    v_fmaak_f32 v251, v175, v175, 0x409d30fc
    v_mul_f32 v248, v248, v172
    v_mul_f32 v249, v249, v173
    v_mfma_f32_16x16x32_bf16 v[188:191], v[44:47], a[124:127], v[188:191]
    ds_read_b128 v[28:31], v5 offset:3072
    v_mul_f32 v250, v250, v174
    v_mul_f32 v251, v251, v175
    v_mfma_f32_16x16x32_bf16 v[188:191], v[48:51], a[132:135], v[188:191]
    buffer_load_dwordx4 v2, s[8:11], s22 offen offset:0 lds
    v_exp_f32 v248, v248
    v_mfma_f32_16x16x32_bf16 v[188:191], v[52:55], a[140:143], v[188:191]
    ds_read_b128 v[32:35], v5 offset:4096
    v_exp_f32 v249, v249
    v_mfma_f32_16x16x32_bf16 v[188:191], v[56:59], a[148:151], v[188:191]
    buffer_load_dwordx4 v2, s[8:11], s22 offen offset:1024 lds
    v_mfma_f32_16x16x32_bf16 v[188:191], v[60:63], a[156:159], v[188:191]
    ds_read_b128 v[36:39], v5 offset:5120
    v_exp_f32 v250, v250
    s_waitcnt lgkmcnt(6)
    v_mfma_f32_16x16x32_bf16 v[184:187], v[64:67], a[160:163], v[184:187]
    v_exp_f32 v251, v251
    v_mfma_f32_16x16x32_bf16 v[184:187], v[68:71], a[168:171], v[184:187]
    ds_read_b128 v[40:43], v5 offset:6144
    v_fma_f32 v248, v248, v255, v255
    v_fma_f32 v249, v249, v255, v255
    v_mfma_f32_16x16x32_bf16 v[184:187], v[72:75], a[176:179], v[184:187]
    buffer_load_dwordx4 v2, s[8:11], s22 offen offset:2048 lds
    v_fma_f32 v250, v250, v255, v255
    v_fma_f32 v251, v251, v255, v255
    v_mfma_f32_16x16x32_bf16 v[184:187], v[76:79], a[184:187], v[184:187]
    ds_read_b128 v[44:47], v5 offset:7168
    v_rcp_f32 v248, v248
    v_mfma_f32_16x16x32_bf16 v[184:187], v[80:83], a[192:195], v[184:187]
    buffer_load_dwordx4 v2, s[8:11], s22 offen offset:3072 lds
    v_mfma_f32_16x16x32_bf16 v[184:187], v[84:87], a[200:203], v[184:187]
    ds_read_b128 v[48:51], v5 offset:8192
    v_rcp_f32 v249, v249
    v_mfma_f32_16x16x32_bf16 v[188:191], v[64:67], a[164:167], v[188:191]
    v_rcp_f32 v250, v250
    v_rcp_f32 v251, v251
    v_mfma_f32_16x16x32_bf16 v[188:191], v[68:71], a[172:175], v[188:191]
    ds_read_b128 v[52:55], v5 offset:9216
    v_mul_f32 v248, v248, v172
    v_mfma_f32_16x16x32_bf16 v[188:191], v[72:75], a[180:183], v[188:191]
    s_add_u32 m0, s21, 4096
    v_mul_f32 v249, v249, v173
    v_mul_f32 v250, v250, v174
    v_mfma_f32_16x16x32_bf16 v[188:191], v[76:79], a[188:191], v[188:191]
    ds_read_b128 v[56:59], v5 offset:10240
    v_mul_f32 v251, v251, v175
    v_cvt_pk_bf16_f32 v246, v248, v249
    v_mfma_f32_16x16x32_bf16 v[188:191], v[80:83], a[196:199], v[188:191]
    s_add_u32 s22, s66, 151552
    v_cvt_pk_bf16_f32 v247, v250, v251
    v_mfma_f32_16x16x32_bf16 v[188:191], v[84:87], a[204:207], v[188:191]
    ds_read_b128 v[60:63], v5 offset:11264
    buffer_store_dwordx4 v[244:247], v2, s[8:11], s18 offen sc1
    s_waitcnt lgkmcnt(6)
    v_mfma_f32_16x16x32_bf16 v[160:163], v[16:19], a[64:67], 0
    buffer_load_dwordx4 v2, s[8:11], s22 offen offset:0 lds
    v_mfma_f32_16x16x32_bf16 v[160:163], v[20:23], a[72:75], v[160:163]
    ds_read_b128 v[64:67], v5 offset:12288
    s_add_u32 s23, s19, 1024
    s_add_u32 s18, s19, 148480
    v_mfma_f32_16x16x32_bf16 v[160:163], v[24:27], a[80:83], v[160:163]
    v_fmaak_f32 v248, v176, v176, 0x409d30fc
    v_fmaak_f32 v249, v177, v177, 0x409d30fc
    v_fmaak_f32 v250, v178, v178, 0x409d30fc
    v_mfma_f32_16x16x32_bf16 v[160:163], v[28:31], a[88:91], v[160:163]
    ds_read_b128 v[68:71], v5 offset:13312
    v_fmaak_f32 v251, v179, v179, 0x409d30fc
    v_mul_f32 v248, v248, v176
    v_mfma_f32_16x16x32_bf16 v[160:163], v[32:35], a[96:99], v[160:163]
    buffer_load_dwordx4 v2, s[8:11], s22 offen offset:1024 lds
    v_mul_f32 v249, v249, v177
    v_mfma_f32_16x16x32_bf16 v[160:163], v[36:39], a[104:107], v[160:163]
    ds_read_b128 v[72:75], v5 offset:14336
    v_mul_f32 v250, v250, v178
    v_mul_f32 v251, v251, v179
    v_mfma_f32_16x16x32_bf16 v[164:167], v[16:19], a[68:71], 0
    v_exp_f32 v248, v248
    v_mfma_f32_16x16x32_bf16 v[164:167], v[20:23], a[76:79], v[164:167]
    ds_read_b128 v[76:79], v5 offset:15360
    v_exp_f32 v249, v249
    v_mfma_f32_16x16x32_bf16 v[164:167], v[24:27], a[84:87], v[164:167]
    buffer_load_dwordx4 v2, s[8:11], s22 offen offset:2048 lds
    v_exp_f32 v250, v250
    v_mfma_f32_16x16x32_bf16 v[164:167], v[28:31], a[92:95], v[164:167]
    ds_read_b128 v[80:83], v5 offset:16384
    v_exp_f32 v251, v251
    v_mfma_f32_16x16x32_bf16 v[164:167], v[32:35], a[100:103], v[164:167]
    v_fma_f32 v248, v248, v255, v255
    v_fma_f32 v249, v249, v255, v255
    v_fma_f32 v250, v250, v255, v255
    v_mfma_f32_16x16x32_bf16 v[164:167], v[36:39], a[108:111], v[164:167]
    ds_read_b128 v[84:87], v5 offset:17408
    v_fma_f32 v251, v251, v255, v255
    s_waitcnt lgkmcnt(6)
    v_mfma_f32_16x16x32_bf16 v[160:163], v[40:43], a[112:115], v[160:163]
    buffer_load_dwordx4 v2, s[8:11], s22 offen offset:3072 lds
    v_rcp_f32 v248, v248
    v_mfma_f32_16x16x32_bf16 v[160:163], v[44:47], a[120:123], v[160:163]
    ds_read_b128 v[16:19], v5 offset:18432
    v_rcp_f32 v249, v249
    v_mfma_f32_16x16x32_bf16 v[160:163], v[48:51], a[128:131], v[160:163]
    s_add_u32 m0, s21, 8192
    v_mfma_f32_16x16x32_bf16 v[160:163], v[52:55], a[136:139], v[160:163]
    ds_read_b128 v[20:23], v5 offset:19456
    v_rcp_f32 v250, v250
    v_mfma_f32_16x16x32_bf16 v[160:163], v[56:59], a[144:147], v[160:163]
    s_add_u32 s22, s66, 155648
    v_rcp_f32 v251, v251
    v_mul_f32 v248, v248, v176
    v_mfma_f32_16x16x32_bf16 v[160:163], v[60:63], a[152:155], v[160:163]
    ds_read_b128 v[24:27], v5 offset:20480
    v_mul_f32 v249, v249, v177
    v_mul_f32 v250, v250, v178
    v_mfma_f32_16x16x32_bf16 v[164:167], v[40:43], a[116:119], v[164:167]
    v_mul_f32 v251, v251, v179
    v_cvt_pk_bf16_f32 v232, v248, v249
    v_mfma_f32_16x16x32_bf16 v[164:167], v[44:47], a[124:127], v[164:167]
    ds_read_b128 v[28:31], v5 offset:21504
    v_cvt_pk_bf16_f32 v233, v250, v251
    v_fmaak_f32 v248, v184, v184, 0x409d30fc
    v_mfma_f32_16x16x32_bf16 v[164:167], v[48:51], a[132:135], v[164:167]
    buffer_load_dwordx4 v2, s[8:11], s22 offen offset:0 lds
    v_fmaak_f32 v249, v185, v185, 0x409d30fc
    v_fmaak_f32 v250, v186, v186, 0x409d30fc
    v_mfma_f32_16x16x32_bf16 v[164:167], v[52:55], a[140:143], v[164:167]
    ds_read_b128 v[32:35], v5 offset:22528
    v_fmaak_f32 v251, v187, v187, 0x409d30fc
    v_mul_f32 v248, v248, v184
    v_mfma_f32_16x16x32_bf16 v[164:167], v[56:59], a[148:151], v[164:167]
    v_mul_f32 v249, v249, v185
    v_mul_f32 v250, v250, v186
    v_mul_f32 v251, v251, v187
    v_mfma_f32_16x16x32_bf16 v[164:167], v[60:63], a[156:159], v[164:167]
    ds_read_b128 v[36:39], v5 offset:23552
    s_waitcnt lgkmcnt(6)
    v_mfma_f32_16x16x32_bf16 v[160:163], v[64:67], a[160:163], v[160:163]
    v_exp_f32 v248, v248
    v_exp_f32 v249, v249
    v_mfma_f32_16x16x32_bf16 v[160:163], v[68:71], a[168:171], v[160:163]
    ds_read_b128 v[40:43], v5 offset:24576
    v_exp_f32 v250, v250
    v_mfma_f32_16x16x32_bf16 v[160:163], v[72:75], a[176:179], v[160:163]
    v_exp_f32 v251, v251
    v_mfma_f32_16x16x32_bf16 v[160:163], v[76:79], a[184:187], v[160:163]
    ds_read_b128 v[44:47], v5 offset:25600
    v_fma_f32 v248, v248, v255, v255
    v_fma_f32 v249, v249, v255, v255
    v_mfma_f32_16x16x32_bf16 v[160:163], v[80:83], a[192:195], v[160:163]
    v_fma_f32 v250, v250, v255, v255
    v_fma_f32 v251, v251, v255, v255
    v_mfma_f32_16x16x32_bf16 v[160:163], v[84:87], a[200:203], v[160:163]
    ds_read_b128 v[48:51], v5 offset:26624
    v_rcp_f32 v248, v248
    v_mfma_f32_16x16x32_bf16 v[164:167], v[64:67], a[164:167], v[164:167]
    v_rcp_f32 v249, v249
    v_rcp_f32 v250, v250
    v_mfma_f32_16x16x32_bf16 v[164:167], v[68:71], a[172:175], v[164:167]
    ds_read_b128 v[52:55], v5 offset:27648
    v_rcp_f32 v251, v251
    v_mfma_f32_16x16x32_bf16 v[164:167], v[72:75], a[180:183], v[164:167]
    v_mul_f32 v248, v248, v184
    v_mul_f32 v249, v249, v185
    v_mfma_f32_16x16x32_bf16 v[164:167], v[76:79], a[188:191], v[164:167]
    ds_read_b128 v[56:59], v5 offset:28672
    v_mul_f32 v250, v250, v186
    v_mul_f32 v251, v251, v187
    v_mfma_f32_16x16x32_bf16 v[164:167], v[80:83], a[196:199], v[164:167]
    v_cvt_pk_bf16_f32 v234, v248, v249
    v_cvt_pk_bf16_f32 v235, v250, v251
    v_mfma_f32_16x16x32_bf16 v[164:167], v[84:87], a[204:207], v[164:167]
    ds_read_b128 v[60:63], v5 offset:29696
    buffer_store_dwordx4 v[232:235], v2, s[8:11], s23 offen sc1
    s_waitcnt lgkmcnt(6)
    v_mfma_f32_16x16x32_bf16 v[168:171], v[16:19], a[64:67], 0
    v_fmaak_f32 v248, v180, v180, 0x409d30fc
    v_fmaak_f32 v249, v181, v181, 0x409d30fc
    v_mfma_f32_16x16x32_bf16 v[168:171], v[20:23], a[72:75], v[168:171]
    ds_read_b128 v[64:67], v5 offset:30720
    v_fmaak_f32 v250, v182, v182, 0x409d30fc
    v_fmaak_f32 v251, v183, v183, 0x409d30fc
    v_mfma_f32_16x16x32_bf16 v[168:171], v[24:27], a[80:83], v[168:171]
    v_mul_f32 v248, v248, v180
    v_mul_f32 v249, v249, v181
    v_mul_f32 v250, v250, v182
    v_mfma_f32_16x16x32_bf16 v[168:171], v[28:31], a[88:91], v[168:171]
    ds_read_b128 v[68:71], v5 offset:31744
    v_mul_f32 v251, v251, v183
    v_mfma_f32_16x16x32_bf16 v[168:171], v[32:35], a[96:99], v[168:171]
    v_exp_f32 v248, v248
    v_exp_f32 v249, v249
    v_mfma_f32_16x16x32_bf16 v[168:171], v[36:39], a[104:107], v[168:171]
    ds_read_b128 v[72:75], v5 offset:32768
    v_exp_f32 v250, v250
    v_mfma_f32_16x16x32_bf16 v[172:175], v[16:19], a[68:71], 0
    v_exp_f32 v251, v251
    v_mfma_f32_16x16x32_bf16 v[172:175], v[20:23], a[76:79], v[172:175]
    ds_read_b128 v[76:79], v5 offset:33792
    v_fma_f32 v248, v248, v255, v255
    v_fma_f32 v249, v249, v255, v255
    v_mfma_f32_16x16x32_bf16 v[172:175], v[24:27], a[84:87], v[172:175]
    v_fma_f32 v250, v250, v255, v255
    v_fma_f32 v251, v251, v255, v255
    v_rcp_f32 v248, v248
    v_mfma_f32_16x16x32_bf16 v[172:175], v[28:31], a[92:95], v[172:175]
    ds_read_b128 v[80:83], v5 offset:34816
    v_mfma_f32_16x16x32_bf16 v[172:175], v[32:35], a[100:103], v[172:175]
    v_rcp_f32 v249, v249
    v_rcp_f32 v250, v250
    v_mfma_f32_16x16x32_bf16 v[172:175], v[36:39], a[108:111], v[172:175]
    ds_read_b128 v[84:87], v5 offset:35840
    s_waitcnt lgkmcnt(6)
    v_mfma_f32_16x16x32_bf16 v[168:171], v[40:43], a[112:115], v[168:171]
    s_waitcnt vmcnt(12)
    s_barrier
    v_rcp_f32 v251, v251
    v_mfma_f32_16x16x32_bf16 v[168:171], v[44:47], a[120:123], v[168:171]
    ds_read_b128 v[16:19], v6 offset:0
    v_mul_f32 v248, v248, v180
    v_mfma_f32_16x16x32_bf16 v[168:171], v[48:51], a[128:131], v[168:171]
    s_add_u32 m0, s21, 36864
    v_mul_f32 v249, v249, v181
    v_mul_f32 v250, v250, v182
    v_mfma_f32_16x16x32_bf16 v[168:171], v[52:55], a[136:139], v[168:171]
    ds_read_b128 v[20:23], v6 offset:1024
    v_mul_f32 v251, v251, v183
    v_cvt_pk_bf16_f32 v236, v248, v249
    v_mfma_f32_16x16x32_bf16 v[168:171], v[56:59], a[144:147], v[168:171]
    s_add_u32 s22, s66, 184320
    v_cvt_pk_bf16_f32 v237, v250, v251
    v_fmaak_f32 v248, v188, v188, 0x409d30fc
    v_mfma_f32_16x16x32_bf16 v[168:171], v[60:63], a[152:155], v[168:171]
    ds_read_b128 v[24:27], v6 offset:2048
    v_fmaak_f32 v249, v189, v189, 0x409d30fc
    v_fmaak_f32 v250, v190, v190, 0x409d30fc
    v_mfma_f32_16x16x32_bf16 v[172:175], v[40:43], a[116:119], v[172:175]
    v_fmaak_f32 v251, v191, v191, 0x409d30fc
    v_mul_f32 v248, v248, v188
    v_mul_f32 v249, v249, v189
    v_mfma_f32_16x16x32_bf16 v[172:175], v[44:47], a[124:127], v[172:175]
    ds_read_b128 v[28:31], v6 offset:3072
    v_mul_f32 v250, v250, v190
    v_mul_f32 v251, v251, v191
    v_mfma_f32_16x16x32_bf16 v[172:175], v[48:51], a[132:135], v[172:175]
    buffer_load_dwordx4 v2, s[8:11], s22 offen offset:0 lds
    v_exp_f32 v248, v248
    v_mfma_f32_16x16x32_bf16 v[172:175], v[52:55], a[140:143], v[172:175]
    ds_read_b128 v[32:35], v6 offset:4096
    v_exp_f32 v249, v249
    v_mfma_f32_16x16x32_bf16 v[172:175], v[56:59], a[148:151], v[172:175]
    buffer_load_dwordx4 v2, s[8:11], s22 offen offset:1024 lds
    v_mfma_f32_16x16x32_bf16 v[172:175], v[60:63], a[156:159], v[172:175]
    ds_read_b128 v[36:39], v6 offset:5120
    v_exp_f32 v250, v250
    s_waitcnt lgkmcnt(6)
    v_mfma_f32_16x16x32_bf16 v[168:171], v[64:67], a[160:163], v[168:171]
    v_exp_f32 v251, v251
    v_mfma_f32_16x16x32_bf16 v[168:171], v[68:71], a[168:171], v[168:171]
    ds_read_b128 v[40:43], v6 offset:6144
    v_fma_f32 v248, v248, v255, v255
    v_fma_f32 v249, v249, v255, v255
    v_mfma_f32_16x16x32_bf16 v[168:171], v[72:75], a[176:179], v[168:171]
    buffer_load_dwordx4 v2, s[8:11], s22 offen offset:2048 lds
    v_fma_f32 v250, v250, v255, v255
    v_fma_f32 v251, v251, v255, v255
    v_mfma_f32_16x16x32_bf16 v[168:171], v[76:79], a[184:187], v[168:171]
    ds_read_b128 v[44:47], v6 offset:7168
    v_rcp_f32 v248, v248
    v_mfma_f32_16x16x32_bf16 v[168:171], v[80:83], a[192:195], v[168:171]
    buffer_load_dwordx4 v2, s[8:11], s22 offen offset:3072 lds
    v_mfma_f32_16x16x32_bf16 v[168:171], v[84:87], a[200:203], v[168:171]
    ds_read_b128 v[48:51], v6 offset:8192
    v_rcp_f32 v249, v249
    v_mfma_f32_16x16x32_bf16 v[172:175], v[64:67], a[164:167], v[172:175]
    v_rcp_f32 v250, v250
    v_rcp_f32 v251, v251
    v_mfma_f32_16x16x32_bf16 v[172:175], v[68:71], a[172:175], v[172:175]
    ds_read_b128 v[52:55], v6 offset:9216
    v_mul_f32 v248, v248, v188
    v_mfma_f32_16x16x32_bf16 v[172:175], v[72:75], a[180:183], v[172:175]
    s_add_u32 m0, s21, 40960
    v_mul_f32 v249, v249, v189
    v_mul_f32 v250, v250, v190
    v_mfma_f32_16x16x32_bf16 v[172:175], v[76:79], a[188:191], v[172:175]
    ds_read_b128 v[56:59], v6 offset:10240
    v_mul_f32 v251, v251, v191
    v_cvt_pk_bf16_f32 v238, v248, v249
    v_mfma_f32_16x16x32_bf16 v[172:175], v[80:83], a[196:199], v[172:175]
    s_add_u32 s22, s66, 188416
    v_cvt_pk_bf16_f32 v239, v250, v251
    v_mfma_f32_16x16x32_bf16 v[172:175], v[84:87], a[204:207], v[172:175]
    ds_read_b128 v[60:63], v6 offset:11264
    buffer_store_dwordx4 v[236:239], v2, s[8:11], s18 offen sc1
    s_waitcnt lgkmcnt(6)
    v_mfma_f32_16x16x32_bf16 v[176:179], v[16:19], a[64:67], 0
    buffer_load_dwordx4 v2, s[8:11], s22 offen offset:0 lds
    v_mfma_f32_16x16x32_bf16 v[176:179], v[20:23], a[72:75], v[176:179]
    ds_read_b128 v[64:67], v6 offset:12288
    s_add_u32 s23, s19, 2048
    s_add_u32 s18, s19, 149504
    v_mfma_f32_16x16x32_bf16 v[176:179], v[24:27], a[80:83], v[176:179]
    v_fmaak_f32 v248, v160, v160, 0x409d30fc
    v_fmaak_f32 v249, v161, v161, 0x409d30fc
    v_fmaak_f32 v250, v162, v162, 0x409d30fc
    v_mfma_f32_16x16x32_bf16 v[176:179], v[28:31], a[88:91], v[176:179]
    ds_read_b128 v[68:71], v6 offset:13312
    v_fmaak_f32 v251, v163, v163, 0x409d30fc
    v_mul_f32 v248, v248, v160
    v_mfma_f32_16x16x32_bf16 v[176:179], v[32:35], a[96:99], v[176:179]
    buffer_load_dwordx4 v2, s[8:11], s22 offen offset:1024 lds
    v_mul_f32 v249, v249, v161
    v_mfma_f32_16x16x32_bf16 v[176:179], v[36:39], a[104:107], v[176:179]
    ds_read_b128 v[72:75], v6 offset:14336
    v_mul_f32 v250, v250, v162
    v_mul_f32 v251, v251, v163
    v_mfma_f32_16x16x32_bf16 v[180:183], v[16:19], a[68:71], 0
    v_exp_f32 v248, v248
    v_mfma_f32_16x16x32_bf16 v[180:183], v[20:23], a[76:79], v[180:183]
    ds_read_b128 v[76:79], v6 offset:15360
    v_exp_f32 v249, v249
    v_mfma_f32_16x16x32_bf16 v[180:183], v[24:27], a[84:87], v[180:183]
    buffer_load_dwordx4 v2, s[8:11], s22 offen offset:2048 lds
    v_exp_f32 v250, v250
    v_mfma_f32_16x16x32_bf16 v[180:183], v[28:31], a[92:95], v[180:183]
    ds_read_b128 v[80:83], v6 offset:16384
    v_exp_f32 v251, v251
    v_mfma_f32_16x16x32_bf16 v[180:183], v[32:35], a[100:103], v[180:183]
    v_fma_f32 v248, v248, v255, v255
    v_fma_f32 v249, v249, v255, v255
    v_fma_f32 v250, v250, v255, v255
    v_mfma_f32_16x16x32_bf16 v[180:183], v[36:39], a[108:111], v[180:183]
    ds_read_b128 v[84:87], v6 offset:17408
    v_fma_f32 v251, v251, v255, v255
    s_waitcnt lgkmcnt(6)
    v_mfma_f32_16x16x32_bf16 v[176:179], v[40:43], a[112:115], v[176:179]
    buffer_load_dwordx4 v2, s[8:11], s22 offen offset:3072 lds
    v_rcp_f32 v248, v248
    v_mfma_f32_16x16x32_bf16 v[176:179], v[44:47], a[120:123], v[176:179]
    ds_read_b128 v[16:19], v6 offset:18432
    v_rcp_f32 v249, v249
    v_mfma_f32_16x16x32_bf16 v[176:179], v[48:51], a[128:131], v[176:179]
    s_add_u32 m0, s21, 45056
    v_mfma_f32_16x16x32_bf16 v[176:179], v[52:55], a[136:139], v[176:179]
    ds_read_b128 v[20:23], v6 offset:19456
    v_rcp_f32 v250, v250
    v_mfma_f32_16x16x32_bf16 v[176:179], v[56:59], a[144:147], v[176:179]
    s_add_u32 s22, s66, 192512
    v_rcp_f32 v251, v251
    v_mul_f32 v248, v248, v160
    v_mfma_f32_16x16x32_bf16 v[176:179], v[60:63], a[152:155], v[176:179]
    ds_read_b128 v[24:27], v6 offset:20480
    v_mul_f32 v249, v249, v161
    v_mul_f32 v250, v250, v162
    v_mfma_f32_16x16x32_bf16 v[180:183], v[40:43], a[116:119], v[180:183]
    v_mul_f32 v251, v251, v163
    v_cvt_pk_bf16_f32 v240, v248, v249
    v_mfma_f32_16x16x32_bf16 v[180:183], v[44:47], a[124:127], v[180:183]
    ds_read_b128 v[28:31], v6 offset:21504
    v_cvt_pk_bf16_f32 v241, v250, v251
    v_fmaak_f32 v248, v168, v168, 0x409d30fc
    v_mfma_f32_16x16x32_bf16 v[180:183], v[48:51], a[132:135], v[180:183]
    buffer_load_dwordx4 v2, s[8:11], s22 offen offset:0 lds
    v_fmaak_f32 v249, v169, v169, 0x409d30fc
    v_fmaak_f32 v250, v170, v170, 0x409d30fc
    v_mfma_f32_16x16x32_bf16 v[180:183], v[52:55], a[140:143], v[180:183]
    ds_read_b128 v[32:35], v6 offset:22528
    v_fmaak_f32 v251, v171, v171, 0x409d30fc
    v_mul_f32 v248, v248, v168
    v_mfma_f32_16x16x32_bf16 v[180:183], v[56:59], a[148:151], v[180:183]
    v_mul_f32 v249, v249, v169
    v_mul_f32 v250, v250, v170
    v_mul_f32 v251, v251, v171
    v_mfma_f32_16x16x32_bf16 v[180:183], v[60:63], a[156:159], v[180:183]
    ds_read_b128 v[36:39], v6 offset:23552
    s_waitcnt lgkmcnt(6)
    v_mfma_f32_16x16x32_bf16 v[176:179], v[64:67], a[160:163], v[176:179]
    v_exp_f32 v248, v248
    v_exp_f32 v249, v249
    v_mfma_f32_16x16x32_bf16 v[176:179], v[68:71], a[168:171], v[176:179]
    ds_read_b128 v[40:43], v6 offset:24576
    v_exp_f32 v250, v250
    v_mfma_f32_16x16x32_bf16 v[176:179], v[72:75], a[176:179], v[176:179]
    v_exp_f32 v251, v251
    v_mfma_f32_16x16x32_bf16 v[176:179], v[76:79], a[184:187], v[176:179]
    ds_read_b128 v[44:47], v6 offset:25600
    v_fma_f32 v248, v248, v255, v255
    v_fma_f32 v249, v249, v255, v255
    v_mfma_f32_16x16x32_bf16 v[176:179], v[80:83], a[192:195], v[176:179]
    v_fma_f32 v250, v250, v255, v255
    v_fma_f32 v251, v251, v255, v255
    v_mfma_f32_16x16x32_bf16 v[176:179], v[84:87], a[200:203], v[176:179]
    ds_read_b128 v[48:51], v6 offset:26624
    v_rcp_f32 v248, v248
    v_mfma_f32_16x16x32_bf16 v[180:183], v[64:67], a[164:167], v[180:183]
    v_rcp_f32 v249, v249
    v_rcp_f32 v250, v250
    v_mfma_f32_16x16x32_bf16 v[180:183], v[68:71], a[172:175], v[180:183]
    ds_read_b128 v[52:55], v6 offset:27648
    v_rcp_f32 v251, v251
    v_mfma_f32_16x16x32_bf16 v[180:183], v[72:75], a[180:183], v[180:183]
    v_mul_f32 v248, v248, v168
    v_mul_f32 v249, v249, v169
    v_mfma_f32_16x16x32_bf16 v[180:183], v[76:79], a[188:191], v[180:183]
    ds_read_b128 v[56:59], v6 offset:28672
    v_mul_f32 v250, v250, v170
    v_mul_f32 v251, v251, v171
    v_mfma_f32_16x16x32_bf16 v[180:183], v[80:83], a[196:199], v[180:183]
    v_cvt_pk_bf16_f32 v242, v248, v249
    v_cvt_pk_bf16_f32 v243, v250, v251
    v_mfma_f32_16x16x32_bf16 v[180:183], v[84:87], a[204:207], v[180:183]
    ds_read_b128 v[60:63], v6 offset:29696
    buffer_store_dwordx4 v[240:243], v2, s[8:11], s23 offen sc1
    s_waitcnt lgkmcnt(6)
    v_mfma_f32_16x16x32_bf16 v[184:187], v[16:19], a[64:67], 0
    v_fmaak_f32 v248, v164, v164, 0x409d30fc
    v_fmaak_f32 v249, v165, v165, 0x409d30fc
    v_mfma_f32_16x16x32_bf16 v[184:187], v[20:23], a[72:75], v[184:187]
    ds_read_b128 v[64:67], v6 offset:30720
    v_fmaak_f32 v250, v166, v166, 0x409d30fc
    v_fmaak_f32 v251, v167, v167, 0x409d30fc
    v_mfma_f32_16x16x32_bf16 v[184:187], v[24:27], a[80:83], v[184:187]
    v_mul_f32 v248, v248, v164
    v_mul_f32 v249, v249, v165
    v_mul_f32 v250, v250, v166
    v_mfma_f32_16x16x32_bf16 v[184:187], v[28:31], a[88:91], v[184:187]
    ds_read_b128 v[68:71], v6 offset:31744
    v_mul_f32 v251, v251, v167
    v_mfma_f32_16x16x32_bf16 v[184:187], v[32:35], a[96:99], v[184:187]
    v_exp_f32 v248, v248
    v_exp_f32 v249, v249
    v_mfma_f32_16x16x32_bf16 v[184:187], v[36:39], a[104:107], v[184:187]
    ds_read_b128 v[72:75], v6 offset:32768
    v_exp_f32 v250, v250
    v_mfma_f32_16x16x32_bf16 v[188:191], v[16:19], a[68:71], 0
    v_exp_f32 v251, v251
    v_mfma_f32_16x16x32_bf16 v[188:191], v[20:23], a[76:79], v[188:191]
    ds_read_b128 v[76:79], v6 offset:33792
    v_fma_f32 v248, v248, v255, v255
    v_fma_f32 v249, v249, v255, v255
    v_mfma_f32_16x16x32_bf16 v[188:191], v[24:27], a[84:87], v[188:191]
    v_fma_f32 v250, v250, v255, v255
    v_fma_f32 v251, v251, v255, v255
    v_rcp_f32 v248, v248
    v_mfma_f32_16x16x32_bf16 v[188:191], v[28:31], a[92:95], v[188:191]
    ds_read_b128 v[80:83], v6 offset:34816
    v_mfma_f32_16x16x32_bf16 v[188:191], v[32:35], a[100:103], v[188:191]
    v_rcp_f32 v249, v249
    v_rcp_f32 v250, v250
    v_mfma_f32_16x16x32_bf16 v[188:191], v[36:39], a[108:111], v[188:191]
    ds_read_b128 v[84:87], v6 offset:35840
    s_waitcnt lgkmcnt(6)
    v_mfma_f32_16x16x32_bf16 v[184:187], v[40:43], a[112:115], v[184:187]
    s_waitcnt vmcnt(12)
    s_barrier
    s_cmp_lg_u32 s3, 0
    s_cbranch_scc1 kmain_kernel_sgb_9
    v_mov_b32 v228, 1
    v_mov_b32 v229, 0
    v_cmp_eq_u32 vcc, 0, v1
    s_nop 3
    s_and_saveexec_b64 s[50:51], vcc
    buffer_atomic_add v228, v229, s[8:11], s45 offen
    s_mov_b64 exec, s[50:51]
kmain_kernel_sgb_9:
    v_rcp_f32 v251, v251
    v_mfma_f32_16x16x32_bf16 v[184:187], v[44:47], a[120:123], v[184:187]
    ds_read_b128 v[16:19], v3 offset:0
    v_mul_f32 v248, v248, v164
    v_mfma_f32_16x16x32_bf16 v[184:187], v[48:51], a[128:131], v[184:187]
    s_add_u32 m0, s21, 73728
    v_mul_f32 v249, v249, v165
    v_mul_f32 v250, v250, v166
    v_mfma_f32_16x16x32_bf16 v[184:187], v[52:55], a[136:139], v[184:187]
    ds_read_b128 v[20:23], v3 offset:1024
    v_mul_f32 v251, v251, v167
    v_cvt_pk_bf16_f32 v244, v248, v249
    v_mfma_f32_16x16x32_bf16 v[184:187], v[56:59], a[144:147], v[184:187]
    s_add_u32 s22, s66, 221184
    v_cvt_pk_bf16_f32 v245, v250, v251
    v_fmaak_f32 v248, v172, v172, 0x409d30fc
    v_mfma_f32_16x16x32_bf16 v[184:187], v[60:63], a[152:155], v[184:187]
    ds_read_b128 v[24:27], v3 offset:2048
    v_fmaak_f32 v249, v173, v173, 0x409d30fc
    v_fmaak_f32 v250, v174, v174, 0x409d30fc
    v_mfma_f32_16x16x32_bf16 v[188:191], v[40:43], a[116:119], v[188:191]
    v_fmaak_f32 v251, v175, v175, 0x409d30fc
    v_mul_f32 v248, v248, v172
    v_mul_f32 v249, v249, v173
    v_mfma_f32_16x16x32_bf16 v[188:191], v[44:47], a[124:127], v[188:191]
    ds_read_b128 v[28:31], v3 offset:3072
    v_mul_f32 v250, v250, v174
    v_mul_f32 v251, v251, v175
    v_mfma_f32_16x16x32_bf16 v[188:191], v[48:51], a[132:135], v[188:191]
    buffer_load_dwordx4 v2, s[8:11], s22 offen offset:0 lds
    v_exp_f32 v248, v248
    v_mfma_f32_16x16x32_bf16 v[188:191], v[52:55], a[140:143], v[188:191]
    ds_read_b128 v[32:35], v3 offset:4096
    v_exp_f32 v249, v249
    v_mfma_f32_16x16x32_bf16 v[188:191], v[56:59], a[148:151], v[188:191]
    buffer_load_dwordx4 v2, s[8:11], s22 offen offset:1024 lds
    v_mfma_f32_16x16x32_bf16 v[188:191], v[60:63], a[156:159], v[188:191]
    ds_read_b128 v[36:39], v3 offset:5120
    v_exp_f32 v250, v250
    s_waitcnt lgkmcnt(6)
    v_mfma_f32_16x16x32_bf16 v[184:187], v[64:67], a[160:163], v[184:187]
    v_exp_f32 v251, v251
    v_mfma_f32_16x16x32_bf16 v[184:187], v[68:71], a[168:171], v[184:187]
    ds_read_b128 v[40:43], v3 offset:6144
    v_fma_f32 v248, v248, v255, v255
    v_fma_f32 v249, v249, v255, v255
    v_mfma_f32_16x16x32_bf16 v[184:187], v[72:75], a[176:179], v[184:187]
    buffer_load_dwordx4 v2, s[8:11], s22 offen offset:2048 lds
    v_fma_f32 v250, v250, v255, v255
    v_fma_f32 v251, v251, v255, v255
    v_mfma_f32_16x16x32_bf16 v[184:187], v[76:79], a[184:187], v[184:187]
    ds_read_b128 v[44:47], v3 offset:7168
    v_rcp_f32 v248, v248
    v_mfma_f32_16x16x32_bf16 v[184:187], v[80:83], a[192:195], v[184:187]
    buffer_load_dwordx4 v2, s[8:11], s22 offen offset:3072 lds
    v_mfma_f32_16x16x32_bf16 v[184:187], v[84:87], a[200:203], v[184:187]
    ds_read_b128 v[48:51], v3 offset:8192
    v_rcp_f32 v249, v249
    v_mfma_f32_16x16x32_bf16 v[188:191], v[64:67], a[164:167], v[188:191]
    v_rcp_f32 v250, v250
    v_rcp_f32 v251, v251
    v_mfma_f32_16x16x32_bf16 v[188:191], v[68:71], a[172:175], v[188:191]
    ds_read_b128 v[52:55], v3 offset:9216
    v_mul_f32 v248, v248, v172
    v_mfma_f32_16x16x32_bf16 v[188:191], v[72:75], a[180:183], v[188:191]
    s_add_u32 m0, s21, 77824
    v_mul_f32 v249, v249, v173
    v_mul_f32 v250, v250, v174
    v_mfma_f32_16x16x32_bf16 v[188:191], v[76:79], a[188:191], v[188:191]
    ds_read_b128 v[56:59], v3 offset:10240
    v_mul_f32 v251, v251, v175
    v_cvt_pk_bf16_f32 v246, v248, v249
    v_mfma_f32_16x16x32_bf16 v[188:191], v[80:83], a[196:199], v[188:191]
    s_add_u32 s22, s66, 225280
    v_cvt_pk_bf16_f32 v247, v250, v251
    v_mfma_f32_16x16x32_bf16 v[188:191], v[84:87], a[204:207], v[188:191]
    ds_read_b128 v[60:63], v3 offset:11264
    buffer_store_dwordx4 v[244:247], v2, s[8:11], s18 offen sc1
    s_waitcnt lgkmcnt(6)
    v_mfma_f32_16x16x32_bf16 v[160:163], v[16:19], a[64:67], 0
    buffer_load_dwordx4 v2, s[8:11], s22 offen offset:0 lds
    v_mfma_f32_16x16x32_bf16 v[160:163], v[20:23], a[72:75], v[160:163]
    ds_read_b128 v[64:67], v3 offset:12288
    s_add_u32 s23, s19, 3072
    s_add_u32 s18, s19, 150528
    v_mfma_f32_16x16x32_bf16 v[160:163], v[24:27], a[80:83], v[160:163]
    v_fmaak_f32 v248, v176, v176, 0x409d30fc
    v_fmaak_f32 v249, v177, v177, 0x409d30fc
    v_fmaak_f32 v250, v178, v178, 0x409d30fc
    v_mfma_f32_16x16x32_bf16 v[160:163], v[28:31], a[88:91], v[160:163]
    ds_read_b128 v[68:71], v3 offset:13312
    v_fmaak_f32 v251, v179, v179, 0x409d30fc
    v_mul_f32 v248, v248, v176
    v_mfma_f32_16x16x32_bf16 v[160:163], v[32:35], a[96:99], v[160:163]
    buffer_load_dwordx4 v2, s[8:11], s22 offen offset:1024 lds
    v_mul_f32 v249, v249, v177
    v_mfma_f32_16x16x32_bf16 v[160:163], v[36:39], a[104:107], v[160:163]
    ds_read_b128 v[72:75], v3 offset:14336
    v_mul_f32 v250, v250, v178
    v_mul_f32 v251, v251, v179
    v_mfma_f32_16x16x32_bf16 v[164:167], v[16:19], a[68:71], 0
    v_exp_f32 v248, v248
    v_mfma_f32_16x16x32_bf16 v[164:167], v[20:23], a[76:79], v[164:167]
    ds_read_b128 v[76:79], v3 offset:15360
    v_exp_f32 v249, v249
    v_mfma_f32_16x16x32_bf16 v[164:167], v[24:27], a[84:87], v[164:167]
    buffer_load_dwordx4 v2, s[8:11], s22 offen offset:2048 lds
    v_exp_f32 v250, v250
    v_mfma_f32_16x16x32_bf16 v[164:167], v[28:31], a[92:95], v[164:167]
    ds_read_b128 v[80:83], v3 offset:16384
    v_exp_f32 v251, v251
    v_mfma_f32_16x16x32_bf16 v[164:167], v[32:35], a[100:103], v[164:167]
    v_fma_f32 v248, v248, v255, v255
    v_fma_f32 v249, v249, v255, v255
    v_fma_f32 v250, v250, v255, v255
    v_mfma_f32_16x16x32_bf16 v[164:167], v[36:39], a[108:111], v[164:167]
    ds_read_b128 v[84:87], v3 offset:17408
    v_fma_f32 v251, v251, v255, v255
    s_waitcnt lgkmcnt(6)
    v_mfma_f32_16x16x32_bf16 v[160:163], v[40:43], a[112:115], v[160:163]
    buffer_load_dwordx4 v2, s[8:11], s22 offen offset:3072 lds
    v_rcp_f32 v248, v248
    v_mfma_f32_16x16x32_bf16 v[160:163], v[44:47], a[120:123], v[160:163]
    ds_read_b128 v[16:19], v3 offset:18432
    v_rcp_f32 v249, v249
    v_mfma_f32_16x16x32_bf16 v[160:163], v[48:51], a[128:131], v[160:163]
    s_add_u32 m0, s21, 81920
    v_mfma_f32_16x16x32_bf16 v[160:163], v[52:55], a[136:139], v[160:163]
    ds_read_b128 v[20:23], v3 offset:19456
    v_rcp_f32 v250, v250
    v_mfma_f32_16x16x32_bf16 v[160:163], v[56:59], a[144:147], v[160:163]
    s_add_u32 s22, s66, 229376
    v_rcp_f32 v251, v251
    v_mul_f32 v248, v248, v176
    v_mfma_f32_16x16x32_bf16 v[160:163], v[60:63], a[152:155], v[160:163]
    ds_read_b128 v[24:27], v3 offset:20480
    v_mul_f32 v249, v249, v177
    v_mul_f32 v250, v250, v178
    v_mfma_f32_16x16x32_bf16 v[164:167], v[40:43], a[116:119], v[164:167]
    v_mul_f32 v251, v251, v179
    v_cvt_pk_bf16_f32 v232, v248, v249
    v_mfma_f32_16x16x32_bf16 v[164:167], v[44:47], a[124:127], v[164:167]
    ds_read_b128 v[28:31], v3 offset:21504
    v_cvt_pk_bf16_f32 v233, v250, v251
    v_fmaak_f32 v248, v184, v184, 0x409d30fc
    v_mfma_f32_16x16x32_bf16 v[164:167], v[48:51], a[132:135], v[164:167]
    buffer_load_dwordx4 v2, s[8:11], s22 offen offset:0 lds
    v_fmaak_f32 v249, v185, v185, 0x409d30fc
    v_fmaak_f32 v250, v186, v186, 0x409d30fc
    v_mfma_f32_16x16x32_bf16 v[164:167], v[52:55], a[140:143], v[164:167]
    ds_read_b128 v[32:35], v3 offset:22528
    v_fmaak_f32 v251, v187, v187, 0x409d30fc
    v_mul_f32 v248, v248, v184
    v_mfma_f32_16x16x32_bf16 v[164:167], v[56:59], a[148:151], v[164:167]
    v_mul_f32 v249, v249, v185
    v_mul_f32 v250, v250, v186
    v_mul_f32 v251, v251, v187
    v_mfma_f32_16x16x32_bf16 v[164:167], v[60:63], a[156:159], v[164:167]
    ds_read_b128 v[36:39], v3 offset:23552
    s_waitcnt lgkmcnt(6)
    v_mfma_f32_16x16x32_bf16 v[160:163], v[64:67], a[160:163], v[160:163]
    v_exp_f32 v248, v248
    v_exp_f32 v249, v249
    v_mfma_f32_16x16x32_bf16 v[160:163], v[68:71], a[168:171], v[160:163]
    ds_read_b128 v[40:43], v3 offset:24576
    v_exp_f32 v250, v250
    v_mfma_f32_16x16x32_bf16 v[160:163], v[72:75], a[176:179], v[160:163]
    v_exp_f32 v251, v251
    v_mfma_f32_16x16x32_bf16 v[160:163], v[76:79], a[184:187], v[160:163]
    ds_read_b128 v[44:47], v3 offset:25600
    v_fma_f32 v248, v248, v255, v255
    v_fma_f32 v249, v249, v255, v255
    v_mfma_f32_16x16x32_bf16 v[160:163], v[80:83], a[192:195], v[160:163]
    v_fma_f32 v250, v250, v255, v255
    v_fma_f32 v251, v251, v255, v255
    v_mfma_f32_16x16x32_bf16 v[160:163], v[84:87], a[200:203], v[160:163]
    ds_read_b128 v[48:51], v3 offset:26624
    v_rcp_f32 v248, v248
    v_mfma_f32_16x16x32_bf16 v[164:167], v[64:67], a[164:167], v[164:167]
    v_rcp_f32 v249, v249
    v_rcp_f32 v250, v250
    v_mfma_f32_16x16x32_bf16 v[164:167], v[68:71], a[172:175], v[164:167]
    ds_read_b128 v[52:55], v3 offset:27648
    v_rcp_f32 v251, v251
    v_mfma_f32_16x16x32_bf16 v[164:167], v[72:75], a[180:183], v[164:167]
    v_mul_f32 v248, v248, v184
    v_mul_f32 v249, v249, v185
    v_mfma_f32_16x16x32_bf16 v[164:167], v[76:79], a[188:191], v[164:167]
    ds_read_b128 v[56:59], v3 offset:28672
    v_mul_f32 v250, v250, v186
    v_mul_f32 v251, v251, v187
    v_mfma_f32_16x16x32_bf16 v[164:167], v[80:83], a[196:199], v[164:167]
    v_cvt_pk_bf16_f32 v234, v248, v249
    v_cvt_pk_bf16_f32 v235, v250, v251
    v_mfma_f32_16x16x32_bf16 v[164:167], v[84:87], a[204:207], v[164:167]
    ds_read_b128 v[60:63], v3 offset:29696
    buffer_store_dwordx4 v[232:235], v2, s[8:11], s23 offen sc1
    s_waitcnt lgkmcnt(6)
    v_mfma_f32_16x16x32_bf16 v[168:171], v[16:19], a[64:67], 0
    v_fmaak_f32 v248, v180, v180, 0x409d30fc
    v_fmaak_f32 v249, v181, v181, 0x409d30fc
    v_mfma_f32_16x16x32_bf16 v[168:171], v[20:23], a[72:75], v[168:171]
    ds_read_b128 v[64:67], v3 offset:30720
    v_fmaak_f32 v250, v182, v182, 0x409d30fc
    v_fmaak_f32 v251, v183, v183, 0x409d30fc
    v_mfma_f32_16x16x32_bf16 v[168:171], v[24:27], a[80:83], v[168:171]
    v_mul_f32 v248, v248, v180
    v_mul_f32 v249, v249, v181
    v_mul_f32 v250, v250, v182
    v_mfma_f32_16x16x32_bf16 v[168:171], v[28:31], a[88:91], v[168:171]
    ds_read_b128 v[68:71], v3 offset:31744
    v_mul_f32 v251, v251, v183
    v_mfma_f32_16x16x32_bf16 v[168:171], v[32:35], a[96:99], v[168:171]
    v_exp_f32 v248, v248
    v_exp_f32 v249, v249
    v_mfma_f32_16x16x32_bf16 v[168:171], v[36:39], a[104:107], v[168:171]
    ds_read_b128 v[72:75], v3 offset:32768
    v_exp_f32 v250, v250
    v_mfma_f32_16x16x32_bf16 v[172:175], v[16:19], a[68:71], 0
    v_exp_f32 v251, v251
    v_mfma_f32_16x16x32_bf16 v[172:175], v[20:23], a[76:79], v[172:175]
    ds_read_b128 v[76:79], v3 offset:33792
    v_fma_f32 v248, v248, v255, v255
    v_fma_f32 v249, v249, v255, v255
    v_mfma_f32_16x16x32_bf16 v[172:175], v[24:27], a[84:87], v[172:175]
    v_fma_f32 v250, v250, v255, v255
    v_fma_f32 v251, v251, v255, v255
    v_rcp_f32 v248, v248
    v_mfma_f32_16x16x32_bf16 v[172:175], v[28:31], a[92:95], v[172:175]
    ds_read_b128 v[80:83], v3 offset:34816
    v_mfma_f32_16x16x32_bf16 v[172:175], v[32:35], a[100:103], v[172:175]
    v_rcp_f32 v249, v249
    v_rcp_f32 v250, v250
    v_mfma_f32_16x16x32_bf16 v[172:175], v[36:39], a[108:111], v[172:175]
    ds_read_b128 v[84:87], v3 offset:35840
    s_waitcnt lgkmcnt(6)
    v_mfma_f32_16x16x32_bf16 v[168:171], v[40:43], a[112:115], v[168:171]
    s_waitcnt vmcnt(12)
    s_barrier
    v_rcp_f32 v251, v251
    v_mfma_f32_16x16x32_bf16 v[168:171], v[44:47], a[120:123], v[168:171]
    ds_read_b128 v[16:19], v4 offset:0
    v_mul_f32 v248, v248, v180
    v_mfma_f32_16x16x32_bf16 v[168:171], v[48:51], a[128:131], v[168:171]
    s_add_u32 m0, s21, 110592
    v_mul_f32 v249, v249, v181
    v_mul_f32 v250, v250, v182
    v_mfma_f32_16x16x32_bf16 v[168:171], v[52:55], a[136:139], v[168:171]
    ds_read_b128 v[20:23], v4 offset:1024
    v_mul_f32 v251, v251, v183
    v_cvt_pk_bf16_f32 v236, v248, v249
    v_mfma_f32_16x16x32_bf16 v[168:171], v[56:59], a[144:147], v[168:171]
    s_add_u32 s22, s66, 258048
    v_cvt_pk_bf16_f32 v237, v250, v251
    v_fmaak_f32 v248, v188, v188, 0x409d30fc
    v_mfma_f32_16x16x32_bf16 v[168:171], v[60:63], a[152:155], v[168:171]
    ds_read_b128 v[24:27], v4 offset:2048
    v_fmaak_f32 v249, v189, v189, 0x409d30fc
    v_fmaak_f32 v250, v190, v190, 0x409d30fc
    v_mfma_f32_16x16x32_bf16 v[172:175], v[40:43], a[116:119], v[172:175]
    v_fmaak_f32 v251, v191, v191, 0x409d30fc
    v_mul_f32 v248, v248, v188
    v_mul_f32 v249, v249, v189
    v_mfma_f32_16x16x32_bf16 v[172:175], v[44:47], a[124:127], v[172:175]
    ds_read_b128 v[28:31], v4 offset:3072
    v_mul_f32 v250, v250, v190
    v_mul_f32 v251, v251, v191
    v_mfma_f32_16x16x32_bf16 v[172:175], v[48:51], a[132:135], v[172:175]
    buffer_load_dwordx4 v2, s[8:11], s22 offen offset:0 lds
    v_exp_f32 v248, v248
    v_mfma_f32_16x16x32_bf16 v[172:175], v[52:55], a[140:143], v[172:175]
    ds_read_b128 v[32:35], v4 offset:4096
    v_exp_f32 v249, v249
    v_mfma_f32_16x16x32_bf16 v[172:175], v[56:59], a[148:151], v[172:175]
    buffer_load_dwordx4 v2, s[8:11], s22 offen offset:1024 lds
    v_mfma_f32_16x16x32_bf16 v[172:175], v[60:63], a[156:159], v[172:175]
    ds_read_b128 v[36:39], v4 offset:5120
    v_exp_f32 v250, v250
    s_waitcnt lgkmcnt(6)
    v_mfma_f32_16x16x32_bf16 v[168:171], v[64:67], a[160:163], v[168:171]
    v_exp_f32 v251, v251
    v_mfma_f32_16x16x32_bf16 v[168:171], v[68:71], a[168:171], v[168:171]
    ds_read_b128 v[40:43], v4 offset:6144
    v_fma_f32 v248, v248, v255, v255
    v_fma_f32 v249, v249, v255, v255
    v_mfma_f32_16x16x32_bf16 v[168:171], v[72:75], a[176:179], v[168:171]
    buffer_load_dwordx4 v2, s[8:11], s22 offen offset:2048 lds
    v_fma_f32 v250, v250, v255, v255
    v_fma_f32 v251, v251, v255, v255
    v_mfma_f32_16x16x32_bf16 v[168:171], v[76:79], a[184:187], v[168:171]
    ds_read_b128 v[44:47], v4 offset:7168
    v_rcp_f32 v248, v248
    v_mfma_f32_16x16x32_bf16 v[168:171], v[80:83], a[192:195], v[168:171]
    buffer_load_dwordx4 v2, s[8:11], s22 offen offset:3072 lds
    v_mfma_f32_16x16x32_bf16 v[168:171], v[84:87], a[200:203], v[168:171]
    ds_read_b128 v[48:51], v4 offset:8192
    v_rcp_f32 v249, v249
    v_mfma_f32_16x16x32_bf16 v[172:175], v[64:67], a[164:167], v[172:175]
    v_rcp_f32 v250, v250
    v_rcp_f32 v251, v251
    v_mfma_f32_16x16x32_bf16 v[172:175], v[68:71], a[172:175], v[172:175]
    ds_read_b128 v[52:55], v4 offset:9216
    v_mul_f32 v248, v248, v188
    v_mfma_f32_16x16x32_bf16 v[172:175], v[72:75], a[180:183], v[172:175]
    s_add_u32 m0, s21, 114688
    v_mul_f32 v249, v249, v189
    v_mul_f32 v250, v250, v190
    v_mfma_f32_16x16x32_bf16 v[172:175], v[76:79], a[188:191], v[172:175]
    ds_read_b128 v[56:59], v4 offset:10240
    v_mul_f32 v251, v251, v191
    v_cvt_pk_bf16_f32 v238, v248, v249
    v_mfma_f32_16x16x32_bf16 v[172:175], v[80:83], a[196:199], v[172:175]
    s_add_u32 s22, s66, 262144
    v_cvt_pk_bf16_f32 v239, v250, v251
    v_mfma_f32_16x16x32_bf16 v[172:175], v[84:87], a[204:207], v[172:175]
    ds_read_b128 v[60:63], v4 offset:11264
    buffer_store_dwordx4 v[236:239], v2, s[8:11], s18 offen sc1
    s_waitcnt lgkmcnt(6)
    v_mfma_f32_16x16x32_bf16 v[176:179], v[16:19], a[64:67], 0
    buffer_load_dwordx4 v2, s[8:11], s22 offen offset:0 lds
    v_mfma_f32_16x16x32_bf16 v[176:179], v[20:23], a[72:75], v[176:179]
    ds_read_b128 v[64:67], v4 offset:12288
    s_add_u32 s23, s19, 4096
    s_add_u32 s18, s19, 151552
    v_mfma_f32_16x16x32_bf16 v[176:179], v[24:27], a[80:83], v[176:179]
    v_fmaak_f32 v248, v160, v160, 0x409d30fc
    v_fmaak_f32 v249, v161, v161, 0x409d30fc
    v_fmaak_f32 v250, v162, v162, 0x409d30fc
    v_mfma_f32_16x16x32_bf16 v[176:179], v[28:31], a[88:91], v[176:179]
    ds_read_b128 v[68:71], v4 offset:13312
    v_fmaak_f32 v251, v163, v163, 0x409d30fc
    v_mul_f32 v248, v248, v160
    v_mfma_f32_16x16x32_bf16 v[176:179], v[32:35], a[96:99], v[176:179]
    buffer_load_dwordx4 v2, s[8:11], s22 offen offset:1024 lds
    v_mul_f32 v249, v249, v161
    v_mfma_f32_16x16x32_bf16 v[176:179], v[36:39], a[104:107], v[176:179]
    ds_read_b128 v[72:75], v4 offset:14336
    v_mul_f32 v250, v250, v162
    v_mul_f32 v251, v251, v163
    v_mfma_f32_16x16x32_bf16 v[180:183], v[16:19], a[68:71], 0
    v_exp_f32 v248, v248
    v_mfma_f32_16x16x32_bf16 v[180:183], v[20:23], a[76:79], v[180:183]
    ds_read_b128 v[76:79], v4 offset:15360
    v_exp_f32 v249, v249
    v_mfma_f32_16x16x32_bf16 v[180:183], v[24:27], a[84:87], v[180:183]
    buffer_load_dwordx4 v2, s[8:11], s22 offen offset:2048 lds
    v_exp_f32 v250, v250
    v_mfma_f32_16x16x32_bf16 v[180:183], v[28:31], a[92:95], v[180:183]
    ds_read_b128 v[80:83], v4 offset:16384
    v_exp_f32 v251, v251
    v_mfma_f32_16x16x32_bf16 v[180:183], v[32:35], a[100:103], v[180:183]
    v_fma_f32 v248, v248, v255, v255
    v_fma_f32 v249, v249, v255, v255
    v_fma_f32 v250, v250, v255, v255
    v_mfma_f32_16x16x32_bf16 v[180:183], v[36:39], a[108:111], v[180:183]
    ds_read_b128 v[84:87], v4 offset:17408
    v_fma_f32 v251, v251, v255, v255
    s_waitcnt lgkmcnt(6)
    v_mfma_f32_16x16x32_bf16 v[176:179], v[40:43], a[112:115], v[176:179]
    buffer_load_dwordx4 v2, s[8:11], s22 offen offset:3072 lds
    v_rcp_f32 v248, v248
    v_mfma_f32_16x16x32_bf16 v[176:179], v[44:47], a[120:123], v[176:179]
    ds_read_b128 v[16:19], v4 offset:18432
    v_rcp_f32 v249, v249
    v_mfma_f32_16x16x32_bf16 v[176:179], v[48:51], a[128:131], v[176:179]
    s_add_u32 m0, s21, 118784
    v_mfma_f32_16x16x32_bf16 v[176:179], v[52:55], a[136:139], v[176:179]
    ds_read_b128 v[20:23], v4 offset:19456
    v_rcp_f32 v250, v250
    v_mfma_f32_16x16x32_bf16 v[176:179], v[56:59], a[144:147], v[176:179]
    s_add_u32 s22, s66, 266240
    v_rcp_f32 v251, v251
    v_mul_f32 v248, v248, v160
    v_mfma_f32_16x16x32_bf16 v[176:179], v[60:63], a[152:155], v[176:179]
    ds_read_b128 v[24:27], v4 offset:20480
    v_mul_f32 v249, v249, v161
    v_mul_f32 v250, v250, v162
    v_mfma_f32_16x16x32_bf16 v[180:183], v[40:43], a[116:119], v[180:183]
    v_mul_f32 v251, v251, v163
    v_cvt_pk_bf16_f32 v240, v248, v249
    v_mfma_f32_16x16x32_bf16 v[180:183], v[44:47], a[124:127], v[180:183]
    ds_read_b128 v[28:31], v4 offset:21504
    v_cvt_pk_bf16_f32 v241, v250, v251
    v_fmaak_f32 v248, v168, v168, 0x409d30fc
    v_mfma_f32_16x16x32_bf16 v[180:183], v[48:51], a[132:135], v[180:183]
    buffer_load_dwordx4 v2, s[8:11], s22 offen offset:0 lds
    v_fmaak_f32 v249, v169, v169, 0x409d30fc
    v_fmaak_f32 v250, v170, v170, 0x409d30fc
    v_mfma_f32_16x16x32_bf16 v[180:183], v[52:55], a[140:143], v[180:183]
    ds_read_b128 v[32:35], v4 offset:22528
    v_fmaak_f32 v251, v171, v171, 0x409d30fc
    v_mul_f32 v248, v248, v168
    v_mfma_f32_16x16x32_bf16 v[180:183], v[56:59], a[148:151], v[180:183]
    v_mul_f32 v249, v249, v169
    v_mul_f32 v250, v250, v170
    v_mul_f32 v251, v251, v171
    v_mfma_f32_16x16x32_bf16 v[180:183], v[60:63], a[156:159], v[180:183]
    ds_read_b128 v[36:39], v4 offset:23552
    s_waitcnt lgkmcnt(6)
    v_mfma_f32_16x16x32_bf16 v[176:179], v[64:67], a[160:163], v[176:179]
    v_exp_f32 v248, v248
    v_exp_f32 v249, v249
    v_mfma_f32_16x16x32_bf16 v[176:179], v[68:71], a[168:171], v[176:179]
    ds_read_b128 v[40:43], v4 offset:24576
    v_exp_f32 v250, v250
    v_mfma_f32_16x16x32_bf16 v[176:179], v[72:75], a[176:179], v[176:179]
    v_exp_f32 v251, v251
    v_mfma_f32_16x16x32_bf16 v[176:179], v[76:79], a[184:187], v[176:179]
    ds_read_b128 v[44:47], v4 offset:25600
    v_fma_f32 v248, v248, v255, v255
    v_fma_f32 v249, v249, v255, v255
    v_mfma_f32_16x16x32_bf16 v[176:179], v[80:83], a[192:195], v[176:179]
    v_fma_f32 v250, v250, v255, v255
    v_fma_f32 v251, v251, v255, v255
    v_mfma_f32_16x16x32_bf16 v[176:179], v[84:87], a[200:203], v[176:179]
    ds_read_b128 v[48:51], v4 offset:26624
    v_rcp_f32 v248, v248
    v_mfma_f32_16x16x32_bf16 v[180:183], v[64:67], a[164:167], v[180:183]
    v_rcp_f32 v249, v249
    v_rcp_f32 v250, v250
    v_mfma_f32_16x16x32_bf16 v[180:183], v[68:71], a[172:175], v[180:183]
    ds_read_b128 v[52:55], v4 offset:27648
    v_rcp_f32 v251, v251
    v_mfma_f32_16x16x32_bf16 v[180:183], v[72:75], a[180:183], v[180:183]
    v_mul_f32 v248, v248, v168
    v_mul_f32 v249, v249, v169
    v_mfma_f32_16x16x32_bf16 v[180:183], v[76:79], a[188:191], v[180:183]
    ds_read_b128 v[56:59], v4 offset:28672
    v_mul_f32 v250, v250, v170
    v_mul_f32 v251, v251, v171
    v_mfma_f32_16x16x32_bf16 v[180:183], v[80:83], a[196:199], v[180:183]
    v_cvt_pk_bf16_f32 v242, v248, v249
    v_cvt_pk_bf16_f32 v243, v250, v251
    v_mfma_f32_16x16x32_bf16 v[180:183], v[84:87], a[204:207], v[180:183]
    ds_read_b128 v[60:63], v4 offset:29696
    buffer_store_dwordx4 v[240:243], v2, s[8:11], s23 offen sc1
    s_waitcnt lgkmcnt(6)
    v_mfma_f32_16x16x32_bf16 v[184:187], v[16:19], a[64:67], 0
    v_fmaak_f32 v248, v164, v164, 0x409d30fc
    v_fmaak_f32 v249, v165, v165, 0x409d30fc
    v_mfma_f32_16x16x32_bf16 v[184:187], v[20:23], a[72:75], v[184:187]
    ds_read_b128 v[64:67], v4 offset:30720
    v_fmaak_f32 v250, v166, v166, 0x409d30fc
    v_fmaak_f32 v251, v167, v167, 0x409d30fc
    v_mfma_f32_16x16x32_bf16 v[184:187], v[24:27], a[80:83], v[184:187]
    v_mul_f32 v248, v248, v164
    v_mul_f32 v249, v249, v165
    v_mul_f32 v250, v250, v166
    v_mfma_f32_16x16x32_bf16 v[184:187], v[28:31], a[88:91], v[184:187]
    ds_read_b128 v[68:71], v4 offset:31744
    v_mul_f32 v251, v251, v167
    v_mfma_f32_16x16x32_bf16 v[184:187], v[32:35], a[96:99], v[184:187]
    v_exp_f32 v248, v248
    v_exp_f32 v249, v249
    v_mfma_f32_16x16x32_bf16 v[184:187], v[36:39], a[104:107], v[184:187]
    ds_read_b128 v[72:75], v4 offset:32768
    v_exp_f32 v250, v250
    v_mfma_f32_16x16x32_bf16 v[188:191], v[16:19], a[68:71], 0
    v_exp_f32 v251, v251
    v_mfma_f32_16x16x32_bf16 v[188:191], v[20:23], a[76:79], v[188:191]
    ds_read_b128 v[76:79], v4 offset:33792
    v_fma_f32 v248, v248, v255, v255
    v_fma_f32 v249, v249, v255, v255
    v_mfma_f32_16x16x32_bf16 v[188:191], v[24:27], a[84:87], v[188:191]
    v_fma_f32 v250, v250, v255, v255
    v_fma_f32 v251, v251, v255, v255
    v_rcp_f32 v248, v248
    v_mfma_f32_16x16x32_bf16 v[188:191], v[28:31], a[92:95], v[188:191]
    ds_read_b128 v[80:83], v4 offset:34816
    v_mfma_f32_16x16x32_bf16 v[188:191], v[32:35], a[100:103], v[188:191]
    v_rcp_f32 v249, v249
    v_rcp_f32 v250, v250
    v_mfma_f32_16x16x32_bf16 v[188:191], v[36:39], a[108:111], v[188:191]
    ds_read_b128 v[84:87], v4 offset:35840
    s_waitcnt lgkmcnt(6)
    v_mfma_f32_16x16x32_bf16 v[184:187], v[40:43], a[112:115], v[184:187]
    s_waitcnt vmcnt(12)
    s_barrier
    v_rcp_f32 v251, v251
    v_mfma_f32_16x16x32_bf16 v[184:187], v[44:47], a[120:123], v[184:187]
    ds_read_b128 v[16:19], v5 offset:0
    v_mul_f32 v248, v248, v164
    v_mfma_f32_16x16x32_bf16 v[184:187], v[48:51], a[128:131], v[184:187]
    s_add_u32 m0, s21, 0
    v_mul_f32 v249, v249, v165
    v_mul_f32 v250, v250, v166
    v_mfma_f32_16x16x32_bf16 v[184:187], v[52:55], a[136:139], v[184:187]
    ds_read_b128 v[20:23], v5 offset:1024
    v_mul_f32 v251, v251, v167
    v_cvt_pk_bf16_f32 v244, v248, v249
    v_mfma_f32_16x16x32_bf16 v[184:187], v[56:59], a[144:147], v[184:187]
    s_add_u32 s22, s66, 294912
    v_cvt_pk_bf16_f32 v245, v250, v251
    v_fmaak_f32 v248, v172, v172, 0x409d30fc
    v_mfma_f32_16x16x32_bf16 v[184:187], v[60:63], a[152:155], v[184:187]
    ds_read_b128 v[24:27], v5 offset:2048
    v_fmaak_f32 v249, v173, v173, 0x409d30fc
    v_fmaak_f32 v250, v174, v174, 0x409d30fc
    v_mfma_f32_16x16x32_bf16 v[188:191], v[40:43], a[116:119], v[188:191]
    v_fmaak_f32 v251, v175, v175, 0x409d30fc
    v_mul_f32 v248, v248, v172
    v_mul_f32 v249, v249, v173
    v_mfma_f32_16x16x32_bf16 v[188:191], v[44:47], a[124:127], v[188:191]
    ds_read_b128 v[28:31], v5 offset:3072
    v_mul_f32 v250, v250, v174
    v_mul_f32 v251, v251, v175
    v_mfma_f32_16x16x32_bf16 v[188:191], v[48:51], a[132:135], v[188:191]
    buffer_load_dwordx4 v2, s[8:11], s22 offen offset:0 lds
    v_exp_f32 v248, v248
    v_mfma_f32_16x16x32_bf16 v[188:191], v[52:55], a[140:143], v[188:191]
    ds_read_b128 v[32:35], v5 offset:4096
    v_exp_f32 v249, v249
    v_mfma_f32_16x16x32_bf16 v[188:191], v[56:59], a[148:151], v[188:191]
    buffer_load_dwordx4 v2, s[8:11], s22 offen offset:1024 lds
    v_mfma_f32_16x16x32_bf16 v[188:191], v[60:63], a[156:159], v[188:191]
    ds_read_b128 v[36:39], v5 offset:5120
    v_exp_f32 v250, v250
    s_waitcnt lgkmcnt(6)
    v_mfma_f32_16x16x32_bf16 v[184:187], v[64:67], a[160:163], v[184:187]
    v_exp_f32 v251, v251
    v_mfma_f32_16x16x32_bf16 v[184:187], v[68:71], a[168:171], v[184:187]
    ds_read_b128 v[40:43], v5 offset:6144
    v_fma_f32 v248, v248, v255, v255
    v_fma_f32 v249, v249, v255, v255
    v_mfma_f32_16x16x32_bf16 v[184:187], v[72:75], a[176:179], v[184:187]
    buffer_load_dwordx4 v2, s[8:11], s22 offen offset:2048 lds
    v_fma_f32 v250, v250, v255, v255
    v_fma_f32 v251, v251, v255, v255
    v_mfma_f32_16x16x32_bf16 v[184:187], v[76:79], a[184:187], v[184:187]
    ds_read_b128 v[44:47], v5 offset:7168
    v_rcp_f32 v248, v248
    v_mfma_f32_16x16x32_bf16 v[184:187], v[80:83], a[192:195], v[184:187]
    buffer_load_dwordx4 v2, s[8:11], s22 offen offset:3072 lds
    v_mfma_f32_16x16x32_bf16 v[184:187], v[84:87], a[200:203], v[184:187]
    ds_read_b128 v[48:51], v5 offset:8192
    v_rcp_f32 v249, v249
    v_mfma_f32_16x16x32_bf16 v[188:191], v[64:67], a[164:167], v[188:191]
    v_rcp_f32 v250, v250
    v_rcp_f32 v251, v251
    v_mfma_f32_16x16x32_bf16 v[188:191], v[68:71], a[172:175], v[188:191]
    ds_read_b128 v[52:55], v5 offset:9216
    v_mul_f32 v248, v248, v172
    v_mfma_f32_16x16x32_bf16 v[188:191], v[72:75], a[180:183], v[188:191]
    s_add_u32 m0, s21, 4096
    v_mul_f32 v249, v249, v173
    v_mul_f32 v250, v250, v174
    v_mfma_f32_16x16x32_bf16 v[188:191], v[76:79], a[188:191], v[188:191]
    ds_read_b128 v[56:59], v5 offset:10240
    v_mul_f32 v251, v251, v175
    v_cvt_pk_bf16_f32 v246, v248, v249
    v_mfma_f32_16x16x32_bf16 v[188:191], v[80:83], a[196:199], v[188:191]
    s_add_u32 s22, s66, 299008
    v_cvt_pk_bf16_f32 v247, v250, v251
    v_mfma_f32_16x16x32_bf16 v[188:191], v[84:87], a[204:207], v[188:191]
    ds_read_b128 v[60:63], v5 offset:11264
    buffer_store_dwordx4 v[244:247], v2, s[8:11], s18 offen sc1
    s_waitcnt lgkmcnt(6)
    v_mfma_f32_16x16x32_bf16 v[160:163], v[16:19], a[64:67], 0
    buffer_load_dwordx4 v2, s[8:11], s22 offen offset:0 lds
    v_mfma_f32_16x16x32_bf16 v[160:163], v[20:23], a[72:75], v[160:163]
    ds_read_b128 v[64:67], v5 offset:12288
    s_add_u32 s23, s19, 5120
    s_add_u32 s18, s19, 152576
    v_mfma_f32_16x16x32_bf16 v[160:163], v[24:27], a[80:83], v[160:163]
    v_fmaak_f32 v248, v176, v176, 0x409d30fc
    v_fmaak_f32 v249, v177, v177, 0x409d30fc
    v_mfma_f32_16x16x32_bf16 v[160:163], v[28:31], a[88:91], v[160:163]
    ds_read_b128 v[68:71], v5 offset:13312
    v_fmaak_f32 v250, v178, v178, 0x409d30fc
    v_fmaak_f32 v251, v179, v179, 0x409d30fc
    v_mfma_f32_16x16x32_bf16 v[160:163], v[32:35], a[96:99], v[160:163]
    buffer_load_dwordx4 v2, s[8:11], s22 offen offset:1024 lds
    v_mul_f32 v248, v248, v176
    v_mfma_f32_16x16x32_bf16 v[160:163], v[36:39], a[104:107], v[160:163]
    ds_read_b128 v[72:75], v5 offset:14336
    v_mul_f32 v249, v249, v177
    v_mul_f32 v250, v250, v178
    v_mfma_f32_16x16x32_bf16 v[164:167], v[16:19], a[68:71], 0
    v_mul_f32 v251, v251, v179
    v_exp_f32 v248, v248
    v_mfma_f32_16x16x32_bf16 v[164:167], v[20:23], a[76:79], v[164:167]
    ds_read_b128 v[76:79], v5 offset:15360
    v_exp_f32 v249, v249
    v_mfma_f32_16x16x32_bf16 v[164:167], v[24:27], a[84:87], v[164:167]
    buffer_load_dwordx4 v2, s[8:11], s22 offen offset:2048 lds
    v_mfma_f32_16x16x32_bf16 v[164:167], v[28:31], a[92:95], v[164:167]
    ds_read_b128 v[80:83], v5 offset:16384
    v_exp_f32 v250, v250
    v_mfma_f32_16x16x32_bf16 v[164:167], v[32:35], a[100:103], v[164:167]
    v_exp_f32 v251, v251
    v_fma_f32 v248, v248, v255, v255
    v_mfma_f32_16x16x32_bf16 v[164:167], v[36:39], a[108:111], v[164:167]
    ds_read_b128 v[84:87], v5 offset:17408
    v_fma_f32 v249, v249, v255, v255
    s_waitcnt lgkmcnt(6)
    v_mfma_f32_16x16x32_bf16 v[160:163], v[40:43], a[112:115], v[160:163]
    buffer_load_dwordx4 v2, s[8:11], s22 offen offset:3072 lds
    v_fma_f32 v250, v250, v255, v255
    v_mfma_f32_16x16x32_bf16 v[160:163], v[44:47], a[120:123], v[160:163]
    ds_read_b128 v[16:19], v5 offset:18432
    v_fma_f32 v251, v251, v255, v255
    v_rcp_f32 v248, v248
    v_mfma_f32_16x16x32_bf16 v[160:163], v[48:51], a[128:131], v[160:163]
    s_add_u32 m0, s21, 8192
    v_mfma_f32_16x16x32_bf16 v[160:163], v[52:55], a[136:139], v[160:163]
    ds_read_b128 v[20:23], v5 offset:19456
    v_rcp_f32 v249, v249
    v_mfma_f32_16x16x32_bf16 v[160:163], v[56:59], a[144:147], v[160:163]
    s_add_u32 s22, s66, 303104
    v_rcp_f32 v250, v250
    v_mfma_f32_16x16x32_bf16 v[160:163], v[60:63], a[152:155], v[160:163]
    ds_read_b128 v[24:27], v5 offset:20480
    v_rcp_f32 v251, v251
    v_mfma_f32_16x16x32_bf16 v[164:167], v[40:43], a[116:119], v[164:167]
    v_mul_f32 v248, v248, v176
    v_mul_f32 v249, v249, v177
    v_mul_f32 v250, v250, v178
    v_mfma_f32_16x16x32_bf16 v[164:167], v[44:47], a[124:127], v[164:167]
    ds_read_b128 v[28:31], v5 offset:21504
    v_mul_f32 v251, v251, v179
    v_cvt_pk_bf16_f32 v232, v248, v249
    v_mfma_f32_16x16x32_bf16 v[164:167], v[48:51], a[132:135], v[164:167]
    buffer_load_dwordx4 v2, s[8:11], s22 offen offset:0 lds
    v_cvt_pk_bf16_f32 v233, v250, v251
    v_mfma_f32_16x16x32_bf16 v[164:167], v[52:55], a[140:143], v[164:167]
    ds_read_b128 v[32:35], v5 offset:22528
    v_fmaak_f32 v248, v184, v184, 0x409d30fc
    v_fmaak_f32 v249, v185, v185, 0x409d30fc
    v_mfma_f32_16x16x32_bf16 v[164:167], v[56:59], a[148:151], v[164:167]
    v_fmaak_f32 v250, v186, v186, 0x409d30fc
    v_fmaak_f32 v251, v187, v187, 0x409d30fc
    v_mfma_f32_16x16x32_bf16 v[164:167], v[60:63], a[156:159], v[164:167]
    ds_read_b128 v[36:39], v5 offset:23552
    v_mul_f32 v248, v248, v184
    s_waitcnt lgkmcnt(6)
    v_mfma_f32_16x16x32_bf16 v[160:163], v[64:67], a[160:163], v[160:163]
    v_mul_f32 v249, v249, v185
    v_mul_f32 v250, v250, v186
    v_mul_f32 v251, v251, v187
    v_mfma_f32_16x16x32_bf16 v[160:163], v[68:71], a[168:171], v[160:163]
    ds_read_b128 v[40:43], v5 offset:24576
    v_exp_f32 v248, v248
    v_mfma_f32_16x16x32_bf16 v[160:163], v[72:75], a[176:179], v[160:163]
    v_exp_f32 v249, v249
    v_mfma_f32_16x16x32_bf16 v[160:163], v[76:79], a[184:187], v[160:163]
    ds_read_b128 v[44:47], v5 offset:25600
    v_exp_f32 v250, v250
    v_mfma_f32_16x16x32_bf16 v[160:163], v[80:83], a[192:195], v[160:163]
    v_exp_f32 v251, v251
    v_fma_f32 v248, v248, v255, v255
    v_mfma_f32_16x16x32_bf16 v[160:163], v[84:87], a[200:203], v[160:163]
    ds_read_b128 v[48:51], v5 offset:26624
    v_fma_f32 v249, v249, v255, v255
    v_fma_f32 v250, v250, v255, v255
    v_mfma_f32_16x16x32_bf16 v[164:167], v[64:67], a[164:167], v[164:167]
    v_fma_f32 v251, v251, v255, v255
    v_rcp_f32 v248, v248
    v_mfma_f32_16x16x32_bf16 v[164:167], v[68:71], a[172:175], v[164:167]
    ds_read_b128 v[52:55], v5 offset:27648
    v_rcp_f32 v249, v249
    v_mfma_f32_16x16x32_bf16 v[164:167], v[72:75], a[180:183], v[164:167]
    v_rcp_f32 v250, v250
    v_mfma_f32_16x16x32_bf16 v[164:167], v[76:79], a[188:191], v[164:167]
    ds_read_b128 v[56:59], v5 offset:28672
    v_rcp_f32 v251, v251
    v_mfma_f32_16x16x32_bf16 v[164:167], v[80:83], a[196:199], v[164:167]
    v_mul_f32 v248, v248, v184
    v_mul_f32 v249, v249, v185
    v_mfma_f32_16x16x32_bf16 v[164:167], v[84:87], a[204:207], v[164:167]
    ds_read_b128 v[60:63], v5 offset:29696
    v_mul_f32 v250, v250, v186
    s_waitcnt lgkmcnt(6)
    v_mfma_f32_16x16x32_bf16 v[168:171], v[16:19], a[64:67], 0
    v_mul_f32 v251, v251, v187
    v_cvt_pk_bf16_f32 v234, v248, v249
    v_cvt_pk_bf16_f32 v235, v250, v251
    v_mfma_f32_16x16x32_bf16 v[168:171], v[20:23], a[72:75], v[168:171]
    ds_read_b128 v[64:67], v5 offset:30720
    buffer_store_dwordx4 v[232:235], v2, s[8:11], s23 offen sc1
    v_mfma_f32_16x16x32_bf16 v[168:171], v[24:27], a[80:83], v[168:171]
    v_fmaak_f32 v248, v180, v180, 0x409d30fc
    v_mfma_f32_16x16x32_bf16 v[168:171], v[28:31], a[88:91], v[168:171]
    ds_read_b128 v[68:71], v5 offset:31744
    v_fmaak_f32 v249, v181, v181, 0x409d30fc
    v_fmaak_f32 v250, v182, v182, 0x409d30fc
    v_mfma_f32_16x16x32_bf16 v[168:171], v[32:35], a[96:99], v[168:171]
    v_fmaak_f32 v251, v183, v183, 0x409d30fc
    v_mul_f32 v248, v248, v180
    v_mul_f32 v249, v249, v181
    v_mfma_f32_16x16x32_bf16 v[168:171], v[36:39], a[104:107], v[168:171]
    ds_read_b128 v[72:75], v5 offset:32768
    v_mul_f32 v250, v250, v182
    v_mul_f32 v251, v251, v183
    v_mfma_f32_16x16x32_bf16 v[172:175], v[16:19], a[68:71], 0
    v_exp_f32 v248, v248
    v_mfma_f32_16x16x32_bf16 v[172:175], v[20:23], a[76:79], v[172:175]
    ds_read_b128 v[76:79], v5 offset:33792
    v_exp_f32 v249, v249
    v_mfma_f32_16x16x32_bf16 v[172:175], v[24:27], a[84:87], v[172:175]
    v_exp_f32 v250, v250
    v_mfma_f32_16x16x32_bf16 v[172:175], v[28:31], a[92:95], v[172:175]
    ds_read_b128 v[80:83], v5 offset:34816
    v_exp_f32 v251, v251
    v_fma_f32 v248, v248, v255, v255
    v_mfma_f32_16x16x32_bf16 v[172:175], v[32:35], a[100:103], v[172:175]
    v_fma_f32 v249, v249, v255, v255
    v_fma_f32 v250, v250, v255, v255
    v_mfma_f32_16x16x32_bf16 v[172:175], v[36:39], a[108:111], v[172:175]
    ds_read_b128 v[84:87], v5 offset:35840
    v_fma_f32 v251, v251, v255, v255
    s_waitcnt lgkmcnt(6)
    v_mfma_f32_16x16x32_bf16 v[168:171], v[40:43], a[112:115], v[168:171]
    s_waitcnt vmcnt(12)
    s_barrier
    v_mfma_f32_16x16x32_bf16 v[168:171], v[44:47], a[120:123], v[168:171]
    ds_read_b128 v[16:19], v6 offset:0
    v_rcp_f32 v248, v248
    v_mfma_f32_16x16x32_bf16 v[168:171], v[48:51], a[128:131], v[168:171]
    v_rcp_f32 v249, v249
    v_rcp_f32 v250, v250
    v_mfma_f32_16x16x32_bf16 v[168:171], v[52:55], a[136:139], v[168:171]
    ds_read_b128 v[20:23], v6 offset:1024
    v_rcp_f32 v251, v251
    v_mfma_f32_16x16x32_bf16 v[168:171], v[56:59], a[144:147], v[168:171]
    v_mul_f32 v248, v248, v180
    v_mul_f32 v249, v249, v181
    v_mfma_f32_16x16x32_bf16 v[168:171], v[60:63], a[152:155], v[168:171]
    ds_read_b128 v[24:27], v6 offset:2048
    v_mul_f32 v250, v250, v182
    v_mul_f32 v251, v251, v183
    v_mfma_f32_16x16x32_bf16 v[172:175], v[40:43], a[116:119], v[172:175]
    v_cvt_pk_bf16_f32 v236, v248, v249
    v_cvt_pk_bf16_f32 v237, v250, v251
    v_mfma_f32_16x16x32_bf16 v[172:175], v[44:47], a[124:127], v[172:175]
    ds_read_b128 v[28:31], v6 offset:3072
    v_fmaak_f32 v248, v188, v188, 0x409d30fc
    v_fmaak_f32 v249, v189, v189, 0x409d30fc
    v_mfma_f32_16x16x32_bf16 v[172:175], v[48:51], a[132:135], v[172:175]
    v_fmaak_f32 v250, v190, v190, 0x409d30fc
    v_fmaak_f32 v251, v191, v191, 0x409d30fc
    v_mul_f32 v248, v248, v188
    v_mfma_f32_16x16x32_bf16 v[172:175], v[52:55], a[140:143], v[172:175]
    ds_read_b128 v[32:35], v6 offset:4096
    v_mul_f32 v249, v249, v189
    v_mul_f32 v250, v250, v190
    v_mfma_f32_16x16x32_bf16 v[172:175], v[56:59], a[148:151], v[172:175]
    v_mul_f32 v251, v251, v191
    v_exp_f32 v248, v248
    v_mfma_f32_16x16x32_bf16 v[172:175], v[60:63], a[156:159], v[172:175]
    ds_read_b128 v[36:39], v6 offset:5120
    s_waitcnt lgkmcnt(6)
    v_mfma_f32_16x16x32_bf16 v[168:171], v[64:67], a[160:163], v[168:171]
    v_exp_f32 v249, v249
    v_mfma_f32_16x16x32_bf16 v[168:171], v[68:71], a[168:171], v[168:171]
    ds_read_b128 v[40:43], v6 offset:6144
    v_exp_f32 v250, v250
    v_mfma_f32_16x16x32_bf16 v[168:171], v[72:75], a[176:179], v[168:171]
    v_exp_f32 v251, v251
    v_fma_f32 v248, v248, v255, v255
    v_mfma_f32_16x16x32_bf16 v[168:171], v[76:79], a[184:187], v[168:171]
    ds_read_b128 v[44:47], v6 offset:7168
    v_fma_f32 v249, v249, v255, v255
    v_fma_f32 v250, v250, v255, v255
    v_mfma_f32_16x16x32_bf16 v[168:171], v[80:83], a[192:195], v[168:171]
    v_fma_f32 v251, v251, v255, v255
    v_rcp_f32 v248, v248
    v_mfma_f32_16x16x32_bf16 v[168:171], v[84:87], a[200:203], v[168:171]
    ds_read_b128 v[48:51], v6 offset:8192
    v_rcp_f32 v249, v249
    v_mfma_f32_16x16x32_bf16 v[172:175], v[64:67], a[164:167], v[172:175]
    v_rcp_f32 v250, v250
    v_mfma_f32_16x16x32_bf16 v[172:175], v[68:71], a[172:175], v[172:175]
    ds_read_b128 v[52:55], v6 offset:9216
    v_rcp_f32 v251, v251
    v_mfma_f32_16x16x32_bf16 v[172:175], v[72:75], a[180:183], v[172:175]
    v_mul_f32 v248, v248, v188
    v_mul_f32 v249, v249, v189
    v_mul_f32 v250, v250, v190
    v_mfma_f32_16x16x32_bf16 v[172:175], v[76:79], a[188:191], v[172:175]
    ds_read_b128 v[56:59], v6 offset:10240
    v_mul_f32 v251, v251, v191
    v_cvt_pk_bf16_f32 v238, v248, v249
    v_mfma_f32_16x16x32_bf16 v[172:175], v[80:83], a[196:199], v[172:175]
    v_cvt_pk_bf16_f32 v239, v250, v251
    v_mfma_f32_16x16x32_bf16 v[172:175], v[84:87], a[204:207], v[172:175]
    ds_read_b128 v[60:63], v6 offset:11264
    buffer_store_dwordx4 v[236:239], v2, s[8:11], s18 offen sc1
    s_waitcnt lgkmcnt(6)
    v_mfma_f32_16x16x32_bf16 v[176:179], v[16:19], a[64:67], 0
    v_mfma_f32_16x16x32_bf16 v[176:179], v[20:23], a[72:75], v[176:179]
    ds_read_b128 v[64:67], v6 offset:12288
    s_add_u32 s23, s19, 6144
    s_add_u32 s18, s19, 153600
    v_mfma_f32_16x16x32_bf16 v[176:179], v[24:27], a[80:83], v[176:179]
    v_fmaak_f32 v248, v160, v160, 0x409d30fc
    v_fmaak_f32 v249, v161, v161, 0x409d30fc
    v_mfma_f32_16x16x32_bf16 v[176:179], v[28:31], a[88:91], v[176:179]
    ds_read_b128 v[68:71], v6 offset:13312
    v_fmaak_f32 v250, v162, v162, 0x409d30fc
    v_fmaak_f32 v251, v163, v163, 0x409d30fc
    v_mfma_f32_16x16x32_bf16 v[176:179], v[32:35], a[96:99], v[176:179]
    v_mul_f32 v248, v248, v160
    v_mul_f32 v249, v249, v161
    v_mul_f32 v250, v250, v162
    v_mfma_f32_16x16x32_bf16 v[176:179], v[36:39], a[104:107], v[176:179]
    ds_read_b128 v[72:75], v6 offset:14336
    v_mul_f32 v251, v251, v163
    v_mfma_f32_16x16x32_bf16 v[180:183], v[16:19], a[68:71], 0
    v_exp_f32 v248, v248
    v_mfma_f32_16x16x32_bf16 v[180:183], v[20:23], a[76:79], v[180:183]
    ds_read_b128 v[76:79], v6 offset:15360
    v_exp_f32 v249, v249
    v_mfma_f32_16x16x32_bf16 v[180:183], v[24:27], a[84:87], v[180:183]
    v_exp_f32 v250, v250
    v_exp_f32 v251, v251
    v_mfma_f32_16x16x32_bf16 v[180:183], v[28:31], a[92:95], v[180:183]
    ds_read_b128 v[80:83], v6 offset:16384
    v_fma_f32 v248, v248, v255, v255
    v_mfma_f32_16x16x32_bf16 v[180:183], v[32:35], a[100:103], v[180:183]
    v_fma_f32 v249, v249, v255, v255
    v_fma_f32 v250, v250, v255, v255
    v_mfma_f32_16x16x32_bf16 v[180:183], v[36:39], a[108:111], v[180:183]
    ds_read_b128 v[84:87], v6 offset:17408
    v_fma_f32 v251, v251, v255, v255
    s_waitcnt lgkmcnt(6)
    v_mfma_f32_16x16x32_bf16 v[176:179], v[40:43], a[112:115], v[176:179]
    v_rcp_f32 v248, v248
    v_mfma_f32_16x16x32_bf16 v[176:179], v[44:47], a[120:123], v[176:179]
    ds_read_b128 v[16:19], v6 offset:18432
    v_rcp_f32 v249, v249
    v_mfma_f32_16x16x32_bf16 v[176:179], v[48:51], a[128:131], v[176:179]
    v_rcp_f32 v250, v250
    v_mfma_f32_16x16x32_bf16 v[176:179], v[52:55], a[136:139], v[176:179]
    ds_read_b128 v[20:23], v6 offset:19456
    v_rcp_f32 v251, v251
    v_mul_f32 v248, v248, v160
    v_mfma_f32_16x16x32_bf16 v[176:179], v[56:59], a[144:147], v[176:179]
    v_mul_f32 v249, v249, v161
    v_mul_f32 v250, v250, v162
    v_mfma_f32_16x16x32_bf16 v[176:179], v[60:63], a[152:155], v[176:179]
    ds_read_b128 v[24:27], v6 offset:20480
    v_mul_f32 v251, v251, v163
    v_cvt_pk_bf16_f32 v240, v248, v249
    v_mfma_f32_16x16x32_bf16 v[180:183], v[40:43], a[116:119], v[180:183]
    v_cvt_pk_bf16_f32 v241, v250, v251
    v_fmaak_f32 v248, v168, v168, 0x409d30fc
    v_mfma_f32_16x16x32_bf16 v[180:183], v[44:47], a[124:127], v[180:183]
    ds_read_b128 v[28:31], v6 offset:21504
    v_fmaak_f32 v249, v169, v169, 0x409d30fc
    v_fmaak_f32 v250, v170, v170, 0x409d30fc
    v_mfma_f32_16x16x32_bf16 v[180:183], v[48:51], a[132:135], v[180:183]
    v_fmaak_f32 v251, v171, v171, 0x409d30fc
    v_mul_f32 v248, v248, v168
    v_mul_f32 v249, v249, v169
    v_mfma_f32_16x16x32_bf16 v[180:183], v[52:55], a[140:143], v[180:183]
    ds_read_b128 v[32:35], v6 offset:22528
    v_mul_f32 v250, v250, v170
    v_mfma_f32_16x16x32_bf16 v[180:183], v[56:59], a[148:151], v[180:183]
    v_mul_f32 v251, v251, v171
    v_exp_f32 v248, v248
    v_mfma_f32_16x16x32_bf16 v[180:183], v[60:63], a[156:159], v[180:183]
    ds_read_b128 v[36:39], v6 offset:23552
    s_waitcnt lgkmcnt(6)
    v_mfma_f32_16x16x32_bf16 v[176:179], v[64:67], a[160:163], v[176:179]
    v_exp_f32 v249, v249
    v_exp_f32 v250, v250
    v_mfma_f32_16x16x32_bf16 v[176:179], v[68:71], a[168:171], v[176:179]
    ds_read_b128 v[40:43], v6 offset:24576
    v_mfma_f32_16x16x32_bf16 v[176:179], v[72:75], a[176:179], v[176:179]
    v_exp_f32 v251, v251
    v_fma_f32 v248, v248, v255, v255
    v_mfma_f32_16x16x32_bf16 v[176:179], v[76:79], a[184:187], v[176:179]
    ds_read_b128 v[44:47], v6 offset:25600
    v_fma_f32 v249, v249, v255, v255
    v_fma_f32 v250, v250, v255, v255
    v_mfma_f32_16x16x32_bf16 v[176:179], v[80:83], a[192:195], v[176:179]
    v_fma_f32 v251, v251, v255, v255
    v_rcp_f32 v248, v248
    v_mfma_f32_16x16x32_bf16 v[176:179], v[84:87], a[200:203], v[176:179]
    ds_read_b128 v[48:51], v6 offset:26624
    v_rcp_f32 v249, v249
    v_mfma_f32_16x16x32_bf16 v[180:183], v[64:67], a[164:167], v[180:183]
    v_rcp_f32 v250, v250
    v_mfma_f32_16x16x32_bf16 v[180:183], v[68:71], a[172:175], v[180:183]
    ds_read_b128 v[52:55], v6 offset:27648
    v_rcp_f32 v251, v251
    v_mfma_f32_16x16x32_bf16 v[180:183], v[72:75], a[180:183], v[180:183]
    v_mul_f32 v248, v248, v168
    v_mul_f32 v249, v249, v169
    v_mfma_f32_16x16x32_bf16 v[180:183], v[76:79], a[188:191], v[180:183]
    ds_read_b128 v[56:59], v6 offset:28672
    v_mul_f32 v250, v250, v170
    v_mul_f32 v251, v251, v171
    v_mfma_f32_16x16x32_bf16 v[180:183], v[80:83], a[196:199], v[180:183]
    v_cvt_pk_bf16_f32 v242, v248, v249
    v_cvt_pk_bf16_f32 v243, v250, v251
    v_mfma_f32_16x16x32_bf16 v[180:183], v[84:87], a[204:207], v[180:183]
    ds_read_b128 v[60:63], v6 offset:29696
    s_waitcnt lgkmcnt(6)
    v_mfma_f32_16x16x32_bf16 v[184:187], v[16:19], a[64:67], 0
    buffer_store_dwordx4 v[240:243], v2, s[8:11], s23 offen sc1
    v_fmaak_f32 v248, v164, v164, 0x409d30fc
    v_mfma_f32_16x16x32_bf16 v[184:187], v[20:23], a[72:75], v[184:187]
    ds_read_b128 v[64:67], v6 offset:30720
    v_fmaak_f32 v249, v165, v165, 0x409d30fc
    v_mfma_f32_16x16x32_bf16 v[184:187], v[24:27], a[80:83], v[184:187]
    v_fmaak_f32 v250, v166, v166, 0x409d30fc
    v_fmaak_f32 v251, v167, v167, 0x409d30fc
    v_mul_f32 v248, v248, v164
    v_mfma_f32_16x16x32_bf16 v[184:187], v[28:31], a[88:91], v[184:187]
    ds_read_b128 v[68:71], v6 offset:31744
    v_mul_f32 v249, v249, v165
    v_mul_f32 v250, v250, v166
    v_mfma_f32_16x16x32_bf16 v[184:187], v[32:35], a[96:99], v[184:187]
    v_mul_f32 v251, v251, v167
    v_exp_f32 v248, v248
    v_mfma_f32_16x16x32_bf16 v[184:187], v[36:39], a[104:107], v[184:187]
    ds_read_b128 v[72:75], v6 offset:32768
    v_mfma_f32_16x16x32_bf16 v[188:191], v[16:19], a[68:71], 0
    v_exp_f32 v249, v249
    v_exp_f32 v250, v250
    v_mfma_f32_16x16x32_bf16 v[188:191], v[20:23], a[76:79], v[188:191]
    ds_read_b128 v[76:79], v6 offset:33792
    v_exp_f32 v251, v251
    v_mfma_f32_16x16x32_bf16 v[188:191], v[24:27], a[84:87], v[188:191]
    v_fma_f32 v248, v248, v255, v255
    v_fma_f32 v249, v249, v255, v255
    v_mfma_f32_16x16x32_bf16 v[188:191], v[28:31], a[92:95], v[188:191]
    ds_read_b128 v[80:83], v6 offset:34816
    v_fma_f32 v250, v250, v255, v255
    v_fma_f32 v251, v251, v255, v255
    v_mfma_f32_16x16x32_bf16 v[188:191], v[32:35], a[100:103], v[188:191]
    v_rcp_f32 v248, v248
    v_mfma_f32_16x16x32_bf16 v[188:191], v[36:39], a[108:111], v[188:191]
    ds_read_b128 v[84:87], v6 offset:35840
    s_waitcnt lgkmcnt(6)
    v_mfma_f32_16x16x32_bf16 v[184:187], v[40:43], a[112:115], v[184:187]
    s_waitcnt vmcnt(3)
    s_barrier
    v_rcp_f32 v249, v249
    v_mfma_f32_16x16x32_bf16 v[184:187], v[44:47], a[120:123], v[184:187]
    ds_read_b128 v[16:19], v3 offset:0
    v_rcp_f32 v250, v250
    v_mfma_f32_16x16x32_bf16 v[184:187], v[48:51], a[128:131], v[184:187]
    v_rcp_f32 v251, v251
    v_mfma_f32_16x16x32_bf16 v[184:187], v[52:55], a[136:139], v[184:187]
    ds_read_b128 v[20:23], v3 offset:1024
    v_mul_f32 v248, v248, v164
    v_mfma_f32_16x16x32_bf16 v[184:187], v[56:59], a[144:147], v[184:187]
    v_mul_f32 v249, v249, v165
    v_mul_f32 v250, v250, v166
    v_mul_f32 v251, v251, v167
    v_mfma_f32_16x16x32_bf16 v[184:187], v[60:63], a[152:155], v[184:187]
    ds_read_b128 v[24:27], v3 offset:2048
    v_cvt_pk_bf16_f32 v244, v248, v249
    v_cvt_pk_bf16_f32 v245, v250, v251
    v_mfma_f32_16x16x32_bf16 v[188:191], v[40:43], a[116:119], v[188:191]
    v_fmaak_f32 v248, v172, v172, 0x409d30fc
    v_fmaak_f32 v249, v173, v173, 0x409d30fc
    v_mfma_f32_16x16x32_bf16 v[188:191], v[44:47], a[124:127], v[188:191]
    ds_read_b128 v[28:31], v3 offset:3072
    v_fmaak_f32 v250, v174, v174, 0x409d30fc
    v_fmaak_f32 v251, v175, v175, 0x409d30fc
    v_mfma_f32_16x16x32_bf16 v[188:191], v[48:51], a[132:135], v[188:191]
    v_mul_f32 v248, v248, v172
    v_mul_f32 v249, v249, v173
    v_mfma_f32_16x16x32_bf16 v[188:191], v[52:55], a[140:143], v[188:191]
    ds_read_b128 v[32:35], v3 offset:4096
    v_mul_f32 v250, v250, v174
    v_mul_f32 v251, v251, v175
    v_mfma_f32_16x16x32_bf16 v[188:191], v[56:59], a[148:151], v[188:191]
    v_exp_f32 v248, v248
    v_mfma_f32_16x16x32_bf16 v[188:191], v[60:63], a[156:159], v[188:191]
    ds_read_b128 v[36:39], v3 offset:5120
    v_exp_f32 v249, v249
    s_waitcnt lgkmcnt(6)
    v_mfma_f32_16x16x32_bf16 v[184:187], v[64:67], a[160:163], v[184:187]
    v_exp_f32 v250, v250
    v_mfma_f32_16x16x32_bf16 v[184:187], v[68:71], a[168:171], v[184:187]
    ds_read_b128 v[40:43], v3 offset:6144
    v_exp_f32 v251, v251
    v_mfma_f32_16x16x32_bf16 v[184:187], v[72:75], a[176:179], v[184:187]
    v_fma_f32 v248, v248, v255, v255
    v_fma_f32 v249, v249, v255, v255
    v_mfma_f32_16x16x32_bf16 v[184:187], v[76:79], a[184:187], v[184:187]
    ds_read_b128 v[44:47], v3 offset:7168
    v_fma_f32 v250, v250, v255, v255
    v_fma_f32 v251, v251, v255, v255
    v_mfma_f32_16x16x32_bf16 v[184:187], v[80:83], a[192:195], v[184:187]
    v_rcp_f32 v248, v248
    v_mfma_f32_16x16x32_bf16 v[184:187], v[84:87], a[200:203], v[184:187]
    ds_read_b128 v[48:51], v3 offset:8192
    v_rcp_f32 v249, v249
    v_mfma_f32_16x16x32_bf16 v[188:191], v[64:67], a[164:167], v[188:191]
    v_rcp_f32 v250, v250
    v_mfma_f32_16x16x32_bf16 v[188:191], v[68:71], a[172:175], v[188:191]
    ds_read_b128 v[52:55], v3 offset:9216
    v_rcp_f32 v251, v251
    v_mfma_f32_16x16x32_bf16 v[188:191], v[72:75], a[180:183], v[188:191]
    v_mul_f32 v248, v248, v172
    v_mul_f32 v249, v249, v173
    v_mul_f32 v250, v250, v174
    v_mfma_f32_16x16x32_bf16 v[188:191], v[76:79], a[188:191], v[188:191]
    ds_read_b128 v[56:59], v3 offset:10240
    v_mul_f32 v251, v251, v175
    v_cvt_pk_bf16_f32 v246, v248, v249
    v_mfma_f32_16x16x32_bf16 v[188:191], v[80:83], a[196:199], v[188:191]
    v_cvt_pk_bf16_f32 v247, v250, v251
    v_mfma_f32_16x16x32_bf16 v[188:191], v[84:87], a[204:207], v[188:191]
    ds_read_b128 v[60:63], v3 offset:11264
    buffer_store_dwordx4 v[244:247], v2, s[8:11], s18 offen sc1
    s_waitcnt lgkmcnt(6)
    v_mfma_f32_16x16x32_bf16 v[160:163], v[16:19], a[64:67], 0
    v_mfma_f32_16x16x32_bf16 v[160:163], v[20:23], a[72:75], v[160:163]
    ds_read_b128 v[64:67], v3 offset:12288
    s_add_u32 s23, s19, 7168
    s_add_u32 s18, s19, 154624
    v_mfma_f32_16x16x32_bf16 v[160:163], v[24:27], a[80:83], v[160:163]
    s_add_u32 s48, s47, 104824832
    v_fmaak_f32 v248, v176, v176, 0x409d30fc
    v_mfma_f32_16x16x32_bf16 v[160:163], v[28:31], a[88:91], v[160:163]
    ds_read_b128 v[68:71], v3 offset:13312
    v_mov_b32 v192, 104819776
    v_fmaak_f32 v249, v177, v177, 0x409d30fc
    v_mfma_f32_16x16x32_bf16 v[160:163], v[32:35], a[96:99], v[160:163]
    v_mov_b32 v193, 0x100
    v_fmaak_f32 v250, v178, v178, 0x409d30fc
    v_mfma_f32_16x16x32_bf16 v[160:163], v[36:39], a[104:107], v[160:163]
    ds_read_b128 v[72:75], v3 offset:14336
    v_mov_b32 v195, s48
    v_fmaak_f32 v251, v179, v179, 0x409d30fc
    v_mfma_f32_16x16x32_bf16 v[164:167], v[16:19], a[68:71], 0
    v_cmp_eq_u32 vcc, 0, v1
    v_mul_f32 v248, v248, v176
    v_mfma_f32_16x16x32_bf16 v[164:167], v[20:23], a[76:79], v[164:167]
    ds_read_b128 v[76:79], v3 offset:15360
    v_mul_f32 v249, v249, v177
    v_mul_f32 v250, v250, v178
    v_mfma_f32_16x16x32_bf16 v[164:167], v[24:27], a[84:87], v[164:167]
    v_mul_f32 v251, v251, v179
    v_exp_f32 v248, v248
    v_mfma_f32_16x16x32_bf16 v[164:167], v[28:31], a[92:95], v[164:167]
    ds_read_b128 v[80:83], v3 offset:16384
    v_cndmask_b32 v192, v192, v195, vcc
    v_mfma_f32_16x16x32_bf16 v[164:167], v[32:35], a[100:103], v[164:167]
    v_cndmask_b32 v193, v193, 16, vcc
    v_exp_f32 v249, v249
    v_mfma_f32_16x16x32_bf16 v[164:167], v[36:39], a[108:111], v[164:167]
    ds_read_b128 v[84:87], v3 offset:17408
    s_waitcnt lgkmcnt(6)
    v_mfma_f32_16x16x32_bf16 v[160:163], v[40:43], a[112:115], v[160:163]
    buffer_load_dword v194, v192, s[8:11], 0 offen sc1
    v_exp_f32 v250, v250
    v_mfma_f32_16x16x32_bf16 v[160:163], v[44:47], a[120:123], v[160:163]
    ds_read_b128 v[16:19], v3 offset:18432
    v_mfma_f32_16x16x32_bf16 v[160:163], v[48:51], a[128:131], v[160:163]
    v_exp_f32 v251, v251
    v_fma_f32 v248, v248, v255, v255
    v_mfma_f32_16x16x32_bf16 v[160:163], v[52:55], a[136:139], v[160:163]
    ds_read_b128 v[20:23], v3 offset:19456
    v_fma_f32 v249, v249, v255, v255
    v_fma_f32 v250, v250, v255, v255
    v_mfma_f32_16x16x32_bf16 v[160:163], v[56:59], a[144:147], v[160:163]
    v_fma_f32 v251, v251, v255, v255
    v_rcp_f32 v248, v248
    v_mfma_f32_16x16x32_bf16 v[160:163], v[60:63], a[152:155], v[160:163]
    ds_read_b128 v[24:27], v3 offset:20480
    v_mfma_f32_16x16x32_bf16 v[164:167], v[40:43], a[116:119], v[164:167]
    v_rcp_f32 v249, v249
    v_rcp_f32 v250, v250
    v_mfma_f32_16x16x32_bf16 v[164:167], v[44:47], a[124:127], v[164:167]
    ds_read_b128 v[28:31], v3 offset:21504
    v_rcp_f32 v251, v251
    v_mfma_f32_16x16x32_bf16 v[164:167], v[48:51], a[132:135], v[164:167]
    v_mul_f32 v248, v248, v176
    v_mul_f32 v249, v249, v177
    v_mfma_f32_16x16x32_bf16 v[164:167], v[52:55], a[140:143], v[164:167]
    ds_read_b128 v[32:35], v3 offset:22528
    v_mul_f32 v250, v250, v178
    v_mfma_f32_16x16x32_bf16 v[164:167], v[56:59], a[148:151], v[164:167]
    v_mul_f32 v251, v251, v179
    v_cvt_pk_bf16_f32 v232, v248, v249
    v_cvt_pk_bf16_f32 v233, v250, v251
    v_mfma_f32_16x16x32_bf16 v[164:167], v[60:63], a[156:159], v[164:167]
    ds_read_b128 v[36:39], v3 offset:23552
    s_waitcnt lgkmcnt(6)
    v_mfma_f32_16x16x32_bf16 v[160:163], v[64:67], a[160:163], v[160:163]
    v_fmaak_f32 v248, v184, v184, 0x409d30fc
    v_fmaak_f32 v249, v185, v185, 0x409d30fc
    v_fmaak_f32 v250, v186, v186, 0x409d30fc
    v_mfma_f32_16x16x32_bf16 v[160:163], v[68:71], a[168:171], v[160:163]
    ds_read_b128 v[40:43], v3 offset:24576
    v_fmaak_f32 v251, v187, v187, 0x409d30fc
    v_mfma_f32_16x16x32_bf16 v[160:163], v[72:75], a[176:179], v[160:163]
    v_mul_f32 v248, v248, v184
    v_mul_f32 v249, v249, v185
    v_mul_f32 v250, v250, v186
    v_mfma_f32_16x16x32_bf16 v[160:163], v[76:79], a[184:187], v[160:163]
    ds_read_b128 v[44:47], v3 offset:25600
    v_mul_f32 v251, v251, v187
    v_mfma_f32_16x16x32_bf16 v[160:163], v[80:83], a[192:195], v[160:163]
    v_exp_f32 v248, v248
    v_exp_f32 v249, v249
    v_mfma_f32_16x16x32_bf16 v[160:163], v[84:87], a[200:203], v[160:163]
    ds_read_b128 v[48:51], v3 offset:26624
    v_mfma_f32_16x16x32_bf16 v[164:167], v[64:67], a[164:167], v[164:167]
    v_exp_f32 v250, v250
    v_exp_f32 v251, v251
    v_mfma_f32_16x16x32_bf16 v[164:167], v[68:71], a[172:175], v[164:167]
    ds_read_b128 v[52:55], v3 offset:27648
    v_fma_f32 v248, v248, v255, v255
    v_mfma_f32_16x16x32_bf16 v[164:167], v[72:75], a[180:183], v[164:167]
    v_fma_f32 v249, v249, v255, v255
    v_fma_f32 v250, v250, v255, v255
    v_mfma_f32_16x16x32_bf16 v[164:167], v[76:79], a[188:191], v[164:167]
    ds_read_b128 v[56:59], v3 offset:28672
    v_fma_f32 v251, v251, v255, v255
    v_mfma_f32_16x16x32_bf16 v[164:167], v[80:83], a[196:199], v[164:167]
    v_rcp_f32 v248, v248
    v_rcp_f32 v249, v249
    v_mfma_f32_16x16x32_bf16 v[164:167], v[84:87], a[204:207], v[164:167]
    ds_read_b128 v[60:63], v3 offset:29696
    s_waitcnt lgkmcnt(6)
    v_mfma_f32_16x16x32_bf16 v[168:171], v[16:19], a[64:67], 0
    v_rcp_f32 v250, v250
    v_mfma_f32_16x16x32_bf16 v[168:171], v[20:23], a[72:75], v[168:171]
    ds_read_b128 v[64:67], v3 offset:30720
    v_rcp_f32 v251, v251
    v_mfma_f32_16x16x32_bf16 v[168:171], v[24:27], a[80:83], v[168:171]
    v_mul_f32 v248, v248, v184
    v_mul_f32 v249, v249, v185
    v_mul_f32 v250, v250, v186
    v_mfma_f32_16x16x32_bf16 v[168:171], v[28:31], a[88:91], v[168:171]
    ds_read_b128 v[68:71], v3 offset:31744
    v_mul_f32 v251, v251, v187
    v_mfma_f32_16x16x32_bf16 v[168:171], v[32:35], a[96:99], v[168:171]
    v_cvt_pk_bf16_f32 v234, v248, v249
    v_cvt_pk_bf16_f32 v235, v250, v251
    v_mfma_f32_16x16x32_bf16 v[168:171], v[36:39], a[104:107], v[168:171]
    ds_read_b128 v[72:75], v3 offset:32768
    buffer_store_dwordx4 v[232:235], v2, s[8:11], s23 offen sc1
    v_mfma_f32_16x16x32_bf16 v[172:175], v[16:19], a[68:71], 0
    v_fmaak_f32 v248, v180, v180, 0x409d30fc
    v_fmaak_f32 v249, v181, v181, 0x409d30fc
    v_mfma_f32_16x16x32_bf16 v[172:175], v[20:23], a[76:79], v[172:175]
    ds_read_b128 v[76:79], v3 offset:33792
    v_fmaak_f32 v250, v182, v182, 0x409d30fc
    v_mfma_f32_16x16x32_bf16 v[172:175], v[24:27], a[84:87], v[172:175]
    v_fmaak_f32 v251, v183, v183, 0x409d30fc
    v_mul_f32 v248, v248, v180
    v_mul_f32 v249, v249, v181
    v_mfma_f32_16x16x32_bf16 v[172:175], v[28:31], a[92:95], v[172:175]
    ds_read_b128 v[80:83], v3 offset:34816
    v_mul_f32 v250, v250, v182
    v_mul_f32 v251, v251, v183
    v_mfma_f32_16x16x32_bf16 v[172:175], v[32:35], a[100:103], v[172:175]
    v_exp_f32 v248, v248
    v_mfma_f32_16x16x32_bf16 v[172:175], v[36:39], a[108:111], v[172:175]
    ds_read_b128 v[84:87], v3 offset:35840
    s_waitcnt lgkmcnt(6)
    v_mfma_f32_16x16x32_bf16 v[168:171], v[40:43], a[112:115], v[168:171]
    v_exp_f32 v249, v249
    v_exp_f32 v250, v250
    v_mfma_f32_16x16x32_bf16 v[168:171], v[44:47], a[120:123], v[168:171]
    v_exp_f32 v251, v251
    v_mfma_f32_16x16x32_bf16 v[168:171], v[48:51], a[128:131], v[168:171]
    v_fma_f32 v248, v248, v255, v255
    v_fma_f32 v249, v249, v255, v255
    v_mfma_f32_16x16x32_bf16 v[168:171], v[52:55], a[136:139], v[168:171]
    v_fma_f32 v250, v250, v255, v255
    v_fma_f32 v251, v251, v255, v255
    v_mfma_f32_16x16x32_bf16 v[168:171], v[56:59], a[144:147], v[168:171]
    v_rcp_f32 v248, v248
    v_rcp_f32 v249, v249
    v_mfma_f32_16x16x32_bf16 v[168:171], v[60:63], a[152:155], v[168:171]
    v_rcp_f32 v250, v250
    v_mfma_f32_16x16x32_bf16 v[172:175], v[40:43], a[116:119], v[172:175]
    v_rcp_f32 v251, v251
    v_mul_f32 v248, v248, v180
    v_mfma_f32_16x16x32_bf16 v[172:175], v[44:47], a[124:127], v[172:175]
    v_mul_f32 v249, v249, v181
    v_mul_f32 v250, v250, v182
    v_mfma_f32_16x16x32_bf16 v[172:175], v[48:51], a[132:135], v[172:175]
    v_mul_f32 v251, v251, v183
    v_cvt_pk_bf16_f32 v236, v248, v249
    v_cvt_pk_bf16_f32 v237, v250, v251
    v_mfma_f32_16x16x32_bf16 v[172:175], v[52:55], a[140:143], v[172:175]
    v_fmaak_f32 v248, v188, v188, 0x409d30fc
    v_fmaak_f32 v249, v189, v189, 0x409d30fc
    v_mfma_f32_16x16x32_bf16 v[172:175], v[56:59], a[148:151], v[172:175]
    v_fmaak_f32 v250, v190, v190, 0x409d30fc
    v_fmaak_f32 v251, v191, v191, 0x409d30fc
    v_mul_f32 v248, v248, v188
    v_mfma_f32_16x16x32_bf16 v[172:175], v[60:63], a[156:159], v[172:175]
    v_mul_f32 v249, v249, v189
    s_waitcnt lgkmcnt(0)
    v_mfma_f32_16x16x32_bf16 v[168:171], v[64:67], a[160:163], v[168:171]
    v_mul_f32 v250, v250, v190
    v_mul_f32 v251, v251, v191
    v_mfma_f32_16x16x32_bf16 v[168:171], v[68:71], a[168:171], v[168:171]
    v_exp_f32 v248, v248
    v_exp_f32 v249, v249
    v_mfma_f32_16x16x32_bf16 v[168:171], v[72:75], a[176:179], v[168:171]
    v_exp_f32 v250, v250
    v_mfma_f32_16x16x32_bf16 v[168:171], v[76:79], a[184:187], v[168:171]
    v_exp_f32 v251, v251
    v_fma_f32 v248, v248, v255, v255
    v_mfma_f32_16x16x32_bf16 v[168:171], v[80:83], a[192:195], v[168:171]
    v_fma_f32 v249, v249, v255, v255
    v_fma_f32 v250, v250, v255, v255
    v_mfma_f32_16x16x32_bf16 v[168:171], v[84:87], a[200:203], v[168:171]
    v_fma_f32 v251, v251, v255, v255
    v_rcp_f32 v248, v248
    v_mfma_f32_16x16x32_bf16 v[172:175], v[64:67], a[164:167], v[172:175]
    v_rcp_f32 v249, v249
    v_mfma_f32_16x16x32_bf16 v[172:175], v[68:71], a[172:175], v[172:175]
    v_rcp_f32 v250, v250
    v_mfma_f32_16x16x32_bf16 v[172:175], v[72:75], a[180:183], v[172:175]
    v_rcp_f32 v251, v251
    v_mul_f32 v248, v248, v188
    v_mfma_f32_16x16x32_bf16 v[172:175], v[76:79], a[188:191], v[172:175]
    v_mul_f32 v249, v249, v189
    v_mul_f32 v250, v250, v190
    v_mul_f32 v251, v251, v191
    v_mfma_f32_16x16x32_bf16 v[172:175], v[80:83], a[196:199], v[172:175]
    v_cvt_pk_bf16_f32 v238, v248, v249
    v_cvt_pk_bf16_f32 v239, v250, v251
    v_mfma_f32_16x16x32_bf16 v[172:175], v[84:87], a[204:207], v[172:175]
    buffer_store_dwordx4 v[236:239], v2, s[8:11], s18 offen sc1
    s_add_u32 s23, s19, 8192
    s_add_u32 s18, s19, 155648
    v_fmaak_f32 v248, v160, v160, 0x409d30fc
    v_fmaak_f32 v249, v161, v161, 0x409d30fc
    v_fmaak_f32 v250, v162, v162, 0x409d30fc
    v_fmaak_f32 v251, v163, v163, 0x409d30fc
    v_mul_f32 v248, v248, v160
    v_mul_f32 v249, v249, v161
    v_mul_f32 v250, v250, v162
    v_mul_f32 v251, v251, v163
    v_exp_f32 v248, v248
    v_exp_f32 v249, v249
    v_exp_f32 v250, v250
    v_exp_f32 v251, v251
    v_fma_f32 v248, v248, v255, v255
    v_fma_f32 v249, v249, v255, v255
    v_fma_f32 v250, v250, v255, v255
    v_fma_f32 v251, v251, v255, v255
    v_rcp_f32 v248, v248
    v_rcp_f32 v249, v249
    v_rcp_f32 v250, v250
    v_rcp_f32 v251, v251
    v_mul_f32 v248, v248, v160
    v_mul_f32 v249, v249, v161
    v_mul_f32 v250, v250, v162
    v_mul_f32 v251, v251, v163
    v_cvt_pk_bf16_f32 v240, v248, v249
    v_cvt_pk_bf16_f32 v241, v250, v251
    v_fmaak_f32 v248, v168, v168, 0x409d30fc
    v_fmaak_f32 v249, v169, v169, 0x409d30fc
    v_fmaak_f32 v250, v170, v170, 0x409d30fc
    v_fmaak_f32 v251, v171, v171, 0x409d30fc
    v_mul_f32 v248, v248, v168
    v_mul_f32 v249, v249, v169
    v_mul_f32 v250, v250, v170
    v_mul_f32 v251, v251, v171
    v_exp_f32 v248, v248
    v_exp_f32 v249, v249
    v_exp_f32 v250, v250
    v_exp_f32 v251, v251
    v_fma_f32 v248, v248, v255, v255
    v_fma_f32 v249, v249, v255, v255
    v_fma_f32 v250, v250, v255, v255
    v_fma_f32 v251, v251, v255, v255
    v_rcp_f32 v248, v248
    v_rcp_f32 v249, v249
    v_rcp_f32 v250, v250
    v_rcp_f32 v251, v251
    v_mul_f32 v248, v248, v168
    v_mul_f32 v249, v249, v169
    v_mul_f32 v250, v250, v170
    v_mul_f32 v251, v251, v171
    v_cvt_pk_bf16_f32 v242, v248, v249
    v_cvt_pk_bf16_f32 v243, v250, v251
    buffer_store_dwordx4 v[240:243], v2, s[8:11], s23 offen sc1
    v_fmaak_f32 v248, v164, v164, 0x409d30fc
    v_fmaak_f32 v249, v165, v165, 0x409d30fc
    v_fmaak_f32 v250, v166, v166, 0x409d30fc
    v_fmaak_f32 v251, v167, v167, 0x409d30fc
    v_mul_f32 v248, v248, v164
    v_mul_f32 v249, v249, v165
    v_mul_f32 v250, v250, v166
    v_mul_f32 v251, v251, v167
    v_exp_f32 v248, v248
    v_exp_f32 v249, v249
    v_exp_f32 v250, v250
    v_exp_f32 v251, v251
    v_fma_f32 v248, v248, v255, v255
    v_fma_f32 v249, v249, v255, v255
    v_fma_f32 v250, v250, v255, v255
    v_fma_f32 v251, v251, v255, v255
    v_rcp_f32 v248, v248
    v_rcp_f32 v249, v249
    v_rcp_f32 v250, v250
    v_rcp_f32 v251, v251
    v_mul_f32 v248, v248, v164
    v_mul_f32 v249, v249, v165
    v_mul_f32 v250, v250, v166
    v_mul_f32 v251, v251, v167
    v_cvt_pk_bf16_f32 v244, v248, v249
    v_cvt_pk_bf16_f32 v245, v250, v251
    v_fmaak_f32 v248, v172, v172, 0x409d30fc
    v_fmaak_f32 v249, v173, v173, 0x409d30fc
    v_fmaak_f32 v250, v174, v174, 0x409d30fc
    v_fmaak_f32 v251, v175, v175, 0x409d30fc
    v_mul_f32 v248, v248, v172
    v_mul_f32 v249, v249, v173
    v_mul_f32 v250, v250, v174
    v_mul_f32 v251, v251, v175
    v_exp_f32 v248, v248
    v_exp_f32 v249, v249
    v_exp_f32 v250, v250
    v_exp_f32 v251, v251
    v_fma_f32 v248, v248, v255, v255
    v_fma_f32 v249, v249, v255, v255
    v_fma_f32 v250, v250, v255, v255
    v_fma_f32 v251, v251, v255, v255
    v_rcp_f32 v248, v248
    v_rcp_f32 v249, v249
    v_rcp_f32 v250, v250
    v_rcp_f32 v251, v251
    v_mul_f32 v248, v248, v172
    v_mul_f32 v249, v249, v173
    v_mul_f32 v250, v250, v174
    v_mul_f32 v251, v251, v175
    v_cvt_pk_bf16_f32 v246, v248, v249
    v_cvt_pk_bf16_f32 v247, v250, v251
    buffer_store_dwordx4 v[244:247], v2, s[8:11], s18 offen sc1
    s_add_u32 s33, s47, 104825856
    s_barrier
    s_mov_b32 s61, s46
    s_and_b32 s30, s2, 7
    s_lshr_b32 s31, s2, 3
    s_lshr_b32 s4, s30, 1
    s_and_b32 s5, s30, 1
    s_lshl_b32 s5, s5, 3
    s_lshr_b32 s16, s31, 2
    s_add_u32 s5, s5, s16
    s_and_b32 s16, s31, 3
    s_lshl_b32 s17, s5, 2
    s_add_u32 s17, s17, s16
    s_and_b32 s28, s4, 1
    s_mul_i32 s28, s28, 5
    s_lshr_b32 s29, s4, 1
    s_mul_i32 s21, s3, 9216
    s_lshl_b32 s36, s5, 3
    s_lshl_b32 s37, s3, 1
    s_add_u32 s36, s36, s37
    s_mul_i32 s30, s3, 9
    v_add_u32 v13, s30, v1
    v_and_b32 v14, 3, v13
    v_and_b32 v15, 3, v1
    v_sub_u32 v14, v14, v15
    v_add_u32 v14, 4, v14
    v_lshrrev_b32 v13, 2, v13
    v_add_u32 v13, s28, v13
    v_subrev_u32 v15, 9, v13
    v_min_u32 v13, v13, v15
    v_mul_u32_u24 v15, 128, v13
    v_add_u32 v15, v15, v14
    v_lshlrev_b32 v15, 10, v15
    s_nop 0
    v_readlane_b32 s52, v15, 0
    v_readlane_b32 s53, v15, 1
    v_readlane_b32 s54, v15, 2
    v_readlane_b32 s55, v15, 3
    v_readlane_b32 s56, v15, 4
    v_readlane_b32 s57, v15, 5
    v_readlane_b32 s58, v15, 6
    v_readlane_b32 s59, v15, 7
    v_readlane_b32 s60, v15, 8
    s_mul_i32 s22, s16, 1152
    s_mul_i32 s31, s4, 32
    s_add_u32 s22, s22, s31
    s_lshl_b32 s22, s22, 10
    s_add_u32 s22, s22, 57036800
    v_add_u32 v7, s22, v2
    s_xor_b32 s22, s29, 0
    s_add_u32 s22, s22, s36
    s_mul_i32 s22, s22, 128
    s_add_u32 s22, s22, s31
    s_lshl_b32 s22, s22, 10
    s_add_u32 s22, s22, 28909568
    v_add_u32 v9, s22, v2
    s_xor_b32 s22, s29, 1
    s_add_u32 s22, s22, s36
    s_mul_i32 s22, s22, 128
    s_add_u32 s22, s22, s31
    s_lshl_b32 s22, s22, 10
    s_add_u32 s22, s22, 28909568
    v_add_u32 v10, s22, v2
    v_mul_u32_u24 v15, 144, v13
    v_add_u32 v15, v15, v14
    v_lshlrev_b32 v15, 10, v15
    s_nop 0
    v_readlane_b32 s62, v15, 0
    v_readlane_b32 s63, v15, 1
    v_readlane_b32 s64, v15, 2
    v_readlane_b32 s65, v15, 3
    v_readlane_b32 s66, v15, 4
    v_readlane_b32 s67, v15, 5
    v_readlane_b32 s68, v15, 6
    v_readlane_b32 s69, v15, 7
    v_readlane_b32 s70, v15, 8
    s_mul_i32 s22, s16, 1296
    s_mul_i32 s31, s4, 36
    s_add_u32 s22, s22, s31
    s_lshl_b32 s22, s22, 10
    s_add_u32 s22, s22, 61755392
    v_add_u32 v8, s22, v2
    s_xor_b32 s22, s29, 0
    s_add_u32 s22, s22, s36
    s_mul_i32 s22, s22, 144
    s_add_u32 s22, s22, s31
    s_lshl_b32 s22, s22, 10
    s_add_u32 s22, s22, 10035200
    v_add_u32 v11, s22, v2
    s_xor_b32 s22, s29, 1
    s_add_u32 s22, s22, s36
    s_mul_i32 s22, s22, 144
    s_add_u32 s22, s22, s31
    s_lshl_b32 s22, s22, 10
    s_add_u32 s22, s22, 10035200
    v_add_u32 v12, s22, v2
    v_mov_b32 v3, v2
    v_add_u32 v4, 36864, v2
    v_add_u32 v5, 73728, v2
    v_add_u32 v6, 110592, v2
    s_waitcnt vmcnt(4)
    v_cmp_lt_u32 vcc, v194, v193
    s_nop 3
    s_cbranch_vccz kmain_kernel_fook
    s_mov_b32 s34, 0
kmain_kernel_w3_11:
    buffer_load_dword v194, v192, s[8:11], 0 offen sc1
    s_waitcnt vmcnt(0)
    v_cmp_lt_u32 vcc, v194, v193
    s_cbranch_vccz kmain_kernel_w3_11_o
    s_add_u32 s34, s34, 1
    s_cmp_ge_u32 s34, 0x20000
    s_cbranch_scc1 kmain_kernel_w3_11_o
    s_sleep 8
    s_branch kmain_kernel_w3_11
kmain_kernel_w3_11_o:
kmain_kernel_fook:
    s_add_u32 m0, s21, 0
    s_nop 0
    buffer_load_dwordx4 v7, s[8:11], s52 offen offset:0 lds
    buffer_load_dwordx4 v7, s[8:11], s53 offen offset:1024 lds
    buffer_load_dwordx4 v7, s[8:11], s54 offen offset:2048 lds
    buffer_load_dwordx4 v7, s[8:11], s55 offen offset:3072 lds
    s_add_u32 m0, s21, 4096
    s_nop 0
    buffer_load_dwordx4 v7, s[8:11], s56 offen offset:0 lds
    buffer_load_dwordx4 v7, s[8:11], s57 offen offset:1024 lds
    buffer_load_dwordx4 v7, s[8:11], s58 offen offset:2048 lds
    buffer_load_dwordx4 v7, s[8:11], s59 offen offset:3072 lds
    s_add_u32 m0, s21, 8192
    s_nop 0
    buffer_load_dwordx4 v7, s[8:11], s60 offen offset:0 lds
    v_add_u32 v7, 4096, v7
    buffer_load_dwordx4 v[16:19], v9, s[8:11], 0 offen offset:0 sc1
    buffer_load_dwordx4 v[20:23], v9, s[8:11], 0 offen offset:1024 sc1
    buffer_load_dwordx4 v[24:27], v9, s[8:11], 0 offen offset:2048 sc1
    buffer_load_dwordx4 v[28:31], v9, s[8:11], 0 offen offset:3072 sc1
    buffer_load_dwordx4 v[32:35], v10, s[8:11], 0 offen offset:0 sc1
    buffer_load_dwordx4 v[36:39], v10, s[8:11], 0 offen offset:1024 sc1
    buffer_load_dwordx4 v[40:43], v10, s[8:11], 0 offen offset:2048 sc1
    buffer_load_dwordx4 v[44:47], v10, s[8:11], 0 offen offset:3072 sc1
    v_add_u32 v9, 4096, v9
    v_add_u32 v10, 4096, v10
    s_add_u32 m0, s21, 36864
    s_nop 0
    buffer_load_dwordx4 v7, s[8:11], s52 offen offset:0 lds
    buffer_load_dwordx4 v7, s[8:11], s53 offen offset:1024 lds
    buffer_load_dwordx4 v7, s[8:11], s54 offen offset:2048 lds
    buffer_load_dwordx4 v7, s[8:11], s55 offen offset:3072 lds
    s_add_u32 m0, s21, 40960
    s_nop 0
    buffer_load_dwordx4 v7, s[8:11], s56 offen offset:0 lds
    buffer_load_dwordx4 v7, s[8:11], s57 offen offset:1024 lds
    buffer_load_dwordx4 v7, s[8:11], s58 offen offset:2048 lds
    buffer_load_dwordx4 v7, s[8:11], s59 offen offset:3072 lds
    s_add_u32 m0, s21, 45056
    s_nop 0
    buffer_load_dwordx4 v7, s[8:11], s60 offen offset:0 lds
    v_add_u32 v7, 4096, v7
    buffer_load_dwordx4 v[48:51], v9, s[8:11], 0 offen offset:0 sc1
    buffer_load_dwordx4 v[52:55], v9, s[8:11], 0 offen offset:1024 sc1
    buffer_load_dwordx4 v[56:59], v9, s[8:11], 0 offen offset:2048 sc1
    buffer_load_dwordx4 v[60:63], v9, s[8:11], 0 offen offset:3072 sc1
    buffer_load_dwordx4 v[64:67], v10, s[8:11], 0 offen offset:0 sc1
    buffer_load_dwordx4 v[68:71], v10, s[8:11], 0 offen offset:1024 sc1
    buffer_load_dwordx4 v[72:75], v10, s[8:11], 0 offen offset:2048 sc1
    buffer_load_dwordx4 v[76:79], v10, s[8:11], 0 offen offset:3072 sc1
    v_add_u32 v9, 4096, v9
    v_add_u32 v10, 4096, v10
    buffer_load_dwordx4 v[80:83], v9, s[8:11], 0 offen offset:0 sc1
    buffer_load_dwordx4 v[84:87], v9, s[8:11], 0 offen offset:1024 sc1
    buffer_load_dwordx4 v[88:91], v9, s[8:11], 0 offen offset:2048 sc1
    buffer_load_dwordx4 v[92:95], v9, s[8:11], 0 offen offset:3072 sc1
    buffer_load_dwordx4 v[96:99], v10, s[8:11], 0 offen offset:0 sc1
    buffer_load_dwordx4 v[100:103], v10, s[8:11], 0 offen offset:1024 sc1
    buffer_load_dwordx4 v[104:107], v10, s[8:11], 0 offen offset:2048 sc1
    buffer_load_dwordx4 v[108:111], v10, s[8:11], 0 offen offset:3072 sc1
    v_add_u32 v9, 4096, v9
    v_add_u32 v10, 4096, v10
    s_lshl_b32 s38, s17, 5
    s_add_u32 s38, s38, s3
    s_mul_i32 s38, s38, 9216
    s_add_u32 s38, s38, 67067904
    s_mul_i32 s39, s4, 36864
    s_add_u32 s39, s39, s38
    s_lshl_b32 s48, s17, 6
    s_add_u32 s48, s48, 104820736
    s_load_dwordx2 s[12:13], s[0:1], 0
    s_load_dwordx2 s[14:15], s[0:1], 80
    v_and_b32 v13, 15, v1
    v_lshrrev_b32 v14, 4, v1
    s_add_u32 s37, s36, s29
    s_lshl_b32 s22, s37, 4
    v_add_u32 v15, s22, v13
    s_movk_i32 s22, 1152
    v_mul_lo_u32 v15, v15, s22
    v_lshl_add_u32 v15, v14, 3, v15
    s_mul_i32 s22, s16, 288
    v_add_u32 v15, s22, v15
    v_lshrrev_b32 v238, 1, v14
    v_lshlrev_b32 v238, 8, v238
    v_lshl_add_u32 v238, v13, 4, v238
    v_and_b32 v239, 1, v14
    v_lshl_add_u32 v238, v239, 3, v238
    s_mul_i32 s37, s37, 18432
    s_add_u32 s37, s37, 4718592
    s_add_u32 s22, s28, 0
    s_cmp_ge_u32 s22, 9
    s_cselect_b32 s23, 9, 0
    s_sub_u32 s22, s22, s23
    s_lshl_b32 s23, s22, 5
    v_add_u32 v228, s23, v15
    s_mul_i32 s23, s16, 9
    s_add_u32 s22, s22, s23
    s_lshr_b32 s23, s22, 1
    s_lshl_b32 s23, s23, 10
    s_and_b32 s22, s22, 1
    s_lshl_b32 s22, s22, 9
    s_add_u32 s22, s22, s23
    s_add_u32 s22, s22, s37
    v_add_u32 v233, s22, v238
    s_add_u32 s22, s28, 1
    s_cmp_ge_u32 s22, 9
    s_cselect_b32 s23, 9, 0
    s_sub_u32 s22, s22, s23
    s_lshl_b32 s23, s22, 5
    v_add_u32 v229, s23, v15
    s_mul_i32 s23, s16, 9
    s_add_u32 s22, s22, s23
    s_lshr_b32 s23, s22, 1
    s_lshl_b32 s23, s23, 10
    s_and_b32 s22, s22, 1
    s_lshl_b32 s22, s22, 9
    s_add_u32 s22, s22, s23
    s_add_u32 s22, s22, s37
    v_add_u32 v234, s22, v238
    s_add_u32 s22, s28, 2
    s_cmp_ge_u32 s22, 9
    s_cselect_b32 s23, 9, 0
    s_sub_u32 s22, s22, s23
    s_lshl_b32 s23, s22, 5
    v_add_u32 v230, s23, v15
    s_mul_i32 s23, s16, 9
    s_add_u32 s22, s22, s23
    s_lshr_b32 s23, s22, 1
    s_lshl_b32 s23, s23, 10
    s_and_b32 s22, s22, 1
    s_lshl_b32 s22, s22, 9
    s_add_u32 s22, s22, s23
    s_add_u32 s22, s22, s37
    v_add_u32 v235, s22, v238
    s_add_u32 s22, s28, 3
    s_cmp_ge_u32 s22, 9
    s_cselect_b32 s23, 9, 0
    s_sub_u32 s22, s22, s23
    s_lshl_b32 s23, s22, 5
    v_add_u32 v231, s23, v15
    s_mul_i32 s23, s16, 9
    s_add_u32 s22, s22, s23
    s_lshr_b32 s23, s22, 1
    s_lshl_b32 s23, s23, 10
    s_and_b32 s22, s22, 1
    s_lshl_b32 s22, s22, 9
    s_add_u32 s22, s22, s23
    s_add_u32 s22, s22, s37
    v_add_u32 v236, s22, v238
    s_add_u32 s22, s28, 4
    s_cmp_ge_u32 s22, 9
    s_cselect_b32 s23, 9, 0
    s_sub_u32 s22, s22, s23
    s_lshl_b32 s23, s22, 5
    v_add_u32 v232, s23, v15
    s_mul_i32 s23, s16, 9
    s_add_u32 s22, s22, s23
    s_lshr_b32 s23, s22, 1
    s_lshl_b32 s23, s23, 10
    s_and_b32 s22, s22, 1
    s_lshl_b32 s22, s22, 9
    s_add_u32 s22, s22, s23
    s_add_u32 s22, s22, s37
    v_add_u32 v237, s22, v238
    s_waitcnt lgkmcnt(0)
    s_mov_b32 s40, s12
    s_mov_b32 s41, s13
    s_mov_b32 s42, 2359296
    s_mov_b32 s43, 0x20000
    s_mov_b32 s44, s14
    s_mov_b32 s45, s15
    s_mov_b32 s46, 2359296
    s_mov_b32 s47, 0x20000
    v_lshlrev_b32 v226, 3, v1
    s_add_u32 s22, s28, 4
    s_cmp_ge_u32 s22, 9
    s_cselect_b32 s23, 9, 0
    s_sub_u32 s22, s22, s23
    s_lshl_b32 s22, s22, 1
    s_xor_b32 s23, s29, 0
    s_add_u32 s22, s22, s23
    s_lshl_b32 s22, s22, 9
    v_add_u32 v212, s22, v226
    s_add_u32 s22, s28, 5
    s_cmp_ge_u32 s22, 9
    s_cselect_b32 s23, 9, 0
    s_sub_u32 s22, s22, s23
    s_lshl_b32 s22, s22, 1
    s_xor_b32 s23, s29, 0
    s_add_u32 s22, s22, s23
    s_lshl_b32 s22, s22, 9
    v_add_u32 v213, s22, v226
    s_add_u32 s22, s28, 6
    s_cmp_ge_u32 s22, 9
    s_cselect_b32 s23, 9, 0
    s_sub_u32 s22, s22, s23
    s_lshl_b32 s22, s22, 1
    s_xor_b32 s23, s29, 0
    s_add_u32 s22, s22, s23
    s_lshl_b32 s22, s22, 9
    v_add_u32 v214, s22, v226
    s_add_u32 s22, s28, 7
    s_cmp_ge_u32 s22, 9
    s_cselect_b32 s23, 9, 0
    s_sub_u32 s22, s22, s23
    s_lshl_b32 s22, s22, 1
    s_xor_b32 s23, s29, 0
    s_add_u32 s22, s22, s23
    s_lshl_b32 s22, s22, 9
    v_add_u32 v215, s22, v226
    s_add_u32 s22, s28, 8
    s_cmp_ge_u32 s22, 9
    s_cselect_b32 s23, 9, 0
    s_sub_u32 s22, s22, s23
    s_lshl_b32 s22, s22, 1
    s_xor_b32 s23, s29, 0
    s_add_u32 s22, s22, s23
    s_lshl_b32 s22, s22, 9
    v_add_u32 v216, s22, v226
    s_add_u32 s22, s28, 0
    s_cmp_ge_u32 s22, 9
    s_cselect_b32 s23, 9, 0
    s_sub_u32 s22, s22, s23
    s_lshl_b32 s22, s22, 1
    s_xor_b32 s23, s29, 1
    s_add_u32 s22, s22, s23
    s_lshl_b32 s22, s22, 9
    v_add_u32 v217, s22, v226
    s_add_u32 s22, s28, 1
    s_cmp_ge_u32 s22, 9
    s_cselect_b32 s23, 9, 0
    s_sub_u32 s22, s22, s23
    s_lshl_b32 s22, s22, 1
    s_xor_b32 s23, s29, 1
    s_add_u32 s22, s22, s23
    s_lshl_b32 s22, s22, 9
    v_add_u32 v218, s22, v226
    s_add_u32 s22, s28, 2
    s_cmp_ge_u32 s22, 9
    s_cselect_b32 s23, 9, 0
    s_sub_u32 s22, s22, s23
    s_lshl_b32 s22, s22, 1
    s_xor_b32 s23, s29, 1
    s_add_u32 s22, s22, s23
    s_lshl_b32 s22, s22, 9
    v_add_u32 v219, s22, v226
    s_add_u32 s22, s28, 3
    s_cmp_ge_u32 s22, 9
    s_cselect_b32 s23, 9, 0
    s_sub_u32 s22, s22, s23
    s_lshl_b32 s22, s22, 1
    s_xor_b32 s23, s29, 1
    s_add_u32 s22, s22, s23
    s_lshl_b32 s22, s22, 9
    v_add_u32 v220, s22, v226
    s_add_u32 s22, s28, 4
    s_cmp_ge_u32 s22, 9
    s_cselect_b32 s23, 9, 0
    s_sub_u32 s22, s22, s23
    s_lshl_b32 s22, s22, 1
    s_xor_b32 s23, s29, 1
    s_add_u32 s22, s22, s23
    s_lshl_b32 s22, s22, 9
    v_add_u32 v221, s22, v226
    s_add_u32 s22, s28, 5
    s_cmp_ge_u32 s22, 9
    s_cselect_b32 s23, 9, 0
    s_sub_u32 s22, s22, s23
    s_lshl_b32 s22, s22, 1
    s_xor_b32 s23, s29, 1
    s_add_u32 s22, s22, s23
    s_lshl_b32 s22, s22, 9
    v_add_u32 v222, s22, v226
    s_add_u32 s22, s28, 6
    s_cmp_ge_u32 s22, 9
    s_cselect_b32 s23, 9, 0
    s_sub_u32 s22, s22, s23
    s_lshl_b32 s22, s22, 1
    s_xor_b32 s23, s29, 1
    s_add_u32 s22, s22, s23
    s_lshl_b32 s22, s22, 9
    v_add_u32 v223, s22, v226
    s_add_u32 s22, s28, 7
    s_cmp_ge_u32 s22, 9
    s_cselect_b32 s23, 9, 0
    s_sub_u32 s22, s22, s23
    s_lshl_b32 s22, s22, 1
    s_xor_b32 s23, s29, 1
    s_add_u32 s22, s22, s23
    s_lshl_b32 s22, s22, 9
    v_add_u32 v224, s22, v226
    s_add_u32 s22, s28, 8
    s_cmp_ge_u32 s22, 9
    s_cselect_b32 s23, 9, 0
    s_sub_u32 s22, s22, s23
    s_lshl_b32 s22, s22, 1
    s_xor_b32 s23, s29, 1
    s_add_u32 s22, s22, s23
    s_lshl_b32 s22, s22, 9
    v_add_u32 v225, s22, v226
    buffer_load_dwordx2 v[192:193], v233, s[8:11], 0 offen sc1
    buffer_load_dwordx2 v[202:203], v228, s[40:43], 0 offen
    buffer_load_dwordx2 v[194:195], v234, s[8:11], 0 offen sc1
    buffer_load_dwordx2 v[204:205], v229, s[40:43], 0 offen
    buffer_load_dwordx2 v[196:197], v235, s[8:11], 0 offen sc1
    buffer_load_dwordx2 v[206:207], v230, s[40:43], 0 offen
    buffer_load_dwordx2 v[198:199], v236, s[8:11], 0 offen sc1
    buffer_load_dwordx2 v[208:209], v231, s[40:43], 0 offen
    buffer_load_dwordx2 v[200:201], v237, s[8:11], 0 offen sc1
    buffer_load_dwordx2 v[210:211], v232, s[40:43], 0 offen
    s_waitcnt vmcnt(35)
    s_barrier
    s_cmp_lg_u32 s3, 0
    s_cbranch_scc1 kmain_kernel_sgh_10
    v_mov_b32 v250, 1
    v_mov_b32 v251, 0
    v_cmp_eq_u32 vcc, 0, v1
    s_nop 3
    s_and_saveexec_b64 s[50:51], vcc
    buffer_atomic_add v250, v251, s[8:11], s61 offen
    s_mov_b64 exec, s[50:51]
kmain_kernel_sgh_10:
    ds_read_b128 v[144:147], v3 offset:0
    ds_read_b128 v[148:151], v3 offset:1024
    ds_read_b128 v[152:155], v3 offset:2048
    ds_read_b128 v[156:159], v3 offset:3072
    ds_read_b128 v[160:163], v3 offset:4096
    ds_read_b128 v[164:167], v3 offset:5120
    ds_read_b128 v[168:171], v3 offset:6144
    ds_read_b128 v[172:175], v3 offset:7168
    s_add_u32 s35, s39, 147456
    s_waitcnt lgkmcnt(4)
    v_mfma_f32_16x16x32_bf16 a[0:3], v[144:147], v[16:19], 0
    s_add_u32 m0, s21, 73728
    v_mfma_f32_16x16x32_bf16 a[0:3], v[148:151], v[20:23], a[0:3]
    ds_read_b128 v[176:179], v3 offset:8192
    v_mfma_f32_16x16x32_bf16 a[0:3], v[152:155], v[24:27], a[0:3]
    buffer_load_dwordx4 v7, s[8:11], s52 offen offset:0 lds
    v_mfma_f32_16x16x32_bf16 a[0:3], v[156:159], v[28:31], a[0:3]
    ds_read_b128 v[180:183], v3 offset:9216
    v_mfma_f32_16x16x32_bf16 a[4:7], v[144:147], v[32:35], 0
    buffer_load_dwordx4 v7, s[8:11], s53 offen offset:1024 lds
    v_mfma_f32_16x16x32_bf16 a[4:7], v[148:151], v[36:39], a[4:7]
    ds_read_b128 v[184:187], v3 offset:10240
    v_mfma_f32_16x16x32_bf16 a[4:7], v[152:155], v[40:43], a[4:7]
    buffer_load_dwordx4 v7, s[8:11], s54 offen offset:2048 lds
    v_mfma_f32_16x16x32_bf16 a[4:7], v[156:159], v[44:47], a[4:7]
    ds_read_b128 v[188:191], v3 offset:11264
    s_waitcnt lgkmcnt(4)
    v_mfma_f32_16x16x32_bf16 a[8:11], v[160:163], v[16:19], 0
    buffer_load_dwordx4 v7, s[8:11], s55 offen offset:3072 lds
    v_mfma_f32_16x16x32_bf16 a[8:11], v[164:167], v[20:23], a[8:11]
    ds_read_b128 v[144:147], v3 offset:12288
    v_mfma_f32_16x16x32_bf16 a[8:11], v[168:171], v[24:27], a[8:11]
    s_add_u32 m0, s21, 77824
    v_mfma_f32_16x16x32_bf16 a[8:11], v[172:175], v[28:31], a[8:11]
    ds_read_b128 v[148:151], v3 offset:13312
    v_mfma_f32_16x16x32_bf16 a[12:15], v[160:163], v[32:35], 0
    buffer_load_dwordx4 v7, s[8:11], s56 offen offset:0 lds
    v_mfma_f32_16x16x32_bf16 a[12:15], v[164:167], v[36:39], a[12:15]
    ds_read_b128 v[152:155], v3 offset:14336
    v_mfma_f32_16x16x32_bf16 a[12:15], v[168:171], v[40:43], a[12:15]
    buffer_load_dwordx4 v7, s[8:11], s57 offen offset:1024 lds
    v_mfma_f32_16x16x32_bf16 a[12:15], v[172:175], v[44:47], a[12:15]
    ds_read_b128 v[156:159], v3 offset:15360
    s_waitcnt lgkmcnt(4)
    v_mfma_f32_16x16x32_bf16 a[16:19], v[176:179], v[16:19], 0
    buffer_load_dwordx4 v7, s[8:11], s58 offen offset:2048 lds
    v_mfma_f32_16x16x32_bf16 a[16:19], v[180:183], v[20:23], a[16:19]
    ds_read_b128 v[160:163], v3 offset:16384
    v_mfma_f32_16x16x32_bf16 a[16:19], v[184:187], v[24:27], a[16:19]
    buffer_load_dwordx4 v7, s[8:11], s59 offen offset:3072 lds
    v_mfma_f32_16x16x32_bf16 a[16:19], v[188:191], v[28:31], a[16:19]
    ds_read_b128 v[164:167], v3 offset:17408
    v_mfma_f32_16x16x32_bf16 a[20:23], v[176:179], v[32:35], 0
    s_add_u32 m0, s21, 81920
    v_mfma_f32_16x16x32_bf16 a[20:23], v[180:183], v[36:39], a[20:23]
    ds_read_b128 v[168:171], v3 offset:18432
    v_mfma_f32_16x16x32_bf16 a[20:23], v[184:187], v[40:43], a[20:23]
    buffer_load_dwordx4 v7, s[8:11], s60 offen offset:0 lds
    v_mfma_f32_16x16x32_bf16 a[20:23], v[188:191], v[44:47], a[20:23]
    ds_read_b128 v[172:175], v3 offset:19456
    s_waitcnt lgkmcnt(4)
    v_mfma_f32_16x16x32_bf16 a[24:27], v[144:147], v[16:19], 0
    v_add_u32 v7, 4096, v7
    v_mfma_f32_16x16x32_bf16 a[24:27], v[148:151], v[20:23], a[24:27]
    ds_read_b128 v[176:179], v3 offset:20480
    v_mfma_f32_16x16x32_bf16 a[24:27], v[152:155], v[24:27], a[24:27]
    buffer_load_dwordx4 v[112:115], v9, s[8:11], 0 offen offset:0 sc1
    v_mfma_f32_16x16x32_bf16 a[24:27], v[156:159], v[28:31], a[24:27]
    ds_read_b128 v[180:183], v3 offset:21504
    v_mfma_f32_16x16x32_bf16 a[28:31], v[144:147], v[32:35], 0
    buffer_load_dwordx4 v[116:119], v9, s[8:11], 0 offen offset:1024 sc1
    v_mfma_f32_16x16x32_bf16 a[28:31], v[148:151], v[36:39], a[28:31]
    ds_read_b128 v[184:187], v3 offset:22528
    v_mfma_f32_16x16x32_bf16 a[28:31], v[152:155], v[40:43], a[28:31]
    v_mfma_f32_16x16x32_bf16 a[28:31], v[156:159], v[44:47], a[28:31]
    ds_read_b128 v[188:191], v3 offset:23552
    s_waitcnt lgkmcnt(4)
    v_mfma_f32_16x16x32_bf16 a[32:35], v[160:163], v[16:19], 0
    buffer_load_dwordx4 v[120:123], v9, s[8:11], 0 offen offset:2048 sc1
    v_mfma_f32_16x16x32_bf16 a[32:35], v[164:167], v[20:23], a[32:35]
    ds_read_b128 v[144:147], v3 offset:24576
    v_mfma_f32_16x16x32_bf16 a[32:35], v[168:171], v[24:27], a[32:35]
    buffer_load_dwordx4 v[124:127], v9, s[8:11], 0 offen offset:3072 sc1
    v_mfma_f32_16x16x32_bf16 a[32:35], v[172:175], v[28:31], a[32:35]
    ds_read_b128 v[148:151], v3 offset:25600
    v_mfma_f32_16x16x32_bf16 a[36:39], v[160:163], v[32:35], 0
    v_mfma_f32_16x16x32_bf16 a[36:39], v[164:167], v[36:39], a[36:39]
    ds_read_b128 v[152:155], v3 offset:26624
    v_mfma_f32_16x16x32_bf16 a[36:39], v[168:171], v[40:43], a[36:39]
    buffer_load_dwordx4 v[128:131], v10, s[8:11], 0 offen offset:0 sc1
    v_mfma_f32_16x16x32_bf16 a[36:39], v[172:175], v[44:47], a[36:39]
    ds_read_b128 v[156:159], v3 offset:27648
    s_waitcnt lgkmcnt(4)
    v_mfma_f32_16x16x32_bf16 a[40:43], v[176:179], v[16:19], 0
    buffer_load_dwordx4 v[132:135], v10, s[8:11], 0 offen offset:1024 sc1
    v_mfma_f32_16x16x32_bf16 a[40:43], v[180:183], v[20:23], a[40:43]
    ds_read_b128 v[160:163], v3 offset:28672
    v_mfma_f32_16x16x32_bf16 a[40:43], v[184:187], v[24:27], a[40:43]
    buffer_load_dwordx4 v[136:139], v10, s[8:11], 0 offen offset:2048 sc1
    v_mfma_f32_16x16x32_bf16 a[40:43], v[188:191], v[28:31], a[40:43]
    ds_read_b128 v[164:167], v3 offset:29696
    v_mfma_f32_16x16x32_bf16 a[44:47], v[176:179], v[32:35], 0
    v_mfma_f32_16x16x32_bf16 a[44:47], v[180:183], v[36:39], a[44:47]
    ds_read_b128 v[168:171], v3 offset:30720
    v_mfma_f32_16x16x32_bf16 a[44:47], v[184:187], v[40:43], a[44:47]
    buffer_load_dwordx4 v[140:143], v10, s[8:11], 0 offen offset:3072 sc1
    v_mfma_f32_16x16x32_bf16 a[44:47], v[188:191], v[44:47], a[44:47]
    ds_read_b128 v[172:175], v3 offset:31744
    s_waitcnt lgkmcnt(4)
    v_mfma_f32_16x16x32_bf16 a[48:51], v[144:147], v[16:19], 0
    v_add_u32 v9, 4096, v9
    v_mfma_f32_16x16x32_bf16 a[48:51], v[148:151], v[20:23], a[48:51]
    ds_read_b128 v[176:179], v3 offset:32768
    v_mfma_f32_16x16x32_bf16 a[48:51], v[152:155], v[24:27], a[48:51]
    v_add_u32 v10, 4096, v10
    v_mfma_f32_16x16x32_bf16 a[48:51], v[156:159], v[28:31], a[48:51]
    ds_read_b128 v[180:183], v3 offset:33792
    v_mfma_f32_16x16x32_bf16 a[52:55], v[144:147], v[32:35], 0
    v_mfma_f32_16x16x32_bf16 a[52:55], v[148:151], v[36:39], a[52:55]
    ds_read_b128 v[184:187], v3 offset:34816
    v_mfma_f32_16x16x32_bf16 a[52:55], v[152:155], v[40:43], a[52:55]
    v_mfma_f32_16x16x32_bf16 a[52:55], v[156:159], v[44:47], a[52:55]
    ds_read_b128 v[188:191], v3 offset:35840
    s_waitcnt lgkmcnt(4)
    v_mfma_f32_16x16x32_bf16 a[56:59], v[160:163], v[16:19], 0
    s_waitcnt vmcnt(43)
    s_barrier
    v_mfma_f32_16x16x32_bf16 a[56:59], v[164:167], v[20:23], a[56:59]
    ds_read_b128 v[144:147], v4 offset:0
    v_mfma_f32_16x16x32_bf16 a[56:59], v[168:171], v[24:27], a[56:59]
    s_add_u32 m0, s21, 110592
    v_mfma_f32_16x16x32_bf16 a[56:59], v[172:175], v[28:31], a[56:59]
    ds_read_b128 v[148:151], v4 offset:1024
    v_mfma_f32_16x16x32_bf16 a[60:63], v[160:163], v[32:35], 0
    buffer_load_dwordx4 v7, s[8:11], s52 offen offset:0 lds
    v_mfma_f32_16x16x32_bf16 a[60:63], v[164:167], v[36:39], a[60:63]
    ds_read_b128 v[152:155], v4 offset:2048
    v_mfma_f32_16x16x32_bf16 a[60:63], v[168:171], v[40:43], a[60:63]
    buffer_load_dwordx4 v7, s[8:11], s53 offen offset:1024 lds
    v_mfma_f32_16x16x32_bf16 a[60:63], v[172:175], v[44:47], a[60:63]
    ds_read_b128 v[156:159], v4 offset:3072
    s_waitcnt lgkmcnt(4)
    v_mfma_f32_16x16x32_bf16 a[64:67], v[176:179], v[16:19], 0
    v_mfma_f32_16x16x32_bf16 a[64:67], v[180:183], v[20:23], a[64:67]
    ds_read_b128 v[160:163], v4 offset:4096
    v_mfma_f32_16x16x32_bf16 a[64:67], v[184:187], v[24:27], a[64:67]
    buffer_load_dwordx4 v7, s[8:11], s54 offen offset:2048 lds
    v_mfma_f32_16x16x32_bf16 a[64:67], v[188:191], v[28:31], a[64:67]
    ds_read_b128 v[164:167], v4 offset:5120
    v_mfma_f32_16x16x32_bf16 a[68:71], v[176:179], v[32:35], 0
    buffer_load_dwordx4 v7, s[8:11], s55 offen offset:3072 lds
    v_mfma_f32_16x16x32_bf16 a[68:71], v[180:183], v[36:39], a[68:71]
    ds_read_b128 v[168:171], v4 offset:6144
    v_mfma_f32_16x16x32_bf16 a[68:71], v[184:187], v[40:43], a[68:71]
    s_add_u32 m0, s21, 114688
    v_mfma_f32_16x16x32_bf16 a[68:71], v[188:191], v[44:47], a[68:71]
    ds_read_b128 v[172:175], v4 offset:7168
    s_waitcnt vmcnt(39)
    s_waitcnt lgkmcnt(4)
    v_mfma_f32_16x16x32_bf16 a[0:3], v[144:147], v[48:51], a[0:3]
    v_mfma_f32_16x16x32_bf16 a[0:3], v[148:151], v[52:55], a[0:3]
    ds_read_b128 v[176:179], v4 offset:8192
    v_mfma_f32_16x16x32_bf16 a[0:3], v[152:155], v[56:59], a[0:3]
    buffer_load_dwordx4 v7, s[8:11], s56 offen offset:0 lds
    v_mfma_f32_16x16x32_bf16 a[0:3], v[156:159], v[60:63], a[0:3]
    ds_read_b128 v[180:183], v4 offset:9216
    v_mfma_f32_16x16x32_bf16 a[4:7], v[144:147], v[64:67], a[4:7]
    buffer_load_dwordx4 v[16:19], v9, s[8:11], 0 offen offset:0 sc1
    v_mfma_f32_16x16x32_bf16 a[4:7], v[148:151], v[68:71], a[4:7]
    ds_read_b128 v[184:187], v4 offset:10240
    v_mfma_f32_16x16x32_bf16 a[4:7], v[152:155], v[72:75], a[4:7]
    buffer_load_dwordx4 v7, s[8:11], s57 offen offset:1024 lds
    v_mfma_f32_16x16x32_bf16 a[4:7], v[156:159], v[76:79], a[4:7]
    ds_read_b128 v[188:191], v4 offset:11264
    s_waitcnt lgkmcnt(4)
    v_mfma_f32_16x16x32_bf16 a[8:11], v[160:163], v[48:51], a[8:11]
    v_mfma_f32_16x16x32_bf16 a[8:11], v[164:167], v[52:55], a[8:11]
    ds_read_b128 v[144:147], v4 offset:12288
    v_mfma_f32_16x16x32_bf16 a[8:11], v[168:171], v[56:59], a[8:11]
    buffer_load_dwordx4 v7, s[8:11], s58 offen offset:2048 lds
    v_mfma_f32_16x16x32_bf16 a[8:11], v[172:175], v[60:63], a[8:11]
    ds_read_b128 v[148:151], v4 offset:13312
    v_mfma_f32_16x16x32_bf16 a[12:15], v[160:163], v[64:67], a[12:15]
    buffer_load_dwordx4 v[20:23], v9, s[8:11], 0 offen offset:1024 sc1
    v_mfma_f32_16x16x32_bf16 a[12:15], v[164:167], v[68:71], a[12:15]
    ds_read_b128 v[152:155], v4 offset:14336
    v_mfma_f32_16x16x32_bf16 a[12:15], v[168:171], v[72:75], a[12:15]
    buffer_load_dwordx4 v7, s[8:11], s59 offen offset:3072 lds
    v_mfma_f32_16x16x32_bf16 a[12:15], v[172:175], v[76:79], a[12:15]
    ds_read_b128 v[156:159], v4 offset:15360
    s_waitcnt lgkmcnt(4)
    v_mfma_f32_16x16x32_bf16 a[16:19], v[176:179], v[48:51], a[16:19]
    s_add_u32 m0, s21, 118784
    v_mfma_f32_16x16x32_bf16 a[16:19], v[180:183], v[52:55], a[16:19]
    ds_read_b128 v[160:163], v4 offset:16384
    v_mfma_f32_16x16x32_bf16 a[16:19], v[184:187], v[56:59], a[16:19]
    v_mfma_f32_16x16x32_bf16 a[16:19], v[188:191], v[60:63], a[16:19]
    ds_read_b128 v[164:167], v4 offset:17408
    v_mfma_f32_16x16x32_bf16 a[20:23], v[176:179], v[64:67], a[20:23]
    buffer_load_dwordx4 v7, s[8:11], s60 offen offset:0 lds
    v_mfma_f32_16x16x32_bf16 a[20:23], v[180:183], v[68:71], a[20:23]
    ds_read_b128 v[168:171], v4 offset:18432
    v_mfma_f32_16x16x32_bf16 a[20:23], v[184:187], v[72:75], a[20:23]
    buffer_load_dwordx4 v[24:27], v9, s[8:11], 0 offen offset:2048 sc1
    v_mfma_f32_16x16x32_bf16 a[20:23], v[188:191], v[76:79], a[20:23]
    ds_read_b128 v[172:175], v4 offset:19456
    s_waitcnt lgkmcnt(4)
    v_mfma_f32_16x16x32_bf16 a[24:27], v[144:147], v[48:51], a[24:27]
    v_add_u32 v7, 4096, v7
    v_mfma_f32_16x16x32_bf16 a[24:27], v[148:151], v[52:55], a[24:27]
    ds_read_b128 v[176:179], v4 offset:20480
    v_mfma_f32_16x16x32_bf16 a[24:27], v[152:155], v[56:59], a[24:27]
    v_mfma_f32_16x16x32_bf16 a[24:27], v[156:159], v[60:63], a[24:27]
    ds_read_b128 v[180:183], v4 offset:21504
    v_mfma_f32_16x16x32_bf16 a[28:31], v[144:147], v[64:67], a[28:31]
    buffer_load_dwordx4 v[28:31], v9, s[8:11], 0 offen offset:3072 sc1
    v_mfma_f32_16x16x32_bf16 a[28:31], v[148:151], v[68:71], a[28:31]
    ds_read_b128 v[184:187], v4 offset:22528
    v_mfma_f32_16x16x32_bf16 a[28:31], v[152:155], v[72:75], a[28:31]
    v_mfma_f32_16x16x32_bf16 a[28:31], v[156:159], v[76:79], a[28:31]
    ds_read_b128 v[188:191], v4 offset:23552
    s_waitcnt lgkmcnt(4)
    v_mfma_f32_16x16x32_bf16 a[32:35], v[160:163], v[48:51], a[32:35]
    buffer_load_dwordx4 v[32:35], v10, s[8:11], 0 offen offset:0 sc1
    v_mfma_f32_16x16x32_bf16 a[32:35], v[164:167], v[52:55], a[32:35]
    ds_read_b128 v[144:147], v4 offset:24576
    v_mfma_f32_16x16x32_bf16 a[32:35], v[168:171], v[56:59], a[32:35]
    v_mfma_f32_16x16x32_bf16 a[32:35], v[172:175], v[60:63], a[32:35]
    ds_read_b128 v[148:151], v4 offset:25600
    v_mfma_f32_16x16x32_bf16 a[36:39], v[160:163], v[64:67], a[36:39]
    buffer_load_dwordx4 v[36:39], v10, s[8:11], 0 offen offset:1024 sc1
    v_mfma_f32_16x16x32_bf16 a[36:39], v[164:167], v[68:71], a[36:39]
    ds_read_b128 v[152:155], v4 offset:26624
    v_mfma_f32_16x16x32_bf16 a[36:39], v[168:171], v[72:75], a[36:39]
    v_mfma_f32_16x16x32_bf16 a[36:39], v[172:175], v[76:79], a[36:39]
    ds_read_b128 v[156:159], v4 offset:27648
    s_waitcnt lgkmcnt(4)
    v_mfma_f32_16x16x32_bf16 a[40:43], v[176:179], v[48:51], a[40:43]
    buffer_load_dwordx4 v[40:43], v10, s[8:11], 0 offen offset:2048 sc1
    v_mfma_f32_16x16x32_bf16 a[40:43], v[180:183], v[52:55], a[40:43]
    ds_read_b128 v[160:163], v4 offset:28672
    v_mfma_f32_16x16x32_bf16 a[40:43], v[184:187], v[56:59], a[40:43]
    v_mfma_f32_16x16x32_bf16 a[40:43], v[188:191], v[60:63], a[40:43]
    ds_read_b128 v[164:167], v4 offset:29696
    v_mfma_f32_16x16x32_bf16 a[44:47], v[176:179], v[64:67], a[44:47]
    buffer_load_dwordx4 v[44:47], v10, s[8:11], 0 offen offset:3072 sc1
    v_mfma_f32_16x16x32_bf16 a[44:47], v[180:183], v[68:71], a[44:47]
    ds_read_b128 v[168:171], v4 offset:30720
    v_mfma_f32_16x16x32_bf16 a[44:47], v[184:187], v[72:75], a[44:47]
    v_mfma_f32_16x16x32_bf16 a[44:47], v[188:191], v[76:79], a[44:47]
    ds_read_b128 v[172:175], v4 offset:31744
    s_waitcnt lgkmcnt(4)
    v_mfma_f32_16x16x32_bf16 a[48:51], v[144:147], v[48:51], a[48:51]
    v_add_u32 v9, 4096, v9
    v_mfma_f32_16x16x32_bf16 a[48:51], v[148:151], v[52:55], a[48:51]
    ds_read_b128 v[176:179], v4 offset:32768
    v_mfma_f32_16x16x32_bf16 a[48:51], v[152:155], v[56:59], a[48:51]
    v_add_u32 v10, 4096, v10
    v_mfma_f32_16x16x32_bf16 a[48:51], v[156:159], v[60:63], a[48:51]
    ds_read_b128 v[180:183], v4 offset:33792
    v_mfma_f32_16x16x32_bf16 a[52:55], v[144:147], v[64:67], a[52:55]
    v_mfma_f32_16x16x32_bf16 a[52:55], v[148:151], v[68:71], a[52:55]
    ds_read_b128 v[184:187], v4 offset:34816
    v_mfma_f32_16x16x32_bf16 a[52:55], v[152:155], v[72:75], a[52:55]
    v_mfma_f32_16x16x32_bf16 a[52:55], v[156:159], v[76:79], a[52:55]
    ds_read_b128 v[188:191], v4 offset:35840
    s_waitcnt lgkmcnt(4)
    v_mfma_f32_16x16x32_bf16 a[56:59], v[160:163], v[48:51], a[56:59]
    s_waitcnt vmcnt(25)
    s_barrier
    v_mfma_f32_16x16x32_bf16 a[56:59], v[164:167], v[52:55], a[56:59]
    ds_read_b128 v[144:147], v5 offset:0
    v_mfma_f32_16x16x32_bf16 a[56:59], v[168:171], v[56:59], a[56:59]
    s_add_u32 m0, s21, 0
    v_mfma_f32_16x16x32_bf16 a[56:59], v[172:175], v[60:63], a[56:59]
    ds_read_b128 v[148:151], v5 offset:1024
    v_mfma_f32_16x16x32_bf16 a[60:63], v[160:163], v[64:67], a[60:63]
    buffer_load_dwordx4 v7, s[8:11], s52 offen offset:0 lds
    v_mfma_f32_16x16x32_bf16 a[60:63], v[164:167], v[68:71], a[60:63]
    ds_read_b128 v[152:155], v5 offset:2048
    v_mfma_f32_16x16x32_bf16 a[60:63], v[168:171], v[72:75], a[60:63]
    buffer_load_dwordx4 v7, s[8:11], s53 offen offset:1024 lds
    v_mfma_f32_16x16x32_bf16 a[60:63], v[172:175], v[76:79], a[60:63]
    ds_read_b128 v[156:159], v5 offset:3072
    s_waitcnt lgkmcnt(4)
    v_mfma_f32_16x16x32_bf16 a[64:67], v[176:179], v[48:51], a[64:67]
    v_mfma_f32_16x16x32_bf16 a[64:67], v[180:183], v[52:55], a[64:67]
    ds_read_b128 v[160:163], v5 offset:4096
    v_mfma_f32_16x16x32_bf16 a[64:67], v[184:187], v[56:59], a[64:67]
    buffer_load_dwordx4 v7, s[8:11], s54 offen offset:2048 lds
    v_mfma_f32_16x16x32_bf16 a[64:67], v[188:191], v[60:63], a[64:67]
    ds_read_b128 v[164:167], v5 offset:5120
    v_mfma_f32_16x16x32_bf16 a[68:71], v[176:179], v[64:67], a[68:71]
    buffer_load_dwordx4 v7, s[8:11], s55 offen offset:3072 lds
    v_mfma_f32_16x16x32_bf16 a[68:71], v[180:183], v[68:71], a[68:71]
    ds_read_b128 v[168:171], v5 offset:6144
    v_mfma_f32_16x16x32_bf16 a[68:71], v[184:187], v[72:75], a[68:71]
    s_add_u32 m0, s21, 4096
    v_mfma_f32_16x16x32_bf16 a[68:71], v[188:191], v[76:79], a[68:71]
    ds_read_b128 v[172:175], v5 offset:7168
    s_waitcnt vmcnt(48)
    s_waitcnt lgkmcnt(4)
    v_mfma_f32_16x16x32_bf16 a[0:3], v[144:147], v[80:83], a[0:3]
    v_mfma_f32_16x16x32_bf16 a[0:3], v[148:151], v[84:87], a[0:3]
    ds_read_b128 v[176:179], v5 offset:8192
    v_mfma_f32_16x16x32_bf16 a[0:3], v[152:155], v[88:91], a[0:3]
    buffer_load_dwordx4 v7, s[8:11], s56 offen offset:0 lds
    v_mfma_f32_16x16x32_bf16 a[0:3], v[156:159], v[92:95], a[0:3]
    ds_read_b128 v[180:183], v5 offset:9216
    v_mfma_f32_16x16x32_bf16 a[4:7], v[144:147], v[96:99], a[4:7]
    buffer_load_dwordx4 v[48:51], v9, s[8:11], 0 offen offset:0 sc1
    v_mfma_f32_16x16x32_bf16 a[4:7], v[148:151], v[100:103], a[4:7]
    ds_read_b128 v[184:187], v5 offset:10240
    v_mfma_f32_16x16x32_bf16 a[4:7], v[152:155], v[104:107], a[4:7]
    buffer_load_dwordx4 v7, s[8:11], s57 offen offset:1024 lds
    v_mfma_f32_16x16x32_bf16 a[4:7], v[156:159], v[108:111], a[4:7]
    ds_read_b128 v[188:191], v5 offset:11264
    s_waitcnt lgkmcnt(4)
    v_mfma_f32_16x16x32_bf16 a[8:11], v[160:163], v[80:83], a[8:11]
    v_mfma_f32_16x16x32_bf16 a[8:11], v[164:167], v[84:87], a[8:11]
    ds_read_b128 v[144:147], v5 offset:12288
    v_mfma_f32_16x16x32_bf16 a[8:11], v[168:171], v[88:91], a[8:11]
    buffer_load_dwordx4 v7, s[8:11], s58 offen offset:2048 lds
    v_mfma_f32_16x16x32_bf16 a[8:11], v[172:175], v[92:95], a[8:11]
    ds_read_b128 v[148:151], v5 offset:13312
    v_mfma_f32_16x16x32_bf16 a[12:15], v[160:163], v[96:99], a[12:15]
    buffer_load_dwordx4 v[52:55], v9, s[8:11], 0 offen offset:1024 sc1
    v_mfma_f32_16x16x32_bf16 a[12:15], v[164:167], v[100:103], a[12:15]
    ds_read_b128 v[152:155], v5 offset:14336
    v_mfma_f32_16x16x32_bf16 a[12:15], v[168:171], v[104:107], a[12:15]
    buffer_load_dwordx4 v7, s[8:11], s59 offen offset:3072 lds
    v_mfma_f32_16x16x32_bf16 a[12:15], v[172:175], v[108:111], a[12:15]
    ds_read_b128 v[156:159], v5 offset:15360
    s_waitcnt lgkmcnt(4)
    v_mfma_f32_16x16x32_bf16 a[16:19], v[176:179], v[80:83], a[16:19]
    s_add_u32 m0, s21, 8192
    v_mfma_f32_16x16x32_bf16 a[16:19], v[180:183], v[84:87], a[16:19]
    ds_read_b128 v[160:163], v5 offset:16384
    v_mfma_f32_16x16x32_bf16 a[16:19], v[184:187], v[88:91], a[16:19]
    v_mfma_f32_16x16x32_bf16 a[16:19], v[188:191], v[92:95], a[16:19]
    ds_read_b128 v[164:167], v5 offset:17408
    v_mfma_f32_16x16x32_bf16 a[20:23], v[176:179], v[96:99], a[20:23]
    buffer_load_dwordx4 v7, s[8:11], s60 offen offset:0 lds
    v_mfma_f32_16x16x32_bf16 a[20:23], v[180:183], v[100:103], a[20:23]
    ds_read_b128 v[168:171], v5 offset:18432
    v_mfma_f32_16x16x32_bf16 a[20:23], v[184:187], v[104:107], a[20:23]
    buffer_load_dwordx4 v[56:59], v9, s[8:11], 0 offen offset:2048 sc1
    v_mfma_f32_16x16x32_bf16 a[20:23], v[188:191], v[108:111], a[20:23]
    ds_read_b128 v[172:175], v5 offset:19456
    s_waitcnt lgkmcnt(4)
    v_mfma_f32_16x16x32_bf16 a[24:27], v[144:147], v[80:83], a[24:27]
    v_add_u32 v7, 4096, v7
    v_mfma_f32_16x16x32_bf16 a[24:27], v[148:151], v[84:87], a[24:27]
    ds_read_b128 v[176:179], v5 offset:20480
    v_mfma_f32_16x16x32_bf16 a[24:27], v[152:155], v[88:91], a[24:27]
    v_mfma_f32_16x16x32_bf16 a[24:27], v[156:159], v[92:95], a[24:27]
    ds_read_b128 v[180:183], v5 offset:21504
    v_mfma_f32_16x16x32_bf16 a[28:31], v[144:147], v[96:99], a[28:31]
    buffer_load_dwordx4 v[60:63], v9, s[8:11], 0 offen offset:3072 sc1
    v_mfma_f32_16x16x32_bf16 a[28:31], v[148:151], v[100:103], a[28:31]
    ds_read_b128 v[184:187], v5 offset:22528
    v_mfma_f32_16x16x32_bf16 a[28:31], v[152:155], v[104:107], a[28:31]
    v_mfma_f32_16x16x32_bf16 a[28:31], v[156:159], v[108:111], a[28:31]
    ds_read_b128 v[188:191], v5 offset:23552
    s_waitcnt lgkmcnt(4)
    v_mfma_f32_16x16x32_bf16 a[32:35], v[160:163], v[80:83], a[32:35]
    buffer_load_dwordx4 v[64:67], v10, s[8:11], 0 offen offset:0 sc1
    v_mfma_f32_16x16x32_bf16 a[32:35], v[164:167], v[84:87], a[32:35]
    ds_read_b128 v[144:147], v5 offset:24576
    v_mfma_f32_16x16x32_bf16 a[32:35], v[168:171], v[88:91], a[32:35]
    v_mfma_f32_16x16x32_bf16 a[32:35], v[172:175], v[92:95], a[32:35]
    ds_read_b128 v[148:151], v5 offset:25600
    v_mfma_f32_16x16x32_bf16 a[36:39], v[160:163], v[96:99], a[36:39]
    buffer_load_dwordx4 v[68:71], v10, s[8:11], 0 offen offset:1024 sc1
    v_mfma_f32_16x16x32_bf16 a[36:39], v[164:167], v[100:103], a[36:39]
    ds_read_b128 v[152:155], v5 offset:26624
    v_mfma_f32_16x16x32_bf16 a[36:39], v[168:171], v[104:107], a[36:39]
    v_mfma_f32_16x16x32_bf16 a[36:39], v[172:175], v[108:111], a[36:39]
    ds_read_b128 v[156:159], v5 offset:27648
    s_waitcnt lgkmcnt(4)
    v_mfma_f32_16x16x32_bf16 a[40:43], v[176:179], v[80:83], a[40:43]
    buffer_load_dwordx4 v[72:75], v10, s[8:11], 0 offen offset:2048 sc1
    v_mfma_f32_16x16x32_bf16 a[40:43], v[180:183], v[84:87], a[40:43]
    ds_read_b128 v[160:163], v5 offset:28672
    v_mfma_f32_16x16x32_bf16 a[40:43], v[184:187], v[88:91], a[40:43]
    v_mfma_f32_16x16x32_bf16 a[40:43], v[188:191], v[92:95], a[40:43]
    ds_read_b128 v[164:167], v5 offset:29696
    v_mfma_f32_16x16x32_bf16 a[44:47], v[176:179], v[96:99], a[44:47]
    buffer_load_dwordx4 v[76:79], v10, s[8:11], 0 offen offset:3072 sc1
    v_mfma_f32_16x16x32_bf16 a[44:47], v[180:183], v[100:103], a[44:47]
    ds_read_b128 v[168:171], v5 offset:30720
    v_mfma_f32_16x16x32_bf16 a[44:47], v[184:187], v[104:107], a[44:47]
    v_mfma_f32_16x16x32_bf16 a[44:47], v[188:191], v[108:111], a[44:47]
    ds_read_b128 v[172:175], v5 offset:31744
    s_waitcnt lgkmcnt(4)
    v_mfma_f32_16x16x32_bf16 a[48:51], v[144:147], v[80:83], a[48:51]
    v_add_u32 v9, 4096, v9
    v_mfma_f32_16x16x32_bf16 a[48:51], v[148:151], v[84:87], a[48:51]
    ds_read_b128 v[176:179], v5 offset:32768
    v_mfma_f32_16x16x32_bf16 a[48:51], v[152:155], v[88:91], a[48:51]
    v_add_u32 v10, 4096, v10
    v_mfma_f32_16x16x32_bf16 a[48:51], v[156:159], v[92:95], a[48:51]
    ds_read_b128 v[180:183], v5 offset:33792
    v_mfma_f32_16x16x32_bf16 a[52:55], v[144:147], v[96:99], a[52:55]
    v_mfma_f32_16x16x32_bf16 a[52:55], v[148:151], v[100:103], a[52:55]
    ds_read_b128 v[184:187], v5 offset:34816
    v_mfma_f32_16x16x32_bf16 a[52:55], v[152:155], v[104:107], a[52:55]
    v_mfma_f32_16x16x32_bf16 a[52:55], v[156:159], v[108:111], a[52:55]
    ds_read_b128 v[188:191], v5 offset:35840
    s_waitcnt lgkmcnt(4)
    v_mfma_f32_16x16x32_bf16 a[56:59], v[160:163], v[80:83], a[56:59]
    s_waitcnt vmcnt(23)
    s_barrier
    v_mfma_f32_16x16x32_bf16 a[56:59], v[164:167], v[84:87], a[56:59]
    ds_read_b128 v[144:147], v6 offset:0
    v_mfma_f32_16x16x32_bf16 a[56:59], v[168:171], v[88:91], a[56:59]
    s_add_u32 m0, s21, 36864
    v_mfma_f32_16x16x32_bf16 a[56:59], v[172:175], v[92:95], a[56:59]
    ds_read_b128 v[148:151], v6 offset:1024
    v_mfma_f32_16x16x32_bf16 a[60:63], v[160:163], v[96:99], a[60:63]
    buffer_load_dwordx4 v7, s[8:11], s52 offen offset:0 lds
    v_mfma_f32_16x16x32_bf16 a[60:63], v[164:167], v[100:103], a[60:63]
    ds_read_b128 v[152:155], v6 offset:2048
    v_mfma_f32_16x16x32_bf16 a[60:63], v[168:171], v[104:107], a[60:63]
    buffer_load_dwordx4 v7, s[8:11], s53 offen offset:1024 lds
    v_mfma_f32_16x16x32_bf16 a[60:63], v[172:175], v[108:111], a[60:63]
    ds_read_b128 v[156:159], v6 offset:3072
    s_waitcnt lgkmcnt(4)
    v_mfma_f32_16x16x32_bf16 a[64:67], v[176:179], v[80:83], a[64:67]
    v_mfma_f32_16x16x32_bf16 a[64:67], v[180:183], v[84:87], a[64:67]
    ds_read_b128 v[160:163], v6 offset:4096
    v_mfma_f32_16x16x32_bf16 a[64:67], v[184:187], v[88:91], a[64:67]
    buffer_load_dwordx4 v7, s[8:11], s54 offen offset:2048 lds
    v_mfma_f32_16x16x32_bf16 a[64:67], v[188:191], v[92:95], a[64:67]
    ds_read_b128 v[164:167], v6 offset:5120
    v_mfma_f32_16x16x32_bf16 a[68:71], v[176:179], v[96:99], a[68:71]
    buffer_load_dwordx4 v7, s[8:11], s55 offen offset:3072 lds
    v_mfma_f32_16x16x32_bf16 a[68:71], v[180:183], v[100:103], a[68:71]
    ds_read_b128 v[168:171], v6 offset:6144
    v_mfma_f32_16x16x32_bf16 a[68:71], v[184:187], v[104:107], a[68:71]
    s_add_u32 m0, s21, 40960
    v_mfma_f32_16x16x32_bf16 a[68:71], v[188:191], v[108:111], a[68:71]
    ds_read_b128 v[172:175], v6 offset:7168
    s_waitcnt vmcnt(38)
    s_waitcnt lgkmcnt(4)
    v_mfma_f32_16x16x32_bf16 a[0:3], v[144:147], v[112:115], a[0:3]
    v_mfma_f32_16x16x32_bf16 a[0:3], v[148:151], v[116:119], a[0:3]
    ds_read_b128 v[176:179], v6 offset:8192
    v_mfma_f32_16x16x32_bf16 a[0:3], v[152:155], v[120:123], a[0:3]
    buffer_load_dwordx4 v7, s[8:11], s56 offen offset:0 lds
    v_mfma_f32_16x16x32_bf16 a[0:3], v[156:159], v[124:127], a[0:3]
    ds_read_b128 v[180:183], v6 offset:9216
    v_mov_b32 v255, 0
    v_mfma_f32_16x16x32_bf16 a[4:7], v[144:147], v[128:131], a[4:7]
    buffer_load_dwordx4 v[80:83], v9, s[8:11], 0 offen offset:0 sc1
    v_mfma_f32_16x16x32_bf16 a[4:7], v[148:151], v[132:135], a[4:7]
    ds_read_b128 v[184:187], v6 offset:10240
    v_mfma_f32_16x16x32_bf16 a[4:7], v[152:155], v[136:139], a[4:7]
    buffer_load_dwordx4 v7, s[8:11], s57 offen offset:1024 lds
    v_mfma_f32_16x16x32_bf16 a[4:7], v[156:159], v[140:143], a[4:7]
    ds_read_b128 v[188:191], v6 offset:11264
    s_waitcnt lgkmcnt(4)
    v_mfma_f32_16x16x32_bf16 a[8:11], v[160:163], v[112:115], a[8:11]
    buffer_load_dword v254, v255, s[8:11], s33 offen sc1
    v_mfma_f32_16x16x32_bf16 a[8:11], v[164:167], v[116:119], a[8:11]
    ds_read_b128 v[144:147], v6 offset:12288
    v_mfma_f32_16x16x32_bf16 a[8:11], v[168:171], v[120:123], a[8:11]
    buffer_load_dwordx4 v7, s[8:11], s58 offen offset:2048 lds
    v_mfma_f32_16x16x32_bf16 a[8:11], v[172:175], v[124:127], a[8:11]
    ds_read_b128 v[148:151], v6 offset:13312
    v_mfma_f32_16x16x32_bf16 a[12:15], v[160:163], v[128:131], a[12:15]
    buffer_load_dwordx4 v[84:87], v9, s[8:11], 0 offen offset:1024 sc1
    v_mfma_f32_16x16x32_bf16 a[12:15], v[164:167], v[132:135], a[12:15]
    ds_read_b128 v[152:155], v6 offset:14336
    v_mfma_f32_16x16x32_bf16 a[12:15], v[168:171], v[136:139], a[12:15]
    buffer_load_dwordx4 v7, s[8:11], s59 offen offset:3072 lds
    v_mfma_f32_16x16x32_bf16 a[12:15], v[172:175], v[140:143], a[12:15]
    ds_read_b128 v[156:159], v6 offset:15360
    s_waitcnt lgkmcnt(4)
    v_mfma_f32_16x16x32_bf16 a[16:19], v[176:179], v[112:115], a[16:19]
    s_add_u32 m0, s21, 45056
    v_mfma_f32_16x16x32_bf16 a[16:19], v[180:183], v[116:119], a[16:19]
    ds_read_b128 v[160:163], v6 offset:16384
    v_mfma_f32_16x16x32_bf16 a[16:19], v[184:187], v[120:123], a[16:19]
    v_mfma_f32_16x16x32_bf16 a[16:19], v[188:191], v[124:127], a[16:19]
    ds_read_b128 v[164:167], v6 offset:17408
    v_mfma_f32_16x16x32_bf16 a[20:23], v[176:179], v[128:131], a[20:23]
    buffer_load_dwordx4 v7, s[8:11], s60 offen offset:0 lds
    v_mfma_f32_16x16x32_bf16 a[20:23], v[180:183], v[132:135], a[20:23]
    ds_read_b128 v[168:171], v6 offset:18432
    v_mfma_f32_16x16x32_bf16 a[20:23], v[184:187], v[136:139], a[20:23]
    buffer_load_dwordx4 v[88:91], v9, s[8:11], 0 offen offset:2048 sc1
    v_mfma_f32_16x16x32_bf16 a[20:23], v[188:191], v[140:143], a[20:23]
    ds_read_b128 v[172:175], v6 offset:19456
    s_waitcnt lgkmcnt(4)
    v_mfma_f32_16x16x32_bf16 a[24:27], v[144:147], v[112:115], a[24:27]
    v_add_u32 v7, 4096, v7
    v_mfma_f32_16x16x32_bf16 a[24:27], v[148:151], v[116:119], a[24:27]
    ds_read_b128 v[176:179], v6 offset:20480
    v_mfma_f32_16x16x32_bf16 a[24:27], v[152:155], v[120:123], a[24:27]
    v_mfma_f32_16x16x32_bf16 a[24:27], v[156:159], v[124:127], a[24:27]
    ds_read_b128 v[180:183], v6 offset:21504
    v_mfma_f32_16x16x32_bf16 a[28:31], v[144:147], v[128:131], a[28:31]
    buffer_load_dwordx4 v[92:95], v9, s[8:11], 0 offen offset:3072 sc1
    v_mfma_f32_16x16x32_bf16 a[28:31], v[148:151], v[132:135], a[28:31]
    ds_read_b128 v[184:187], v6 offset:22528
    v_mfma_f32_16x16x32_bf16 a[28:31], v[152:155], v[136:139], a[28:31]
    v_mfma_f32_16x16x32_bf16 a[28:31], v[156:159], v[140:143], a[28:31]
    ds_read_b128 v[188:191], v6 offset:23552
    s_waitcnt lgkmcnt(4)
    v_mfma_f32_16x16x32_bf16 a[32:35], v[160:163], v[112:115], a[32:35]
    buffer_load_dwordx4 v[96:99], v10, s[8:11], 0 offen offset:0 sc1
    v_mfma_f32_16x16x32_bf16 a[32:35], v[164:167], v[116:119], a[32:35]
    ds_read_b128 v[144:147], v6 offset:24576
    v_mfma_f32_16x16x32_bf16 a[32:35], v[168:171], v[120:123], a[32:35]
    v_mfma_f32_16x16x32_bf16 a[32:35], v[172:175], v[124:127], a[32:35]
    ds_read_b128 v[148:151], v6 offset:25600
    v_mfma_f32_16x16x32_bf16 a[36:39], v[160:163], v[128:131], a[36:39]
    buffer_load_dwordx4 v[100:103], v10, s[8:11], 0 offen offset:1024 sc1
    v_mfma_f32_16x16x32_bf16 a[36:39], v[164:167], v[132:135], a[36:39]
    ds_read_b128 v[152:155], v6 offset:26624
    v_mfma_f32_16x16x32_bf16 a[36:39], v[168:171], v[136:139], a[36:39]
    v_mfma_f32_16x16x32_bf16 a[36:39], v[172:175], v[140:143], a[36:39]
    ds_read_b128 v[156:159], v6 offset:27648
    s_waitcnt lgkmcnt(4)
    v_mfma_f32_16x16x32_bf16 a[40:43], v[176:179], v[112:115], a[40:43]
    buffer_load_dwordx4 v[104:107], v10, s[8:11], 0 offen offset:2048 sc1
    v_mfma_f32_16x16x32_bf16 a[40:43], v[180:183], v[116:119], a[40:43]
    ds_read_b128 v[160:163], v6 offset:28672
    v_mfma_f32_16x16x32_bf16 a[40:43], v[184:187], v[120:123], a[40:43]
    v_mfma_f32_16x16x32_bf16 a[40:43], v[188:191], v[124:127], a[40:43]
    ds_read_b128 v[164:167], v6 offset:29696
    v_mfma_f32_16x16x32_bf16 a[44:47], v[176:179], v[128:131], a[44:47]
    buffer_load_dwordx4 v[108:111], v10, s[8:11], 0 offen offset:3072 sc1
    v_mfma_f32_16x16x32_bf16 a[44:47], v[180:183], v[132:135], a[44:47]
    ds_read_b128 v[168:171], v6 offset:30720
    v_mfma_f32_16x16x32_bf16 a[44:47], v[184:187], v[136:139], a[44:47]
    v_mfma_f32_16x16x32_bf16 a[44:47], v[188:191], v[140:143], a[44:47]
    ds_read_b128 v[172:175], v6 offset:31744
    s_waitcnt lgkmcnt(4)
    v_mfma_f32_16x16x32_bf16 a[48:51], v[144:147], v[112:115], a[48:51]
    v_add_u32 v9, 4096, v9
    v_mfma_f32_16x16x32_bf16 a[48:51], v[148:151], v[116:119], a[48:51]
    ds_read_b128 v[176:179], v6 offset:32768
    v_mfma_f32_16x16x32_bf16 a[48:51], v[152:155], v[120:123], a[48:51]
    v_add_u32 v10, 4096, v10
    v_mfma_f32_16x16x32_bf16 a[48:51], v[156:159], v[124:127], a[48:51]
    ds_read_b128 v[180:183], v6 offset:33792
    v_mfma_f32_16x16x32_bf16 a[52:55], v[144:147], v[128:131], a[52:55]
    v_mfma_f32_16x16x32_bf16 a[52:55], v[148:151], v[132:135], a[52:55]
    ds_read_b128 v[184:187], v6 offset:34816
    v_mfma_f32_16x16x32_bf16 a[52:55], v[152:155], v[136:139], a[52:55]
    v_mfma_f32_16x16x32_bf16 a[52:55], v[156:159], v[140:143], a[52:55]
    ds_read_b128 v[188:191], v6 offset:35840
    s_waitcnt lgkmcnt(4)
    v_mfma_f32_16x16x32_bf16 a[56:59], v[160:163], v[112:115], a[56:59]
    s_waitcnt vmcnt(24)
    s_barrier
    v_mfma_f32_16x16x32_bf16 a[56:59], v[164:167], v[116:119], a[56:59]
    ds_read_b128 v[144:147], v3 offset:0
    v_mfma_f32_16x16x32_bf16 a[56:59], v[168:171], v[120:123], a[56:59]
    s_add_u32 m0, s21, 73728
    v_mfma_f32_16x16x32_bf16 a[56:59], v[172:175], v[124:127], a[56:59]
    ds_read_b128 v[148:151], v3 offset:1024
    v_mfma_f32_16x16x32_bf16 a[60:63], v[160:163], v[128:131], a[60:63]
    buffer_load_dwordx4 v7, s[8:11], s52 offen offset:0 lds
    v_mfma_f32_16x16x32_bf16 a[60:63], v[164:167], v[132:135], a[60:63]
    ds_read_b128 v[152:155], v3 offset:2048
    v_mfma_f32_16x16x32_bf16 a[60:63], v[168:171], v[136:139], a[60:63]
    buffer_load_dwordx4 v7, s[8:11], s53 offen offset:1024 lds
    v_mfma_f32_16x16x32_bf16 a[60:63], v[172:175], v[140:143], a[60:63]
    ds_read_b128 v[156:159], v3 offset:3072
    s_waitcnt lgkmcnt(4)
    v_mfma_f32_16x16x32_bf16 a[64:67], v[176:179], v[112:115], a[64:67]
    v_mfma_f32_16x16x32_bf16 a[64:67], v[180:183], v[116:119], a[64:67]
    ds_read_b128 v[160:163], v3 offset:4096
    v_mfma_f32_16x16x32_bf16 a[64:67], v[184:187], v[120:123], a[64:67]
    buffer_load_dwordx4 v7, s[8:11], s54 offen offset:2048 lds
    v_mfma_f32_16x16x32_bf16 a[64:67], v[188:191], v[124:127], a[64:67]
    ds_read_b128 v[164:167], v3 offset:5120
    v_mfma_f32_16x16x32_bf16 a[68:71], v[176:179], v[128:131], a[68:71]
    buffer_load_dwordx4 v7, s[8:11], s55 offen offset:3072 lds
    v_mfma_f32_16x16x32_bf16 a[68:71], v[180:183], v[132:135], a[68:71]
    ds_read_b128 v[168:171], v3 offset:6144
    v_mfma_f32_16x16x32_bf16 a[68:71], v[184:187], v[136:139], a[68:71]
    s_add_u32 m0, s21, 77824
    v_mfma_f32_16x16x32_bf16 a[68:71], v[188:191], v[140:143], a[68:71]
    ds_read_b128 v[172:175], v3 offset:7168
    s_waitcnt vmcnt(39)
    s_waitcnt lgkmcnt(4)
    v_mfma_f32_16x16x32_bf16 a[0:3], v[144:147], v[16:19], a[0:3]
    v_mfma_f32_16x16x32_bf16 a[0:3], v[148:151], v[20:23], a[0:3]
    ds_read_b128 v[176:179], v3 offset:8192
    v_mfma_f32_16x16x32_bf16 a[0:3], v[152:155], v[24:27], a[0:3]
    buffer_load_dwordx4 v7, s[8:11], s56 offen offset:0 lds
    v_mfma_f32_16x16x32_bf16 a[0:3], v[156:159], v[28:31], a[0:3]
    ds_read_b128 v[180:183], v3 offset:9216
    v_mfma_f32_16x16x32_bf16 a[4:7], v[144:147], v[32:35], a[4:7]
    buffer_load_dwordx4 v[112:115], v9, s[8:11], 0 offen offset:0 sc1
    v_mfma_f32_16x16x32_bf16 a[4:7], v[148:151], v[36:39], a[4:7]
    ds_read_b128 v[184:187], v3 offset:10240
    v_mfma_f32_16x16x32_bf16 a[4:7], v[152:155], v[40:43], a[4:7]
    buffer_load_dwordx4 v7, s[8:11], s57 offen offset:1024 lds
    v_mfma_f32_16x16x32_bf16 a[4:7], v[156:159], v[44:47], a[4:7]
    ds_read_b128 v[188:191], v3 offset:11264
    s_waitcnt lgkmcnt(4)
    v_mfma_f32_16x16x32_bf16 a[8:11], v[160:163], v[16:19], a[8:11]
    v_mfma_f32_16x16x32_bf16 a[8:11], v[164:167], v[20:23], a[8:11]
    ds_read_b128 v[144:147], v3 offset:12288
    v_mfma_f32_16x16x32_bf16 a[8:11], v[168:171], v[24:27], a[8:11]
    buffer_load_dwordx4 v7, s[8:11], s58 offen offset:2048 lds
    v_mfma_f32_16x16x32_bf16 a[8:11], v[172:175], v[28:31], a[8:11]
    ds_read_b128 v[148:151], v3 offset:13312
    v_mfma_f32_16x16x32_bf16 a[12:15], v[160:163], v[32:35], a[12:15]
    buffer_load_dwordx4 v[116:119], v9, s[8:11], 0 offen offset:1024 sc1
    v_mfma_f32_16x16x32_bf16 a[12:15], v[164:167], v[36:39], a[12:15]
    ds_read_b128 v[152:155], v3 offset:14336
    v_mfma_f32_16x16x32_bf16 a[12:15], v[168:171], v[40:43], a[12:15]
    buffer_load_dwordx4 v7, s[8:11], s59 offen offset:3072 lds
    v_mfma_f32_16x16x32_bf16 a[12:15], v[172:175], v[44:47], a[12:15]
    ds_read_b128 v[156:159], v3 offset:15360
    s_waitcnt lgkmcnt(4)
    v_mfma_f32_16x16x32_bf16 a[16:19], v[176:179], v[16:19], a[16:19]
    s_add_u32 m0, s21, 81920
    v_mfma_f32_16x16x32_bf16 a[16:19], v[180:183], v[20:23], a[16:19]
    ds_read_b128 v[160:163], v3 offset:16384
    v_mfma_f32_16x16x32_bf16 a[16:19], v[184:187], v[24:27], a[16:19]
    v_mfma_f32_16x16x32_bf16 a[16:19], v[188:191], v[28:31], a[16:19]
    ds_read_b128 v[164:167], v3 offset:17408
    v_mfma_f32_16x16x32_bf16 a[20:23], v[176:179], v[32:35], a[20:23]
    buffer_load_dwordx4 v7, s[8:11], s60 offen offset:0 lds
    v_mfma_f32_16x16x32_bf16 a[20:23], v[180:183], v[36:39], a[20:23]
    ds_read_b128 v[168:171], v3 offset:18432
    v_mfma_f32_16x16x32_bf16 a[20:23], v[184:187], v[40:43], a[20:23]
    buffer_load_dwordx4 v[120:123], v9, s[8:11], 0 offen offset:2048 sc1
    v_mfma_f32_16x16x32_bf16 a[20:23], v[188:191], v[44:47], a[20:23]
    ds_read_b128 v[172:175], v3 offset:19456
    s_waitcnt lgkmcnt(4)
    v_mfma_f32_16x16x32_bf16 a[24:27], v[144:147], v[16:19], a[24:27]
    v_add_u32 v7, 4096, v7
    v_mfma_f32_16x16x32_bf16 a[24:27], v[148:151], v[20:23], a[24:27]
    ds_read_b128 v[176:179], v3 offset:20480
    v_mfma_f32_16x16x32_bf16 a[24:27], v[152:155], v[24:27], a[24:27]
    v_mfma_f32_16x16x32_bf16 a[24:27], v[156:159], v[28:31], a[24:27]
    ds_read_b128 v[180:183], v3 offset:21504
    v_mfma_f32_16x16x32_bf16 a[28:31], v[144:147], v[32:35], a[28:31]
    buffer_load_dwordx4 v[124:127], v9, s[8:11], 0 offen offset:3072 sc1
    v_mfma_f32_16x16x32_bf16 a[28:31], v[148:151], v[36:39], a[28:31]
    ds_read_b128 v[184:187], v3 offset:22528
    v_mfma_f32_16x16x32_bf16 a[28:31], v[152:155], v[40:43], a[28:31]
    v_mfma_f32_16x16x32_bf16 a[28:31], v[156:159], v[44:47], a[28:31]
    ds_read_b128 v[188:191], v3 offset:23552
    s_waitcnt lgkmcnt(4)
    v_mfma_f32_16x16x32_bf16 a[32:35], v[160:163], v[16:19], a[32:35]
    buffer_load_dwordx4 v[128:131], v10, s[8:11], 0 offen offset:0 sc1
    v_mfma_f32_16x16x32_bf16 a[32:35], v[164:167], v[20:23], a[32:35]
    ds_read_b128 v[144:147], v3 offset:24576
    v_mfma_f32_16x16x32_bf16 a[32:35], v[168:171], v[24:27], a[32:35]
    v_mfma_f32_16x16x32_bf16 a[32:35], v[172:175], v[28:31], a[32:35]
    ds_read_b128 v[148:151], v3 offset:25600
    v_mfma_f32_16x16x32_bf16 a[36:39], v[160:163], v[32:35], a[36:39]
    buffer_load_dwordx4 v[132:135], v10, s[8:11], 0 offen offset:1024 sc1
    v_mfma_f32_16x16x32_bf16 a[36:39], v[164:167], v[36:39], a[36:39]
    ds_read_b128 v[152:155], v3 offset:26624
    v_mfma_f32_16x16x32_bf16 a[36:39], v[168:171], v[40:43], a[36:39]
    v_mfma_f32_16x16x32_bf16 a[36:39], v[172:175], v[44:47], a[36:39]
    ds_read_b128 v[156:159], v3 offset:27648
    s_waitcnt lgkmcnt(4)
    v_mfma_f32_16x16x32_bf16 a[40:43], v[176:179], v[16:19], a[40:43]
    buffer_load_dwordx4 v[136:139], v10, s[8:11], 0 offen offset:2048 sc1
    v_mfma_f32_16x16x32_bf16 a[40:43], v[180:183], v[20:23], a[40:43]
    ds_read_b128 v[160:163], v3 offset:28672
    v_mfma_f32_16x16x32_bf16 a[40:43], v[184:187], v[24:27], a[40:43]
    v_mfma_f32_16x16x32_bf16 a[40:43], v[188:191], v[28:31], a[40:43]
    ds_read_b128 v[164:167], v3 offset:29696
    v_mfma_f32_16x16x32_bf16 a[44:47], v[176:179], v[32:35], a[44:47]
    buffer_load_dwordx4 v[140:143], v10, s[8:11], 0 offen offset:3072 sc1
    v_mfma_f32_16x16x32_bf16 a[44:47], v[180:183], v[36:39], a[44:47]
    ds_read_b128 v[168:171], v3 offset:30720
    v_mfma_f32_16x16x32_bf16 a[44:47], v[184:187], v[40:43], a[44:47]
    v_mfma_f32_16x16x32_bf16 a[44:47], v[188:191], v[44:47], a[44:47]
    ds_read_b128 v[172:175], v3 offset:31744
    s_waitcnt lgkmcnt(4)
    v_mfma_f32_16x16x32_bf16 a[48:51], v[144:147], v[16:19], a[48:51]
    v_add_u32 v9, 4096, v9
    v_mfma_f32_16x16x32_bf16 a[48:51], v[148:151], v[20:23], a[48:51]
    ds_read_b128 v[176:179], v3 offset:32768
    v_mfma_f32_16x16x32_bf16 a[48:51], v[152:155], v[24:27], a[48:51]
    v_add_u32 v10, 4096, v10
    v_mfma_f32_16x16x32_bf16 a[48:51], v[156:159], v[28:31], a[48:51]
    ds_read_b128 v[180:183], v3 offset:33792
    v_mfma_f32_16x16x32_bf16 a[52:55], v[144:147], v[32:35], a[52:55]
    v_mfma_f32_16x16x32_bf16 a[52:55], v[148:151], v[36:39], a[52:55]
    ds_read_b128 v[184:187], v3 offset:34816
    v_mfma_f32_16x16x32_bf16 a[52:55], v[152:155], v[40:43], a[52:55]
    v_mfma_f32_16x16x32_bf16 a[52:55], v[156:159], v[44:47], a[52:55]
    ds_read_b128 v[188:191], v3 offset:35840
    s_waitcnt lgkmcnt(4)
    v_mfma_f32_16x16x32_bf16 a[56:59], v[160:163], v[16:19], a[56:59]
    s_waitcnt vmcnt(23)
    s_barrier
    v_mfma_f32_16x16x32_bf16 a[56:59], v[164:167], v[20:23], a[56:59]
    ds_read_b128 v[144:147], v4 offset:0
    v_mfma_f32_16x16x32_bf16 a[56:59], v[168:171], v[24:27], a[56:59]
    s_add_u32 m0, s21, 110592
    v_mfma_f32_16x16x32_bf16 a[56:59], v[172:175], v[28:31], a[56:59]
    ds_read_b128 v[148:151], v4 offset:1024
    v_mfma_f32_16x16x32_bf16 a[60:63], v[160:163], v[32:35], a[60:63]
    buffer_load_dwordx4 v7, s[8:11], s52 offen offset:0 lds
    v_mfma_f32_16x16x32_bf16 a[60:63], v[164:167], v[36:39], a[60:63]
    ds_read_b128 v[152:155], v4 offset:2048
    v_mfma_f32_16x16x32_bf16 a[60:63], v[168:171], v[40:43], a[60:63]
    buffer_load_dwordx4 v7, s[8:11], s53 offen offset:1024 lds
    v_mfma_f32_16x16x32_bf16 a[60:63], v[172:175], v[44:47], a[60:63]
    ds_read_b128 v[156:159], v4 offset:3072
    s_waitcnt lgkmcnt(4)
    v_mfma_f32_16x16x32_bf16 a[64:67], v[176:179], v[16:19], a[64:67]
    v_mfma_f32_16x16x32_bf16 a[64:67], v[180:183], v[20:23], a[64:67]
    ds_read_b128 v[160:163], v4 offset:4096
    v_mfma_f32_16x16x32_bf16 a[64:67], v[184:187], v[24:27], a[64:67]
    buffer_load_dwordx4 v7, s[8:11], s54 offen offset:2048 lds
    v_mfma_f32_16x16x32_bf16 a[64:67], v[188:191], v[28:31], a[64:67]
    ds_read_b128 v[164:167], v4 offset:5120
    v_mfma_f32_16x16x32_bf16 a[68:71], v[176:179], v[32:35], a[68:71]
    buffer_load_dwordx4 v7, s[8:11], s55 offen offset:3072 lds
    v_mfma_f32_16x16x32_bf16 a[68:71], v[180:183], v[36:39], a[68:71]
    ds_read_b128 v[168:171], v4 offset:6144
    v_mfma_f32_16x16x32_bf16 a[68:71], v[184:187], v[40:43], a[68:71]
    s_add_u32 m0, s21, 114688
    v_mfma_f32_16x16x32_bf16 a[68:71], v[188:191], v[44:47], a[68:71]
    ds_read_b128 v[172:175], v4 offset:7168
    s_waitcnt vmcnt(31)
    v_readfirstlane_b32 s49, v254
    s_mov_b32 s34, 0
kmain_kernel_hsp:
    s_nop 2
    s_cmp_ge_u32 s49, 16
    s_cbranch_scc1 kmain_kernel_hok
    s_add_u32 s34, s34, 1
    s_cmp_ge_u32 s34, 0x40000
    s_cbranch_scc1 kmain_kernel_hok
    s_sleep 2
    buffer_load_dword v254, v255, s[8:11], s33 offen sc1
    s_waitcnt vmcnt(0)
    v_readfirstlane_b32 s49, v254
    s_branch kmain_kernel_hsp
kmain_kernel_hok:
    s_waitcnt vmcnt(39)
    s_waitcnt lgkmcnt(4)
    v_mfma_f32_16x16x32_bf16 a[0:3], v[144:147], v[48:51], a[0:3]
    v_mfma_f32_16x16x32_bf16 a[0:3], v[148:151], v[52:55], a[0:3]
    ds_read_b128 v[176:179], v4 offset:8192
    v_mfma_f32_16x16x32_bf16 a[0:3], v[152:155], v[56:59], a[0:3]
    buffer_load_dwordx4 v7, s[8:11], s56 offen offset:0 lds
    v_mfma_f32_16x16x32_bf16 a[0:3], v[156:159], v[60:63], a[0:3]
    ds_read_b128 v[180:183], v4 offset:9216
    v_mfma_f32_16x16x32_bf16 a[4:7], v[144:147], v[64:67], a[4:7]
    buffer_load_dwordx4 v[16:19], v11, s[8:11], 0 offen offset:0 sc1
    v_mfma_f32_16x16x32_bf16 a[4:7], v[148:151], v[68:71], a[4:7]
    ds_read_b128 v[184:187], v4 offset:10240
    v_mfma_f32_16x16x32_bf16 a[4:7], v[152:155], v[72:75], a[4:7]
    buffer_load_dwordx4 v7, s[8:11], s57 offen offset:1024 lds
    v_mfma_f32_16x16x32_bf16 a[4:7], v[156:159], v[76:79], a[4:7]
    ds_read_b128 v[188:191], v4 offset:11264
    s_waitcnt lgkmcnt(4)
    v_mfma_f32_16x16x32_bf16 a[8:11], v[160:163], v[48:51], a[8:11]
    v_mfma_f32_16x16x32_bf16 a[8:11], v[164:167], v[52:55], a[8:11]
    ds_read_b128 v[144:147], v4 offset:12288
    v_mfma_f32_16x16x32_bf16 a[8:11], v[168:171], v[56:59], a[8:11]
    buffer_load_dwordx4 v7, s[8:11], s58 offen offset:2048 lds
    v_mfma_f32_16x16x32_bf16 a[8:11], v[172:175], v[60:63], a[8:11]
    ds_read_b128 v[148:151], v4 offset:13312
    v_mfma_f32_16x16x32_bf16 a[12:15], v[160:163], v[64:67], a[12:15]
    buffer_load_dwordx4 v[20:23], v11, s[8:11], 0 offen offset:1024 sc1
    v_mfma_f32_16x16x32_bf16 a[12:15], v[164:167], v[68:71], a[12:15]
    ds_read_b128 v[152:155], v4 offset:14336
    v_mfma_f32_16x16x32_bf16 a[12:15], v[168:171], v[72:75], a[12:15]
    buffer_load_dwordx4 v7, s[8:11], s59 offen offset:3072 lds
    v_mfma_f32_16x16x32_bf16 a[12:15], v[172:175], v[76:79], a[12:15]
    ds_read_b128 v[156:159], v4 offset:15360
    s_waitcnt lgkmcnt(4)
    v_mfma_f32_16x16x32_bf16 a[16:19], v[176:179], v[48:51], a[16:19]
    s_add_u32 m0, s21, 118784
    v_mfma_f32_16x16x32_bf16 a[16:19], v[180:183], v[52:55], a[16:19]
    ds_read_b128 v[160:163], v4 offset:16384
    v_mfma_f32_16x16x32_bf16 a[16:19], v[184:187], v[56:59], a[16:19]
    v_mfma_f32_16x16x32_bf16 a[16:19], v[188:191], v[60:63], a[16:19]
    ds_read_b128 v[164:167], v4 offset:17408
    v_mfma_f32_16x16x32_bf16 a[20:23], v[176:179], v[64:67], a[20:23]
    buffer_load_dwordx4 v7, s[8:11], s60 offen offset:0 lds
    v_mfma_f32_16x16x32_bf16 a[20:23], v[180:183], v[68:71], a[20:23]
    ds_read_b128 v[168:171], v4 offset:18432
    v_mfma_f32_16x16x32_bf16 a[20:23], v[184:187], v[72:75], a[20:23]
    buffer_load_dwordx4 v[24:27], v11, s[8:11], 0 offen offset:2048 sc1
    v_mfma_f32_16x16x32_bf16 a[20:23], v[188:191], v[76:79], a[20:23]
    ds_read_b128 v[172:175], v4 offset:19456
    s_waitcnt lgkmcnt(4)
    v_mfma_f32_16x16x32_bf16 a[24:27], v[144:147], v[48:51], a[24:27]
    v_add_u32 v7, 4096, v7
    v_mfma_f32_16x16x32_bf16 a[24:27], v[148:151], v[52:55], a[24:27]
    ds_read_b128 v[176:179], v4 offset:20480
    v_mfma_f32_16x16x32_bf16 a[24:27], v[152:155], v[56:59], a[24:27]
    v_mfma_f32_16x16x32_bf16 a[24:27], v[156:159], v[60:63], a[24:27]
    ds_read_b128 v[180:183], v4 offset:21504
    v_mfma_f32_16x16x32_bf16 a[28:31], v[144:147], v[64:67], a[28:31]
    buffer_load_dwordx4 v[28:31], v11, s[8:11], 0 offen offset:3072 sc1
    v_mfma_f32_16x16x32_bf16 a[28:31], v[148:151], v[68:71], a[28:31]
    ds_read_b128 v[184:187], v4 offset:22528
    v_mfma_f32_16x16x32_bf16 a[28:31], v[152:155], v[72:75], a[28:31]
    v_mfma_f32_16x16x32_bf16 a[28:31], v[156:159], v[76:79], a[28:31]
    ds_read_b128 v[188:191], v4 offset:23552
    s_waitcnt lgkmcnt(4)
    v_mfma_f32_16x16x32_bf16 a[32:35], v[160:163], v[48:51], a[32:35]
    buffer_load_dwordx4 v[32:35], v12, s[8:11], 0 offen offset:0 sc1
    v_mfma_f32_16x16x32_bf16 a[32:35], v[164:167], v[52:55], a[32:35]
    ds_read_b128 v[144:147], v4 offset:24576
    v_mfma_f32_16x16x32_bf16 a[32:35], v[168:171], v[56:59], a[32:35]
    v_mfma_f32_16x16x32_bf16 a[32:35], v[172:175], v[60:63], a[32:35]
    ds_read_b128 v[148:151], v4 offset:25600
    v_mfma_f32_16x16x32_bf16 a[36:39], v[160:163], v[64:67], a[36:39]
    buffer_load_dwordx4 v[36:39], v12, s[8:11], 0 offen offset:1024 sc1
    v_mfma_f32_16x16x32_bf16 a[36:39], v[164:167], v[68:71], a[36:39]
    ds_read_b128 v[152:155], v4 offset:26624
    v_mfma_f32_16x16x32_bf16 a[36:39], v[168:171], v[72:75], a[36:39]
    v_mfma_f32_16x16x32_bf16 a[36:39], v[172:175], v[76:79], a[36:39]
    ds_read_b128 v[156:159], v4 offset:27648
    s_waitcnt lgkmcnt(4)
    v_mfma_f32_16x16x32_bf16 a[40:43], v[176:179], v[48:51], a[40:43]
    buffer_load_dwordx4 v[40:43], v12, s[8:11], 0 offen offset:2048 sc1
    v_mfma_f32_16x16x32_bf16 a[40:43], v[180:183], v[52:55], a[40:43]
    ds_read_b128 v[160:163], v4 offset:28672
    v_mfma_f32_16x16x32_bf16 a[40:43], v[184:187], v[56:59], a[40:43]
    v_mfma_f32_16x16x32_bf16 a[40:43], v[188:191], v[60:63], a[40:43]
    ds_read_b128 v[164:167], v4 offset:29696
    v_mfma_f32_16x16x32_bf16 a[44:47], v[176:179], v[64:67], a[44:47]
    buffer_load_dwordx4 v[44:47], v12, s[8:11], 0 offen offset:3072 sc1
    v_mfma_f32_16x16x32_bf16 a[44:47], v[180:183], v[68:71], a[44:47]
    ds_read_b128 v[168:171], v4 offset:30720
    v_mfma_f32_16x16x32_bf16 a[44:47], v[184:187], v[72:75], a[44:47]
    v_mfma_f32_16x16x32_bf16 a[44:47], v[188:191], v[76:79], a[44:47]
    ds_read_b128 v[172:175], v4 offset:31744
    s_waitcnt lgkmcnt(4)
    v_mfma_f32_16x16x32_bf16 a[48:51], v[144:147], v[48:51], a[48:51]
    v_add_u32 v11, 4096, v11
    v_mfma_f32_16x16x32_bf16 a[48:51], v[148:151], v[52:55], a[48:51]
    ds_read_b128 v[176:179], v4 offset:32768
    v_mfma_f32_16x16x32_bf16 a[48:51], v[152:155], v[56:59], a[48:51]
    v_add_u32 v12, 4096, v12
    v_mfma_f32_16x16x32_bf16 a[48:51], v[156:159], v[60:63], a[48:51]
    ds_read_b128 v[180:183], v4 offset:33792
    v_mfma_f32_16x16x32_bf16 a[52:55], v[144:147], v[64:67], a[52:55]
    v_mfma_f32_16x16x32_bf16 a[52:55], v[148:151], v[68:71], a[52:55]
    ds_read_b128 v[184:187], v4 offset:34816
    v_mfma_f32_16x16x32_bf16 a[52:55], v[152:155], v[72:75], a[52:55]
    v_mfma_f32_16x16x32_bf16 a[52:55], v[156:159], v[76:79], a[52:55]
    ds_read_b128 v[188:191], v4 offset:35840
    s_waitcnt lgkmcnt(4)
    v_mfma_f32_16x16x32_bf16 a[56:59], v[160:163], v[48:51], a[56:59]
    s_waitcnt vmcnt(23)
    s_barrier
    v_mfma_f32_16x16x32_bf16 a[56:59], v[164:167], v[52:55], a[56:59]
    ds_read_b128 v[144:147], v5 offset:0
    v_mfma_f32_16x16x32_bf16 a[56:59], v[168:171], v[56:59], a[56:59]
    s_add_u32 m0, s21, 0
    v_mfma_f32_16x16x32_bf16 a[56:59], v[172:175], v[60:63], a[56:59]
    ds_read_b128 v[148:151], v5 offset:1024
    v_mfma_f32_16x16x32_bf16 a[60:63], v[160:163], v[64:67], a[60:63]
    buffer_load_dwordx4 v8, s[8:11], s62 offen offset:0 lds
    v_mfma_f32_16x16x32_bf16 a[60:63], v[164:167], v[68:71], a[60:63]
    ds_read_b128 v[152:155], v5 offset:2048
    v_mfma_f32_16x16x32_bf16 a[60:63], v[168:171], v[72:75], a[60:63]
    buffer_load_dwordx4 v8, s[8:11], s63 offen offset:1024 lds
    v_mfma_f32_16x16x32_bf16 a[60:63], v[172:175], v[76:79], a[60:63]
    ds_read_b128 v[156:159], v5 offset:3072
    s_waitcnt lgkmcnt(4)
    v_mfma_f32_16x16x32_bf16 a[64:67], v[176:179], v[48:51], a[64:67]
    v_mfma_f32_16x16x32_bf16 a[64:67], v[180:183], v[52:55], a[64:67]
    ds_read_b128 v[160:163], v5 offset:4096
    v_mfma_f32_16x16x32_bf16 a[64:67], v[184:187], v[56:59], a[64:67]
    buffer_load_dwordx4 v8, s[8:11], s64 offen offset:2048 lds
    v_mfma_f32_16x16x32_bf16 a[64:67], v[188:191], v[60:63], a[64:67]
    ds_read_b128 v[164:167], v5 offset:5120
    v_mfma_f32_16x16x32_bf16 a[68:71], v[176:179], v[64:67], a[68:71]
    buffer_load_dwordx4 v8, s[8:11], s65 offen offset:3072 lds
    v_mfma_f32_16x16x32_bf16 a[68:71], v[180:183], v[68:71], a[68:71]
    ds_read_b128 v[168:171], v5 offset:6144
    v_mfma_f32_16x16x32_bf16 a[68:71], v[184:187], v[72:75], a[68:71]
    s_add_u32 m0, s21, 4096
    v_mfma_f32_16x16x32_bf16 a[68:71], v[188:191], v[76:79], a[68:71]
    ds_read_b128 v[172:175], v5 offset:7168
    s_waitcnt vmcnt(38)
    s_waitcnt lgkmcnt(4)
    v_mfma_f32_16x16x32_bf16 a[0:3], v[144:147], v[80:83], a[0:3]
    v_mfma_f32_16x16x32_bf16 a[0:3], v[148:151], v[84:87], a[0:3]
    ds_read_b128 v[176:179], v5 offset:8192
    v_mfma_f32_16x16x32_bf16 a[0:3], v[152:155], v[88:91], a[0:3]
    buffer_load_dwordx4 v8, s[8:11], s66 offen offset:0 lds
    v_mfma_f32_16x16x32_bf16 a[0:3], v[156:159], v[92:95], a[0:3]
    ds_read_b128 v[180:183], v5 offset:9216
    v_mfma_f32_16x16x32_bf16 a[4:7], v[144:147], v[96:99], a[4:7]
    buffer_load_dwordx4 v[48:51], v11, s[8:11], 0 offen offset:0 sc1
    v_mfma_f32_16x16x32_bf16 a[4:7], v[148:151], v[100:103], a[4:7]
    ds_read_b128 v[184:187], v5 offset:10240
    v_mfma_f32_16x16x32_bf16 a[4:7], v[152:155], v[104:107], a[4:7]
    buffer_load_dwordx4 v8, s[8:11], s67 offen offset:1024 lds
    v_mfma_f32_16x16x32_bf16 a[4:7], v[156:159], v[108:111], a[4:7]
    ds_read_b128 v[188:191], v5 offset:11264
    s_waitcnt lgkmcnt(4)
    v_mfma_f32_16x16x32_bf16 a[8:11], v[160:163], v[80:83], a[8:11]
    v_mfma_f32_16x16x32_bf16 a[8:11], v[164:167], v[84:87], a[8:11]
    ds_read_b128 v[144:147], v5 offset:12288
    v_mfma_f32_16x16x32_bf16 a[8:11], v[168:171], v[88:91], a[8:11]
    buffer_load_dwordx4 v8, s[8:11], s68 offen offset:2048 lds
    v_mfma_f32_16x16x32_bf16 a[8:11], v[172:175], v[92:95], a[8:11]
    ds_read_b128 v[148:151], v5 offset:13312
    v_mfma_f32_16x16x32_bf16 a[12:15], v[160:163], v[96:99], a[12:15]
    buffer_load_dwordx4 v[52:55], v11, s[8:11], 0 offen offset:1024 sc1
    v_mfma_f32_16x16x32_bf16 a[12:15], v[164:167], v[100:103], a[12:15]
    ds_read_b128 v[152:155], v5 offset:14336
    v_mfma_f32_16x16x32_bf16 a[12:15], v[168:171], v[104:107], a[12:15]
    buffer_load_dwordx4 v8, s[8:11], s69 offen offset:3072 lds
    v_mfma_f32_16x16x32_bf16 a[12:15], v[172:175], v[108:111], a[12:15]
    ds_read_b128 v[156:159], v5 offset:15360
    s_waitcnt lgkmcnt(4)
    v_mfma_f32_16x16x32_bf16 a[16:19], v[176:179], v[80:83], a[16:19]
    s_add_u32 m0, s21, 8192
    v_mfma_f32_16x16x32_bf16 a[16:19], v[180:183], v[84:87], a[16:19]
    ds_read_b128 v[160:163], v5 offset:16384
    v_mfma_f32_16x16x32_bf16 a[16:19], v[184:187], v[88:91], a[16:19]
    v_mfma_f32_16x16x32_bf16 a[16:19], v[188:191], v[92:95], a[16:19]
    ds_read_b128 v[164:167], v5 offset:17408
    v_mfma_f32_16x16x32_bf16 a[20:23], v[176:179], v[96:99], a[20:23]
    buffer_load_dwordx4 v8, s[8:11], s70 offen offset:0 lds
    v_mfma_f32_16x16x32_bf16 a[20:23], v[180:183], v[100:103], a[20:23]
    ds_read_b128 v[168:171], v5 offset:18432
    v_mfma_f32_16x16x32_bf16 a[20:23], v[184:187], v[104:107], a[20:23]
    buffer_load_dwordx4 v[56:59], v11, s[8:11], 0 offen offset:2048 sc1
    v_mfma_f32_16x16x32_bf16 a[20:23], v[188:191], v[108:111], a[20:23]
    ds_read_b128 v[172:175], v5 offset:19456
    s_waitcnt lgkmcnt(4)
    v_mfma_f32_16x16x32_bf16 a[24:27], v[144:147], v[80:83], a[24:27]
    v_add_u32 v8, 4096, v8
    v_mfma_f32_16x16x32_bf16 a[24:27], v[148:151], v[84:87], a[24:27]
    ds_read_b128 v[176:179], v5 offset:20480
    v_mfma_f32_16x16x32_bf16 a[24:27], v[152:155], v[88:91], a[24:27]
    v_mfma_f32_16x16x32_bf16 a[24:27], v[156:159], v[92:95], a[24:27]
    ds_read_b128 v[180:183], v5 offset:21504
    v_mfma_f32_16x16x32_bf16 a[28:31], v[144:147], v[96:99], a[28:31]
    buffer_load_dwordx4 v[60:63], v11, s[8:11], 0 offen offset:3072 sc1
    v_mfma_f32_16x16x32_bf16 a[28:31], v[148:151], v[100:103], a[28:31]
    ds_read_b128 v[184:187], v5 offset:22528
    v_mfma_f32_16x16x32_bf16 a[28:31], v[152:155], v[104:107], a[28:31]
    v_mfma_f32_16x16x32_bf16 a[28:31], v[156:159], v[108:111], a[28:31]
    ds_read_b128 v[188:191], v5 offset:23552
    s_waitcnt lgkmcnt(4)
    v_mfma_f32_16x16x32_bf16 a[32:35], v[160:163], v[80:83], a[32:35]
    buffer_load_dwordx4 v[64:67], v12, s[8:11], 0 offen offset:0 sc1
    v_mfma_f32_16x16x32_bf16 a[32:35], v[164:167], v[84:87], a[32:35]
    ds_read_b128 v[144:147], v5 offset:24576
    v_mfma_f32_16x16x32_bf16 a[32:35], v[168:171], v[88:91], a[32:35]
    v_mfma_f32_16x16x32_bf16 a[32:35], v[172:175], v[92:95], a[32:35]
    ds_read_b128 v[148:151], v5 offset:25600
    v_mfma_f32_16x16x32_bf16 a[36:39], v[160:163], v[96:99], a[36:39]
    buffer_load_dwordx4 v[68:71], v12, s[8:11], 0 offen offset:1024 sc1
    v_mfma_f32_16x16x32_bf16 a[36:39], v[164:167], v[100:103], a[36:39]
    ds_read_b128 v[152:155], v5 offset:26624
    v_mfma_f32_16x16x32_bf16 a[36:39], v[168:171], v[104:107], a[36:39]
    v_mfma_f32_16x16x32_bf16 a[36:39], v[172:175], v[108:111], a[36:39]
    ds_read_b128 v[156:159], v5 offset:27648
    s_waitcnt lgkmcnt(4)
    v_mfma_f32_16x16x32_bf16 a[40:43], v[176:179], v[80:83], a[40:43]
    buffer_load_dwordx4 v[72:75], v12, s[8:11], 0 offen offset:2048 sc1
    v_mfma_f32_16x16x32_bf16 a[40:43], v[180:183], v[84:87], a[40:43]
    ds_read_b128 v[160:163], v5 offset:28672
    v_mfma_f32_16x16x32_bf16 a[40:43], v[184:187], v[88:91], a[40:43]
    v_mfma_f32_16x16x32_bf16 a[40:43], v[188:191], v[92:95], a[40:43]
    ds_read_b128 v[164:167], v5 offset:29696
    v_mfma_f32_16x16x32_bf16 a[44:47], v[176:179], v[96:99], a[44:47]
    buffer_load_dwordx4 v[76:79], v12, s[8:11], 0 offen offset:3072 sc1
    v_mfma_f32_16x16x32_bf16 a[44:47], v[180:183], v[100:103], a[44:47]
    ds_read_b128 v[168:171], v5 offset:30720
    v_mfma_f32_16x16x32_bf16 a[44:47], v[184:187], v[104:107], a[44:47]
    v_mfma_f32_16x16x32_bf16 a[44:47], v[188:191], v[108:111], a[44:47]
    ds_read_b128 v[172:175], v5 offset:31744
    s_waitcnt lgkmcnt(4)
    v_mfma_f32_16x16x32_bf16 a[48:51], v[144:147], v[80:83], a[48:51]
    v_add_u32 v11, 4096, v11
    v_mfma_f32_16x16x32_bf16 a[48:51], v[148:151], v[84:87], a[48:51]
    ds_read_b128 v[176:179], v5 offset:32768
    v_mfma_f32_16x16x32_bf16 a[48:51], v[152:155], v[88:91], a[48:51]
    v_add_u32 v12, 4096, v12
    v_mfma_f32_16x16x32_bf16 a[48:51], v[156:159], v[92:95], a[48:51]
    ds_read_b128 v[180:183], v5 offset:33792
    v_mfma_f32_16x16x32_bf16 a[52:55], v[144:147], v[96:99], a[52:55]
    v_mfma_f32_16x16x32_bf16 a[52:55], v[148:151], v[100:103], a[52:55]
    ds_read_b128 v[184:187], v5 offset:34816
    v_mfma_f32_16x16x32_bf16 a[52:55], v[152:155], v[104:107], a[52:55]
    v_mfma_f32_16x16x32_bf16 a[52:55], v[156:159], v[108:111], a[52:55]
    ds_read_b128 v[188:191], v5 offset:35840
    s_waitcnt lgkmcnt(4)
    v_mfma_f32_16x16x32_bf16 a[56:59], v[160:163], v[80:83], a[56:59]
    s_waitcnt vmcnt(23)
    s_barrier
    v_mfma_f32_16x16x32_bf16 a[56:59], v[164:167], v[84:87], a[56:59]
    ds_read_b128 v[144:147], v6 offset:0
    v_mfma_f32_16x16x32_bf16 a[56:59], v[168:171], v[88:91], a[56:59]
    s_add_u32 m0, s21, 36864
    v_mfma_f32_16x16x32_bf16 a[56:59], v[172:175], v[92:95], a[56:59]
    ds_read_b128 v[148:151], v6 offset:1024
    v_mfma_f32_16x16x32_bf16 a[60:63], v[160:163], v[96:99], a[60:63]
    buffer_load_dwordx4 v8, s[8:11], s62 offen offset:0 lds
    v_mfma_f32_16x16x32_bf16 a[60:63], v[164:167], v[100:103], a[60:63]
    ds_read_b128 v[152:155], v6 offset:2048
    v_mfma_f32_16x16x32_bf16 a[60:63], v[168:171], v[104:107], a[60:63]
    buffer_load_dwordx4 v8, s[8:11], s63 offen offset:1024 lds
    v_mfma_f32_16x16x32_bf16 a[60:63], v[172:175], v[108:111], a[60:63]
    ds_read_b128 v[156:159], v6 offset:3072
    s_waitcnt lgkmcnt(4)
    v_mfma_f32_16x16x32_bf16 a[64:67], v[176:179], v[80:83], a[64:67]
    v_mfma_f32_16x16x32_bf16 a[64:67], v[180:183], v[84:87], a[64:67]
    ds_read_b128 v[160:163], v6 offset:4096
    v_mfma_f32_16x16x32_bf16 a[64:67], v[184:187], v[88:91], a[64:67]
    buffer_load_dwordx4 v8, s[8:11], s64 offen offset:2048 lds
    v_mfma_f32_16x16x32_bf16 a[64:67], v[188:191], v[92:95], a[64:67]
    ds_read_b128 v[164:167], v6 offset:5120
    v_mfma_f32_16x16x32_bf16 a[68:71], v[176:179], v[96:99], a[68:71]
    buffer_load_dwordx4 v8, s[8:11], s65 offen offset:3072 lds
    v_mfma_f32_16x16x32_bf16 a[68:71], v[180:183], v[100:103], a[68:71]
    ds_read_b128 v[168:171], v6 offset:6144
    v_mfma_f32_16x16x32_bf16 a[68:71], v[184:187], v[104:107], a[68:71]
    s_add_u32 m0, s21, 40960
    v_mfma_f32_16x16x32_bf16 a[68:71], v[188:191], v[108:111], a[68:71]
    ds_read_b128 v[172:175], v6 offset:7168
    s_waitcnt vmcnt(38)
    s_waitcnt lgkmcnt(4)
    v_mfma_f32_16x16x32_bf16 a[0:3], v[144:147], v[112:115], a[0:3]
    v_mfma_f32_16x16x32_bf16 a[0:3], v[148:151], v[116:119], a[0:3]
    ds_read_b128 v[176:179], v6 offset:8192
    v_mfma_f32_16x16x32_bf16 a[0:3], v[152:155], v[120:123], a[0:3]
    buffer_load_dwordx4 v8, s[8:11], s66 offen offset:0 lds
    v_mfma_f32_16x16x32_bf16 a[0:3], v[156:159], v[124:127], a[0:3]
    ds_read_b128 v[180:183], v6 offset:9216
    v_mfma_f32_16x16x32_bf16 a[4:7], v[144:147], v[128:131], a[4:7]
    buffer_load_dwordx4 v[80:83], v11, s[8:11], 0 offen offset:0 sc1
    v_mfma_f32_16x16x32_bf16 a[4:7], v[148:151], v[132:135], a[4:7]
    ds_read_b128 v[184:187], v6 offset:10240
    v_mfma_f32_16x16x32_bf16 a[4:7], v[152:155], v[136:139], a[4:7]
    buffer_load_dwordx4 v8, s[8:11], s67 offen offset:1024 lds
    v_mfma_f32_16x16x32_bf16 a[4:7], v[156:159], v[140:143], a[4:7]
    ds_read_b128 v[188:191], v6 offset:11264
    s_waitcnt lgkmcnt(4)
    v_mfma_f32_16x16x32_bf16 a[8:11], v[160:163], v[112:115], a[8:11]
    v_mfma_f32_16x16x32_bf16 a[8:11], v[164:167], v[116:119], a[8:11]
    ds_read_b128 v[144:147], v6 offset:12288
    v_mfma_f32_16x16x32_bf16 a[8:11], v[168:171], v[120:123], a[8:11]
    buffer_load_dwordx4 v8, s[8:11], s68 offen offset:2048 lds
    v_mfma_f32_16x16x32_bf16 a[8:11], v[172:175], v[124:127], a[8:11]
    ds_read_b128 v[148:151], v6 offset:13312
    v_mfma_f32_16x16x32_bf16 a[12:15], v[160:163], v[128:131], a[12:15]
    buffer_load_dwordx4 v[84:87], v11, s[8:11], 0 offen offset:1024 sc1
    v_mfma_f32_16x16x32_bf16 a[12:15], v[164:167], v[132:135], a[12:15]
    ds_read_b128 v[152:155], v6 offset:14336
    v_mfma_f32_16x16x32_bf16 a[12:15], v[168:171], v[136:139], a[12:15]
    buffer_load_dwordx4 v8, s[8:11], s69 offen offset:3072 lds
    v_mfma_f32_16x16x32_bf16 a[12:15], v[172:175], v[140:143], a[12:15]
    ds_read_b128 v[156:159], v6 offset:15360
    s_waitcnt lgkmcnt(4)
    v_mfma_f32_16x16x32_bf16 a[16:19], v[176:179], v[112:115], a[16:19]
    s_add_u32 m0, s21, 45056
    v_mfma_f32_16x16x32_bf16 a[16:19], v[180:183], v[116:119], a[16:19]
    ds_read_b128 v[160:163], v6 offset:16384
    v_mfma_f32_16x16x32_bf16 a[16:19], v[184:187], v[120:123], a[16:19]
    v_mfma_f32_16x16x32_bf16 a[16:19], v[188:191], v[124:127], a[16:19]
    ds_read_b128 v[164:167], v6 offset:17408
    v_mfma_f32_16x16x32_bf16 a[20:23], v[176:179], v[128:131], a[20:23]
    buffer_load_dwordx4 v8, s[8:11], s70 offen offset:0 lds
    v_mfma_f32_16x16x32_bf16 a[20:23], v[180:183], v[132:135], a[20:23]
    ds_read_b128 v[168:171], v6 offset:18432
    v_mfma_f32_16x16x32_bf16 a[20:23], v[184:187], v[136:139], a[20:23]
    buffer_load_dwordx4 v[88:91], v11, s[8:11], 0 offen offset:2048 sc1
    v_mfma_f32_16x16x32_bf16 a[20:23], v[188:191], v[140:143], a[20:23]
    ds_read_b128 v[172:175], v6 offset:19456
    s_waitcnt lgkmcnt(4)
    v_mfma_f32_16x16x32_bf16 a[24:27], v[144:147], v[112:115], a[24:27]
    v_add_u32 v8, 4096, v8
    v_mfma_f32_16x16x32_bf16 a[24:27], v[148:151], v[116:119], a[24:27]
    ds_read_b128 v[176:179], v6 offset:20480
    v_mfma_f32_16x16x32_bf16 a[24:27], v[152:155], v[120:123], a[24:27]
    v_mfma_f32_16x16x32_bf16 a[24:27], v[156:159], v[124:127], a[24:27]
    ds_read_b128 v[180:183], v6 offset:21504
    v_mfma_f32_16x16x32_bf16 a[28:31], v[144:147], v[128:131], a[28:31]
    buffer_load_dwordx4 v[92:95], v11, s[8:11], 0 offen offset:3072 sc1
    v_mfma_f32_16x16x32_bf16 a[28:31], v[148:151], v[132:135], a[28:31]
    ds_read_b128 v[184:187], v6 offset:22528
    v_mfma_f32_16x16x32_bf16 a[28:31], v[152:155], v[136:139], a[28:31]
    v_mfma_f32_16x16x32_bf16 a[28:31], v[156:159], v[140:143], a[28:31]
    ds_read_b128 v[188:191], v6 offset:23552
    s_waitcnt lgkmcnt(4)
    v_mfma_f32_16x16x32_bf16 a[32:35], v[160:163], v[112:115], a[32:35]
    buffer_load_dwordx4 v[96:99], v12, s[8:11], 0 offen offset:0 sc1
    v_mfma_f32_16x16x32_bf16 a[32:35], v[164:167], v[116:119], a[32:35]
    ds_read_b128 v[144:147], v6 offset:24576
    v_mfma_f32_16x16x32_bf16 a[32:35], v[168:171], v[120:123], a[32:35]
    v_mfma_f32_16x16x32_bf16 a[32:35], v[172:175], v[124:127], a[32:35]
    ds_read_b128 v[148:151], v6 offset:25600
    v_mfma_f32_16x16x32_bf16 a[36:39], v[160:163], v[128:131], a[36:39]
    buffer_load_dwordx4 v[100:103], v12, s[8:11], 0 offen offset:1024 sc1
    v_mfma_f32_16x16x32_bf16 a[36:39], v[164:167], v[132:135], a[36:39]
    ds_read_b128 v[152:155], v6 offset:26624
    v_mfma_f32_16x16x32_bf16 a[36:39], v[168:171], v[136:139], a[36:39]
    v_mfma_f32_16x16x32_bf16 a[36:39], v[172:175], v[140:143], a[36:39]
    ds_read_b128 v[156:159], v6 offset:27648
    s_waitcnt lgkmcnt(4)
    v_mfma_f32_16x16x32_bf16 a[40:43], v[176:179], v[112:115], a[40:43]
    buffer_load_dwordx4 v[104:107], v12, s[8:11], 0 offen offset:2048 sc1
    v_mfma_f32_16x16x32_bf16 a[40:43], v[180:183], v[116:119], a[40:43]
    ds_read_b128 v[160:163], v6 offset:28672
    v_mfma_f32_16x16x32_bf16 a[40:43], v[184:187], v[120:123], a[40:43]
    v_mfma_f32_16x16x32_bf16 a[40:43], v[188:191], v[124:127], a[40:43]
    ds_read_b128 v[164:167], v6 offset:29696
    v_mfma_f32_16x16x32_bf16 a[44:47], v[176:179], v[128:131], a[44:47]
    buffer_load_dwordx4 v[108:111], v12, s[8:11], 0 offen offset:3072 sc1
    v_mfma_f32_16x16x32_bf16 a[44:47], v[180:183], v[132:135], a[44:47]
    ds_read_b128 v[168:171], v6 offset:30720
    v_mfma_f32_16x16x32_bf16 a[44:47], v[184:187], v[136:139], a[44:47]
    v_mfma_f32_16x16x32_bf16 a[44:47], v[188:191], v[140:143], a[44:47]
    ds_read_b128 v[172:175], v6 offset:31744
    s_waitcnt lgkmcnt(4)
    v_mfma_f32_16x16x32_bf16 a[48:51], v[144:147], v[112:115], a[48:51]
    v_add_u32 v11, 4096, v11
    v_mfma_f32_16x16x32_bf16 a[48:51], v[148:151], v[116:119], a[48:51]
    ds_read_b128 v[176:179], v6 offset:32768
    v_mfma_f32_16x16x32_bf16 a[48:51], v[152:155], v[120:123], a[48:51]
    v_add_u32 v12, 4096, v12
    v_mfma_f32_16x16x32_bf16 a[48:51], v[156:159], v[124:127], a[48:51]
    ds_read_b128 v[180:183], v6 offset:33792
    v_mfma_f32_16x16x32_bf16 a[52:55], v[144:147], v[128:131], a[52:55]
    v_mfma_f32_16x16x32_bf16 a[52:55], v[148:151], v[132:135], a[52:55]
    ds_read_b128 v[184:187], v6 offset:34816
    v_mfma_f32_16x16x32_bf16 a[52:55], v[152:155], v[136:139], a[52:55]
    v_mfma_f32_16x16x32_bf16 a[52:55], v[156:159], v[140:143], a[52:55]
    ds_read_b128 v[188:191], v6 offset:35840
    s_waitcnt lgkmcnt(4)
    v_mfma_f32_16x16x32_bf16 a[56:59], v[160:163], v[112:115], a[56:59]
    s_waitcnt vmcnt(23)
    s_barrier
    v_mfma_f32_16x16x32_bf16 a[56:59], v[164:167], v[116:119], a[56:59]
    ds_read_b128 v[144:147], v3 offset:0
    v_mfma_f32_16x16x32_bf16 a[56:59], v[168:171], v[120:123], a[56:59]
    s_add_u32 m0, s21, 73728
    v_mfma_f32_16x16x32_bf16 a[56:59], v[172:175], v[124:127], a[56:59]
    ds_read_b128 v[148:151], v3 offset:1024
    v_mfma_f32_16x16x32_bf16 a[60:63], v[160:163], v[128:131], a[60:63]
    buffer_load_dwordx4 v8, s[8:11], s62 offen offset:0 lds
    v_mfma_f32_16x16x32_bf16 a[60:63], v[164:167], v[132:135], a[60:63]
    ds_read_b128 v[152:155], v3 offset:2048
    v_mfma_f32_16x16x32_bf16 a[60:63], v[168:171], v[136:139], a[60:63]
    buffer_load_dwordx4 v8, s[8:11], s63 offen offset:1024 lds
    v_mfma_f32_16x16x32_bf16 a[60:63], v[172:175], v[140:143], a[60:63]
    ds_read_b128 v[156:159], v3 offset:3072
    s_waitcnt lgkmcnt(4)
    v_mfma_f32_16x16x32_bf16 a[64:67], v[176:179], v[112:115], a[64:67]
    v_mfma_f32_16x16x32_bf16 a[64:67], v[180:183], v[116:119], a[64:67]
    ds_read_b128 v[160:163], v3 offset:4096
    v_mfma_f32_16x16x32_bf16 a[64:67], v[184:187], v[120:123], a[64:67]
    buffer_load_dwordx4 v8, s[8:11], s64 offen offset:2048 lds
    v_mfma_f32_16x16x32_bf16 a[64:67], v[188:191], v[124:127], a[64:67]
    ds_read_b128 v[164:167], v3 offset:5120
    v_mfma_f32_16x16x32_bf16 a[68:71], v[176:179], v[128:131], a[68:71]
    buffer_load_dwordx4 v8, s[8:11], s65 offen offset:3072 lds
    v_mfma_f32_16x16x32_bf16 a[68:71], v[180:183], v[132:135], a[68:71]
    ds_read_b128 v[168:171], v3 offset:6144
    v_mfma_f32_16x16x32_bf16 a[68:71], v[184:187], v[136:139], a[68:71]
    s_add_u32 m0, s21, 77824
    v_mfma_f32_16x16x32_bf16 a[68:71], v[188:191], v[140:143], a[68:71]
    ds_read_b128 v[172:175], v3 offset:7168
    s_waitcnt vmcnt(38)
    s_waitcnt lgkmcnt(4)
    v_mfma_f32_16x16x32_bf16 a[72:75], v[144:147], v[16:19], 0
    v_mfma_f32_16x16x32_bf16 a[72:75], v[148:151], v[20:23], a[72:75]
    ds_read_b128 v[176:179], v3 offset:8192
    v_mfma_f32_16x16x32_bf16 a[72:75], v[152:155], v[24:27], a[72:75]
    buffer_load_dwordx4 v8, s[8:11], s66 offen offset:0 lds
    v_mfma_f32_16x16x32_bf16 a[72:75], v[156:159], v[28:31], a[72:75]
    ds_read_b128 v[180:183], v3 offset:9216
    v_mfma_f32_16x16x32_bf16 a[76:79], v[144:147], v[32:35], 0
    buffer_load_dwordx4 v[112:115], v11, s[8:11], 0 offen offset:0 sc1
    v_mfma_f32_16x16x32_bf16 a[76:79], v[148:151], v[36:39], a[76:79]
    ds_read_b128 v[184:187], v3 offset:10240
    v_mfma_f32_16x16x32_bf16 a[76:79], v[152:155], v[40:43], a[76:79]
    buffer_load_dwordx4 v8, s[8:11], s67 offen offset:1024 lds
    v_accvgpr_read_b32 v240, a32
    v_mfma_f32_16x16x32_bf16 a[76:79], v[156:159], v[44:47], a[76:79]
    ds_read_b128 v[188:191], v3 offset:11264
    v_accvgpr_read_b32 v241, a33
    s_waitcnt lgkmcnt(4)
    v_mfma_f32_16x16x32_bf16 a[80:83], v[160:163], v[16:19], 0
    v_accvgpr_read_b32 v242, a34
    v_accvgpr_read_b32 v243, a35
    v_cvt_pk_bf16_f32 v244, v240, v241
    v_mfma_f32_16x16x32_bf16 a[80:83], v[164:167], v[20:23], a[80:83]
    ds_read_b128 v[144:147], v3 offset:12288
    v_cvt_pk_bf16_f32 v245, v242, v243
    v_mfma_f32_16x16x32_bf16 a[80:83], v[168:171], v[24:27], a[80:83]
    buffer_load_dwordx4 v8, s[8:11], s68 offen offset:2048 lds
    buffer_store_dwordx2 v[244:245], v212, s[8:11], s39 offen sc1
    v_mfma_f32_16x16x32_bf16 a[80:83], v[172:175], v[28:31], a[80:83]
    ds_read_b128 v[148:151], v3 offset:13312
    v_accvgpr_read_b32 v246, a40
    v_accvgpr_read_b32 v247, a41
    v_mfma_f32_16x16x32_bf16 a[84:87], v[160:163], v[32:35], 0
    buffer_load_dwordx4 v[116:119], v11, s[8:11], 0 offen offset:1024 sc1
    v_accvgpr_read_b32 v248, a42
    v_mfma_f32_16x16x32_bf16 a[84:87], v[164:167], v[36:39], a[84:87]
    ds_read_b128 v[152:155], v3 offset:14336
    v_accvgpr_read_b32 v249, a43
    v_cvt_pk_bf16_f32 v250, v246, v247
    v_mfma_f32_16x16x32_bf16 a[84:87], v[168:171], v[40:43], a[84:87]
    buffer_load_dwordx4 v8, s[8:11], s69 offen offset:3072 lds
    v_cvt_pk_bf16_f32 v251, v248, v249
    v_mfma_f32_16x16x32_bf16 a[84:87], v[172:175], v[44:47], a[84:87]
    ds_read_b128 v[156:159], v3 offset:15360
    buffer_store_dwordx2 v[250:251], v213, s[8:11], s39 offen sc1
    s_waitcnt lgkmcnt(4)
    v_mfma_f32_16x16x32_bf16 a[88:91], v[176:179], v[16:19], 0
    s_add_u32 m0, s21, 81920
    v_accvgpr_read_b32 v240, a48
    v_mfma_f32_16x16x32_bf16 a[88:91], v[180:183], v[20:23], a[88:91]
    ds_read_b128 v[160:163], v3 offset:16384
    v_accvgpr_read_b32 v241, a49
    v_accvgpr_read_b32 v242, a50
    v_mfma_f32_16x16x32_bf16 a[88:91], v[184:187], v[24:27], a[88:91]
    v_accvgpr_read_b32 v243, a51
    v_cvt_pk_bf16_f32 v244, v240, v241
    v_cvt_pk_bf16_f32 v245, v242, v243
    v_mfma_f32_16x16x32_bf16 a[88:91], v[188:191], v[28:31], a[88:91]
    ds_read_b128 v[164:167], v3 offset:17408
    buffer_store_dwordx2 v[244:245], v214, s[8:11], s39 offen sc1
    v_mfma_f32_16x16x32_bf16 a[92:95], v[176:179], v[32:35], 0
    buffer_load_dwordx4 v8, s[8:11], s70 offen offset:0 lds
    v_mfma_f32_16x16x32_bf16 a[92:95], v[180:183], v[36:39], a[92:95]
    ds_read_b128 v[168:171], v3 offset:18432
    v_accvgpr_read_b32 v246, a56
    v_accvgpr_read_b32 v247, a57
    v_mfma_f32_16x16x32_bf16 a[92:95], v[184:187], v[40:43], a[92:95]
    buffer_load_dwordx4 v[120:123], v11, s[8:11], 0 offen offset:2048 sc1
    v_accvgpr_read_b32 v248, a58
    v_accvgpr_read_b32 v249, a59
    v_mfma_f32_16x16x32_bf16 a[92:95], v[188:191], v[44:47], a[92:95]
    ds_read_b128 v[172:175], v3 offset:19456
    v_cvt_pk_bf16_f32 v250, v246, v247
    s_waitcnt lgkmcnt(4)
    v_mfma_f32_16x16x32_bf16 a[96:99], v[144:147], v[16:19], 0
    v_add_u32 v8, 4096, v8
    v_cvt_pk_bf16_f32 v251, v248, v249
    v_mfma_f32_16x16x32_bf16 a[96:99], v[148:151], v[20:23], a[96:99]
    ds_read_b128 v[176:179], v3 offset:20480
    buffer_store_dwordx2 v[250:251], v215, s[8:11], s39 offen sc1
    v_mfma_f32_16x16x32_bf16 a[96:99], v[152:155], v[24:27], a[96:99]
    v_accvgpr_read_b32 v240, a64
    v_accvgpr_read_b32 v241, a65
    v_accvgpr_read_b32 v242, a66
    v_mfma_f32_16x16x32_bf16 a[96:99], v[156:159], v[28:31], a[96:99]
    ds_read_b128 v[180:183], v3 offset:21504
    v_accvgpr_read_b32 v243, a67
    v_cvt_pk_bf16_f32 v244, v240, v241
    v_mfma_f32_16x16x32_bf16 a[100:103], v[144:147], v[32:35], 0
    buffer_load_dwordx4 v[124:127], v11, s[8:11], 0 offen offset:3072 sc1
    v_cvt_pk_bf16_f32 v245, v242, v243
    v_mfma_f32_16x16x32_bf16 a[100:103], v[148:151], v[36:39], a[100:103]
    ds_read_b128 v[184:187], v3 offset:22528
    buffer_store_dwordx2 v[244:245], v216, s[8:11], s39 offen sc1
    v_mfma_f32_16x16x32_bf16 a[100:103], v[152:155], v[40:43], a[100:103]
    v_accvgpr_read_b32 v246, a4
    v_accvgpr_read_b32 v247, a5
    v_mfma_f32_16x16x32_bf16 a[100:103], v[156:159], v[44:47], a[100:103]
    ds_read_b128 v[188:191], v3 offset:23552
    v_accvgpr_read_b32 v248, a6
    s_waitcnt lgkmcnt(4)
    v_mfma_f32_16x16x32_bf16 a[104:107], v[160:163], v[16:19], 0
    buffer_load_dwordx4 v[128:131], v12, s[8:11], 0 offen offset:0 sc1
    v_accvgpr_read_b32 v249, a7
    v_cvt_pk_bf16_f32 v250, v246, v247
    v_mfma_f32_16x16x32_bf16 a[104:107], v[164:167], v[20:23], a[104:107]
    ds_read_b128 v[144:147], v3 offset:24576
    v_cvt_pk_bf16_f32 v251, v248, v249
    v_mfma_f32_16x16x32_bf16 a[104:107], v[168:171], v[24:27], a[104:107]
    buffer_store_dwordx2 v[250:251], v217, s[8:11], s39 offen sc1
    v_accvgpr_read_b32 v240, a12
    v_mfma_f32_16x16x32_bf16 a[104:107], v[172:175], v[28:31], a[104:107]
    ds_read_b128 v[148:151], v3 offset:25600
    v_accvgpr_read_b32 v241, a13
    v_accvgpr_read_b32 v242, a14
    v_mfma_f32_16x16x32_bf16 a[108:111], v[160:163], v[32:35], 0
    buffer_load_dwordx4 v[132:135], v12, s[8:11], 0 offen offset:1024 sc1
    v_accvgpr_read_b32 v243, a15
    v_mfma_f32_16x16x32_bf16 a[108:111], v[164:167], v[36:39], a[108:111]
    ds_read_b128 v[152:155], v3 offset:26624
    v_cvt_pk_bf16_f32 v244, v240, v241
    v_cvt_pk_bf16_f32 v245, v242, v243
    v_mfma_f32_16x16x32_bf16 a[108:111], v[168:171], v[40:43], a[108:111]
    buffer_store_dwordx2 v[244:245], v218, s[8:11], s39 offen sc1
    v_mfma_f32_16x16x32_bf16 a[108:111], v[172:175], v[44:47], a[108:111]
    ds_read_b128 v[156:159], v3 offset:27648
    v_accvgpr_read_b32 v246, a20
    s_waitcnt lgkmcnt(4)
    v_mfma_f32_16x16x32_bf16 a[112:115], v[176:179], v[16:19], 0
    buffer_load_dwordx4 v[136:139], v12, s[8:11], 0 offen offset:2048 sc1
    v_accvgpr_read_b32 v247, a21
    v_accvgpr_read_b32 v248, a22
    v_mfma_f32_16x16x32_bf16 a[112:115], v[180:183], v[20:23], a[112:115]
    ds_read_b128 v[160:163], v3 offset:28672
    v_accvgpr_read_b32 v249, a23
    v_cvt_pk_bf16_f32 v250, v246, v247
    v_mfma_f32_16x16x32_bf16 a[112:115], v[184:187], v[24:27], a[112:115]
    v_cvt_pk_bf16_f32 v251, v248, v249
    buffer_store_dwordx2 v[250:251], v219, s[8:11], s39 offen sc1
    v_mfma_f32_16x16x32_bf16 a[112:115], v[188:191], v[28:31], a[112:115]
    ds_read_b128 v[164:167], v3 offset:29696
    v_accvgpr_read_b32 v240, a28
    v_mfma_f32_16x16x32_bf16 a[116:119], v[176:179], v[32:35], 0
    buffer_load_dwordx4 v[140:143], v12, s[8:11], 0 offen offset:3072 sc1
    v_accvgpr_read_b32 v241, a29
    v_mfma_f32_16x16x32_bf16 a[116:119], v[180:183], v[36:39], a[116:119]
    ds_read_b128 v[168:171], v3 offset:30720
    v_accvgpr_read_b32 v242, a30
    v_accvgpr_read_b32 v243, a31
    v_mfma_f32_16x16x32_bf16 a[116:119], v[184:187], v[40:43], a[116:119]
    v_cvt_pk_bf16_f32 v244, v240, v241
    v_cvt_pk_bf16_f32 v245, v242, v243
    v_mfma_f32_16x16x32_bf16 a[116:119], v[188:191], v[44:47], a[116:119]
    ds_read_b128 v[172:175], v3 offset:31744
    buffer_store_dwordx2 v[244:245], v220, s[8:11], s39 offen sc1
    s_waitcnt lgkmcnt(4)
    v_mfma_f32_16x16x32_bf16 a[120:123], v[144:147], v[16:19], 0
    v_add_u32 v11, 4096, v11
    v_accvgpr_read_b32 v246, a36
    v_mfma_f32_16x16x32_bf16 a[120:123], v[148:151], v[20:23], a[120:123]
    ds_read_b128 v[176:179], v3 offset:32768
    v_accvgpr_read_b32 v247, a37
    v_accvgpr_read_b32 v248, a38
    v_mfma_f32_16x16x32_bf16 a[120:123], v[152:155], v[24:27], a[120:123]
    v_add_u32 v12, 4096, v12
    v_accvgpr_read_b32 v249, a39
    v_cvt_pk_bf16_f32 v250, v246, v247
    v_mfma_f32_16x16x32_bf16 a[120:123], v[156:159], v[28:31], a[120:123]
    ds_read_b128 v[180:183], v3 offset:33792
    v_cvt_pk_bf16_f32 v251, v248, v249
    v_mfma_f32_16x16x32_bf16 a[124:127], v[144:147], v[32:35], 0
    buffer_store_dwordx2 v[250:251], v221, s[8:11], s39 offen sc1
    v_accvgpr_read_b32 v240, a44
    v_mfma_f32_16x16x32_bf16 a[124:127], v[148:151], v[36:39], a[124:127]
    ds_read_b128 v[184:187], v3 offset:34816
    v_accvgpr_read_b32 v241, a45
    v_accvgpr_read_b32 v242, a46
    v_mfma_f32_16x16x32_bf16 a[124:127], v[152:155], v[40:43], a[124:127]
    v_accvgpr_read_b32 v243, a47
    v_cvt_pk_bf16_f32 v244, v240, v241
    v_cvt_pk_bf16_f32 v245, v242, v243
    v_mfma_f32_16x16x32_bf16 a[124:127], v[156:159], v[44:47], a[124:127]
    ds_read_b128 v[188:191], v3 offset:35840
    s_waitcnt lgkmcnt(4)
    v_mfma_f32_16x16x32_bf16 a[128:131], v[160:163], v[16:19], 0
    s_waitcnt vmcnt(33)
    s_barrier
    buffer_store_dwordx2 v[244:245], v222, s[8:11], s39 offen sc1
    v_mfma_f32_16x16x32_bf16 a[128:131], v[164:167], v[20:23], a[128:131]
    ds_read_b128 v[144:147], v4 offset:0
    v_accvgpr_read_b32 v246, a52
    v_mfma_f32_16x16x32_bf16 a[128:131], v[168:171], v[24:27], a[128:131]
    s_add_u32 m0, s21, 110592
    v_accvgpr_read_b32 v247, a53
    v_accvgpr_read_b32 v248, a54
    v_mfma_f32_16x16x32_bf16 a[128:131], v[172:175], v[28:31], a[128:131]
    ds_read_b128 v[148:151], v4 offset:1024
    v_accvgpr_read_b32 v249, a55
    v_cvt_pk_bf16_f32 v250, v246, v247
    v_mfma_f32_16x16x32_bf16 a[132:135], v[160:163], v[32:35], 0
    buffer_load_dwordx4 v8, s[8:11], s62 offen offset:0 lds
    v_cvt_pk_bf16_f32 v251, v248, v249
    v_mfma_f32_16x16x32_bf16 a[132:135], v[164:167], v[36:39], a[132:135]
    ds_read_b128 v[152:155], v4 offset:2048
    buffer_store_dwordx2 v[250:251], v223, s[8:11], s39 offen sc1
    v_mfma_f32_16x16x32_bf16 a[132:135], v[168:171], v[40:43], a[132:135]
    buffer_load_dwordx4 v8, s[8:11], s63 offen offset:1024 lds
    v_accvgpr_read_b32 v240, a60
    v_mfma_f32_16x16x32_bf16 a[132:135], v[172:175], v[44:47], a[132:135]
    ds_read_b128 v[156:159], v4 offset:3072
    v_accvgpr_read_b32 v241, a61
    s_waitcnt lgkmcnt(4)
    v_mfma_f32_16x16x32_bf16 a[136:139], v[176:179], v[16:19], 0
    v_accvgpr_read_b32 v242, a62
    v_accvgpr_read_b32 v243, a63
    v_cvt_pk_bf16_f32 v244, v240, v241
    v_mfma_f32_16x16x32_bf16 a[136:139], v[180:183], v[20:23], a[136:139]
    ds_read_b128 v[160:163], v4 offset:4096
    v_cvt_pk_bf16_f32 v245, v242, v243
    v_mfma_f32_16x16x32_bf16 a[136:139], v[184:187], v[24:27], a[136:139]
    buffer_load_dwordx4 v8, s[8:11], s64 offen offset:2048 lds
    buffer_store_dwordx2 v[244:245], v224, s[8:11], s39 offen sc1
    v_mfma_f32_16x16x32_bf16 a[136:139], v[188:191], v[28:31], a[136:139]
    ds_read_b128 v[164:167], v4 offset:5120
    v_accvgpr_read_b32 v246, a68
    v_accvgpr_read_b32 v247, a69
    v_mfma_f32_16x16x32_bf16 a[140:143], v[176:179], v[32:35], 0
    buffer_load_dwordx4 v8, s[8:11], s65 offen offset:3072 lds
    v_accvgpr_read_b32 v248, a70
    v_mfma_f32_16x16x32_bf16 a[140:143], v[180:183], v[36:39], a[140:143]
    ds_read_b128 v[168:171], v4 offset:6144
    v_accvgpr_read_b32 v249, a71
    v_cvt_pk_bf16_f32 v250, v246, v247
    v_mfma_f32_16x16x32_bf16 a[140:143], v[184:187], v[40:43], a[140:143]
    s_add_u32 m0, s21, 114688
    v_cvt_pk_bf16_f32 v251, v248, v249
    v_mfma_f32_16x16x32_bf16 a[140:143], v[188:191], v[44:47], a[140:143]
    ds_read_b128 v[172:175], v4 offset:7168
    buffer_store_dwordx2 v[250:251], v225, s[8:11], s39 offen sc1
    s_waitcnt vmcnt(52)
    s_waitcnt lgkmcnt(4)
    v_mfma_f32_16x16x32_bf16 a[72:75], v[144:147], v[48:51], a[72:75]
    v_mfma_f32_16x16x32_bf16 a[72:75], v[148:151], v[52:55], a[72:75]
    ds_read_b128 v[176:179], v4 offset:8192
    v_mfma_f32_16x16x32_bf16 a[72:75], v[152:155], v[56:59], a[72:75]
    buffer_load_dwordx4 v8, s[8:11], s66 offen offset:0 lds
    v_mfma_f32_16x16x32_bf16 a[72:75], v[156:159], v[60:63], a[72:75]
    ds_read_b128 v[180:183], v4 offset:9216
    v_mfma_f32_16x16x32_bf16 a[76:79], v[144:147], v[64:67], a[76:79]
    buffer_load_dwordx4 v[16:19], v11, s[8:11], 0 offen offset:0 sc1
    v_mfma_f32_16x16x32_bf16 a[76:79], v[148:151], v[68:71], a[76:79]
    ds_read_b128 v[184:187], v4 offset:10240
    v_mfma_f32_16x16x32_bf16 a[76:79], v[152:155], v[72:75], a[76:79]
    buffer_load_dwordx4 v8, s[8:11], s67 offen offset:1024 lds
    v_mfma_f32_16x16x32_bf16 a[76:79], v[156:159], v[76:79], a[76:79]
    ds_read_b128 v[188:191], v4 offset:11264
    s_waitcnt lgkmcnt(4)
    v_mfma_f32_16x16x32_bf16 a[80:83], v[160:163], v[48:51], a[80:83]
    v_mfma_f32_16x16x32_bf16 a[80:83], v[164:167], v[52:55], a[80:83]
    ds_read_b128 v[144:147], v4 offset:12288
    v_mfma_f32_16x16x32_bf16 a[80:83], v[168:171], v[56:59], a[80:83]
    buffer_load_dwordx4 v8, s[8:11], s68 offen offset:2048 lds
    v_mfma_f32_16x16x32_bf16 a[80:83], v[172:175], v[60:63], a[80:83]
    ds_read_b128 v[148:151], v4 offset:13312
    v_mfma_f32_16x16x32_bf16 a[84:87], v[160:163], v[64:67], a[84:87]
    buffer_load_dwordx4 v[20:23], v11, s[8:11], 0 offen offset:1024 sc1
    v_mfma_f32_16x16x32_bf16 a[84:87], v[164:167], v[68:71], a[84:87]
    ds_read_b128 v[152:155], v4 offset:14336
    v_mfma_f32_16x16x32_bf16 a[84:87], v[168:171], v[72:75], a[84:87]
    buffer_load_dwordx4 v8, s[8:11], s69 offen offset:3072 lds
    v_mfma_f32_16x16x32_bf16 a[84:87], v[172:175], v[76:79], a[84:87]
    ds_read_b128 v[156:159], v4 offset:15360
    s_waitcnt lgkmcnt(4)
    v_mfma_f32_16x16x32_bf16 a[88:91], v[176:179], v[48:51], a[88:91]
    s_add_u32 m0, s21, 118784
    v_mfma_f32_16x16x32_bf16 a[88:91], v[180:183], v[52:55], a[88:91]
    ds_read_b128 v[160:163], v4 offset:16384
    v_mfma_f32_16x16x32_bf16 a[88:91], v[184:187], v[56:59], a[88:91]
    v_mfma_f32_16x16x32_bf16 a[88:91], v[188:191], v[60:63], a[88:91]
    ds_read_b128 v[164:167], v4 offset:17408
    v_mfma_f32_16x16x32_bf16 a[92:95], v[176:179], v[64:67], a[92:95]
    buffer_load_dwordx4 v8, s[8:11], s70 offen offset:0 lds
    v_mfma_f32_16x16x32_bf16 a[92:95], v[180:183], v[68:71], a[92:95]
    ds_read_b128 v[168:171], v4 offset:18432
    v_mfma_f32_16x16x32_bf16 a[92:95], v[184:187], v[72:75], a[92:95]
    buffer_load_dwordx4 v[24:27], v11, s[8:11], 0 offen offset:2048 sc1
    v_mfma_f32_16x16x32_bf16 a[92:95], v[188:191], v[76:79], a[92:95]
    ds_read_b128 v[172:175], v4 offset:19456
    s_waitcnt lgkmcnt(4)
    v_mfma_f32_16x16x32_bf16 a[96:99], v[144:147], v[48:51], a[96:99]
    v_add_u32 v8, 4096, v8
    v_mfma_f32_16x16x32_bf16 a[96:99], v[148:151], v[52:55], a[96:99]
    ds_read_b128 v[176:179], v4 offset:20480
    v_mfma_f32_16x16x32_bf16 a[96:99], v[152:155], v[56:59], a[96:99]
    v_mfma_f32_16x16x32_bf16 a[96:99], v[156:159], v[60:63], a[96:99]
    ds_read_b128 v[180:183], v4 offset:21504
    v_mfma_f32_16x16x32_bf16 a[100:103], v[144:147], v[64:67], a[100:103]
    buffer_load_dwordx4 v[28:31], v11, s[8:11], 0 offen offset:3072 sc1
    v_mfma_f32_16x16x32_bf16 a[100:103], v[148:151], v[68:71], a[100:103]
    ds_read_b128 v[184:187], v4 offset:22528
    v_mfma_f32_16x16x32_bf16 a[100:103], v[152:155], v[72:75], a[100:103]
    v_mfma_f32_16x16x32_bf16 a[100:103], v[156:159], v[76:79], a[100:103]
    ds_read_b128 v[188:191], v4 offset:23552
    s_waitcnt lgkmcnt(4)
    v_mfma_f32_16x16x32_bf16 a[104:107], v[160:163], v[48:51], a[104:107]
    buffer_load_dwordx4 v[32:35], v12, s[8:11], 0 offen offset:0 sc1
    v_mfma_f32_16x16x32_bf16 a[104:107], v[164:167], v[52:55], a[104:107]
    ds_read_b128 v[144:147], v4 offset:24576
    v_mfma_f32_16x16x32_bf16 a[104:107], v[168:171], v[56:59], a[104:107]
    v_mfma_f32_16x16x32_bf16 a[104:107], v[172:175], v[60:63], a[104:107]
    ds_read_b128 v[148:151], v4 offset:25600
    v_mfma_f32_16x16x32_bf16 a[108:111], v[160:163], v[64:67], a[108:111]
    buffer_load_dwordx4 v[36:39], v12, s[8:11], 0 offen offset:1024 sc1
    v_mfma_f32_16x16x32_bf16 a[108:111], v[164:167], v[68:71], a[108:111]
    ds_read_b128 v[152:155], v4 offset:26624
    v_mfma_f32_16x16x32_bf16 a[108:111], v[168:171], v[72:75], a[108:111]
    v_mfma_f32_16x16x32_bf16 a[108:111], v[172:175], v[76:79], a[108:111]
    ds_read_b128 v[156:159], v4 offset:27648
    s_waitcnt lgkmcnt(4)
    v_mfma_f32_16x16x32_bf16 a[112:115], v[176:179], v[48:51], a[112:115]
    buffer_load_dwordx4 v[40:43], v12, s[8:11], 0 offen offset:2048 sc1
    v_mfma_f32_16x16x32_bf16 a[112:115], v[180:183], v[52:55], a[112:115]
    ds_read_b128 v[160:163], v4 offset:28672
    v_mfma_f32_16x16x32_bf16 a[112:115], v[184:187], v[56:59], a[112:115]
    v_mfma_f32_16x16x32_bf16 a[112:115], v[188:191], v[60:63], a[112:115]
    ds_read_b128 v[164:167], v4 offset:29696
    v_mfma_f32_16x16x32_bf16 a[116:119], v[176:179], v[64:67], a[116:119]
    buffer_load_dwordx4 v[44:47], v12, s[8:11], 0 offen offset:3072 sc1
    v_mfma_f32_16x16x32_bf16 a[116:119], v[180:183], v[68:71], a[116:119]
    ds_read_b128 v[168:171], v4 offset:30720
    v_mfma_f32_16x16x32_bf16 a[116:119], v[184:187], v[72:75], a[116:119]
    v_mfma_f32_16x16x32_bf16 a[116:119], v[188:191], v[76:79], a[116:119]
    ds_read_b128 v[172:175], v4 offset:31744
    s_waitcnt lgkmcnt(4)
    v_mfma_f32_16x16x32_bf16 a[120:123], v[144:147], v[48:51], a[120:123]
    v_add_u32 v11, 4096, v11
    v_mfma_f32_16x16x32_bf16 a[120:123], v[148:151], v[52:55], a[120:123]
    ds_read_b128 v[176:179], v4 offset:32768
    v_mfma_f32_16x16x32_bf16 a[120:123], v[152:155], v[56:59], a[120:123]
    v_add_u32 v12, 4096, v12
    v_mfma_f32_16x16x32_bf16 a[120:123], v[156:159], v[60:63], a[120:123]
    ds_read_b128 v[180:183], v4 offset:33792
    v_mfma_f32_16x16x32_bf16 a[124:127], v[144:147], v[64:67], a[124:127]
    v_mfma_f32_16x16x32_bf16 a[124:127], v[148:151], v[68:71], a[124:127]
    ds_read_b128 v[184:187], v4 offset:34816
    v_mfma_f32_16x16x32_bf16 a[124:127], v[152:155], v[72:75], a[124:127]
    v_mfma_f32_16x16x32_bf16 a[124:127], v[156:159], v[76:79], a[124:127]
    ds_read_b128 v[188:191], v4 offset:35840
    s_waitcnt lgkmcnt(4)
    v_mfma_f32_16x16x32_bf16 a[128:131], v[160:163], v[48:51], a[128:131]
    s_waitcnt vmcnt(13)
    s_barrier
    s_cmp_lg_u32 s3, 0
    s_cbranch_scc1 kmain_kernel_sg_12
    v_mov_b32 v252, 1
    v_mov_b32 v253, 0
    v_cmp_eq_u32 vcc, 0, v1
    s_nop 3
    s_and_saveexec_b64 s[50:51], vcc
    buffer_atomic_add v252, v253, s[8:11], s48 offen
    s_mov_b64 exec, s[50:51]
kmain_kernel_sg_12:
    v_mfma_f32_16x16x32_bf16 a[128:131], v[164:167], v[52:55], a[128:131]
    ds_read_b128 v[144:147], v5 offset:0
    v_mfma_f32_16x16x32_bf16 a[128:131], v[168:171], v[56:59], a[128:131]
    s_add_u32 m0, s21, 0
    v_mfma_f32_16x16x32_bf16 a[128:131], v[172:175], v[60:63], a[128:131]
    ds_read_b128 v[148:151], v5 offset:1024
    v_mfma_f32_16x16x32_bf16 a[132:135], v[160:163], v[64:67], a[132:135]
    buffer_load_dwordx4 v8, s[8:11], s62 offen offset:0 lds
    v_mfma_f32_16x16x32_bf16 a[132:135], v[164:167], v[68:71], a[132:135]
    ds_read_b128 v[152:155], v5 offset:2048
    v_mfma_f32_16x16x32_bf16 a[132:135], v[168:171], v[72:75], a[132:135]
    buffer_load_dwordx4 v8, s[8:11], s63 offen offset:1024 lds
    v_mfma_f32_16x16x32_bf16 a[132:135], v[172:175], v[76:79], a[132:135]
    ds_read_b128 v[156:159], v5 offset:3072
    s_waitcnt lgkmcnt(4)
    v_mfma_f32_16x16x32_bf16 a[136:139], v[176:179], v[48:51], a[136:139]
    v_mfma_f32_16x16x32_bf16 a[136:139], v[180:183], v[52:55], a[136:139]
    ds_read_b128 v[160:163], v5 offset:4096
    v_mfma_f32_16x16x32_bf16 a[136:139], v[184:187], v[56:59], a[136:139]
    buffer_load_dwordx4 v8, s[8:11], s64 offen offset:2048 lds
    v_mfma_f32_16x16x32_bf16 a[136:139], v[188:191], v[60:63], a[136:139]
    ds_read_b128 v[164:167], v5 offset:5120
    v_mfma_f32_16x16x32_bf16 a[140:143], v[176:179], v[64:67], a[140:143]
    buffer_load_dwordx4 v8, s[8:11], s65 offen offset:3072 lds
    v_mfma_f32_16x16x32_bf16 a[140:143], v[180:183], v[68:71], a[140:143]
    ds_read_b128 v[168:171], v5 offset:6144
    v_mfma_f32_16x16x32_bf16 a[140:143], v[184:187], v[72:75], a[140:143]
    s_add_u32 m0, s21, 4096
    v_mfma_f32_16x16x32_bf16 a[140:143], v[188:191], v[76:79], a[140:143]
    ds_read_b128 v[172:175], v5 offset:7168
    s_waitcnt vmcnt(52)
    s_waitcnt lgkmcnt(4)
    v_mfma_f32_16x16x32_bf16 a[72:75], v[144:147], v[80:83], a[72:75]
    v_mfma_f32_16x16x32_bf16 a[72:75], v[148:151], v[84:87], a[72:75]
    ds_read_b128 v[176:179], v5 offset:8192
    v_mfma_f32_16x16x32_bf16 a[72:75], v[152:155], v[88:91], a[72:75]
    buffer_load_dwordx4 v8, s[8:11], s66 offen offset:0 lds
    v_mfma_f32_16x16x32_bf16 a[72:75], v[156:159], v[92:95], a[72:75]
    ds_read_b128 v[180:183], v5 offset:9216
    v_mfma_f32_16x16x32_bf16 a[76:79], v[144:147], v[96:99], a[76:79]
    buffer_load_dwordx4 v[48:51], v11, s[8:11], 0 offen offset:0 sc1
    v_mfma_f32_16x16x32_bf16 a[76:79], v[148:151], v[100:103], a[76:79]
    ds_read_b128 v[184:187], v5 offset:10240
    v_mfma_f32_16x16x32_bf16 a[76:79], v[152:155], v[104:107], a[76:79]
    buffer_load_dwordx4 v8, s[8:11], s67 offen offset:1024 lds
    v_mfma_f32_16x16x32_bf16 a[76:79], v[156:159], v[108:111], a[76:79]
    ds_read_b128 v[188:191], v5 offset:11264
    s_waitcnt lgkmcnt(4)
    v_mfma_f32_16x16x32_bf16 a[80:83], v[160:163], v[80:83], a[80:83]
    v_mfma_f32_16x16x32_bf16 a[80:83], v[164:167], v[84:87], a[80:83]
    ds_read_b128 v[144:147], v5 offset:12288
    v_mfma_f32_16x16x32_bf16 a[80:83], v[168:171], v[88:91], a[80:83]
    buffer_load_dwordx4 v8, s[8:11], s68 offen offset:2048 lds
    v_mfma_f32_16x16x32_bf16 a[80:83], v[172:175], v[92:95], a[80:83]
    ds_read_b128 v[148:151], v5 offset:13312
    v_mfma_f32_16x16x32_bf16 a[84:87], v[160:163], v[96:99], a[84:87]
    buffer_load_dwordx4 v[52:55], v11, s[8:11], 0 offen offset:1024 sc1
    v_mfma_f32_16x16x32_bf16 a[84:87], v[164:167], v[100:103], a[84:87]
    ds_read_b128 v[152:155], v5 offset:14336
    v_mfma_f32_16x16x32_bf16 a[84:87], v[168:171], v[104:107], a[84:87]
    buffer_load_dwordx4 v8, s[8:11], s69 offen offset:3072 lds
    v_mfma_f32_16x16x32_bf16 a[84:87], v[172:175], v[108:111], a[84:87]
    ds_read_b128 v[156:159], v5 offset:15360
    s_waitcnt lgkmcnt(4)
    v_mfma_f32_16x16x32_bf16 a[88:91], v[176:179], v[80:83], a[88:91]
    s_add_u32 m0, s21, 8192
    v_mfma_f32_16x16x32_bf16 a[88:91], v[180:183], v[84:87], a[88:91]
    ds_read_b128 v[160:163], v5 offset:16384
    v_mfma_f32_16x16x32_bf16 a[88:91], v[184:187], v[88:91], a[88:91]
    v_mfma_f32_16x16x32_bf16 a[88:91], v[188:191], v[92:95], a[88:91]
    ds_read_b128 v[164:167], v5 offset:17408
    v_mfma_f32_16x16x32_bf16 a[92:95], v[176:179], v[96:99], a[92:95]
    buffer_load_dwordx4 v8, s[8:11], s70 offen offset:0 lds
    v_mfma_f32_16x16x32_bf16 a[92:95], v[180:183], v[100:103], a[92:95]
    ds_read_b128 v[168:171], v5 offset:18432
    v_mfma_f32_16x16x32_bf16 a[92:95], v[184:187], v[104:107], a[92:95]
    buffer_load_dwordx4 v[56:59], v11, s[8:11], 0 offen offset:2048 sc1
    v_mfma_f32_16x16x32_bf16 a[92:95], v[188:191], v[108:111], a[92:95]
    ds_read_b128 v[172:175], v5 offset:19456
    s_waitcnt lgkmcnt(4)
    v_mfma_f32_16x16x32_bf16 a[96:99], v[144:147], v[80:83], a[96:99]
    v_add_u32 v8, 4096, v8
    v_mfma_f32_16x16x32_bf16 a[96:99], v[148:151], v[84:87], a[96:99]
    ds_read_b128 v[176:179], v5 offset:20480
    v_mfma_f32_16x16x32_bf16 a[96:99], v[152:155], v[88:91], a[96:99]
    v_mfma_f32_16x16x32_bf16 a[96:99], v[156:159], v[92:95], a[96:99]
    ds_read_b128 v[180:183], v5 offset:21504
    v_mfma_f32_16x16x32_bf16 a[100:103], v[144:147], v[96:99], a[100:103]
    buffer_load_dwordx4 v[60:63], v11, s[8:11], 0 offen offset:3072 sc1
    v_mfma_f32_16x16x32_bf16 a[100:103], v[148:151], v[100:103], a[100:103]
    ds_read_b128 v[184:187], v5 offset:22528
    v_mfma_f32_16x16x32_bf16 a[100:103], v[152:155], v[104:107], a[100:103]
    v_mfma_f32_16x16x32_bf16 a[100:103], v[156:159], v[108:111], a[100:103]
    ds_read_b128 v[188:191], v5 offset:23552
    s_waitcnt lgkmcnt(4)
    v_mfma_f32_16x16x32_bf16 a[104:107], v[160:163], v[80:83], a[104:107]
    buffer_load_dwordx4 v[64:67], v12, s[8:11], 0 offen offset:0 sc1
    v_mfma_f32_16x16x32_bf16 a[104:107], v[164:167], v[84:87], a[104:107]
    ds_read_b128 v[144:147], v5 offset:24576
    v_mfma_f32_16x16x32_bf16 a[104:107], v[168:171], v[88:91], a[104:107]
    v_mfma_f32_16x16x32_bf16 a[104:107], v[172:175], v[92:95], a[104:107]
    ds_read_b128 v[148:151], v5 offset:25600
    v_mfma_f32_16x16x32_bf16 a[108:111], v[160:163], v[96:99], a[108:111]
    buffer_load_dwordx4 v[68:71], v12, s[8:11], 0 offen offset:1024 sc1
    v_mfma_f32_16x16x32_bf16 a[108:111], v[164:167], v[100:103], a[108:111]
    ds_read_b128 v[152:155], v5 offset:26624
    v_mfma_f32_16x16x32_bf16 a[108:111], v[168:171], v[104:107], a[108:111]
    v_mfma_f32_16x16x32_bf16 a[108:111], v[172:175], v[108:111], a[108:111]
    ds_read_b128 v[156:159], v5 offset:27648
    s_waitcnt lgkmcnt(4)
    v_mfma_f32_16x16x32_bf16 a[112:115], v[176:179], v[80:83], a[112:115]
    buffer_load_dwordx4 v[72:75], v12, s[8:11], 0 offen offset:2048 sc1
    v_mfma_f32_16x16x32_bf16 a[112:115], v[180:183], v[84:87], a[112:115]
    ds_read_b128 v[160:163], v5 offset:28672
    v_mfma_f32_16x16x32_bf16 a[112:115], v[184:187], v[88:91], a[112:115]
    v_mfma_f32_16x16x32_bf16 a[112:115], v[188:191], v[92:95], a[112:115]
    ds_read_b128 v[164:167], v5 offset:29696
    v_mfma_f32_16x16x32_bf16 a[116:119], v[176:179], v[96:99], a[116:119]
    buffer_load_dwordx4 v[76:79], v12, s[8:11], 0 offen offset:3072 sc1
    v_mfma_f32_16x16x32_bf16 a[116:119], v[180:183], v[100:103], a[116:119]
    ds_read_b128 v[168:171], v5 offset:30720
    v_mfma_f32_16x16x32_bf16 a[116:119], v[184:187], v[104:107], a[116:119]
    v_mfma_f32_16x16x32_bf16 a[116:119], v[188:191], v[108:111], a[116:119]
    ds_read_b128 v[172:175], v5 offset:31744
    s_waitcnt lgkmcnt(4)
    v_mfma_f32_16x16x32_bf16 a[120:123], v[144:147], v[80:83], a[120:123]
    v_add_u32 v11, 4096, v11
    v_mfma_f32_16x16x32_bf16 a[120:123], v[148:151], v[84:87], a[120:123]
    ds_read_b128 v[176:179], v5 offset:32768
    v_mfma_f32_16x16x32_bf16 a[120:123], v[152:155], v[88:91], a[120:123]
    v_add_u32 v12, 4096, v12
    v_mfma_f32_16x16x32_bf16 a[120:123], v[156:159], v[92:95], a[120:123]
    ds_read_b128 v[180:183], v5 offset:33792
    v_mfma_f32_16x16x32_bf16 a[124:127], v[144:147], v[96:99], a[124:127]
    v_mfma_f32_16x16x32_bf16 a[124:127], v[148:151], v[100:103], a[124:127]
    ds_read_b128 v[184:187], v5 offset:34816
    v_mfma_f32_16x16x32_bf16 a[124:127], v[152:155], v[104:107], a[124:127]
    v_mfma_f32_16x16x32_bf16 a[124:127], v[156:159], v[108:111], a[124:127]
    ds_read_b128 v[188:191], v5 offset:35840
    s_waitcnt lgkmcnt(4)
    v_mfma_f32_16x16x32_bf16 a[128:131], v[160:163], v[80:83], a[128:131]
    s_waitcnt vmcnt(23)
    s_barrier
    v_mfma_f32_16x16x32_bf16 a[128:131], v[164:167], v[84:87], a[128:131]
    ds_read_b128 v[144:147], v6 offset:0
    v_mfma_f32_16x16x32_bf16 a[128:131], v[168:171], v[88:91], a[128:131]
    s_add_u32 m0, s21, 36864
    v_mfma_f32_16x16x32_bf16 a[128:131], v[172:175], v[92:95], a[128:131]
    ds_read_b128 v[148:151], v6 offset:1024
    v_mfma_f32_16x16x32_bf16 a[132:135], v[160:163], v[96:99], a[132:135]
    buffer_load_dwordx4 v8, s[8:11], s62 offen offset:0 lds
    v_mfma_f32_16x16x32_bf16 a[132:135], v[164:167], v[100:103], a[132:135]
    ds_read_b128 v[152:155], v6 offset:2048
    v_mfma_f32_16x16x32_bf16 a[132:135], v[168:171], v[104:107], a[132:135]
    buffer_load_dwordx4 v8, s[8:11], s63 offen offset:1024 lds
    v_mfma_f32_16x16x32_bf16 a[132:135], v[172:175], v[108:111], a[132:135]
    ds_read_b128 v[156:159], v6 offset:3072
    s_waitcnt lgkmcnt(4)
    v_mfma_f32_16x16x32_bf16 a[136:139], v[176:179], v[80:83], a[136:139]
    v_mfma_f32_16x16x32_bf16 a[136:139], v[180:183], v[84:87], a[136:139]
    ds_read_b128 v[160:163], v6 offset:4096
    v_mfma_f32_16x16x32_bf16 a[136:139], v[184:187], v[88:91], a[136:139]
    buffer_load_dwordx4 v8, s[8:11], s64 offen offset:2048 lds
    v_mfma_f32_16x16x32_bf16 a[136:139], v[188:191], v[92:95], a[136:139]
    ds_read_b128 v[164:167], v6 offset:5120
    v_mfma_f32_16x16x32_bf16 a[140:143], v[176:179], v[96:99], a[140:143]
    buffer_load_dwordx4 v8, s[8:11], s65 offen offset:3072 lds
    v_mfma_f32_16x16x32_bf16 a[140:143], v[180:183], v[100:103], a[140:143]
    ds_read_b128 v[168:171], v6 offset:6144
    v_mfma_f32_16x16x32_bf16 a[140:143], v[184:187], v[104:107], a[140:143]
    s_add_u32 m0, s21, 40960
    v_mfma_f32_16x16x32_bf16 a[140:143], v[188:191], v[108:111], a[140:143]
    ds_read_b128 v[172:175], v6 offset:7168
    s_waitcnt vmcnt(44)
    s_waitcnt lgkmcnt(4)
    v_mfma_f32_16x16x32_bf16 a[72:75], v[144:147], v[112:115], a[72:75]
    v_mfma_f32_16x16x32_bf16 a[72:75], v[148:151], v[116:119], a[72:75]
    ds_read_b128 v[176:179], v6 offset:8192
    v_mfma_f32_16x16x32_bf16 a[72:75], v[152:155], v[120:123], a[72:75]
    buffer_load_dwordx4 v8, s[8:11], s66 offen offset:0 lds
    v_mfma_f32_16x16x32_bf16 a[72:75], v[156:159], v[124:127], a[72:75]
    ds_read_b128 v[180:183], v6 offset:9216
    v_mfma_f32_16x16x32_bf16 a[76:79], v[144:147], v[128:131], a[76:79]
    buffer_load_dwordx4 v[80:83], v11, s[8:11], 0 offen offset:0 sc1
    v_mfma_f32_16x16x32_bf16 a[76:79], v[148:151], v[132:135], a[76:79]
    ds_read_b128 v[184:187], v6 offset:10240
    v_mfma_f32_16x16x32_bf16 a[76:79], v[152:155], v[136:139], a[76:79]
    buffer_load_dwordx4 v8, s[8:11], s67 offen offset:1024 lds
    v_mfma_f32_16x16x32_bf16 a[76:79], v[156:159], v[140:143], a[76:79]
    ds_read_b128 v[188:191], v6 offset:11264
    s_waitcnt lgkmcnt(4)
    v_mfma_f32_16x16x32_bf16 a[80:83], v[160:163], v[112:115], a[80:83]
    v_mfma_f32_16x16x32_bf16 a[80:83], v[164:167], v[116:119], a[80:83]
    ds_read_b128 v[144:147], v6 offset:12288
    v_mfma_f32_16x16x32_bf16 a[80:83], v[168:171], v[120:123], a[80:83]
    buffer_load_dwordx4 v8, s[8:11], s68 offen offset:2048 lds
    v_mfma_f32_16x16x32_bf16 a[80:83], v[172:175], v[124:127], a[80:83]
    ds_read_b128 v[148:151], v6 offset:13312
    v_mfma_f32_16x16x32_bf16 a[84:87], v[160:163], v[128:131], a[84:87]
    buffer_load_dwordx4 v[84:87], v11, s[8:11], 0 offen offset:1024 sc1
    v_mfma_f32_16x16x32_bf16 a[84:87], v[164:167], v[132:135], a[84:87]
    ds_read_b128 v[152:155], v6 offset:14336
    v_mfma_f32_16x16x32_bf16 a[84:87], v[168:171], v[136:139], a[84:87]
    buffer_load_dwordx4 v8, s[8:11], s69 offen offset:3072 lds
    v_mfma_f32_16x16x32_bf16 a[84:87], v[172:175], v[140:143], a[84:87]
    ds_read_b128 v[156:159], v6 offset:15360
    s_waitcnt lgkmcnt(4)
    v_mfma_f32_16x16x32_bf16 a[88:91], v[176:179], v[112:115], a[88:91]
    s_add_u32 m0, s21, 45056
    v_mfma_f32_16x16x32_bf16 a[88:91], v[180:183], v[116:119], a[88:91]
    ds_read_b128 v[160:163], v6 offset:16384
    v_mfma_f32_16x16x32_bf16 a[88:91], v[184:187], v[120:123], a[88:91]
    v_mfma_f32_16x16x32_bf16 a[88:91], v[188:191], v[124:127], a[88:91]
    ds_read_b128 v[164:167], v6 offset:17408
    v_mfma_f32_16x16x32_bf16 a[92:95], v[176:179], v[128:131], a[92:95]
    buffer_load_dwordx4 v8, s[8:11], s70 offen offset:0 lds
    v_mfma_f32_16x16x32_bf16 a[92:95], v[180:183], v[132:135], a[92:95]
    ds_read_b128 v[168:171], v6 offset:18432
    v_mfma_f32_16x16x32_bf16 a[92:95], v[184:187], v[136:139], a[92:95]
    buffer_load_dwordx4 v[88:91], v11, s[8:11], 0 offen offset:2048 sc1
    v_mfma_f32_16x16x32_bf16 a[92:95], v[188:191], v[140:143], a[92:95]
    ds_read_b128 v[172:175], v6 offset:19456
    s_waitcnt lgkmcnt(4)
    v_mfma_f32_16x16x32_bf16 a[96:99], v[144:147], v[112:115], a[96:99]
    v_add_u32 v8, 4096, v8
    v_mfma_f32_16x16x32_bf16 a[96:99], v[148:151], v[116:119], a[96:99]
    ds_read_b128 v[176:179], v6 offset:20480
    v_mfma_f32_16x16x32_bf16 a[96:99], v[152:155], v[120:123], a[96:99]
    v_mfma_f32_16x16x32_bf16 a[96:99], v[156:159], v[124:127], a[96:99]
    ds_read_b128 v[180:183], v6 offset:21504
    v_mfma_f32_16x16x32_bf16 a[100:103], v[144:147], v[128:131], a[100:103]
    buffer_load_dwordx4 v[92:95], v11, s[8:11], 0 offen offset:3072 sc1
    v_mfma_f32_16x16x32_bf16 a[100:103], v[148:151], v[132:135], a[100:103]
    ds_read_b128 v[184:187], v6 offset:22528
    v_mfma_f32_16x16x32_bf16 a[100:103], v[152:155], v[136:139], a[100:103]
    v_mfma_f32_16x16x32_bf16 a[100:103], v[156:159], v[140:143], a[100:103]
    ds_read_b128 v[188:191], v6 offset:23552
    s_waitcnt lgkmcnt(4)
    v_mfma_f32_16x16x32_bf16 a[104:107], v[160:163], v[112:115], a[104:107]
    buffer_load_dwordx4 v[96:99], v12, s[8:11], 0 offen offset:0 sc1
    v_mfma_f32_16x16x32_bf16 a[104:107], v[164:167], v[116:119], a[104:107]
    ds_read_b128 v[144:147], v6 offset:24576
    v_mfma_f32_16x16x32_bf16 a[104:107], v[168:171], v[120:123], a[104:107]
    v_mfma_f32_16x16x32_bf16 a[104:107], v[172:175], v[124:127], a[104:107]
    ds_read_b128 v[148:151], v6 offset:25600
    v_mfma_f32_16x16x32_bf16 a[108:111], v[160:163], v[128:131], a[108:111]
    buffer_load_dwordx4 v[100:103], v12, s[8:11], 0 offen offset:1024 sc1
    v_mfma_f32_16x16x32_bf16 a[108:111], v[164:167], v[132:135], a[108:111]
    ds_read_b128 v[152:155], v6 offset:26624
    v_mfma_f32_16x16x32_bf16 a[108:111], v[168:171], v[136:139], a[108:111]
    v_mfma_f32_16x16x32_bf16 a[108:111], v[172:175], v[140:143], a[108:111]
    ds_read_b128 v[156:159], v6 offset:27648
    s_waitcnt lgkmcnt(4)
    v_mfma_f32_16x16x32_bf16 a[112:115], v[176:179], v[112:115], a[112:115]
    buffer_load_dwordx4 v[104:107], v12, s[8:11], 0 offen offset:2048 sc1
    v_mfma_f32_16x16x32_bf16 a[112:115], v[180:183], v[116:119], a[112:115]
    ds_read_b128 v[160:163], v6 offset:28672
    v_mfma_f32_16x16x32_bf16 a[112:115], v[184:187], v[120:123], a[112:115]
    v_mfma_f32_16x16x32_bf16 a[112:115], v[188:191], v[124:127], a[112:115]
    ds_read_b128 v[164:167], v6 offset:29696
    v_mfma_f32_16x16x32_bf16 a[116:119], v[176:179], v[128:131], a[116:119]
    buffer_load_dwordx4 v[108:111], v12, s[8:11], 0 offen offset:3072 sc1
    v_mfma_f32_16x16x32_bf16 a[116:119], v[180:183], v[132:135], a[116:119]
    ds_read_b128 v[168:171], v6 offset:30720
    v_mfma_f32_16x16x32_bf16 a[116:119], v[184:187], v[136:139], a[116:119]
    v_mfma_f32_16x16x32_bf16 a[116:119], v[188:191], v[140:143], a[116:119]
    ds_read_b128 v[172:175], v6 offset:31744
    s_waitcnt lgkmcnt(4)
    v_mfma_f32_16x16x32_bf16 a[120:123], v[144:147], v[112:115], a[120:123]
    v_add_u32 v11, 4096, v11
    v_mfma_f32_16x16x32_bf16 a[120:123], v[148:151], v[116:119], a[120:123]
    ds_read_b128 v[176:179], v6 offset:32768
    v_mfma_f32_16x16x32_bf16 a[120:123], v[152:155], v[120:123], a[120:123]
    v_add_u32 v12, 4096, v12
    v_mfma_f32_16x16x32_bf16 a[120:123], v[156:159], v[124:127], a[120:123]
    ds_read_b128 v[180:183], v6 offset:33792
    v_mfma_f32_16x16x32_bf16 a[124:127], v[144:147], v[128:131], a[124:127]
    v_mfma_f32_16x16x32_bf16 a[124:127], v[148:151], v[132:135], a[124:127]
    ds_read_b128 v[184:187], v6 offset:34816
    v_mfma_f32_16x16x32_bf16 a[124:127], v[152:155], v[136:139], a[124:127]
    v_mfma_f32_16x16x32_bf16 a[124:127], v[156:159], v[140:143], a[124:127]
    ds_read_b128 v[188:191], v6 offset:35840
    s_waitcnt lgkmcnt(4)
    v_mfma_f32_16x16x32_bf16 a[128:131], v[160:163], v[112:115], a[128:131]
    s_waitcnt vmcnt(23)
    s_barrier
    v_mfma_f32_16x16x32_bf16 a[128:131], v[164:167], v[116:119], a[128:131]
    ds_read_b128 v[144:147], v3 offset:0
    v_mfma_f32_16x16x32_bf16 a[128:131], v[168:171], v[120:123], a[128:131]
    s_add_u32 m0, s21, 73728
    v_mfma_f32_16x16x32_bf16 a[128:131], v[172:175], v[124:127], a[128:131]
    ds_read_b128 v[148:151], v3 offset:1024
    v_mfma_f32_16x16x32_bf16 a[132:135], v[160:163], v[128:131], a[132:135]
    buffer_load_dwordx4 v8, s[8:11], s62 offen offset:0 lds
    v_mfma_f32_16x16x32_bf16 a[132:135], v[164:167], v[132:135], a[132:135]
    ds_read_b128 v[152:155], v3 offset:2048
    v_mfma_f32_16x16x32_bf16 a[132:135], v[168:171], v[136:139], a[132:135]
    buffer_load_dwordx4 v8, s[8:11], s63 offen offset:1024 lds
    v_mfma_f32_16x16x32_bf16 a[132:135], v[172:175], v[140:143], a[132:135]
    ds_read_b128 v[156:159], v3 offset:3072
    s_waitcnt lgkmcnt(4)
    v_mfma_f32_16x16x32_bf16 a[136:139], v[176:179], v[112:115], a[136:139]
    v_mfma_f32_16x16x32_bf16 a[136:139], v[180:183], v[116:119], a[136:139]
    ds_read_b128 v[160:163], v3 offset:4096
    v_mfma_f32_16x16x32_bf16 a[136:139], v[184:187], v[120:123], a[136:139]
    buffer_load_dwordx4 v8, s[8:11], s64 offen offset:2048 lds
    v_mfma_f32_16x16x32_bf16 a[136:139], v[188:191], v[124:127], a[136:139]
    ds_read_b128 v[164:167], v3 offset:5120
    v_mfma_f32_16x16x32_bf16 a[140:143], v[176:179], v[128:131], a[140:143]
    buffer_load_dwordx4 v8, s[8:11], s65 offen offset:3072 lds
    v_mfma_f32_16x16x32_bf16 a[140:143], v[180:183], v[132:135], a[140:143]
    ds_read_b128 v[168:171], v3 offset:6144
    v_mfma_f32_16x16x32_bf16 a[140:143], v[184:187], v[136:139], a[140:143]
    s_add_u32 m0, s21, 77824
    v_mfma_f32_16x16x32_bf16 a[140:143], v[188:191], v[140:143], a[140:143]
    ds_read_b128 v[172:175], v3 offset:7168
    s_waitcnt vmcnt(38)
    s_waitcnt lgkmcnt(4)
    v_mfma_f32_16x16x32_bf16 a[72:75], v[144:147], v[16:19], a[72:75]
    v_mfma_f32_16x16x32_bf16 a[72:75], v[148:151], v[20:23], a[72:75]
    ds_read_b128 v[176:179], v3 offset:8192
    v_mfma_f32_16x16x32_bf16 a[72:75], v[152:155], v[24:27], a[72:75]
    buffer_load_dwordx4 v8, s[8:11], s66 offen offset:0 lds
    v_mfma_f32_16x16x32_bf16 a[72:75], v[156:159], v[28:31], a[72:75]
    ds_read_b128 v[180:183], v3 offset:9216
    v_mfma_f32_16x16x32_bf16 a[76:79], v[144:147], v[32:35], a[76:79]
    buffer_load_dwordx4 v[112:115], v11, s[8:11], 0 offen offset:0 sc1
    v_mfma_f32_16x16x32_bf16 a[76:79], v[148:151], v[36:39], a[76:79]
    ds_read_b128 v[184:187], v3 offset:10240
    v_mfma_f32_16x16x32_bf16 a[76:79], v[152:155], v[40:43], a[76:79]
    buffer_load_dwordx4 v8, s[8:11], s67 offen offset:1024 lds
    v_mfma_f32_16x16x32_bf16 a[76:79], v[156:159], v[44:47], a[76:79]
    ds_read_b128 v[188:191], v3 offset:11264
    s_waitcnt lgkmcnt(4)
    v_mfma_f32_16x16x32_bf16 a[80:83], v[160:163], v[16:19], a[80:83]
    v_mfma_f32_16x16x32_bf16 a[80:83], v[164:167], v[20:23], a[80:83]
    ds_read_b128 v[144:147], v3 offset:12288
    v_mfma_f32_16x16x32_bf16 a[80:83], v[168:171], v[24:27], a[80:83]
    buffer_load_dwordx4 v8, s[8:11], s68 offen offset:2048 lds
    v_mfma_f32_16x16x32_bf16 a[80:83], v[172:175], v[28:31], a[80:83]
    ds_read_b128 v[148:151], v3 offset:13312
    v_mfma_f32_16x16x32_bf16 a[84:87], v[160:163], v[32:35], a[84:87]
    buffer_load_dwordx4 v[116:119], v11, s[8:11], 0 offen offset:1024 sc1
    v_mfma_f32_16x16x32_bf16 a[84:87], v[164:167], v[36:39], a[84:87]
    ds_read_b128 v[152:155], v3 offset:14336
    v_mfma_f32_16x16x32_bf16 a[84:87], v[168:171], v[40:43], a[84:87]
    buffer_load_dwordx4 v8, s[8:11], s69 offen offset:3072 lds
    v_mfma_f32_16x16x32_bf16 a[84:87], v[172:175], v[44:47], a[84:87]
    ds_read_b128 v[156:159], v3 offset:15360
    s_waitcnt lgkmcnt(4)
    v_mfma_f32_16x16x32_bf16 a[88:91], v[176:179], v[16:19], a[88:91]
    s_add_u32 m0, s21, 81920
    v_mfma_f32_16x16x32_bf16 a[88:91], v[180:183], v[20:23], a[88:91]
    ds_read_b128 v[160:163], v3 offset:16384
    v_mfma_f32_16x16x32_bf16 a[88:91], v[184:187], v[24:27], a[88:91]
    v_mfma_f32_16x16x32_bf16 a[88:91], v[188:191], v[28:31], a[88:91]
    ds_read_b128 v[164:167], v3 offset:17408
    v_mfma_f32_16x16x32_bf16 a[92:95], v[176:179], v[32:35], a[92:95]
    buffer_load_dwordx4 v8, s[8:11], s70 offen offset:0 lds
    v_mfma_f32_16x16x32_bf16 a[92:95], v[180:183], v[36:39], a[92:95]
    ds_read_b128 v[168:171], v3 offset:18432
    v_mfma_f32_16x16x32_bf16 a[92:95], v[184:187], v[40:43], a[92:95]
    buffer_load_dwordx4 v[120:123], v11, s[8:11], 0 offen offset:2048 sc1
    v_mfma_f32_16x16x32_bf16 a[92:95], v[188:191], v[44:47], a[92:95]
    ds_read_b128 v[172:175], v3 offset:19456
    s_waitcnt lgkmcnt(4)
    v_mfma_f32_16x16x32_bf16 a[96:99], v[144:147], v[16:19], a[96:99]
    v_add_u32 v8, 4096, v8
    v_mfma_f32_16x16x32_bf16 a[96:99], v[148:151], v[20:23], a[96:99]
    ds_read_b128 v[176:179], v3 offset:20480
    v_mfma_f32_16x16x32_bf16 a[96:99], v[152:155], v[24:27], a[96:99]
    v_mfma_f32_16x16x32_bf16 a[96:99], v[156:159], v[28:31], a[96:99]
    ds_read_b128 v[180:183], v3 offset:21504
    v_mfma_f32_16x16x32_bf16 a[100:103], v[144:147], v[32:35], a[100:103]
    buffer_load_dwordx4 v[124:127], v11, s[8:11], 0 offen offset:3072 sc1
    v_mfma_f32_16x16x32_bf16 a[100:103], v[148:151], v[36:39], a[100:103]
    ds_read_b128 v[184:187], v3 offset:22528
    v_mfma_f32_16x16x32_bf16 a[100:103], v[152:155], v[40:43], a[100:103]
    v_mfma_f32_16x16x32_bf16 a[100:103], v[156:159], v[44:47], a[100:103]
    ds_read_b128 v[188:191], v3 offset:23552
    s_waitcnt lgkmcnt(4)
    v_mfma_f32_16x16x32_bf16 a[104:107], v[160:163], v[16:19], a[104:107]
    buffer_load_dwordx4 v[128:131], v12, s[8:11], 0 offen offset:0 sc1
    v_mfma_f32_16x16x32_bf16 a[104:107], v[164:167], v[20:23], a[104:107]
    ds_read_b128 v[144:147], v3 offset:24576
    v_mfma_f32_16x16x32_bf16 a[104:107], v[168:171], v[24:27], a[104:107]
    v_mfma_f32_16x16x32_bf16 a[104:107], v[172:175], v[28:31], a[104:107]
    ds_read_b128 v[148:151], v3 offset:25600
    v_mfma_f32_16x16x32_bf16 a[108:111], v[160:163], v[32:35], a[108:111]
    buffer_load_dwordx4 v[132:135], v12, s[8:11], 0 offen offset:1024 sc1
    v_mfma_f32_16x16x32_bf16 a[108:111], v[164:167], v[36:39], a[108:111]
    ds_read_b128 v[152:155], v3 offset:26624
    v_mfma_f32_16x16x32_bf16 a[108:111], v[168:171], v[40:43], a[108:111]
    v_mfma_f32_16x16x32_bf16 a[108:111], v[172:175], v[44:47], a[108:111]
    ds_read_b128 v[156:159], v3 offset:27648
    s_waitcnt lgkmcnt(4)
    v_mfma_f32_16x16x32_bf16 a[112:115], v[176:179], v[16:19], a[112:115]
    buffer_load_dwordx4 v[136:139], v12, s[8:11], 0 offen offset:2048 sc1
    v_mfma_f32_16x16x32_bf16 a[112:115], v[180:183], v[20:23], a[112:115]
    ds_read_b128 v[160:163], v3 offset:28672
    v_mfma_f32_16x16x32_bf16 a[112:115], v[184:187], v[24:27], a[112:115]
    v_mfma_f32_16x16x32_bf16 a[112:115], v[188:191], v[28:31], a[112:115]
    ds_read_b128 v[164:167], v3 offset:29696
    v_mfma_f32_16x16x32_bf16 a[116:119], v[176:179], v[32:35], a[116:119]
    buffer_load_dwordx4 v[140:143], v12, s[8:11], 0 offen offset:3072 sc1
    v_mfma_f32_16x16x32_bf16 a[116:119], v[180:183], v[36:39], a[116:119]
    ds_read_b128 v[168:171], v3 offset:30720
    v_mfma_f32_16x16x32_bf16 a[116:119], v[184:187], v[40:43], a[116:119]
    v_mfma_f32_16x16x32_bf16 a[116:119], v[188:191], v[44:47], a[116:119]
    ds_read_b128 v[172:175], v3 offset:31744
    s_waitcnt lgkmcnt(4)
    v_mfma_f32_16x16x32_bf16 a[120:123], v[144:147], v[16:19], a[120:123]
    v_add_u32 v11, 4096, v11
    v_mfma_f32_16x16x32_bf16 a[120:123], v[148:151], v[20:23], a[120:123]
    ds_read_b128 v[176:179], v3 offset:32768
    v_mfma_f32_16x16x32_bf16 a[120:123], v[152:155], v[24:27], a[120:123]
    v_add_u32 v12, 4096, v12
    v_mfma_f32_16x16x32_bf16 a[120:123], v[156:159], v[28:31], a[120:123]
    ds_read_b128 v[180:183], v3 offset:33792
    v_mfma_f32_16x16x32_bf16 a[124:127], v[144:147], v[32:35], a[124:127]
    v_mfma_f32_16x16x32_bf16 a[124:127], v[148:151], v[36:39], a[124:127]
    ds_read_b128 v[184:187], v3 offset:34816
    v_mfma_f32_16x16x32_bf16 a[124:127], v[152:155], v[40:43], a[124:127]
    v_mfma_f32_16x16x32_bf16 a[124:127], v[156:159], v[44:47], a[124:127]
    ds_read_b128 v[188:191], v3 offset:35840
    s_waitcnt lgkmcnt(4)
    v_mfma_f32_16x16x32_bf16 a[128:131], v[160:163], v[16:19], a[128:131]
    s_waitcnt vmcnt(23)
    s_barrier
    v_mfma_f32_16x16x32_bf16 a[128:131], v[164:167], v[20:23], a[128:131]
    ds_read_b128 v[144:147], v4 offset:0
    v_mfma_f32_16x16x32_bf16 a[128:131], v[168:171], v[24:27], a[128:131]
    s_add_u32 m0, s21, 110592
    v_mfma_f32_16x16x32_bf16 a[128:131], v[172:175], v[28:31], a[128:131]
    ds_read_b128 v[148:151], v4 offset:1024
    v_mfma_f32_16x16x32_bf16 a[132:135], v[160:163], v[32:35], a[132:135]
    buffer_load_dwordx4 v8, s[8:11], s62 offen offset:0 lds
    v_mfma_f32_16x16x32_bf16 a[132:135], v[164:167], v[36:39], a[132:135]
    ds_read_b128 v[152:155], v4 offset:2048
    v_mfma_f32_16x16x32_bf16 a[132:135], v[168:171], v[40:43], a[132:135]
    buffer_load_dwordx4 v8, s[8:11], s63 offen offset:1024 lds
    v_mfma_f32_16x16x32_bf16 a[132:135], v[172:175], v[44:47], a[132:135]
    ds_read_b128 v[156:159], v4 offset:3072
    s_waitcnt lgkmcnt(4)
    v_mfma_f32_16x16x32_bf16 a[136:139], v[176:179], v[16:19], a[136:139]
    v_mfma_f32_16x16x32_bf16 a[136:139], v[180:183], v[20:23], a[136:139]
    ds_read_b128 v[160:163], v4 offset:4096
    v_mfma_f32_16x16x32_bf16 a[136:139], v[184:187], v[24:27], a[136:139]
    buffer_load_dwordx4 v8, s[8:11], s64 offen offset:2048 lds
    v_mfma_f32_16x16x32_bf16 a[136:139], v[188:191], v[28:31], a[136:139]
    ds_read_b128 v[164:167], v4 offset:5120
    v_mfma_f32_16x16x32_bf16 a[140:143], v[176:179], v[32:35], a[140:143]
    buffer_load_dwordx4 v8, s[8:11], s65 offen offset:3072 lds
    v_mfma_f32_16x16x32_bf16 a[140:143], v[180:183], v[36:39], a[140:143]
    ds_read_b128 v[168:171], v4 offset:6144
    v_mfma_f32_16x16x32_bf16 a[140:143], v[184:187], v[40:43], a[140:143]
    s_add_u32 m0, s21, 114688
    v_mfma_f32_16x16x32_bf16 a[140:143], v[188:191], v[44:47], a[140:143]
    ds_read_b128 v[172:175], v4 offset:7168
    s_waitcnt vmcnt(38)
    s_waitcnt lgkmcnt(4)
    v_mfma_f32_16x16x32_bf16 a[72:75], v[144:147], v[48:51], a[72:75]
    v_mfma_f32_16x16x32_bf16 a[72:75], v[148:151], v[52:55], a[72:75]
    ds_read_b128 v[176:179], v4 offset:8192
    v_mfma_f32_16x16x32_bf16 a[72:75], v[152:155], v[56:59], a[72:75]
    buffer_load_dwordx4 v8, s[8:11], s66 offen offset:0 lds
    v_mfma_f32_16x16x32_bf16 a[72:75], v[156:159], v[60:63], a[72:75]
    ds_read_b128 v[180:183], v4 offset:9216
    v_mfma_f32_16x16x32_bf16 a[76:79], v[144:147], v[64:67], a[76:79]
    buffer_load_dwordx4 v[16:19], v11, s[8:11], 0 offen offset:0 sc1
    v_mfma_f32_16x16x32_bf16 a[76:79], v[148:151], v[68:71], a[76:79]
    ds_read_b128 v[184:187], v4 offset:10240
    v_mfma_f32_16x16x32_bf16 a[76:79], v[152:155], v[72:75], a[76:79]
    buffer_load_dwordx4 v8, s[8:11], s67 offen offset:1024 lds
    v_mfma_f32_16x16x32_bf16 a[76:79], v[156:159], v[76:79], a[76:79]
    ds_read_b128 v[188:191], v4 offset:11264
    s_waitcnt lgkmcnt(4)
    v_mfma_f32_16x16x32_bf16 a[80:83], v[160:163], v[48:51], a[80:83]
    v_mfma_f32_16x16x32_bf16 a[80:83], v[164:167], v[52:55], a[80:83]
    ds_read_b128 v[144:147], v4 offset:12288
    v_mfma_f32_16x16x32_bf16 a[80:83], v[168:171], v[56:59], a[80:83]
    buffer_load_dwordx4 v8, s[8:11], s68 offen offset:2048 lds
    v_mfma_f32_16x16x32_bf16 a[80:83], v[172:175], v[60:63], a[80:83]
    ds_read_b128 v[148:151], v4 offset:13312
    v_mfma_f32_16x16x32_bf16 a[84:87], v[160:163], v[64:67], a[84:87]
    buffer_load_dwordx4 v[20:23], v11, s[8:11], 0 offen offset:1024 sc1
    v_mfma_f32_16x16x32_bf16 a[84:87], v[164:167], v[68:71], a[84:87]
    ds_read_b128 v[152:155], v4 offset:14336
    v_mfma_f32_16x16x32_bf16 a[84:87], v[168:171], v[72:75], a[84:87]
    buffer_load_dwordx4 v8, s[8:11], s69 offen offset:3072 lds
    v_mfma_f32_16x16x32_bf16 a[84:87], v[172:175], v[76:79], a[84:87]
    ds_read_b128 v[156:159], v4 offset:15360
    s_waitcnt lgkmcnt(4)
    v_mfma_f32_16x16x32_bf16 a[88:91], v[176:179], v[48:51], a[88:91]
    s_add_u32 m0, s21, 118784
    v_mfma_f32_16x16x32_bf16 a[88:91], v[180:183], v[52:55], a[88:91]
    ds_read_b128 v[160:163], v4 offset:16384
    v_mfma_f32_16x16x32_bf16 a[88:91], v[184:187], v[56:59], a[88:91]
    v_mfma_f32_16x16x32_bf16 a[88:91], v[188:191], v[60:63], a[88:91]
    ds_read_b128 v[164:167], v4 offset:17408
    v_mfma_f32_16x16x32_bf16 a[92:95], v[176:179], v[64:67], a[92:95]
    buffer_load_dwordx4 v8, s[8:11], s70 offen offset:0 lds
    v_mfma_f32_16x16x32_bf16 a[92:95], v[180:183], v[68:71], a[92:95]
    ds_read_b128 v[168:171], v4 offset:18432
    v_mfma_f32_16x16x32_bf16 a[92:95], v[184:187], v[72:75], a[92:95]
    buffer_load_dwordx4 v[24:27], v11, s[8:11], 0 offen offset:2048 sc1
    v_mfma_f32_16x16x32_bf16 a[92:95], v[188:191], v[76:79], a[92:95]
    ds_read_b128 v[172:175], v4 offset:19456
    s_waitcnt lgkmcnt(4)
    v_mfma_f32_16x16x32_bf16 a[96:99], v[144:147], v[48:51], a[96:99]
    v_add_u32 v8, 4096, v8
    v_mfma_f32_16x16x32_bf16 a[96:99], v[148:151], v[52:55], a[96:99]
    ds_read_b128 v[176:179], v4 offset:20480
    v_mfma_f32_16x16x32_bf16 a[96:99], v[152:155], v[56:59], a[96:99]
    v_mfma_f32_16x16x32_bf16 a[96:99], v[156:159], v[60:63], a[96:99]
    ds_read_b128 v[180:183], v4 offset:21504
    v_mfma_f32_16x16x32_bf16 a[100:103], v[144:147], v[64:67], a[100:103]
    buffer_load_dwordx4 v[28:31], v11, s[8:11], 0 offen offset:3072 sc1
    v_mfma_f32_16x16x32_bf16 a[100:103], v[148:151], v[68:71], a[100:103]
    ds_read_b128 v[184:187], v4 offset:22528
    v_mfma_f32_16x16x32_bf16 a[100:103], v[152:155], v[72:75], a[100:103]
    v_mfma_f32_16x16x32_bf16 a[100:103], v[156:159], v[76:79], a[100:103]
    ds_read_b128 v[188:191], v4 offset:23552
    s_waitcnt lgkmcnt(4)
    v_mfma_f32_16x16x32_bf16 a[104:107], v[160:163], v[48:51], a[104:107]
    buffer_load_dwordx4 v[32:35], v12, s[8:11], 0 offen offset:0 sc1
    v_mfma_f32_16x16x32_bf16 a[104:107], v[164:167], v[52:55], a[104:107]
    ds_read_b128 v[144:147], v4 offset:24576
    v_mfma_f32_16x16x32_bf16 a[104:107], v[168:171], v[56:59], a[104:107]
    v_mfma_f32_16x16x32_bf16 a[104:107], v[172:175], v[60:63], a[104:107]
    ds_read_b128 v[148:151], v4 offset:25600
    v_mfma_f32_16x16x32_bf16 a[108:111], v[160:163], v[64:67], a[108:111]
    buffer_load_dwordx4 v[36:39], v12, s[8:11], 0 offen offset:1024 sc1
    v_mfma_f32_16x16x32_bf16 a[108:111], v[164:167], v[68:71], a[108:111]
    ds_read_b128 v[152:155], v4 offset:26624
    v_mfma_f32_16x16x32_bf16 a[108:111], v[168:171], v[72:75], a[108:111]
    v_mfma_f32_16x16x32_bf16 a[108:111], v[172:175], v[76:79], a[108:111]
    ds_read_b128 v[156:159], v4 offset:27648
    s_waitcnt lgkmcnt(4)
    v_mfma_f32_16x16x32_bf16 a[112:115], v[176:179], v[48:51], a[112:115]
    buffer_load_dwordx4 v[40:43], v12, s[8:11], 0 offen offset:2048 sc1
    v_mfma_f32_16x16x32_bf16 a[112:115], v[180:183], v[52:55], a[112:115]
    ds_read_b128 v[160:163], v4 offset:28672
    v_mfma_f32_16x16x32_bf16 a[112:115], v[184:187], v[56:59], a[112:115]
    v_mfma_f32_16x16x32_bf16 a[112:115], v[188:191], v[60:63], a[112:115]
    ds_read_b128 v[164:167], v4 offset:29696
    v_mfma_f32_16x16x32_bf16 a[116:119], v[176:179], v[64:67], a[116:119]
    buffer_load_dwordx4 v[44:47], v12, s[8:11], 0 offen offset:3072 sc1
    v_mfma_f32_16x16x32_bf16 a[116:119], v[180:183], v[68:71], a[116:119]
    ds_read_b128 v[168:171], v4 offset:30720
    v_mfma_f32_16x16x32_bf16 a[116:119], v[184:187], v[72:75], a[116:119]
    v_mfma_f32_16x16x32_bf16 a[116:119], v[188:191], v[76:79], a[116:119]
    ds_read_b128 v[172:175], v4 offset:31744
    s_waitcnt lgkmcnt(4)
    v_mfma_f32_16x16x32_bf16 a[120:123], v[144:147], v[48:51], a[120:123]
    v_add_u32 v11, 4096, v11
    v_mfma_f32_16x16x32_bf16 a[120:123], v[148:151], v[52:55], a[120:123]
    ds_read_b128 v[176:179], v4 offset:32768
    v_mfma_f32_16x16x32_bf16 a[120:123], v[152:155], v[56:59], a[120:123]
    v_add_u32 v12, 4096, v12
    v_mfma_f32_16x16x32_bf16 a[120:123], v[156:159], v[60:63], a[120:123]
    ds_read_b128 v[180:183], v4 offset:33792
    v_mfma_f32_16x16x32_bf16 a[124:127], v[144:147], v[64:67], a[124:127]
    v_mfma_f32_16x16x32_bf16 a[124:127], v[148:151], v[68:71], a[124:127]
    ds_read_b128 v[184:187], v4 offset:34816
    v_mfma_f32_16x16x32_bf16 a[124:127], v[152:155], v[72:75], a[124:127]
    v_mfma_f32_16x16x32_bf16 a[124:127], v[156:159], v[76:79], a[124:127]
    ds_read_b128 v[188:191], v4 offset:35840
    s_waitcnt lgkmcnt(4)
    v_mfma_f32_16x16x32_bf16 a[128:131], v[160:163], v[48:51], a[128:131]
    s_waitcnt vmcnt(23)
    s_barrier
    v_mfma_f32_16x16x32_bf16 a[128:131], v[164:167], v[52:55], a[128:131]
    ds_read_b128 v[144:147], v5 offset:0
    v_mfma_f32_16x16x32_bf16 a[128:131], v[168:171], v[56:59], a[128:131]
    s_add_u32 m0, s21, 0
    v_mfma_f32_16x16x32_bf16 a[128:131], v[172:175], v[60:63], a[128:131]
    ds_read_b128 v[148:151], v5 offset:1024
    v_mfma_f32_16x16x32_bf16 a[132:135], v[160:163], v[64:67], a[132:135]
    buffer_load_dwordx4 v8, s[8:11], s62 offen offset:0 lds
    v_mfma_f32_16x16x32_bf16 a[132:135], v[164:167], v[68:71], a[132:135]
    ds_read_b128 v[152:155], v5 offset:2048
    v_mfma_f32_16x16x32_bf16 a[132:135], v[168:171], v[72:75], a[132:135]
    buffer_load_dwordx4 v8, s[8:11], s63 offen offset:1024 lds
    v_mfma_f32_16x16x32_bf16 a[132:135], v[172:175], v[76:79], a[132:135]
    ds_read_b128 v[156:159], v5 offset:3072
    s_waitcnt lgkmcnt(4)
    v_mfma_f32_16x16x32_bf16 a[136:139], v[176:179], v[48:51], a[136:139]
    v_mfma_f32_16x16x32_bf16 a[136:139], v[180:183], v[52:55], a[136:139]
    ds_read_b128 v[160:163], v5 offset:4096
    v_mfma_f32_16x16x32_bf16 a[136:139], v[184:187], v[56:59], a[136:139]
    buffer_load_dwordx4 v8, s[8:11], s64 offen offset:2048 lds
    v_mfma_f32_16x16x32_bf16 a[136:139], v[188:191], v[60:63], a[136:139]
    ds_read_b128 v[164:167], v5 offset:5120
    v_mfma_f32_16x16x32_bf16 a[140:143], v[176:179], v[64:67], a[140:143]
    buffer_load_dwordx4 v8, s[8:11], s65 offen offset:3072 lds
    v_mfma_f32_16x16x32_bf16 a[140:143], v[180:183], v[68:71], a[140:143]
    ds_read_b128 v[168:171], v5 offset:6144
    v_mfma_f32_16x16x32_bf16 a[140:143], v[184:187], v[72:75], a[140:143]
    s_add_u32 m0, s21, 4096
    v_mfma_f32_16x16x32_bf16 a[140:143], v[188:191], v[76:79], a[140:143]
    ds_read_b128 v[172:175], v5 offset:7168
    s_waitcnt vmcnt(38)
    s_waitcnt lgkmcnt(4)
    v_mfma_f32_16x16x32_bf16 a[72:75], v[144:147], v[80:83], a[72:75]
    v_mfma_f32_16x16x32_bf16 a[72:75], v[148:151], v[84:87], a[72:75]
    ds_read_b128 v[176:179], v5 offset:8192
    v_mfma_f32_16x16x32_bf16 a[72:75], v[152:155], v[88:91], a[72:75]
    buffer_load_dwordx4 v8, s[8:11], s66 offen offset:0 lds
    v_mfma_f32_16x16x32_bf16 a[72:75], v[156:159], v[92:95], a[72:75]
    ds_read_b128 v[180:183], v5 offset:9216
    v_mfma_f32_16x16x32_bf16 a[76:79], v[144:147], v[96:99], a[76:79]
    v_mfma_f32_16x16x32_bf16 a[76:79], v[148:151], v[100:103], a[76:79]
    ds_read_b128 v[184:187], v5 offset:10240
    v_mfma_f32_16x16x32_bf16 a[76:79], v[152:155], v[104:107], a[76:79]
    buffer_load_dwordx4 v8, s[8:11], s67 offen offset:1024 lds
    v_mfma_f32_16x16x32_bf16 a[76:79], v[156:159], v[108:111], a[76:79]
    ds_read_b128 v[188:191], v5 offset:11264
    s_waitcnt lgkmcnt(4)
    v_mfma_f32_16x16x32_bf16 a[80:83], v[160:163], v[80:83], a[80:83]
    v_mfma_f32_16x16x32_bf16 a[80:83], v[164:167], v[84:87], a[80:83]
    ds_read_b128 v[144:147], v5 offset:12288
    v_mfma_f32_16x16x32_bf16 a[80:83], v[168:171], v[88:91], a[80:83]
    buffer_load_dwordx4 v8, s[8:11], s68 offen offset:2048 lds
    v_mfma_f32_16x16x32_bf16 a[80:83], v[172:175], v[92:95], a[80:83]
    ds_read_b128 v[148:151], v5 offset:13312
    v_mfma_f32_16x16x32_bf16 a[84:87], v[160:163], v[96:99], a[84:87]
    v_mfma_f32_16x16x32_bf16 a[84:87], v[164:167], v[100:103], a[84:87]
    ds_read_b128 v[152:155], v5 offset:14336
    v_mfma_f32_16x16x32_bf16 a[84:87], v[168:171], v[104:107], a[84:87]
    buffer_load_dwordx4 v8, s[8:11], s69 offen offset:3072 lds
    v_mfma_f32_16x16x32_bf16 a[84:87], v[172:175], v[108:111], a[84:87]
    ds_read_b128 v[156:159], v5 offset:15360
    s_waitcnt lgkmcnt(4)
    v_mfma_f32_16x16x32_bf16 a[88:91], v[176:179], v[80:83], a[88:91]
    s_add_u32 m0, s21, 8192
    v_mfma_f32_16x16x32_bf16 a[88:91], v[180:183], v[84:87], a[88:91]
    ds_read_b128 v[160:163], v5 offset:16384
    v_mfma_f32_16x16x32_bf16 a[88:91], v[184:187], v[88:91], a[88:91]
    v_mfma_f32_16x16x32_bf16 a[88:91], v[188:191], v[92:95], a[88:91]
    ds_read_b128 v[164:167], v5 offset:17408
    v_mfma_f32_16x16x32_bf16 a[92:95], v[176:179], v[96:99], a[92:95]
    buffer_load_dwordx4 v8, s[8:11], s70 offen offset:0 lds
    v_mfma_f32_16x16x32_bf16 a[92:95], v[180:183], v[100:103], a[92:95]
    ds_read_b128 v[168:171], v5 offset:18432
    v_mfma_f32_16x16x32_bf16 a[92:95], v[184:187], v[104:107], a[92:95]
    v_mfma_f32_16x16x32_bf16 a[92:95], v[188:191], v[108:111], a[92:95]
    ds_read_b128 v[172:175], v5 offset:19456
    s_waitcnt lgkmcnt(4)
    v_mfma_f32_16x16x32_bf16 a[96:99], v[144:147], v[80:83], a[96:99]
    v_add_u32 v8, 4096, v8
    v_mfma_f32_16x16x32_bf16 a[96:99], v[148:151], v[84:87], a[96:99]
    ds_read_b128 v[176:179], v5 offset:20480
    v_mfma_f32_16x16x32_bf16 a[96:99], v[152:155], v[88:91], a[96:99]
    v_mfma_f32_16x16x32_bf16 a[96:99], v[156:159], v[92:95], a[96:99]
    ds_read_b128 v[180:183], v5 offset:21504
    v_mfma_f32_16x16x32_bf16 a[100:103], v[144:147], v[96:99], a[100:103]
    v_mfma_f32_16x16x32_bf16 a[100:103], v[148:151], v[100:103], a[100:103]
    ds_read_b128 v[184:187], v5 offset:22528
    v_mfma_f32_16x16x32_bf16 a[100:103], v[152:155], v[104:107], a[100:103]
    v_mfma_f32_16x16x32_bf16 a[100:103], v[156:159], v[108:111], a[100:103]
    ds_read_b128 v[188:191], v5 offset:23552
    s_waitcnt lgkmcnt(4)
    v_mfma_f32_16x16x32_bf16 a[104:107], v[160:163], v[80:83], a[104:107]
    v_mfma_f32_16x16x32_bf16 a[104:107], v[164:167], v[84:87], a[104:107]
    ds_read_b128 v[144:147], v5 offset:24576
    v_mfma_f32_16x16x32_bf16 a[104:107], v[168:171], v[88:91], a[104:107]
    v_mfma_f32_16x16x32_bf16 a[104:107], v[172:175], v[92:95], a[104:107]
    ds_read_b128 v[148:151], v5 offset:25600
    v_mfma_f32_16x16x32_bf16 a[108:111], v[160:163], v[96:99], a[108:111]
    v_mfma_f32_16x16x32_bf16 a[108:111], v[164:167], v[100:103], a[108:111]
    ds_read_b128 v[152:155], v5 offset:26624
    v_mfma_f32_16x16x32_bf16 a[108:111], v[168:171], v[104:107], a[108:111]
    v_mfma_f32_16x16x32_bf16 a[108:111], v[172:175], v[108:111], a[108:111]
    ds_read_b128 v[156:159], v5 offset:27648
    s_waitcnt lgkmcnt(4)
    v_mfma_f32_16x16x32_bf16 a[112:115], v[176:179], v[80:83], a[112:115]
    v_mfma_f32_16x16x32_bf16 a[112:115], v[180:183], v[84:87], a[112:115]
    ds_read_b128 v[160:163], v5 offset:28672
    v_mfma_f32_16x16x32_bf16 a[112:115], v[184:187], v[88:91], a[112:115]
    v_mfma_f32_16x16x32_bf16 a[112:115], v[188:191], v[92:95], a[112:115]
    ds_read_b128 v[164:167], v5 offset:29696
    v_mfma_f32_16x16x32_bf16 a[116:119], v[176:179], v[96:99], a[116:119]
    v_mfma_f32_16x16x32_bf16 a[116:119], v[180:183], v[100:103], a[116:119]
    ds_read_b128 v[168:171], v5 offset:30720
    v_mfma_f32_16x16x32_bf16 a[116:119], v[184:187], v[104:107], a[116:119]
    v_mfma_f32_16x16x32_bf16 a[116:119], v[188:191], v[108:111], a[116:119]
    ds_read_b128 v[172:175], v5 offset:31744
    s_waitcnt lgkmcnt(4)
    v_mfma_f32_16x16x32_bf16 a[120:123], v[144:147], v[80:83], a[120:123]
    v_mfma_f32_16x16x32_bf16 a[120:123], v[148:151], v[84:87], a[120:123]
    ds_read_b128 v[176:179], v5 offset:32768
    v_mfma_f32_16x16x32_bf16 a[120:123], v[152:155], v[88:91], a[120:123]
    v_mfma_f32_16x16x32_bf16 a[120:123], v[156:159], v[92:95], a[120:123]
    ds_read_b128 v[180:183], v5 offset:33792
    v_mfma_f32_16x16x32_bf16 a[124:127], v[144:147], v[96:99], a[124:127]
    v_mfma_f32_16x16x32_bf16 a[124:127], v[148:151], v[100:103], a[124:127]
    ds_read_b128 v[184:187], v5 offset:34816
    v_mfma_f32_16x16x32_bf16 a[124:127], v[152:155], v[104:107], a[124:127]
    v_mfma_f32_16x16x32_bf16 a[124:127], v[156:159], v[108:111], a[124:127]
    ds_read_b128 v[188:191], v5 offset:35840
    s_waitcnt lgkmcnt(4)
    v_mfma_f32_16x16x32_bf16 a[128:131], v[160:163], v[80:83], a[128:131]
    s_waitcnt vmcnt(15)
    s_barrier
    v_mfma_f32_16x16x32_bf16 a[128:131], v[164:167], v[84:87], a[128:131]
    ds_read_b128 v[144:147], v6 offset:0
    v_mfma_f32_16x16x32_bf16 a[128:131], v[168:171], v[88:91], a[128:131]
    v_mfma_f32_16x16x32_bf16 a[128:131], v[172:175], v[92:95], a[128:131]
    ds_read_b128 v[148:151], v6 offset:1024
    v_mfma_f32_16x16x32_bf16 a[132:135], v[160:163], v[96:99], a[132:135]
    v_mfma_f32_16x16x32_bf16 a[132:135], v[164:167], v[100:103], a[132:135]
    ds_read_b128 v[152:155], v6 offset:2048
    v_mfma_f32_16x16x32_bf16 a[132:135], v[168:171], v[104:107], a[132:135]
    v_mfma_f32_16x16x32_bf16 a[132:135], v[172:175], v[108:111], a[132:135]
    ds_read_b128 v[156:159], v6 offset:3072
    s_waitcnt lgkmcnt(4)
    v_mfma_f32_16x16x32_bf16 a[136:139], v[176:179], v[80:83], a[136:139]
    v_mfma_f32_16x16x32_bf16 a[136:139], v[180:183], v[84:87], a[136:139]
    ds_read_b128 v[160:163], v6 offset:4096
    v_mfma_f32_16x16x32_bf16 a[136:139], v[184:187], v[88:91], a[136:139]
    v_mfma_f32_16x16x32_bf16 a[136:139], v[188:191], v[92:95], a[136:139]
    ds_read_b128 v[164:167], v6 offset:5120
    v_mfma_f32_16x16x32_bf16 a[140:143], v[176:179], v[96:99], a[140:143]
    v_mfma_f32_16x16x32_bf16 a[140:143], v[180:183], v[100:103], a[140:143]
    ds_read_b128 v[168:171], v6 offset:6144
    v_mfma_f32_16x16x32_bf16 a[140:143], v[184:187], v[104:107], a[140:143]
    v_mfma_f32_16x16x32_bf16 a[140:143], v[188:191], v[108:111], a[140:143]
    ds_read_b128 v[172:175], v6 offset:7168
    s_waitcnt vmcnt(26)
    s_waitcnt lgkmcnt(4)
    v_mfma_f32_16x16x32_bf16 a[72:75], v[144:147], v[112:115], a[72:75]
    v_mfma_f32_16x16x32_bf16 a[72:75], v[148:151], v[116:119], a[72:75]
    ds_read_b128 v[176:179], v6 offset:8192
    v_mfma_f32_16x16x32_bf16 a[72:75], v[152:155], v[120:123], a[72:75]
    v_mfma_f32_16x16x32_bf16 a[72:75], v[156:159], v[124:127], a[72:75]
    ds_read_b128 v[180:183], v6 offset:9216
    v_mfma_f32_16x16x32_bf16 a[76:79], v[144:147], v[128:131], a[76:79]
    v_mfma_f32_16x16x32_bf16 a[76:79], v[148:151], v[132:135], a[76:79]
    ds_read_b128 v[184:187], v6 offset:10240
    v_mfma_f32_16x16x32_bf16 a[76:79], v[152:155], v[136:139], a[76:79]
    v_mfma_f32_16x16x32_bf16 a[76:79], v[156:159], v[140:143], a[76:79]
    ds_read_b128 v[188:191], v6 offset:11264
    s_waitcnt lgkmcnt(4)
    v_mfma_f32_16x16x32_bf16 a[80:83], v[160:163], v[112:115], a[80:83]
    v_mfma_f32_16x16x32_bf16 a[80:83], v[164:167], v[116:119], a[80:83]
    ds_read_b128 v[144:147], v6 offset:12288
    v_mfma_f32_16x16x32_bf16 a[80:83], v[168:171], v[120:123], a[80:83]
    v_mfma_f32_16x16x32_bf16 a[80:83], v[172:175], v[124:127], a[80:83]
    ds_read_b128 v[148:151], v6 offset:13312
    v_mfma_f32_16x16x32_bf16 a[84:87], v[160:163], v[128:131], a[84:87]
    v_mfma_f32_16x16x32_bf16 a[84:87], v[164:167], v[132:135], a[84:87]
    ds_read_b128 v[152:155], v6 offset:14336
    v_mfma_f32_16x16x32_bf16 a[84:87], v[168:171], v[136:139], a[84:87]
    v_mfma_f32_16x16x32_bf16 a[84:87], v[172:175], v[140:143], a[84:87]
    ds_read_b128 v[156:159], v6 offset:15360
    s_waitcnt lgkmcnt(4)
    v_mfma_f32_16x16x32_bf16 a[88:91], v[176:179], v[112:115], a[88:91]
    v_mfma_f32_16x16x32_bf16 a[88:91], v[180:183], v[116:119], a[88:91]
    ds_read_b128 v[160:163], v6 offset:16384
    v_mfma_f32_16x16x32_bf16 a[88:91], v[184:187], v[120:123], a[88:91]
    v_mfma_f32_16x16x32_bf16 a[88:91], v[188:191], v[124:127], a[88:91]
    ds_read_b128 v[164:167], v6 offset:17408
    v_mfma_f32_16x16x32_bf16 a[92:95], v[176:179], v[128:131], a[92:95]
    v_mfma_f32_16x16x32_bf16 a[92:95], v[180:183], v[132:135], a[92:95]
    ds_read_b128 v[168:171], v6 offset:18432
    v_mfma_f32_16x16x32_bf16 a[92:95], v[184:187], v[136:139], a[92:95]
    v_mfma_f32_16x16x32_bf16 a[92:95], v[188:191], v[140:143], a[92:95]
    ds_read_b128 v[172:175], v6 offset:19456
    s_waitcnt lgkmcnt(4)
    v_mfma_f32_16x16x32_bf16 a[96:99], v[144:147], v[112:115], a[96:99]
    v_mfma_f32_16x16x32_bf16 a[96:99], v[148:151], v[116:119], a[96:99]
    ds_read_b128 v[176:179], v6 offset:20480
    v_mfma_f32_16x16x32_bf16 a[96:99], v[152:155], v[120:123], a[96:99]
    v_mfma_f32_16x16x32_bf16 a[96:99], v[156:159], v[124:127], a[96:99]
    ds_read_b128 v[180:183], v6 offset:21504
    v_mfma_f32_16x16x32_bf16 a[100:103], v[144:147], v[128:131], a[100:103]
    v_mfma_f32_16x16x32_bf16 a[100:103], v[148:151], v[132:135], a[100:103]
    ds_read_b128 v[184:187], v6 offset:22528
    v_mfma_f32_16x16x32_bf16 a[100:103], v[152:155], v[136:139], a[100:103]
    v_mfma_f32_16x16x32_bf16 a[100:103], v[156:159], v[140:143], a[100:103]
    ds_read_b128 v[188:191], v6 offset:23552
    s_waitcnt lgkmcnt(4)
    v_mfma_f32_16x16x32_bf16 a[104:107], v[160:163], v[112:115], a[104:107]
    v_mfma_f32_16x16x32_bf16 a[104:107], v[164:167], v[116:119], a[104:107]
    ds_read_b128 v[144:147], v6 offset:24576
    v_mfma_f32_16x16x32_bf16 a[104:107], v[168:171], v[120:123], a[104:107]
    v_mfma_f32_16x16x32_bf16 a[104:107], v[172:175], v[124:127], a[104:107]
    ds_read_b128 v[148:151], v6 offset:25600
    v_mfma_f32_16x16x32_bf16 a[108:111], v[160:163], v[128:131], a[108:111]
    v_mfma_f32_16x16x32_bf16 a[108:111], v[164:167], v[132:135], a[108:111]
    ds_read_b128 v[152:155], v6 offset:26624
    v_mfma_f32_16x16x32_bf16 a[108:111], v[168:171], v[136:139], a[108:111]
    v_mfma_f32_16x16x32_bf16 a[108:111], v[172:175], v[140:143], a[108:111]
    ds_read_b128 v[156:159], v6 offset:27648
    s_waitcnt lgkmcnt(4)
    v_mfma_f32_16x16x32_bf16 a[112:115], v[176:179], v[112:115], a[112:115]
    v_mfma_f32_16x16x32_bf16 a[112:115], v[180:183], v[116:119], a[112:115]
    ds_read_b128 v[160:163], v6 offset:28672
    v_mfma_f32_16x16x32_bf16 a[112:115], v[184:187], v[120:123], a[112:115]
    v_mfma_f32_16x16x32_bf16 a[112:115], v[188:191], v[124:127], a[112:115]
    ds_read_b128 v[164:167], v6 offset:29696
    v_mfma_f32_16x16x32_bf16 a[116:119], v[176:179], v[128:131], a[116:119]
    v_mfma_f32_16x16x32_bf16 a[116:119], v[180:183], v[132:135], a[116:119]
    ds_read_b128 v[168:171], v6 offset:30720
    v_mfma_f32_16x16x32_bf16 a[116:119], v[184:187], v[136:139], a[116:119]
    v_mfma_f32_16x16x32_bf16 a[116:119], v[188:191], v[140:143], a[116:119]
    ds_read_b128 v[172:175], v6 offset:31744
    s_waitcnt lgkmcnt(4)
    v_mfma_f32_16x16x32_bf16 a[120:123], v[144:147], v[112:115], a[120:123]
    v_mfma_f32_16x16x32_bf16 a[120:123], v[148:151], v[116:119], a[120:123]
    ds_read_b128 v[176:179], v6 offset:32768
    v_mfma_f32_16x16x32_bf16 a[120:123], v[152:155], v[120:123], a[120:123]
    v_mfma_f32_16x16x32_bf16 a[120:123], v[156:159], v[124:127], a[120:123]
    ds_read_b128 v[180:183], v6 offset:33792
    v_mfma_f32_16x16x32_bf16 a[124:127], v[144:147], v[128:131], a[124:127]
    v_mfma_f32_16x16x32_bf16 a[124:127], v[148:151], v[132:135], a[124:127]
    ds_read_b128 v[184:187], v6 offset:34816
    v_mfma_f32_16x16x32_bf16 a[124:127], v[152:155], v[136:139], a[124:127]
    v_mfma_f32_16x16x32_bf16 a[124:127], v[156:159], v[140:143], a[124:127]
    ds_read_b128 v[188:191], v6 offset:35840
    s_waitcnt lgkmcnt(4)
    v_mfma_f32_16x16x32_bf16 a[128:131], v[160:163], v[112:115], a[128:131]
    s_waitcnt vmcnt(0)
    s_barrier
    v_mfma_f32_16x16x32_bf16 a[128:131], v[164:167], v[116:119], a[128:131]
    ds_read_b128 v[144:147], v3 offset:0
    v_mfma_f32_16x16x32_bf16 a[128:131], v[168:171], v[120:123], a[128:131]
    v_mfma_f32_16x16x32_bf16 a[128:131], v[172:175], v[124:127], a[128:131]
    ds_read_b128 v[148:151], v3 offset:1024
    v_mfma_f32_16x16x32_bf16 a[132:135], v[160:163], v[128:131], a[132:135]
    v_mfma_f32_16x16x32_bf16 a[132:135], v[164:167], v[132:135], a[132:135]
    ds_read_b128 v[152:155], v3 offset:2048
    v_mfma_f32_16x16x32_bf16 a[132:135], v[168:171], v[136:139], a[132:135]
    v_mfma_f32_16x16x32_bf16 a[132:135], v[172:175], v[140:143], a[132:135]
    ds_read_b128 v[156:159], v3 offset:3072
    s_waitcnt lgkmcnt(4)
    v_mfma_f32_16x16x32_bf16 a[136:139], v[176:179], v[112:115], a[136:139]
    v_mfma_f32_16x16x32_bf16 a[136:139], v[180:183], v[116:119], a[136:139]
    ds_read_b128 v[160:163], v3 offset:4096
    v_mfma_f32_16x16x32_bf16 a[136:139], v[184:187], v[120:123], a[136:139]
    v_mfma_f32_16x16x32_bf16 a[136:139], v[188:191], v[124:127], a[136:139]
    ds_read_b128 v[164:167], v3 offset:5120
    v_mfma_f32_16x16x32_bf16 a[140:143], v[176:179], v[128:131], a[140:143]
    v_mfma_f32_16x16x32_bf16 a[140:143], v[180:183], v[132:135], a[140:143]
    ds_read_b128 v[168:171], v3 offset:6144
    v_mfma_f32_16x16x32_bf16 a[140:143], v[184:187], v[136:139], a[140:143]
    v_mfma_f32_16x16x32_bf16 a[140:143], v[188:191], v[140:143], a[140:143]
    ds_read_b128 v[172:175], v3 offset:7168
    s_waitcnt vmcnt(9)
    s_waitcnt lgkmcnt(4)
    v_mfma_f32_16x16x32_bf16 a[72:75], v[144:147], v[16:19], a[72:75]
    v_mfma_f32_16x16x32_bf16 a[72:75], v[148:151], v[20:23], a[72:75]
    ds_read_b128 v[176:179], v3 offset:8192
    v_mfma_f32_16x16x32_bf16 a[72:75], v[152:155], v[24:27], a[72:75]
    v_mov_b32 v255, 0
    v_mfma_f32_16x16x32_bf16 a[72:75], v[156:159], v[28:31], a[72:75]
    ds_read_b128 v[180:183], v3 offset:9216
    v_mfma_f32_16x16x32_bf16 a[76:79], v[144:147], v[32:35], a[76:79]
    v_mfma_f32_16x16x32_bf16 a[76:79], v[148:151], v[36:39], a[76:79]
    ds_read_b128 v[184:187], v3 offset:10240
    v_mfma_f32_16x16x32_bf16 a[76:79], v[152:155], v[40:43], a[76:79]
    buffer_load_dword v254, v255, s[8:11], s48 offen sc1
    v_mfma_f32_16x16x32_bf16 a[76:79], v[156:159], v[44:47], a[76:79]
    ds_read_b128 v[188:191], v3 offset:11264
    s_waitcnt lgkmcnt(4)
    v_mfma_f32_16x16x32_bf16 a[80:83], v[160:163], v[16:19], a[80:83]
    v_mfma_f32_16x16x32_bf16 a[80:83], v[164:167], v[20:23], a[80:83]
    ds_read_b128 v[144:147], v3 offset:12288
    v_mfma_f32_16x16x32_bf16 a[80:83], v[168:171], v[24:27], a[80:83]
    v_mfma_f32_16x16x32_bf16 a[80:83], v[172:175], v[28:31], a[80:83]
    ds_read_b128 v[148:151], v3 offset:13312
    v_mfma_f32_16x16x32_bf16 a[84:87], v[160:163], v[32:35], a[84:87]
    v_mfma_f32_16x16x32_bf16 a[84:87], v[164:167], v[36:39], a[84:87]
    ds_read_b128 v[152:155], v3 offset:14336
    v_mfma_f32_16x16x32_bf16 a[84:87], v[168:171], v[40:43], a[84:87]
    v_mfma_f32_16x16x32_bf16 a[84:87], v[172:175], v[44:47], a[84:87]
    ds_read_b128 v[156:159], v3 offset:15360
    s_waitcnt lgkmcnt(4)
    v_mfma_f32_16x16x32_bf16 a[88:91], v[176:179], v[16:19], a[88:91]
    v_mfma_f32_16x16x32_bf16 a[88:91], v[180:183], v[20:23], a[88:91]
    ds_read_b128 v[160:163], v3 offset:16384
    v_mfma_f32_16x16x32_bf16 a[88:91], v[184:187], v[24:27], a[88:91]
    v_mfma_f32_16x16x32_bf16 a[88:91], v[188:191], v[28:31], a[88:91]
    ds_read_b128 v[164:167], v3 offset:17408
    v_mfma_f32_16x16x32_bf16 a[92:95], v[176:179], v[32:35], a[92:95]
    v_mfma_f32_16x16x32_bf16 a[92:95], v[180:183], v[36:39], a[92:95]
    ds_read_b128 v[168:171], v3 offset:18432
    v_mfma_f32_16x16x32_bf16 a[92:95], v[184:187], v[40:43], a[92:95]
    v_mfma_f32_16x16x32_bf16 a[92:95], v[188:191], v[44:47], a[92:95]
    ds_read_b128 v[172:175], v3 offset:19456
    s_waitcnt lgkmcnt(4)
    v_mfma_f32_16x16x32_bf16 a[96:99], v[144:147], v[16:19], a[96:99]
    v_mfma_f32_16x16x32_bf16 a[96:99], v[148:151], v[20:23], a[96:99]
    ds_read_b128 v[176:179], v3 offset:20480
    v_mfma_f32_16x16x32_bf16 a[96:99], v[152:155], v[24:27], a[96:99]
    v_mfma_f32_16x16x32_bf16 a[96:99], v[156:159], v[28:31], a[96:99]
    ds_read_b128 v[180:183], v3 offset:21504
    v_mfma_f32_16x16x32_bf16 a[100:103], v[144:147], v[32:35], a[100:103]
    v_mfma_f32_16x16x32_bf16 a[100:103], v[148:151], v[36:39], a[100:103]
    ds_read_b128 v[184:187], v3 offset:22528
    v_mfma_f32_16x16x32_bf16 a[100:103], v[152:155], v[40:43], a[100:103]
    v_mfma_f32_16x16x32_bf16 a[100:103], v[156:159], v[44:47], a[100:103]
    ds_read_b128 v[188:191], v3 offset:23552
    s_waitcnt lgkmcnt(4)
    v_mfma_f32_16x16x32_bf16 a[104:107], v[160:163], v[16:19], a[104:107]
    v_mfma_f32_16x16x32_bf16 a[104:107], v[164:167], v[20:23], a[104:107]
    ds_read_b128 v[144:147], v3 offset:24576
    v_mfma_f32_16x16x32_bf16 a[104:107], v[168:171], v[24:27], a[104:107]
    v_mfma_f32_16x16x32_bf16 a[104:107], v[172:175], v[28:31], a[104:107]
    ds_read_b128 v[148:151], v3 offset:25600
    v_mfma_f32_16x16x32_bf16 a[108:111], v[160:163], v[32:35], a[108:111]
    v_mfma_f32_16x16x32_bf16 a[108:111], v[164:167], v[36:39], a[108:111]
    ds_read_b128 v[152:155], v3 offset:26624
    v_mfma_f32_16x16x32_bf16 a[108:111], v[168:171], v[40:43], a[108:111]
    v_mfma_f32_16x16x32_bf16 a[108:111], v[172:175], v[44:47], a[108:111]
    ds_read_b128 v[156:159], v3 offset:27648
    s_waitcnt lgkmcnt(4)
    v_mfma_f32_16x16x32_bf16 a[112:115], v[176:179], v[16:19], a[112:115]
    v_mfma_f32_16x16x32_bf16 a[112:115], v[180:183], v[20:23], a[112:115]
    ds_read_b128 v[160:163], v3 offset:28672
    v_mfma_f32_16x16x32_bf16 a[112:115], v[184:187], v[24:27], a[112:115]
    v_mfma_f32_16x16x32_bf16 a[112:115], v[188:191], v[28:31], a[112:115]
    ds_read_b128 v[164:167], v3 offset:29696
    v_mfma_f32_16x16x32_bf16 a[116:119], v[176:179], v[32:35], a[116:119]
    v_mfma_f32_16x16x32_bf16 a[116:119], v[180:183], v[36:39], a[116:119]
    ds_read_b128 v[168:171], v3 offset:30720
    v_mfma_f32_16x16x32_bf16 a[116:119], v[184:187], v[40:43], a[116:119]
    v_mfma_f32_16x16x32_bf16 a[116:119], v[188:191], v[44:47], a[116:119]
    ds_read_b128 v[172:175], v3 offset:31744
    s_waitcnt lgkmcnt(4)
    v_mfma_f32_16x16x32_bf16 a[120:123], v[144:147], v[16:19], a[120:123]
    v_mfma_f32_16x16x32_bf16 a[120:123], v[148:151], v[20:23], a[120:123]
    ds_read_b128 v[176:179], v3 offset:32768
    v_mfma_f32_16x16x32_bf16 a[120:123], v[152:155], v[24:27], a[120:123]
    v_mfma_f32_16x16x32_bf16 a[120:123], v[156:159], v[28:31], a[120:123]
    ds_read_b128 v[180:183], v3 offset:33792
    v_mfma_f32_16x16x32_bf16 a[124:127], v[144:147], v[32:35], a[124:127]
    v_mfma_f32_16x16x32_bf16 a[124:127], v[148:151], v[36:39], a[124:127]
    ds_read_b128 v[184:187], v3 offset:34816
    v_mfma_f32_16x16x32_bf16 a[124:127], v[152:155], v[40:43], a[124:127]
    v_mfma_f32_16x16x32_bf16 a[124:127], v[156:159], v[44:47], a[124:127]
    ds_read_b128 v[188:191], v3 offset:35840
    s_waitcnt lgkmcnt(4)
    v_mfma_f32_16x16x32_bf16 a[128:131], v[160:163], v[16:19], a[128:131]
    v_mfma_f32_16x16x32_bf16 a[128:131], v[164:167], v[20:23], a[128:131]
    v_mfma_f32_16x16x32_bf16 a[128:131], v[168:171], v[24:27], a[128:131]
    v_mfma_f32_16x16x32_bf16 a[128:131], v[172:175], v[28:31], a[128:131]
    v_mfma_f32_16x16x32_bf16 a[132:135], v[160:163], v[32:35], a[132:135]
    v_mfma_f32_16x16x32_bf16 a[132:135], v[164:167], v[36:39], a[132:135]
    v_mfma_f32_16x16x32_bf16 a[132:135], v[168:171], v[40:43], a[132:135]
    v_mfma_f32_16x16x32_bf16 a[132:135], v[172:175], v[44:47], a[132:135]
    s_waitcnt lgkmcnt(0)
    v_mfma_f32_16x16x32_bf16 a[136:139], v[176:179], v[16:19], a[136:139]
    v_mfma_f32_16x16x32_bf16 a[136:139], v[180:183], v[20:23], a[136:139]
    v_mfma_f32_16x16x32_bf16 a[136:139], v[184:187], v[24:27], a[136:139]
    v_mfma_f32_16x16x32_bf16 a[136:139], v[188:191], v[28:31], a[136:139]
    v_mfma_f32_16x16x32_bf16 a[140:143], v[176:179], v[32:35], a[140:143]
    v_mfma_f32_16x16x32_bf16 a[140:143], v[180:183], v[36:39], a[140:143]
    v_mfma_f32_16x16x32_bf16 a[140:143], v[184:187], v[40:43], a[140:143]
    v_mfma_f32_16x16x32_bf16 a[140:143], v[188:191], v[44:47], a[140:143]
    s_add_u32 s22, s4, 1
    s_and_b32 s22, s22, 3
    s_mul_i32 s22, s22, 36864
    s_add_u32 s25, s22, s38
    s_add_u32 s22, s4, 2
    s_and_b32 s22, s22, 3
    s_mul_i32 s22, s22, 36864
    s_add_u32 s26, s22, s38
    s_add_u32 s22, s4, 3
    s_and_b32 s22, s22, 3
    s_mul_i32 s22, s22, 36864
    s_add_u32 s27, s22, s38
    s_add_u32 s22, s28, 0
    s_cmp_ge_u32 s22, 9
    s_cselect_b32 s23, 9, 0
    s_sub_u32 s22, s22, s23
    s_lshl_b32 s22, s22, 1
    s_add_u32 s22, s22, s29
    s_lshl_b32 s22, s22, 9
    v_add_u32 v132, s22, v226
    s_add_u32 s22, s28, 1
    s_cmp_ge_u32 s22, 9
    s_cselect_b32 s23, 9, 0
    s_sub_u32 s22, s22, s23
    s_lshl_b32 s22, s22, 1
    s_add_u32 s22, s22, s29
    s_lshl_b32 s22, s22, 9
    v_add_u32 v133, s22, v226
    s_add_u32 s22, s28, 2
    s_cmp_ge_u32 s22, 9
    s_cselect_b32 s23, 9, 0
    s_sub_u32 s22, s22, s23
    s_lshl_b32 s22, s22, 1
    s_add_u32 s22, s22, s29
    s_lshl_b32 s22, s22, 9
    v_add_u32 v134, s22, v226
    s_add_u32 s22, s28, 3
    s_cmp_ge_u32 s22, 9
    s_cselect_b32 s23, 9, 0
    s_sub_u32 s22, s22, s23
    s_lshl_b32 s22, s22, 1
    s_add_u32 s22, s22, s29
    s_lshl_b32 s22, s22, 9
    v_add_u32 v135, s22, v226
    s_add_u32 s22, s28, 4
    s_cmp_ge_u32 s22, 9
    s_cselect_b32 s23, 9, 0
    s_sub_u32 s22, s22, s23
    s_lshl_b32 s22, s22, 1
    s_add_u32 s22, s22, s29
    s_lshl_b32 s22, s22, 9
    v_add_u32 v136, s22, v226
    s_nop 7
    v_accvgpr_read_b32 v240, a104
    v_accvgpr_read_b32 v241, a105
    v_accvgpr_read_b32 v242, a106
    v_accvgpr_read_b32 v243, a107
    v_cvt_pk_bf16_f32 v244, v240, v241
    v_cvt_pk_bf16_f32 v245, v242, v243
    buffer_store_dwordx2 v[244:245], v212, s[8:11], s35 offen sc1
    v_accvgpr_read_b32 v246, a112
    v_accvgpr_read_b32 v247, a113
    v_accvgpr_read_b32 v248, a114
    v_accvgpr_read_b32 v249, a115
    v_cvt_pk_bf16_f32 v250, v246, v247
    v_cvt_pk_bf16_f32 v251, v248, v249
    buffer_store_dwordx2 v[250:251], v213, s[8:11], s35 offen sc1
    v_accvgpr_read_b32 v240, a120
    v_accvgpr_read_b32 v241, a121
    v_accvgpr_read_b32 v242, a122
    v_accvgpr_read_b32 v243, a123
    v_cvt_pk_bf16_f32 v244, v240, v241
    v_cvt_pk_bf16_f32 v245, v242, v243
    buffer_store_dwordx2 v[244:245], v214, s[8:11], s35 offen sc1
    v_accvgpr_read_b32 v246, a128
    v_accvgpr_read_b32 v247, a129
    v_accvgpr_read_b32 v248, a130
    v_accvgpr_read_b32 v249, a131
    v_cvt_pk_bf16_f32 v250, v246, v247
    v_cvt_pk_bf16_f32 v251, v248, v249
    buffer_store_dwordx2 v[250:251], v215, s[8:11], s35 offen sc1
    v_accvgpr_read_b32 v240, a136
    v_accvgpr_read_b32 v241, a137
    v_accvgpr_read_b32 v242, a138
    v_accvgpr_read_b32 v243, a139
    v_cvt_pk_bf16_f32 v244, v240, v241
    v_cvt_pk_bf16_f32 v245, v242, v243
    buffer_store_dwordx2 v[244:245], v216, s[8:11], s35 offen sc1
    v_accvgpr_read_b32 v246, a76
    v_accvgpr_read_b32 v247, a77
    v_accvgpr_read_b32 v248, a78
    v_accvgpr_read_b32 v249, a79
    v_cvt_pk_bf16_f32 v250, v246, v247
    v_cvt_pk_bf16_f32 v251, v248, v249
    buffer_store_dwordx2 v[250:251], v217, s[8:11], s35 offen sc1
    v_accvgpr_read_b32 v240, a84
    v_accvgpr_read_b32 v241, a85
    v_accvgpr_read_b32 v242, a86
    v_accvgpr_read_b32 v243, a87
    v_cvt_pk_bf16_f32 v244, v240, v241
    v_cvt_pk_bf16_f32 v245, v242, v243
    buffer_store_dwordx2 v[244:245], v218, s[8:11], s35 offen sc1
    v_accvgpr_read_b32 v246, a92
    v_accvgpr_read_b32 v247, a93
    v_accvgpr_read_b32 v248, a94
    v_accvgpr_read_b32 v249, a95
    v_cvt_pk_bf16_f32 v250, v246, v247
    v_cvt_pk_bf16_f32 v251, v248, v249
    buffer_store_dwordx2 v[250:251], v219, s[8:11], s35 offen sc1
    v_accvgpr_read_b32 v240, a100
    v_accvgpr_read_b32 v241, a101
    v_accvgpr_read_b32 v242, a102
    v_accvgpr_read_b32 v243, a103
    v_cvt_pk_bf16_f32 v244, v240, v241
    v_cvt_pk_bf16_f32 v245, v242, v243
    buffer_store_dwordx2 v[244:245], v220, s[8:11], s35 offen sc1
    v_accvgpr_read_b32 v246, a108
    v_accvgpr_read_b32 v247, a109
    v_accvgpr_read_b32 v248, a110
    v_accvgpr_read_b32 v249, a111
    v_cvt_pk_bf16_f32 v250, v246, v247
    v_cvt_pk_bf16_f32 v251, v248, v249
    buffer_store_dwordx2 v[250:251], v221, s[8:11], s35 offen sc1
    v_accvgpr_read_b32 v240, a116
    v_accvgpr_read_b32 v241, a117
    v_accvgpr_read_b32 v242, a118
    v_accvgpr_read_b32 v243, a119
    v_cvt_pk_bf16_f32 v244, v240, v241
    v_cvt_pk_bf16_f32 v245, v242, v243
    buffer_store_dwordx2 v[244:245], v222, s[8:11], s35 offen sc1
    v_accvgpr_read_b32 v246, a124
    v_accvgpr_read_b32 v247, a125
    v_accvgpr_read_b32 v248, a126
    v_accvgpr_read_b32 v249, a127
    v_cvt_pk_bf16_f32 v250, v246, v247
    v_cvt_pk_bf16_f32 v251, v248, v249
    buffer_store_dwordx2 v[250:251], v223, s[8:11], s35 offen sc1
    v_accvgpr_read_b32 v240, a132
    v_accvgpr_read_b32 v241, a133
    v_accvgpr_read_b32 v242, a134
    v_accvgpr_read_b32 v243, a135
    v_cvt_pk_bf16_f32 v244, v240, v241
    v_cvt_pk_bf16_f32 v245, v242, v243
    buffer_store_dwordx2 v[244:245], v224, s[8:11], s35 offen sc1
    v_accvgpr_read_b32 v246, a140
    v_accvgpr_read_b32 v247, a141
    v_accvgpr_read_b32 v248, a142
    v_accvgpr_read_b32 v249, a143
    v_cvt_pk_bf16_f32 v250, v246, v247
    v_cvt_pk_bf16_f32 v251, v248, v249
    buffer_store_dwordx2 v[250:251], v225, s[8:11], s35 offen sc1
    s_waitcnt vmcnt(14)
    v_readfirstlane_b32 s49, v254
    s_nop 3
    s_cmp_ge_u32 s49, 4
    s_cbranch_scc1 kmain_kernel_sok
    v_mov_b32 v253, 0
    s_mov_b32 s34, 0
kmain_kernel_pls:
    buffer_load_dword v252, v253, s[8:11], s48 offen sc1
    s_waitcnt vmcnt(0)
    v_readfirstlane_b32 s49, v252
    s_nop 3
    s_cmp_ge_u32 s49, 4
    s_cbranch_scc1 kmain_kernel_pls_ok
    s_add_u32 s34, s34, 1
    s_cmp_ge_u32 s34, 0x40000
    s_cbranch_scc1 kmain_kernel_pls_ok
    s_sleep 1
    s_branch kmain_kernel_pls
kmain_kernel_pls_ok:
kmain_kernel_sok:
    buffer_load_dwordx2 v[56:57], v132, s[8:11], s25 offen sc1
    buffer_load_dwordx2 v[58:59], v132, s[8:11], s26 offen sc1
    buffer_load_dwordx2 v[60:61], v132, s[8:11], s27 offen sc1
    buffer_load_dwordx2 v[68:69], v133, s[8:11], s25 offen sc1
    buffer_load_dwordx2 v[70:71], v133, s[8:11], s26 offen sc1
    buffer_load_dwordx2 v[72:73], v133, s[8:11], s27 offen sc1
    buffer_load_dwordx2 v[80:81], v134, s[8:11], s25 offen sc1
    buffer_load_dwordx2 v[82:83], v134, s[8:11], s26 offen sc1
    buffer_load_dwordx2 v[84:85], v134, s[8:11], s27 offen sc1
    buffer_load_dwordx2 v[92:93], v135, s[8:11], s25 offen sc1
    buffer_load_dwordx2 v[94:95], v135, s[8:11], s26 offen sc1
    buffer_load_dwordx2 v[96:97], v135, s[8:11], s27 offen sc1
    buffer_load_dwordx2 v[104:105], v136, s[8:11], s25 offen sc1
    buffer_load_dwordx2 v[106:107], v136, s[8:11], s26 offen sc1
    buffer_load_dwordx2 v[108:109], v136, s[8:11], s27 offen sc1
    v_accvgpr_read_b32 v16, a0
    v_accvgpr_read_b32 v17, a1
    v_accvgpr_read_b32 v18, a2
    v_accvgpr_read_b32 v19, a3
    v_accvgpr_read_b32 v36, a72
    v_accvgpr_read_b32 v37, a73
    v_accvgpr_read_b32 v38, a74
    v_accvgpr_read_b32 v39, a75
    v_lshlrev_b32 v244, 16, v192
    v_and_b32 v245, 0xffff0000, v192
    v_lshlrev_b32 v246, 16, v193
    v_and_b32 v247, 0xffff0000, v193
    v_pk_add_f32 v[36:37], v[36:37], v[244:245]
    v_pk_add_f32 v[38:39], v[38:39], v[246:247]
    v_accvgpr_read_b32 v20, a8
    v_accvgpr_read_b32 v21, a9
    v_accvgpr_read_b32 v22, a10
    v_accvgpr_read_b32 v23, a11
    v_accvgpr_read_b32 v40, a80
    v_accvgpr_read_b32 v41, a81
    v_accvgpr_read_b32 v42, a82
    v_accvgpr_read_b32 v43, a83
    v_lshlrev_b32 v244, 16, v194
    v_and_b32 v245, 0xffff0000, v194
    v_lshlrev_b32 v246, 16, v195
    v_and_b32 v247, 0xffff0000, v195
    v_pk_add_f32 v[40:41], v[40:41], v[244:245]
    v_pk_add_f32 v[42:43], v[42:43], v[246:247]
    v_accvgpr_read_b32 v24, a16
    v_accvgpr_read_b32 v25, a17
    v_accvgpr_read_b32 v26, a18
    v_accvgpr_read_b32 v27, a19
    v_accvgpr_read_b32 v44, a88
    v_accvgpr_read_b32 v45, a89
    v_accvgpr_read_b32 v46, a90
    v_accvgpr_read_b32 v47, a91
    v_lshlrev_b32 v244, 16, v196
    v_and_b32 v245, 0xffff0000, v196
    v_lshlrev_b32 v246, 16, v197
    v_and_b32 v247, 0xffff0000, v197
    v_pk_add_f32 v[44:45], v[44:45], v[244:245]
    v_pk_add_f32 v[46:47], v[46:47], v[246:247]
    v_accvgpr_read_b32 v28, a24
    v_accvgpr_read_b32 v29, a25
    v_accvgpr_read_b32 v30, a26
    v_accvgpr_read_b32 v31, a27
    v_accvgpr_read_b32 v48, a96
    v_accvgpr_read_b32 v49, a97
    v_accvgpr_read_b32 v50, a98
    v_accvgpr_read_b32 v51, a99
    v_lshlrev_b32 v244, 16, v198
    v_and_b32 v245, 0xffff0000, v198
    v_lshlrev_b32 v246, 16, v199
    v_and_b32 v247, 0xffff0000, v199
    v_pk_add_f32 v[48:49], v[48:49], v[244:245]
    v_pk_add_f32 v[50:51], v[50:51], v[246:247]
    v_accvgpr_read_b32 v32, a32
    v_accvgpr_read_b32 v33, a33
    v_accvgpr_read_b32 v34, a34
    v_accvgpr_read_b32 v35, a35
    v_accvgpr_read_b32 v52, a104
    v_accvgpr_read_b32 v53, a105
    v_accvgpr_read_b32 v54, a106
    v_accvgpr_read_b32 v55, a107
    v_lshlrev_b32 v244, 16, v200
    v_and_b32 v245, 0xffff0000, v200
    v_lshlrev_b32 v246, 16, v201
    v_and_b32 v247, 0xffff0000, v201
    v_pk_add_f32 v[52:53], v[52:53], v[244:245]
    v_pk_add_f32 v[54:55], v[54:55], v[246:247]
    s_waitcnt vmcnt(15)
    s_barrier
    s_cmp_lg_u32 s3, 0
    s_cbranch_scc1 kmain_kernel_sg_13
    v_mov_b32 v252, 1
    v_mov_b32 v253, 4
    v_cmp_eq_u32 vcc, 0, v1
    s_nop 3
    s_and_saveexec_b64 s[50:51], vcc
    buffer_atomic_add v252, v253, s[8:11], s48 offen
    s_mov_b64 exec, s[50:51]
kmain_kernel_sg_13:
    v_mov_b32 v253, 4
    s_mov_b32 s34, 0
kmain_kernel_plh:
    buffer_load_dword v252, v253, s[8:11], s48 offen sc1
    s_waitcnt vmcnt(0)
    v_readfirstlane_b32 s49, v252
    s_nop 3
    s_cmp_ge_u32 s49, 4
    s_cbranch_scc1 kmain_kernel_plh_ok
    s_add_u32 s34, s34, 1
    s_cmp_ge_u32 s34, 0x40000
    s_cbranch_scc1 kmain_kernel_plh_ok
    s_sleep 1
    s_branch kmain_kernel_plh
kmain_kernel_plh_ok:
    s_add_u32 s29, s25, 147456
    buffer_load_dwordx2 v[62:63], v132, s[8:11], s29 offen sc1
    s_add_u32 s30, s26, 147456
    buffer_load_dwordx2 v[64:65], v132, s[8:11], s30 offen sc1
    s_add_u32 s31, s27, 147456
    buffer_load_dwordx2 v[66:67], v132, s[8:11], s31 offen sc1
    buffer_load_dwordx2 v[74:75], v133, s[8:11], s29 offen sc1
    buffer_load_dwordx2 v[76:77], v133, s[8:11], s30 offen sc1
    buffer_load_dwordx2 v[78:79], v133, s[8:11], s31 offen sc1
    buffer_load_dwordx2 v[86:87], v134, s[8:11], s29 offen sc1
    buffer_load_dwordx2 v[88:89], v134, s[8:11], s30 offen sc1
    buffer_load_dwordx2 v[90:91], v134, s[8:11], s31 offen sc1
    buffer_load_dwordx2 v[98:99], v135, s[8:11], s29 offen sc1
    buffer_load_dwordx2 v[100:101], v135, s[8:11], s30 offen sc1
    buffer_load_dwordx2 v[102:103], v135, s[8:11], s31 offen sc1
    buffer_load_dwordx2 v[110:111], v136, s[8:11], s29 offen sc1
    buffer_load_dwordx2 v[112:113], v136, s[8:11], s30 offen sc1
    buffer_load_dwordx2 v[114:115], v136, s[8:11], s31 offen sc1
    v_lshlrev_b32 v120, 16, v56
    v_and_b32 v121, 0xffff0000, v56
    v_lshlrev_b32 v122, 16, v57
    v_and_b32 v123, 0xffff0000, v57
    v_pk_add_f32 v[16:17], v[16:17], v[120:121]
    v_pk_add_f32 v[18:19], v[18:19], v[122:123]
    v_lshlrev_b32 v124, 16, v58
    v_and_b32 v125, 0xffff0000, v58
    v_lshlrev_b32 v126, 16, v59
    v_and_b32 v127, 0xffff0000, v59
    v_pk_add_f32 v[16:17], v[16:17], v[124:125]
    v_pk_add_f32 v[18:19], v[18:19], v[126:127]
    v_lshlrev_b32 v120, 16, v60
    v_and_b32 v121, 0xffff0000, v60
    v_lshlrev_b32 v122, 16, v61
    v_and_b32 v123, 0xffff0000, v61
    v_pk_add_f32 v[16:17], v[16:17], v[120:121]
    v_pk_add_f32 v[18:19], v[18:19], v[122:123]
    v_lshlrev_b32 v120, 16, v68
    v_and_b32 v121, 0xffff0000, v68
    v_lshlrev_b32 v122, 16, v69
    v_and_b32 v123, 0xffff0000, v69
    v_pk_add_f32 v[20:21], v[20:21], v[120:121]
    v_pk_add_f32 v[22:23], v[22:23], v[122:123]
    v_lshlrev_b32 v124, 16, v70
    v_and_b32 v125, 0xffff0000, v70
    v_lshlrev_b32 v126, 16, v71
    v_and_b32 v127, 0xffff0000, v71
    v_pk_add_f32 v[20:21], v[20:21], v[124:125]
    v_pk_add_f32 v[22:23], v[22:23], v[126:127]
    v_lshlrev_b32 v120, 16, v72
    v_and_b32 v121, 0xffff0000, v72
    v_lshlrev_b32 v122, 16, v73
    v_and_b32 v123, 0xffff0000, v73
    v_pk_add_f32 v[20:21], v[20:21], v[120:121]
    v_pk_add_f32 v[22:23], v[22:23], v[122:123]
    v_lshlrev_b32 v120, 16, v80
    v_and_b32 v121, 0xffff0000, v80
    v_lshlrev_b32 v122, 16, v81
    v_and_b32 v123, 0xffff0000, v81
    v_pk_add_f32 v[24:25], v[24:25], v[120:121]
    v_pk_add_f32 v[26:27], v[26:27], v[122:123]
    v_lshlrev_b32 v124, 16, v82
    v_and_b32 v125, 0xffff0000, v82
    v_lshlrev_b32 v126, 16, v83
    v_and_b32 v127, 0xffff0000, v83
    v_pk_add_f32 v[24:25], v[24:25], v[124:125]
    v_pk_add_f32 v[26:27], v[26:27], v[126:127]
    v_lshlrev_b32 v120, 16, v84
    v_and_b32 v121, 0xffff0000, v84
    v_lshlrev_b32 v122, 16, v85
    v_and_b32 v123, 0xffff0000, v85
    v_pk_add_f32 v[24:25], v[24:25], v[120:121]
    v_pk_add_f32 v[26:27], v[26:27], v[122:123]
    v_lshlrev_b32 v120, 16, v92
    v_and_b32 v121, 0xffff0000, v92
    v_lshlrev_b32 v122, 16, v93
    v_and_b32 v123, 0xffff0000, v93
    v_pk_add_f32 v[28:29], v[28:29], v[120:121]
    v_pk_add_f32 v[30:31], v[30:31], v[122:123]
    v_lshlrev_b32 v124, 16, v94
    v_and_b32 v125, 0xffff0000, v94
    v_lshlrev_b32 v126, 16, v95
    v_and_b32 v127, 0xffff0000, v95
    v_pk_add_f32 v[28:29], v[28:29], v[124:125]
    v_pk_add_f32 v[30:31], v[30:31], v[126:127]
    v_lshlrev_b32 v120, 16, v96
    v_and_b32 v121, 0xffff0000, v96
    v_lshlrev_b32 v122, 16, v97
    v_and_b32 v123, 0xffff0000, v97
    v_pk_add_f32 v[28:29], v[28:29], v[120:121]
    v_pk_add_f32 v[30:31], v[30:31], v[122:123]
    v_lshlrev_b32 v120, 16, v104
    v_and_b32 v121, 0xffff0000, v104
    v_lshlrev_b32 v122, 16, v105
    v_and_b32 v123, 0xffff0000, v105
    v_pk_add_f32 v[32:33], v[32:33], v[120:121]
    v_pk_add_f32 v[34:35], v[34:35], v[122:123]
    v_lshlrev_b32 v124, 16, v106
    v_and_b32 v125, 0xffff0000, v106
    v_lshlrev_b32 v126, 16, v107
    v_and_b32 v127, 0xffff0000, v107
    v_pk_add_f32 v[32:33], v[32:33], v[124:125]
    v_pk_add_f32 v[34:35], v[34:35], v[126:127]
    v_lshlrev_b32 v120, 16, v108
    v_and_b32 v121, 0xffff0000, v108
    v_lshlrev_b32 v122, 16, v109
    v_and_b32 v123, 0xffff0000, v109
    v_pk_add_f32 v[32:33], v[32:33], v[120:121]
    v_pk_add_f32 v[34:35], v[34:35], v[122:123]
    v_mov_b32 v176, 0xbfb8aa3b
    v_mov_b32 v177, 1.0
    s_waitcnt vmcnt(12)
    v_lshlrev_b32 v120, 16, v62
    v_and_b32 v121, 0xffff0000, v62
    v_lshlrev_b32 v122, 16, v63
    v_and_b32 v123, 0xffff0000, v63
    v_pk_add_f32 v[36:37], v[36:37], v[120:121]
    v_pk_add_f32 v[38:39], v[38:39], v[122:123]
    v_lshlrev_b32 v124, 16, v64
    v_and_b32 v125, 0xffff0000, v64
    v_lshlrev_b32 v126, 16, v65
    v_and_b32 v127, 0xffff0000, v65
    v_pk_add_f32 v[36:37], v[36:37], v[124:125]
    v_pk_add_f32 v[38:39], v[38:39], v[126:127]
    v_lshlrev_b32 v120, 16, v66
    v_and_b32 v121, 0xffff0000, v66
    v_lshlrev_b32 v122, 16, v67
    v_and_b32 v123, 0xffff0000, v67
    v_pk_add_f32 v[36:37], v[36:37], v[120:121]
    v_pk_add_f32 v[38:39], v[38:39], v[122:123]
    v_pk_mul_f32 v[128:129], v[36:37], v[176:177] op_sel_hi:[1,0]
    v_pk_mul_f32 v[130:131], v[38:39], v[176:177] op_sel_hi:[1,0]
    v_exp_f32 v128, v128
    v_exp_f32 v129, v129
    v_exp_f32 v130, v130
    v_exp_f32 v131, v131
    v_pk_add_f32 v[128:129], v[128:129], v[176:177] op_sel:[0,1] op_sel_hi:[1,1]
    v_pk_add_f32 v[130:131], v[130:131], v[176:177] op_sel:[0,1] op_sel_hi:[1,1]
    v_rcp_f32 v128, v128
    v_rcp_f32 v129, v129
    v_rcp_f32 v130, v130
    v_rcp_f32 v131, v131
    v_lshlrev_b32 v178, 16, v202
    v_and_b32 v179, 0xffff0000, v202
    v_lshlrev_b32 v180, 16, v203
    v_and_b32 v181, 0xffff0000, v203
    v_pk_mul_f32 v[36:37], v[36:37], v[128:129]
    v_pk_mul_f32 v[38:39], v[38:39], v[130:131]
    v_pk_fma_f32 v[178:179], v[36:37], v[16:17], v[178:179]
    v_pk_fma_f32 v[180:181], v[38:39], v[18:19], v[180:181]
    v_cvt_pk_bf16_f32 v182, v178, v179
    v_cvt_pk_bf16_f32 v183, v180, v181
    buffer_store_dwordx2 v[182:183], v228, s[44:47], 0 offen
    s_waitcnt vmcnt(10)
    v_lshlrev_b32 v120, 16, v74
    v_and_b32 v121, 0xffff0000, v74
    v_lshlrev_b32 v122, 16, v75
    v_and_b32 v123, 0xffff0000, v75
    v_pk_add_f32 v[40:41], v[40:41], v[120:121]
    v_pk_add_f32 v[42:43], v[42:43], v[122:123]
    v_lshlrev_b32 v124, 16, v76
    v_and_b32 v125, 0xffff0000, v76
    v_lshlrev_b32 v126, 16, v77
    v_and_b32 v127, 0xffff0000, v77
    v_pk_add_f32 v[40:41], v[40:41], v[124:125]
    v_pk_add_f32 v[42:43], v[42:43], v[126:127]
    v_lshlrev_b32 v120, 16, v78
    v_and_b32 v121, 0xffff0000, v78
    v_lshlrev_b32 v122, 16, v79
    v_and_b32 v123, 0xffff0000, v79
    v_pk_add_f32 v[40:41], v[40:41], v[120:121]
    v_pk_add_f32 v[42:43], v[42:43], v[122:123]
    v_pk_mul_f32 v[128:129], v[40:41], v[176:177] op_sel_hi:[1,0]
    v_pk_mul_f32 v[130:131], v[42:43], v[176:177] op_sel_hi:[1,0]
    v_exp_f32 v128, v128
    v_exp_f32 v129, v129
    v_exp_f32 v130, v130
    v_exp_f32 v131, v131
    v_pk_add_f32 v[128:129], v[128:129], v[176:177] op_sel:[0,1] op_sel_hi:[1,1]
    v_pk_add_f32 v[130:131], v[130:131], v[176:177] op_sel:[0,1] op_sel_hi:[1,1]
    v_rcp_f32 v128, v128
    v_rcp_f32 v129, v129
    v_rcp_f32 v130, v130
    v_rcp_f32 v131, v131
    v_lshlrev_b32 v184, 16, v204
    v_and_b32 v185, 0xffff0000, v204
    v_lshlrev_b32 v186, 16, v205
    v_and_b32 v187, 0xffff0000, v205
    v_pk_mul_f32 v[40:41], v[40:41], v[128:129]
    v_pk_mul_f32 v[42:43], v[42:43], v[130:131]
    v_pk_fma_f32 v[184:185], v[40:41], v[20:21], v[184:185]
    v_pk_fma_f32 v[186:187], v[42:43], v[22:23], v[186:187]
    v_cvt_pk_bf16_f32 v188, v184, v185
    v_cvt_pk_bf16_f32 v189, v186, v187
    buffer_store_dwordx2 v[188:189], v229, s[44:47], 0 offen
    s_waitcnt vmcnt(8)
    v_lshlrev_b32 v120, 16, v86
    v_and_b32 v121, 0xffff0000, v86
    v_lshlrev_b32 v122, 16, v87
    v_and_b32 v123, 0xffff0000, v87
    v_pk_add_f32 v[44:45], v[44:45], v[120:121]
    v_pk_add_f32 v[46:47], v[46:47], v[122:123]
    v_lshlrev_b32 v124, 16, v88
    v_and_b32 v125, 0xffff0000, v88
    v_lshlrev_b32 v126, 16, v89
    v_and_b32 v127, 0xffff0000, v89
    v_pk_add_f32 v[44:45], v[44:45], v[124:125]
    v_pk_add_f32 v[46:47], v[46:47], v[126:127]
    v_lshlrev_b32 v120, 16, v90
    v_and_b32 v121, 0xffff0000, v90
    v_lshlrev_b32 v122, 16, v91
    v_and_b32 v123, 0xffff0000, v91
    v_pk_add_f32 v[44:45], v[44:45], v[120:121]
    v_pk_add_f32 v[46:47], v[46:47], v[122:123]
    v_pk_mul_f32 v[128:129], v[44:45], v[176:177] op_sel_hi:[1,0]
    v_pk_mul_f32 v[130:131], v[46:47], v[176:177] op_sel_hi:[1,0]
    v_exp_f32 v128, v128
    v_exp_f32 v129, v129
    v_exp_f32 v130, v130
    v_exp_f32 v131, v131
    v_pk_add_f32 v[128:129], v[128:129], v[176:177] op_sel:[0,1] op_sel_hi:[1,1]
    v_pk_add_f32 v[130:131], v[130:131], v[176:177] op_sel:[0,1] op_sel_hi:[1,1]
    v_rcp_f32 v128, v128
    v_rcp_f32 v129, v129
    v_rcp_f32 v130, v130
    v_rcp_f32 v131, v131
    v_lshlrev_b32 v178, 16, v206
    v_and_b32 v179, 0xffff0000, v206
    v_lshlrev_b32 v180, 16, v207
    v_and_b32 v181, 0xffff0000, v207
    v_pk_mul_f32 v[44:45], v[44:45], v[128:129]
    v_pk_mul_f32 v[46:47], v[46:47], v[130:131]
    v_pk_fma_f32 v[178:179], v[44:45], v[24:25], v[178:179]
    v_pk_fma_f32 v[180:181], v[46:47], v[26:27], v[180:181]
    v_cvt_pk_bf16_f32 v182, v178, v179
    v_cvt_pk_bf16_f32 v183, v180, v181
    buffer_store_dwordx2 v[182:183], v230, s[44:47], 0 offen
    s_waitcnt vmcnt(6)
    v_lshlrev_b32 v120, 16, v98
    v_and_b32 v121, 0xffff0000, v98
    v_lshlrev_b32 v122, 16, v99
    v_and_b32 v123, 0xffff0000, v99
    v_pk_add_f32 v[48:49], v[48:49], v[120:121]
    v_pk_add_f32 v[50:51], v[50:51], v[122:123]
    v_lshlrev_b32 v124, 16, v100
    v_and_b32 v125, 0xffff0000, v100
    v_lshlrev_b32 v126, 16, v101
    v_and_b32 v127, 0xffff0000, v101
    v_pk_add_f32 v[48:49], v[48:49], v[124:125]
    v_pk_add_f32 v[50:51], v[50:51], v[126:127]
    v_lshlrev_b32 v120, 16, v102
    v_and_b32 v121, 0xffff0000, v102
    v_lshlrev_b32 v122, 16, v103
    v_and_b32 v123, 0xffff0000, v103
    v_pk_add_f32 v[48:49], v[48:49], v[120:121]
    v_pk_add_f32 v[50:51], v[50:51], v[122:123]
    v_pk_mul_f32 v[128:129], v[48:49], v[176:177] op_sel_hi:[1,0]
    v_pk_mul_f32 v[130:131], v[50:51], v[176:177] op_sel_hi:[1,0]
    v_exp_f32 v128, v128
    v_exp_f32 v129, v129
    v_exp_f32 v130, v130
    v_exp_f32 v131, v131
    v_pk_add_f32 v[128:129], v[128:129], v[176:177] op_sel:[0,1] op_sel_hi:[1,1]
    v_pk_add_f32 v[130:131], v[130:131], v[176:177] op_sel:[0,1] op_sel_hi:[1,1]
    v_rcp_f32 v128, v128
    v_rcp_f32 v129, v129
    v_rcp_f32 v130, v130
    v_rcp_f32 v131, v131
    v_lshlrev_b32 v184, 16, v208
    v_and_b32 v185, 0xffff0000, v208
    v_lshlrev_b32 v186, 16, v209
    v_and_b32 v187, 0xffff0000, v209
    v_pk_mul_f32 v[48:49], v[48:49], v[128:129]
    v_pk_mul_f32 v[50:51], v[50:51], v[130:131]
    v_pk_fma_f32 v[184:185], v[48:49], v[28:29], v[184:185]
    v_pk_fma_f32 v[186:187], v[50:51], v[30:31], v[186:187]
    v_cvt_pk_bf16_f32 v188, v184, v185
    v_cvt_pk_bf16_f32 v189, v186, v187
    buffer_store_dwordx2 v[188:189], v231, s[44:47], 0 offen
    s_bitcmp1_b32 s4, 0
    s_cbranch_scc1 kmain_kernel_f4
    s_waitcnt vmcnt(4)
    v_lshlrev_b32 v120, 16, v110
    v_and_b32 v121, 0xffff0000, v110
    v_lshlrev_b32 v122, 16, v111
    v_and_b32 v123, 0xffff0000, v111
    v_pk_add_f32 v[52:53], v[52:53], v[120:121]
    v_pk_add_f32 v[54:55], v[54:55], v[122:123]
    v_lshlrev_b32 v124, 16, v112
    v_and_b32 v125, 0xffff0000, v112
    v_lshlrev_b32 v126, 16, v113
    v_and_b32 v127, 0xffff0000, v113
    v_pk_add_f32 v[52:53], v[52:53], v[124:125]
    v_pk_add_f32 v[54:55], v[54:55], v[126:127]
    v_lshlrev_b32 v120, 16, v114
    v_and_b32 v121, 0xffff0000, v114
    v_lshlrev_b32 v122, 16, v115
    v_and_b32 v123, 0xffff0000, v115
    v_pk_add_f32 v[52:53], v[52:53], v[120:121]
    v_pk_add_f32 v[54:55], v[54:55], v[122:123]
    v_pk_mul_f32 v[128:129], v[52:53], v[176:177] op_sel_hi:[1,0]
    v_pk_mul_f32 v[130:131], v[54:55], v[176:177] op_sel_hi:[1,0]
    v_exp_f32 v128, v128
    v_exp_f32 v129, v129
    v_exp_f32 v130, v130
    v_exp_f32 v131, v131
    v_pk_add_f32 v[128:129], v[128:129], v[176:177] op_sel:[0,1] op_sel_hi:[1,1]
    v_pk_add_f32 v[130:131], v[130:131], v[176:177] op_sel:[0,1] op_sel_hi:[1,1]
    v_rcp_f32 v128, v128
    v_rcp_f32 v129, v129
    v_rcp_f32 v130, v130
    v_rcp_f32 v131, v131
    v_lshlrev_b32 v178, 16, v210
    v_and_b32 v179, 0xffff0000, v210
    v_lshlrev_b32 v180, 16, v211
    v_and_b32 v181, 0xffff0000, v211
    v_pk_mul_f32 v[52:53], v[52:53], v[128:129]
    v_pk_mul_f32 v[54:55], v[54:55], v[130:131]
    v_pk_fma_f32 v[178:179], v[52:53], v[32:33], v[178:179]
    v_pk_fma_f32 v[180:181], v[54:55], v[34:35], v[180:181]
    v_cvt_pk_bf16_f32 v182, v178, v179
    v_cvt_pk_bf16_f32 v183, v180, v181
    buffer_store_dwordx2 v[182:183], v232, s[44:47], 0 offen
kmain_kernel_f4:
    s_waitcnt vmcnt(0)
kmain_kernel_end:
    s_endpgm
.section .rodata,"a"
.p2align 6
.amdhsa_kernel kmain_kernel
  .amdhsa_next_free_vgpr 512
  .amdhsa_next_free_sgpr 102
  .amdhsa_accum_offset 256
  .amdhsa_group_segment_fixed_size 0
  .amdhsa_kernarg_size 104
  .amdhsa_user_sgpr_count 2
  .amdhsa_user_sgpr_kernarg_segment_ptr 1
  .amdhsa_system_sgpr_workgroup_id_x 1
  .amdhsa_float_denorm_mode_32 3
.end_amdhsa_kernel
```
